```python
import torch

def _softmax(x, axis=-1):
    return torch.softmax(x, dim=axis)
def _gelu(x):
    return torch.nn.functional.gelu(x, approximate="tanh")
def _silu(x):
    return torch.nn.functional.silu(x)
def _sigmoid(x):
    return torch.sigmoid(x)
def _layernorm(x, axis=-1, eps=1e-5):
    m = x.mean(dim=axis, keepdim=True)
    v = x.var(dim=axis, keepdim=True, unbiased=False)
    return (x - m) / torch.sqrt(v + eps)
def _scatter_add(tgt, idx, src, axis=0):
    return tgt.clone().index_add_(axis, idx, src)
def _segment_sum(src, seg, n):
    out = torch.zeros((n,) + src.shape[1:], dtype=src.dtype)
    return out.index_add_(0, seg, src)
def _pad(x, pw):
    flat = tuple(v for pair in reversed(pw) for v in pair)
    return torch.nn.functional.pad(x, flat)

kernel_name = 'parallel_sum__spectral_fnet__dense_activation_relu__prompt'

def setup_inputs():

    _w = (lambda a: (lambda t: t.to(torch.bfloat16) if t.is_floating_point() else t)(torch.as_tensor(a)))
    def _A_setup():
        B, S, D = 1, 2048, 576
        ns = torch.arange(S)[:, None] * torch.arange(S)[None, :]
        nd = torch.arange(D)[:, None] * torch.arange(D)[None, :]
        Ws_re = torch.cos(-2.0 * torch.pi * ns / S).to(float)
        Ws_im = torch.sin(-2.0 * torch.pi * ns / S).to(float)
        Wd_re = torch.cos(-2.0 * torch.pi * nd / D).to(float)
        Wd_im = torch.sin(-2.0 * torch.pi * nd / D).to(float)
        return {
            "x": _w((lambda *s: torch.randn(*s, dtype=torch.bfloat16) * 0.05)(B, S, D)),
            "dft_seq_re": _w(Ws_re),
            "dft_seq_im": _w(Ws_im),
            "dft_hid_re": _w(Wd_re),
            "dft_hid_im": _w(Wd_im),
        }
    _A_in = _A_setup()

    def _B_setup():
        B, S, D, Dff = 1, 2048, 576, 4608
        return {
            "x": _w((lambda *s: torch.randn(*s, dtype=torch.bfloat16) * 0.05)(B, S, D)),
            "w1": _w((lambda *s: torch.randn(*s, dtype=torch.bfloat16) * 0.4)(D, Dff)),
            "w2": _w((lambda *s: torch.randn(*s, dtype=torch.bfloat16) * 0.4)(Dff, D)),
        }
    _B_in = _B_setup()

    return {
        "A_x": _A_in["x"],
        "A_dft_seq_re": _A_in["dft_seq_re"],
        "A_dft_seq_im": _A_in["dft_seq_im"],
        "A_dft_hid_re": _A_in["dft_hid_re"],
        "A_dft_hid_im": _A_in["dft_hid_im"],
        "B_x": _B_in["x"],
        "B_w1": _B_in["w1"],
        "B_w2": _B_in["w2"],
    }

def reference(A_x, A_dft_seq_re, A_dft_seq_im, A_dft_hid_re, A_dft_hid_im, B_x, B_w1, B_w2):
    def _A_ref(x, dft_seq_re, dft_seq_im, dft_hid_re, dft_hid_im):
        a = torch.einsum("bsd,ed->bse", x, dft_hid_re)
        b = torch.einsum("bsd,ed->bse", x, dft_hid_im)
        y = torch.einsum("ts,bse->bte", dft_seq_re, a) - torch.einsum("ts,bse->bte", dft_seq_im, b)
        return y

    def _B_ref(x, w1, w2):
        h = torch.einsum("bsd,df->bsf", x, w1)
        zero = torch.zeros_like(h)
        h = torch.maximum(h, zero)
        return torch.einsum("bsf,fd->bsd", h, w2)

    x = A_x
    xn = _layernorm(x, axis=-1)
    return x + _A_ref(xn, A_dft_seq_re, A_dft_seq_im, A_dft_hid_re, A_dft_hid_im) + _B_ref(xn, B_w1, B_w2)
```

```asm
; @launch kernel=k1_kernel grid=(256,1,1) block=(256,1,1) lds=163840
; @launch kernel=k2_kernel grid=(256,1,1) block=(256,1,1) lds=163840
.amdgcn_target "amdgcn-amd-amdhsa--gfx950"
.text
.globl k1_kernel
.p2align 8
.type k1_kernel,@function
k1_kernel:
    s_cmp_ge_u32 s2, 256
    s_cbranch_scc1 K1_end
    s_load_dwordx16 s[16:31], s[0:1], 0
    s_load_dwordx4 s[32:35], s[0:1], 64
    s_load_dwordx2 s[36:37], s[0:1], 80
    v_lshrrev_b32 v2, 6, v0
    v_and_b32 v1, 63, v0
    v_readfirstlane_b32 s3, v2
    s_mov_b32 s95, 0xffff0000
    v_and_b32 v2, 15, v1
    v_lshrrev_b32 v3, 4, v1
    v_and_b32 v4, 7, v1
    v_lshrrev_b32 v5, 3, v1
    s_and_b32 s4, s2, 1
    s_lshl_b32 s4, s4, 3
    s_lshr_b32 s5, s2, 5
    s_add_u32 s4, s4, s5
    s_bfe_u32 s5, s2, 0x20001
    s_lshl_b32 s5, s5, 4
    s_bfe_u32 s8, s2, 0x20003
    s_lshl_b32 s8, s8, 2
    s_add_u32 s5, s5, s8
    s_mov_b32 s10, 0xfed87210
    s_mov_b32 s11, 0xcba96543
    s_lshr_b64 s[10:11], s[10:11], s5
    s_and_b32 s5, s10, 15
    v_xor_b32 v6, v4, v5
    v_lshlrev_b32 v6, 4, v6
    v_mov_b32 v7, 1152
    v_mad_u32_u24 v6, v5, v7, v6
    s_mul_i32 s6, s3, 36864
    s_lshl_b32 s7, s4, 7
    s_lshl_b32 s8, s3, 5
    s_add_u32 s7, s7, s8
    s_mul_i32 s7, s7, 1152
    s_lshl_b32 s9, s2, 2
    s_add_u32 s9, s9, s3
    s_sub_u32 s39, s5, 3
    s_lshl_b32 s39, s39, 4
    s_add_u32 s39, s39, s4
    s_lshl_b32 s39, s39, 2
    s_add_u32 s39, s39, s3
    s_waitcnt lgkmcnt(0)
    s_cmp_eq_u32 s5, 15
    s_cbranch_scc1 K1_help
    s_mov_b32 s40, s16
    s_mov_b32 s41, s17
    s_mov_b32 s42, 2359296
    s_mov_b32 s43, 0x20000
    s_add_u32 m0, s6, 0
    s_add_u32 s11, s7, 0
    buffer_load_dwordx4 v6, s[40:43], s11 offen lds
    s_add_u32 m0, s6, 1024
    s_add_u32 s11, s7, 128
    buffer_load_dwordx4 v6, s[40:43], s11 offen lds
    s_add_u32 m0, s6, 2048
    s_add_u32 s11, s7, 256
    buffer_load_dwordx4 v6, s[40:43], s11 offen lds
    s_add_u32 m0, s6, 3072
    s_add_u32 s11, s7, 384
    buffer_load_dwordx4 v6, s[40:43], s11 offen lds
    s_add_u32 m0, s6, 4096
    s_add_u32 s11, s7, 512
    buffer_load_dwordx4 v6, s[40:43], s11 offen lds
    s_add_u32 m0, s6, 5120
    s_add_u32 s11, s7, 640
    buffer_load_dwordx4 v6, s[40:43], s11 offen lds
    s_add_u32 m0, s6, 6144
    s_add_u32 s11, s7, 768
    buffer_load_dwordx4 v6, s[40:43], s11 offen lds
    s_add_u32 m0, s6, 7168
    s_add_u32 s11, s7, 896
    buffer_load_dwordx4 v6, s[40:43], s11 offen lds
    s_add_u32 m0, s6, 8192
    s_add_u32 s11, s7, 1024
    buffer_load_dwordx4 v6, s[40:43], s11 offen lds
    s_add_u32 m0, s6, 9216
    s_add_u32 s11, s7, 9216
    buffer_load_dwordx4 v6, s[40:43], s11 offen lds
    s_add_u32 m0, s6, 10240
    s_add_u32 s11, s7, 9344
    buffer_load_dwordx4 v6, s[40:43], s11 offen lds
    s_add_u32 m0, s6, 11264
    s_add_u32 s11, s7, 9472
    buffer_load_dwordx4 v6, s[40:43], s11 offen lds
    s_add_u32 m0, s6, 12288
    s_add_u32 s11, s7, 9600
    buffer_load_dwordx4 v6, s[40:43], s11 offen lds
    s_add_u32 m0, s6, 13312
    s_add_u32 s11, s7, 9728
    buffer_load_dwordx4 v6, s[40:43], s11 offen lds
    s_add_u32 m0, s6, 14336
    s_add_u32 s11, s7, 9856
    buffer_load_dwordx4 v6, s[40:43], s11 offen lds
    s_add_u32 m0, s6, 15360
    s_add_u32 s11, s7, 9984
    buffer_load_dwordx4 v6, s[40:43], s11 offen lds
    s_add_u32 m0, s6, 16384
    s_add_u32 s11, s7, 10112
    buffer_load_dwordx4 v6, s[40:43], s11 offen lds
    s_add_u32 m0, s6, 17408
    s_add_u32 s11, s7, 10240
    buffer_load_dwordx4 v6, s[40:43], s11 offen lds
    s_cmp_lt_u32 s2, 16
    s_cbranch_scc0 K1_nocpf
    s_getpc_b64 s[44:45]
    s_mov_b32 s46, 96000
    s_mov_b32 s47, 0x20000
    v_lshlrev_b32 v9, 7, v1
    s_lshl_b32 s11, s3, 13
    buffer_load_dword v255, v9, s[44:47], s11 offen
    s_add_u32 s11, s11, 32768
    buffer_load_dword v255, v9, s[44:47], s11 offen
    s_add_u32 s11, s11, 32768
    buffer_load_dword v255, v9, s[44:47], s11 offen
    s_add_u32 s11, s11, 32768
    buffer_load_dword v255, v9, s[44:47], s11 offen
    s_add_u32 s11, s11, 32768
K1_nocpf:
    s_cmp_lt_u32 s5, 3
    s_cbranch_scc1 K1_ab
    s_lshl_b32 s12, s3, 12
    s_add_u32 s12, s12, 147456
    s_mov_b32 s44, s28
    s_mov_b32 s45, s29
    s_mov_b32 s46, 5308416
    s_mov_b32 s47, 0x20000
    s_sub_u32 s13, s5, 3
    s_mul_i32 s13, s13, 768
    s_mul_i32 s14, s3, 192
    s_add_u32 s13, s13, s14
    v_add_u32 v180, 0, v1
    v_mul_u32_u24 v181, 0x1556, v180
    v_lshrrev_b32 v181, 16, v181
    v_mul_u32_u24 v182, 12, v181
    v_sub_u32 v182, v180, v182
    v_mul_u32_u24 v183, 9216, v181
    v_lshl_add_u32 v184, v182, 4, v183
    v_lshrrev_b32 v183, 1, v182
    v_mul_u32_u24 v183, 544, v183
    v_lshl_add_u32 v183, v181, 5, v183
    v_and_b32 v182, 1, v182
    v_lshl_add_u32 v183, v182, 4, v183
    v_add_u32 v187, s12, v183
    v_add_u32 v180, 64, v1
    v_mul_u32_u24 v181, 0x1556, v180
    v_lshrrev_b32 v181, 16, v181
    v_mul_u32_u24 v182, 12, v181
    v_sub_u32 v182, v180, v182
    v_mul_u32_u24 v183, 9216, v181
    v_lshl_add_u32 v185, v182, 4, v183
    v_lshrrev_b32 v183, 1, v182
    v_mul_u32_u24 v183, 544, v183
    v_lshl_add_u32 v183, v181, 5, v183
    v_and_b32 v182, 1, v182
    v_lshl_add_u32 v183, v182, 4, v183
    v_add_u32 v188, s12, v183
    v_add_u32 v180, 128, v1
    v_mul_u32_u24 v181, 0x1556, v180
    v_lshrrev_b32 v181, 16, v181
    v_mul_u32_u24 v182, 12, v181
    v_sub_u32 v182, v180, v182
    v_mul_u32_u24 v183, 9216, v181
    v_lshl_add_u32 v186, v182, 4, v183
    v_lshrrev_b32 v183, 1, v182
    v_mul_u32_u24 v183, 544, v183
    v_lshl_add_u32 v183, v181, 5, v183
    v_and_b32 v182, 1, v182
    v_lshl_add_u32 v183, v182, 4, v183
    v_add_u32 v189, s12, v183
    v_lshrrev_b32 v180, 2, v1
    v_and_b32 v181, 3, v1
    v_lshlrev_b32 v181, 3, v181
    v_lshl_add_u32 v180, v180, 5, v181
    v_add_u32 v190, s12, v180
    s_add_u32 s52, s36, 25165824
    s_addc_u32 s53, s37, 0
    s_mov_b32 s54, 9437184
    s_mov_b32 s55, 0x20000
    s_bfe_u32 s38, s2, 0x20001
    s_and_b32 s56, s2, 1
    s_lshl_b32 s56, s56, 3
    s_lshr_b32 s59, s2, 5
    s_add_u32 s56, s56, s59
    s_lshl_b32 s56, s56, 2
    s_bfe_u32 s59, s2, 0x20003
    s_add_u32 s56, s56, s59
    s_lshl_b32 s63, s56, 14
    s_add_u32 s63, s63, 8388608
    s_lshl_b32 s59, s38, 10
    s_add_u32 s63, s63, s59
    s_lshl_b32 s56, s56, 17
    s_lshl_b32 s59, s3, 13
    s_add_u32 s56, s56, s59
    s_add_u32 s59, s3, s38
    s_and_b32 s59, s59, 3
    s_lshl_b32 s59, s59, 11
    s_add_u32 s56, s56, s59
    s_mov_b32 s76, s18
    s_mov_b32 s77, s19
    s_mov_b32 s78, 8388608
    s_mov_b32 s79, 0x20000
    s_mov_b32 s72, s20
    s_mov_b32 s73, s21
    s_mov_b32 s74, 8388608
    s_mov_b32 s75, 0x20000
    s_lshl_b32 s57, s9, 13
    s_lshl_b32 s58, s39, 11
    v_and_b32 v180, 7, v2
    v_lshrrev_b32 v181, 3, v2
    v_mul_u32_u24 v181, 9216, v181
    v_lshl_add_u32 v181, v180, 7, v181
    v_xor_b32 v182, v3, v180
    v_lshl_add_u32 v192, v182, 4, v181
    v_add_u32 v193, s6, v192
    v_xor_b32 v194, 64, v193
    v_and_b32 v182, 1, v3
    v_lshlrev_b32 v182, 1, v182
    v_xor_b32 v182, v182, v180
    v_lshl_add_u32 v182, v182, 4, v181
    v_lshrrev_b32 v183, 1, v3
    v_lshl_add_u32 v182, v183, 3, v182
    v_add_u32 v195, s6, v182
    v_xor_b32 v196, 16, v195
    v_xor_b32 v197, 64, v195
    v_xor_b32 v198, 80, v195
    v_lshrrev_b32 v182, 2, v2
    v_lshl_add_u32 v182, v182, 4, v2
    v_lshlrev_b32 v199, 2, v182
    v_and_b32 v182, 3, v1
    v_cmp_eq_u32 s[64:65], 1, v182
    v_cmp_eq_u32 s[66:67], 2, v182
    v_cmp_eq_u32 s[68:69], 3, v182
    v_mov_b32 v176, 0x3f803f80
    v_mov_b32 v177, 0x3f803f80
    v_mov_b32 v178, 0x3f803f80
    v_mov_b32 v179, 0x3f803f80
    s_mov_b32 s70, 0x3ae38e39
    s_mov_b32 s71, 0x3727c5ac
    v_lshrrev_b32 v0, 2, v1
    v_lshlrev_b32 v0, 7, v0
    v_mov_b32 v12, -1
    v_mov_b32 v13, -1
    v_mov_b32 v14, -1
    v_mov_b32 v15, -1
    v_lshlrev_b32 v8, 4, v1
    s_waitcnt vmcnt(0)
    ds_read_b128 v[16:19], v193 offset:0
    ds_read_b128 v[20:23], v194 offset:0
    ds_read_b128 v[24:27], v193 offset:1024
    ds_read_b128 v[28:31], v194 offset:1024
    ds_read_b128 v[32:35], v193 offset:2048
    ds_read_b128 v[36:39], v194 offset:2048
    ds_read_b128 v[40:43], v193 offset:3072
    ds_read_b128 v[44:47], v194 offset:3072
    ds_read_b128 v[48:51], v193 offset:4096
    ds_read_b128 v[52:55], v194 offset:4096
    ds_read_b128 v[56:59], v193 offset:5120
    ds_read_b128 v[60:63], v194 offset:5120
    ds_read_b128 v[64:67], v193 offset:6144
    ds_read_b128 v[68:71], v194 offset:6144
    ds_read_b128 v[72:75], v193 offset:7168
    ds_read_b128 v[76:79], v194 offset:7168
    ds_read_b128 v[80:83], v193 offset:8192
    ds_read_b128 v[84:87], v194 offset:8192
    s_waitcnt lgkmcnt(15)
    v_mfma_f32_16x16x32_bf16 v[160:163], v[176:179], v[16:19], 0
    v_mfma_f32_16x16x32_bf16 v[164:167], v[16:19], v[16:19], 0
    v_mfma_f32_16x16x32_bf16 v[160:163], v[176:179], v[20:23], v[160:163]
    v_mfma_f32_16x16x32_bf16 v[164:167], v[20:23], v[20:23], v[164:167]
    v_mfma_f32_16x16x32_bf16 v[160:163], v[176:179], v[24:27], v[160:163]
    v_mfma_f32_16x16x32_bf16 v[164:167], v[24:27], v[24:27], v[164:167]
    s_add_u32 m0, s6, 18432
    s_add_u32 s11, s7, 18432
    buffer_load_dwordx4 v6, s[40:43], s11 offen lds
    s_waitcnt lgkmcnt(14)
    v_mfma_f32_16x16x32_bf16 v[160:163], v[176:179], v[28:31], v[160:163]
    v_mfma_f32_16x16x32_bf16 v[164:167], v[28:31], v[28:31], v[164:167]
    s_waitcnt lgkmcnt(13)
    v_mfma_f32_16x16x32_bf16 v[160:163], v[176:179], v[32:35], v[160:163]
    v_mfma_f32_16x16x32_bf16 v[164:167], v[32:35], v[32:35], v[164:167]
    s_waitcnt lgkmcnt(12)
    v_mfma_f32_16x16x32_bf16 v[160:163], v[176:179], v[36:39], v[160:163]
    v_mfma_f32_16x16x32_bf16 v[164:167], v[36:39], v[36:39], v[164:167]
    s_add_u32 m0, s6, 19456
    s_add_u32 s11, s7, 18560
    buffer_load_dwordx4 v6, s[40:43], s11 offen lds
    s_waitcnt lgkmcnt(11)
    v_mfma_f32_16x16x32_bf16 v[160:163], v[176:179], v[40:43], v[160:163]
    v_mfma_f32_16x16x32_bf16 v[164:167], v[40:43], v[40:43], v[164:167]
    s_waitcnt lgkmcnt(10)
    v_mfma_f32_16x16x32_bf16 v[160:163], v[176:179], v[44:47], v[160:163]
    v_mfma_f32_16x16x32_bf16 v[164:167], v[44:47], v[44:47], v[164:167]
    s_waitcnt lgkmcnt(9)
    v_mfma_f32_16x16x32_bf16 v[160:163], v[176:179], v[48:51], v[160:163]
    v_mfma_f32_16x16x32_bf16 v[164:167], v[48:51], v[48:51], v[164:167]
    s_add_u32 m0, s6, 20480
    s_add_u32 s11, s7, 18688
    buffer_load_dwordx4 v6, s[40:43], s11 offen lds
    s_waitcnt lgkmcnt(8)
    v_mfma_f32_16x16x32_bf16 v[160:163], v[176:179], v[52:55], v[160:163]
    v_mfma_f32_16x16x32_bf16 v[164:167], v[52:55], v[52:55], v[164:167]
    s_waitcnt lgkmcnt(7)
    v_mfma_f32_16x16x32_bf16 v[160:163], v[176:179], v[56:59], v[160:163]
    v_mfma_f32_16x16x32_bf16 v[164:167], v[56:59], v[56:59], v[164:167]
    s_waitcnt lgkmcnt(6)
    v_mfma_f32_16x16x32_bf16 v[160:163], v[176:179], v[60:63], v[160:163]
    v_mfma_f32_16x16x32_bf16 v[164:167], v[60:63], v[60:63], v[164:167]
    s_add_u32 m0, s6, 21504
    s_add_u32 s11, s7, 18816
    buffer_load_dwordx4 v6, s[40:43], s11 offen lds
    s_waitcnt lgkmcnt(5)
    v_mfma_f32_16x16x32_bf16 v[160:163], v[176:179], v[64:67], v[160:163]
    v_mfma_f32_16x16x32_bf16 v[164:167], v[64:67], v[64:67], v[164:167]
    s_waitcnt lgkmcnt(4)
    v_mfma_f32_16x16x32_bf16 v[160:163], v[176:179], v[68:71], v[160:163]
    v_mfma_f32_16x16x32_bf16 v[164:167], v[68:71], v[68:71], v[164:167]
    s_waitcnt lgkmcnt(3)
    v_mfma_f32_16x16x32_bf16 v[160:163], v[176:179], v[72:75], v[160:163]
    v_mfma_f32_16x16x32_bf16 v[164:167], v[72:75], v[72:75], v[164:167]
    s_add_u32 m0, s6, 22528
    s_add_u32 s11, s7, 18944
    buffer_load_dwordx4 v6, s[40:43], s11 offen lds
    s_waitcnt lgkmcnt(2)
    v_mfma_f32_16x16x32_bf16 v[160:163], v[176:179], v[76:79], v[160:163]
    v_mfma_f32_16x16x32_bf16 v[164:167], v[76:79], v[76:79], v[164:167]
    s_waitcnt lgkmcnt(1)
    v_mfma_f32_16x16x32_bf16 v[160:163], v[176:179], v[80:83], v[160:163]
    v_mfma_f32_16x16x32_bf16 v[164:167], v[80:83], v[80:83], v[164:167]
    s_waitcnt lgkmcnt(0)
    v_mfma_f32_16x16x32_bf16 v[160:163], v[176:179], v[84:87], v[160:163]
    v_mfma_f32_16x16x32_bf16 v[164:167], v[84:87], v[84:87], v[164:167]
    s_add_u32 m0, s6, 23552
    s_add_u32 s11, s7, 19072
    buffer_load_dwordx4 v6, s[40:43], s11 offen lds
    s_nop 15
    v_cndmask_b32 v164, v164, v165, s[64:65]
    v_cndmask_b32 v164, v164, v166, s[66:67]
    v_cndmask_b32 v164, v164, v167, s[68:69]
    ds_bpermute_b32 v165, v199, v164
    s_waitcnt lgkmcnt(0)
    v_mul_f32 v160, s70, v160
    v_mul_f32 v165, s70, v165
    v_fma_f32 v165, -v160, v160, v165
    v_max_f32 v165, 0, v165
    v_cvt_pk_bf16_f32 v164, v160, v165
    v_lshlrev_b32 v160, 16, v164
    v_and_b32 v165, s95, v164
    v_add_f32 v165, s71, v165
    v_cvt_pk_bf16_f32 v165, v165, v165
    v_and_b32 v165, s95, v165
    v_sqrt_f32 v165, v165
    s_nop 0
    v_cvt_pk_bf16_f32 v165, v165, v165
    v_and_b32 v165, s95, v165
    v_rcp_f32 v166, v165
    s_nop 0
    v_fma_f32 v167, -v165, v166, 1.0
    v_fma_f32 v166, v167, v166, v166
    v_mov_b32 v167, v166
    v_sub_f32 v160, 0, v160
    v_mov_b32 v161, v160
    v_lshlrev_b32 v200, 16, v16
    v_and_b32 v201, s95, v16
    v_lshlrev_b32 v202, 16, v17
    v_and_b32 v203, s95, v17
    v_lshlrev_b32 v204, 16, v18
    v_and_b32 v205, s95, v18
    v_lshlrev_b32 v206, 16, v19
    v_and_b32 v207, s95, v19
    s_add_u32 m0, s6, 24576
    s_add_u32 s11, s7, 19200
    buffer_load_dwordx4 v6, s[40:43], s11 offen lds
    v_pk_add_f32 v[200:201], v[200:201], v[160:161]
    v_pk_add_f32 v[202:203], v[202:203], v[160:161]
    v_pk_add_f32 v[204:205], v[204:205], v[160:161]
    v_pk_add_f32 v[206:207], v[206:207], v[160:161]
    v_cvt_pk_bf16_f32 v16, v200, v201
    v_cvt_pk_bf16_f32 v17, v202, v203
    v_cvt_pk_bf16_f32 v18, v204, v205
    v_cvt_pk_bf16_f32 v19, v206, v207
    v_lshlrev_b32 v200, 16, v16
    v_and_b32 v201, s95, v16
    v_lshlrev_b32 v202, 16, v17
    v_and_b32 v203, s95, v17
    v_lshlrev_b32 v204, 16, v18
    v_and_b32 v205, s95, v18
    v_lshlrev_b32 v206, 16, v19
    v_and_b32 v207, s95, v19
    s_add_u32 m0, s6, 25600
    s_add_u32 s11, s7, 19328
    buffer_load_dwordx4 v6, s[40:43], s11 offen lds
    v_pk_mul_f32 v[200:201], v[200:201], v[166:167]
    v_pk_mul_f32 v[202:203], v[202:203], v[166:167]
    v_pk_mul_f32 v[204:205], v[204:205], v[166:167]
    v_pk_mul_f32 v[206:207], v[206:207], v[166:167]
    v_cvt_pk_bf16_f32 v16, v200, v201
    v_cvt_pk_bf16_f32 v17, v202, v203
    v_cvt_pk_bf16_f32 v18, v204, v205
    v_cvt_pk_bf16_f32 v19, v206, v207
    ds_write_b64 v195, v[16:17] offset:0
    ds_write_b64 v196, v[18:19] offset:0
    v_lshlrev_b32 v200, 16, v20
    v_and_b32 v201, s95, v20
    v_lshlrev_b32 v202, 16, v21
    v_and_b32 v203, s95, v21
    v_lshlrev_b32 v204, 16, v22
    v_and_b32 v205, s95, v22
    v_lshlrev_b32 v206, 16, v23
    v_and_b32 v207, s95, v23
    s_add_u32 m0, s6, 26624
    s_add_u32 s11, s7, 19456
    buffer_load_dwordx4 v6, s[40:43], s11 offen lds
    v_pk_add_f32 v[200:201], v[200:201], v[160:161]
    v_pk_add_f32 v[202:203], v[202:203], v[160:161]
    v_pk_add_f32 v[204:205], v[204:205], v[160:161]
    v_pk_add_f32 v[206:207], v[206:207], v[160:161]
    v_cvt_pk_bf16_f32 v20, v200, v201
    v_cvt_pk_bf16_f32 v21, v202, v203
    v_cvt_pk_bf16_f32 v22, v204, v205
    v_cvt_pk_bf16_f32 v23, v206, v207
    v_lshlrev_b32 v200, 16, v20
    v_and_b32 v201, s95, v20
    v_lshlrev_b32 v202, 16, v21
    v_and_b32 v203, s95, v21
    v_lshlrev_b32 v204, 16, v22
    v_and_b32 v205, s95, v22
    v_lshlrev_b32 v206, 16, v23
    v_and_b32 v207, s95, v23
    s_add_u32 m0, s6, 27648
    s_add_u32 s11, s7, 27648
    buffer_load_dwordx4 v6, s[40:43], s11 offen lds
    v_pk_mul_f32 v[200:201], v[200:201], v[166:167]
    v_pk_mul_f32 v[202:203], v[202:203], v[166:167]
    v_pk_mul_f32 v[204:205], v[204:205], v[166:167]
    v_pk_mul_f32 v[206:207], v[206:207], v[166:167]
    v_cvt_pk_bf16_f32 v20, v200, v201
    v_cvt_pk_bf16_f32 v21, v202, v203
    v_cvt_pk_bf16_f32 v22, v204, v205
    v_cvt_pk_bf16_f32 v23, v206, v207
    ds_write_b64 v197, v[20:21] offset:0
    ds_write_b64 v198, v[22:23] offset:0
    v_lshlrev_b32 v200, 16, v24
    v_and_b32 v201, s95, v24
    v_lshlrev_b32 v202, 16, v25
    v_and_b32 v203, s95, v25
    v_lshlrev_b32 v204, 16, v26
    v_and_b32 v205, s95, v26
    v_lshlrev_b32 v206, 16, v27
    v_and_b32 v207, s95, v27
    s_add_u32 m0, s6, 28672
    s_add_u32 s11, s7, 27776
    buffer_load_dwordx4 v6, s[40:43], s11 offen lds
    v_pk_add_f32 v[200:201], v[200:201], v[160:161]
    v_pk_add_f32 v[202:203], v[202:203], v[160:161]
    v_pk_add_f32 v[204:205], v[204:205], v[160:161]
    v_pk_add_f32 v[206:207], v[206:207], v[160:161]
    v_cvt_pk_bf16_f32 v24, v200, v201
    v_cvt_pk_bf16_f32 v25, v202, v203
    v_cvt_pk_bf16_f32 v26, v204, v205
    v_cvt_pk_bf16_f32 v27, v206, v207
    v_lshlrev_b32 v200, 16, v24
    v_and_b32 v201, s95, v24
    v_lshlrev_b32 v202, 16, v25
    v_and_b32 v203, s95, v25
    v_lshlrev_b32 v204, 16, v26
    v_and_b32 v205, s95, v26
    v_lshlrev_b32 v206, 16, v27
    v_and_b32 v207, s95, v27
    s_add_u32 m0, s6, 29696
    s_add_u32 s11, s7, 27904
    buffer_load_dwordx4 v6, s[40:43], s11 offen lds
    v_pk_mul_f32 v[200:201], v[200:201], v[166:167]
    v_pk_mul_f32 v[202:203], v[202:203], v[166:167]
    v_pk_mul_f32 v[204:205], v[204:205], v[166:167]
    v_pk_mul_f32 v[206:207], v[206:207], v[166:167]
    v_cvt_pk_bf16_f32 v24, v200, v201
    v_cvt_pk_bf16_f32 v25, v202, v203
    v_cvt_pk_bf16_f32 v26, v204, v205
    v_cvt_pk_bf16_f32 v27, v206, v207
    ds_write_b64 v195, v[24:25] offset:1024
    ds_write_b64 v196, v[26:27] offset:1024
    v_lshlrev_b32 v200, 16, v28
    v_and_b32 v201, s95, v28
    v_lshlrev_b32 v202, 16, v29
    v_and_b32 v203, s95, v29
    v_lshlrev_b32 v204, 16, v30
    v_and_b32 v205, s95, v30
    v_lshlrev_b32 v206, 16, v31
    v_and_b32 v207, s95, v31
    s_add_u32 m0, s6, 30720
    s_add_u32 s11, s7, 28032
    buffer_load_dwordx4 v6, s[40:43], s11 offen lds
    v_pk_add_f32 v[200:201], v[200:201], v[160:161]
    v_pk_add_f32 v[202:203], v[202:203], v[160:161]
    v_pk_add_f32 v[204:205], v[204:205], v[160:161]
    v_pk_add_f32 v[206:207], v[206:207], v[160:161]
    v_cvt_pk_bf16_f32 v28, v200, v201
    v_cvt_pk_bf16_f32 v29, v202, v203
    v_cvt_pk_bf16_f32 v30, v204, v205
    v_cvt_pk_bf16_f32 v31, v206, v207
    v_lshlrev_b32 v200, 16, v28
    v_and_b32 v201, s95, v28
    v_lshlrev_b32 v202, 16, v29
    v_and_b32 v203, s95, v29
    v_lshlrev_b32 v204, 16, v30
    v_and_b32 v205, s95, v30
    v_lshlrev_b32 v206, 16, v31
    v_and_b32 v207, s95, v31
    s_add_u32 m0, s6, 31744
    s_add_u32 s11, s7, 28160
    buffer_load_dwordx4 v6, s[40:43], s11 offen lds
    v_pk_mul_f32 v[200:201], v[200:201], v[166:167]
    v_pk_mul_f32 v[202:203], v[202:203], v[166:167]
    v_pk_mul_f32 v[204:205], v[204:205], v[166:167]
    v_pk_mul_f32 v[206:207], v[206:207], v[166:167]
    v_cvt_pk_bf16_f32 v28, v200, v201
    v_cvt_pk_bf16_f32 v29, v202, v203
    v_cvt_pk_bf16_f32 v30, v204, v205
    v_cvt_pk_bf16_f32 v31, v206, v207
    ds_write_b64 v197, v[28:29] offset:1024
    ds_write_b64 v198, v[30:31] offset:1024
    v_lshlrev_b32 v200, 16, v32
    v_and_b32 v201, s95, v32
    v_lshlrev_b32 v202, 16, v33
    v_and_b32 v203, s95, v33
    v_lshlrev_b32 v204, 16, v34
    v_and_b32 v205, s95, v34
    v_lshlrev_b32 v206, 16, v35
    v_and_b32 v207, s95, v35
    s_add_u32 m0, s6, 32768
    s_add_u32 s11, s7, 28288
    buffer_load_dwordx4 v6, s[40:43], s11 offen lds
    v_pk_add_f32 v[200:201], v[200:201], v[160:161]
    v_pk_add_f32 v[202:203], v[202:203], v[160:161]
    v_pk_add_f32 v[204:205], v[204:205], v[160:161]
    v_pk_add_f32 v[206:207], v[206:207], v[160:161]
    v_cvt_pk_bf16_f32 v32, v200, v201
    v_cvt_pk_bf16_f32 v33, v202, v203
    v_cvt_pk_bf16_f32 v34, v204, v205
    v_cvt_pk_bf16_f32 v35, v206, v207
    v_lshlrev_b32 v200, 16, v32
    v_and_b32 v201, s95, v32
    v_lshlrev_b32 v202, 16, v33
    v_and_b32 v203, s95, v33
    v_lshlrev_b32 v204, 16, v34
    v_and_b32 v205, s95, v34
    v_lshlrev_b32 v206, 16, v35
    v_and_b32 v207, s95, v35
    s_add_u32 m0, s6, 33792
    s_add_u32 s11, s7, 28416
    buffer_load_dwordx4 v6, s[40:43], s11 offen lds
    v_pk_mul_f32 v[200:201], v[200:201], v[166:167]
    v_pk_mul_f32 v[202:203], v[202:203], v[166:167]
    v_pk_mul_f32 v[204:205], v[204:205], v[166:167]
    v_pk_mul_f32 v[206:207], v[206:207], v[166:167]
    v_cvt_pk_bf16_f32 v32, v200, v201
    v_cvt_pk_bf16_f32 v33, v202, v203
    v_cvt_pk_bf16_f32 v34, v204, v205
    v_cvt_pk_bf16_f32 v35, v206, v207
    ds_write_b64 v195, v[32:33] offset:2048
    ds_write_b64 v196, v[34:35] offset:2048
    v_lshlrev_b32 v200, 16, v36
    v_and_b32 v201, s95, v36
    v_lshlrev_b32 v202, 16, v37
    v_and_b32 v203, s95, v37
    v_lshlrev_b32 v204, 16, v38
    v_and_b32 v205, s95, v38
    v_lshlrev_b32 v206, 16, v39
    v_and_b32 v207, s95, v39
    s_add_u32 m0, s6, 34816
    s_add_u32 s11, s7, 28544
    buffer_load_dwordx4 v6, s[40:43], s11 offen lds
    v_pk_add_f32 v[200:201], v[200:201], v[160:161]
    v_pk_add_f32 v[202:203], v[202:203], v[160:161]
    v_pk_add_f32 v[204:205], v[204:205], v[160:161]
    v_pk_add_f32 v[206:207], v[206:207], v[160:161]
    v_cvt_pk_bf16_f32 v36, v200, v201
    v_cvt_pk_bf16_f32 v37, v202, v203
    v_cvt_pk_bf16_f32 v38, v204, v205
    v_cvt_pk_bf16_f32 v39, v206, v207
    v_lshlrev_b32 v200, 16, v36
    v_and_b32 v201, s95, v36
    v_lshlrev_b32 v202, 16, v37
    v_and_b32 v203, s95, v37
    v_lshlrev_b32 v204, 16, v38
    v_and_b32 v205, s95, v38
    v_lshlrev_b32 v206, 16, v39
    v_and_b32 v207, s95, v39
    s_add_u32 m0, s6, 35840
    s_add_u32 s11, s7, 28672
    buffer_load_dwordx4 v6, s[40:43], s11 offen lds
    v_pk_mul_f32 v[200:201], v[200:201], v[166:167]
    v_pk_mul_f32 v[202:203], v[202:203], v[166:167]
    v_pk_mul_f32 v[204:205], v[204:205], v[166:167]
    v_pk_mul_f32 v[206:207], v[206:207], v[166:167]
    v_cvt_pk_bf16_f32 v36, v200, v201
    v_cvt_pk_bf16_f32 v37, v202, v203
    v_cvt_pk_bf16_f32 v38, v204, v205
    v_cvt_pk_bf16_f32 v39, v206, v207
    ds_write_b64 v197, v[36:37] offset:2048
    ds_write_b64 v198, v[38:39] offset:2048
    v_lshlrev_b32 v200, 16, v40
    v_and_b32 v201, s95, v40
    v_lshlrev_b32 v202, 16, v41
    v_and_b32 v203, s95, v41
    v_lshlrev_b32 v204, 16, v42
    v_and_b32 v205, s95, v42
    v_lshlrev_b32 v206, 16, v43
    v_and_b32 v207, s95, v43
    s_add_u32 s14, s13, 0
    buffer_load_dwordx4 a[64:67], v184, s[44:47], s14 offen
    v_pk_add_f32 v[200:201], v[200:201], v[160:161]
    v_pk_add_f32 v[202:203], v[202:203], v[160:161]
    v_pk_add_f32 v[204:205], v[204:205], v[160:161]
    v_pk_add_f32 v[206:207], v[206:207], v[160:161]
    v_cvt_pk_bf16_f32 v40, v200, v201
    v_cvt_pk_bf16_f32 v41, v202, v203
    v_cvt_pk_bf16_f32 v42, v204, v205
    v_cvt_pk_bf16_f32 v43, v206, v207
    v_lshlrev_b32 v200, 16, v40
    v_and_b32 v201, s95, v40
    v_lshlrev_b32 v202, 16, v41
    v_and_b32 v203, s95, v41
    v_lshlrev_b32 v204, 16, v42
    v_and_b32 v205, s95, v42
    v_lshlrev_b32 v206, 16, v43
    v_and_b32 v207, s95, v43
    s_add_u32 s14, s13, 0
    buffer_load_dwordx4 a[68:71], v185, s[44:47], s14 offen
    v_pk_mul_f32 v[200:201], v[200:201], v[166:167]
    v_pk_mul_f32 v[202:203], v[202:203], v[166:167]
    v_pk_mul_f32 v[204:205], v[204:205], v[166:167]
    v_pk_mul_f32 v[206:207], v[206:207], v[166:167]
    v_cvt_pk_bf16_f32 v40, v200, v201
    v_cvt_pk_bf16_f32 v41, v202, v203
    v_cvt_pk_bf16_f32 v42, v204, v205
    v_cvt_pk_bf16_f32 v43, v206, v207
    ds_write_b64 v195, v[40:41] offset:3072
    ds_write_b64 v196, v[42:43] offset:3072
    v_lshlrev_b32 v200, 16, v44
    v_and_b32 v201, s95, v44
    v_lshlrev_b32 v202, 16, v45
    v_and_b32 v203, s95, v45
    v_lshlrev_b32 v204, 16, v46
    v_and_b32 v205, s95, v46
    v_lshlrev_b32 v206, 16, v47
    v_and_b32 v207, s95, v47
    s_add_u32 s14, s13, 0
    buffer_load_dwordx4 a[72:75], v186, s[44:47], s14 offen
    v_pk_add_f32 v[200:201], v[200:201], v[160:161]
    v_pk_add_f32 v[202:203], v[202:203], v[160:161]
    v_pk_add_f32 v[204:205], v[204:205], v[160:161]
    v_pk_add_f32 v[206:207], v[206:207], v[160:161]
    v_cvt_pk_bf16_f32 v44, v200, v201
    v_cvt_pk_bf16_f32 v45, v202, v203
    v_cvt_pk_bf16_f32 v46, v204, v205
    v_cvt_pk_bf16_f32 v47, v206, v207
    v_lshlrev_b32 v200, 16, v44
    v_and_b32 v201, s95, v44
    v_lshlrev_b32 v202, 16, v45
    v_and_b32 v203, s95, v45
    v_lshlrev_b32 v204, 16, v46
    v_and_b32 v205, s95, v46
    v_lshlrev_b32 v206, 16, v47
    v_and_b32 v207, s95, v47
    s_add_u32 s14, s13, 147456
    buffer_load_dwordx4 a[76:79], v184, s[44:47], s14 offen
    v_pk_mul_f32 v[200:201], v[200:201], v[166:167]
    v_pk_mul_f32 v[202:203], v[202:203], v[166:167]
    v_pk_mul_f32 v[204:205], v[204:205], v[166:167]
    v_pk_mul_f32 v[206:207], v[206:207], v[166:167]
    v_cvt_pk_bf16_f32 v44, v200, v201
    v_cvt_pk_bf16_f32 v45, v202, v203
    v_cvt_pk_bf16_f32 v46, v204, v205
    v_cvt_pk_bf16_f32 v47, v206, v207
    ds_write_b64 v197, v[44:45] offset:3072
    ds_write_b64 v198, v[46:47] offset:3072
    v_lshlrev_b32 v200, 16, v48
    v_and_b32 v201, s95, v48
    v_lshlrev_b32 v202, 16, v49
    v_and_b32 v203, s95, v49
    v_lshlrev_b32 v204, 16, v50
    v_and_b32 v205, s95, v50
    v_lshlrev_b32 v206, 16, v51
    v_and_b32 v207, s95, v51
    s_add_u32 s14, s13, 147456
    buffer_load_dwordx4 a[80:83], v185, s[44:47], s14 offen
    v_pk_add_f32 v[200:201], v[200:201], v[160:161]
    v_pk_add_f32 v[202:203], v[202:203], v[160:161]
    v_pk_add_f32 v[204:205], v[204:205], v[160:161]
    v_pk_add_f32 v[206:207], v[206:207], v[160:161]
    v_cvt_pk_bf16_f32 v48, v200, v201
    v_cvt_pk_bf16_f32 v49, v202, v203
    v_cvt_pk_bf16_f32 v50, v204, v205
    v_cvt_pk_bf16_f32 v51, v206, v207
    v_lshlrev_b32 v200, 16, v48
    v_and_b32 v201, s95, v48
    v_lshlrev_b32 v202, 16, v49
    v_and_b32 v203, s95, v49
    v_lshlrev_b32 v204, 16, v50
    v_and_b32 v205, s95, v50
    v_lshlrev_b32 v206, 16, v51
    v_and_b32 v207, s95, v51
    s_add_u32 s14, s13, 147456
    buffer_load_dwordx4 a[84:87], v186, s[44:47], s14 offen
    v_pk_mul_f32 v[200:201], v[200:201], v[166:167]
    v_pk_mul_f32 v[202:203], v[202:203], v[166:167]
    v_pk_mul_f32 v[204:205], v[204:205], v[166:167]
    v_pk_mul_f32 v[206:207], v[206:207], v[166:167]
    v_cvt_pk_bf16_f32 v48, v200, v201
    v_cvt_pk_bf16_f32 v49, v202, v203
    v_cvt_pk_bf16_f32 v50, v204, v205
    v_cvt_pk_bf16_f32 v51, v206, v207
    ds_write_b64 v195, v[48:49] offset:4096
    ds_write_b64 v196, v[50:51] offset:4096
    v_lshlrev_b32 v200, 16, v52
    v_and_b32 v201, s95, v52
    v_lshlrev_b32 v202, 16, v53
    v_and_b32 v203, s95, v53
    v_lshlrev_b32 v204, 16, v54
    v_and_b32 v205, s95, v54
    v_lshlrev_b32 v206, 16, v55
    v_and_b32 v207, s95, v55
    s_add_u32 s14, s13, 294912
    buffer_load_dwordx4 a[88:91], v184, s[44:47], s14 offen
    v_pk_add_f32 v[200:201], v[200:201], v[160:161]
    v_pk_add_f32 v[202:203], v[202:203], v[160:161]
    v_pk_add_f32 v[204:205], v[204:205], v[160:161]
    v_pk_add_f32 v[206:207], v[206:207], v[160:161]
    v_cvt_pk_bf16_f32 v52, v200, v201
    v_cvt_pk_bf16_f32 v53, v202, v203
    v_cvt_pk_bf16_f32 v54, v204, v205
    v_cvt_pk_bf16_f32 v55, v206, v207
    v_lshlrev_b32 v200, 16, v52
    v_and_b32 v201, s95, v52
    v_lshlrev_b32 v202, 16, v53
    v_and_b32 v203, s95, v53
    v_lshlrev_b32 v204, 16, v54
    v_and_b32 v205, s95, v54
    v_lshlrev_b32 v206, 16, v55
    v_and_b32 v207, s95, v55
    s_add_u32 s14, s13, 294912
    buffer_load_dwordx4 a[92:95], v185, s[44:47], s14 offen
    v_pk_mul_f32 v[200:201], v[200:201], v[166:167]
    v_pk_mul_f32 v[202:203], v[202:203], v[166:167]
    v_pk_mul_f32 v[204:205], v[204:205], v[166:167]
    v_pk_mul_f32 v[206:207], v[206:207], v[166:167]
    v_cvt_pk_bf16_f32 v52, v200, v201
    v_cvt_pk_bf16_f32 v53, v202, v203
    v_cvt_pk_bf16_f32 v54, v204, v205
    v_cvt_pk_bf16_f32 v55, v206, v207
    ds_write_b64 v197, v[52:53] offset:4096
    ds_write_b64 v198, v[54:55] offset:4096
    v_lshlrev_b32 v200, 16, v56
    v_and_b32 v201, s95, v56
    v_lshlrev_b32 v202, 16, v57
    v_and_b32 v203, s95, v57
    v_lshlrev_b32 v204, 16, v58
    v_and_b32 v205, s95, v58
    v_lshlrev_b32 v206, 16, v59
    v_and_b32 v207, s95, v59
    s_add_u32 s14, s13, 294912
    buffer_load_dwordx4 a[96:99], v186, s[44:47], s14 offen
    v_pk_add_f32 v[200:201], v[200:201], v[160:161]
    v_pk_add_f32 v[202:203], v[202:203], v[160:161]
    v_pk_add_f32 v[204:205], v[204:205], v[160:161]
    v_pk_add_f32 v[206:207], v[206:207], v[160:161]
    v_cvt_pk_bf16_f32 v56, v200, v201
    v_cvt_pk_bf16_f32 v57, v202, v203
    v_cvt_pk_bf16_f32 v58, v204, v205
    v_cvt_pk_bf16_f32 v59, v206, v207
    v_lshlrev_b32 v200, 16, v56
    v_and_b32 v201, s95, v56
    v_lshlrev_b32 v202, 16, v57
    v_and_b32 v203, s95, v57
    v_lshlrev_b32 v204, 16, v58
    v_and_b32 v205, s95, v58
    v_lshlrev_b32 v206, 16, v59
    v_and_b32 v207, s95, v59
    s_add_u32 s14, s13, 442368
    buffer_load_dwordx4 a[100:103], v184, s[44:47], s14 offen
    v_pk_mul_f32 v[200:201], v[200:201], v[166:167]
    v_pk_mul_f32 v[202:203], v[202:203], v[166:167]
    v_pk_mul_f32 v[204:205], v[204:205], v[166:167]
    v_pk_mul_f32 v[206:207], v[206:207], v[166:167]
    v_cvt_pk_bf16_f32 v56, v200, v201
    v_cvt_pk_bf16_f32 v57, v202, v203
    v_cvt_pk_bf16_f32 v58, v204, v205
    v_cvt_pk_bf16_f32 v59, v206, v207
    ds_write_b64 v195, v[56:57] offset:5120
    ds_write_b64 v196, v[58:59] offset:5120
    v_lshlrev_b32 v200, 16, v60
    v_and_b32 v201, s95, v60
    v_lshlrev_b32 v202, 16, v61
    v_and_b32 v203, s95, v61
    v_lshlrev_b32 v204, 16, v62
    v_and_b32 v205, s95, v62
    v_lshlrev_b32 v206, 16, v63
    v_and_b32 v207, s95, v63
    s_add_u32 s14, s13, 442368
    buffer_load_dwordx4 a[104:107], v185, s[44:47], s14 offen
    v_pk_add_f32 v[200:201], v[200:201], v[160:161]
    v_pk_add_f32 v[202:203], v[202:203], v[160:161]
    v_pk_add_f32 v[204:205], v[204:205], v[160:161]
    v_pk_add_f32 v[206:207], v[206:207], v[160:161]
    v_cvt_pk_bf16_f32 v60, v200, v201
    v_cvt_pk_bf16_f32 v61, v202, v203
    v_cvt_pk_bf16_f32 v62, v204, v205
    v_cvt_pk_bf16_f32 v63, v206, v207
    v_lshlrev_b32 v200, 16, v60
    v_and_b32 v201, s95, v60
    v_lshlrev_b32 v202, 16, v61
    v_and_b32 v203, s95, v61
    v_lshlrev_b32 v204, 16, v62
    v_and_b32 v205, s95, v62
    v_lshlrev_b32 v206, 16, v63
    v_and_b32 v207, s95, v63
    s_add_u32 s14, s13, 442368
    buffer_load_dwordx4 a[108:111], v186, s[44:47], s14 offen
    v_pk_mul_f32 v[200:201], v[200:201], v[166:167]
    v_pk_mul_f32 v[202:203], v[202:203], v[166:167]
    v_pk_mul_f32 v[204:205], v[204:205], v[166:167]
    v_pk_mul_f32 v[206:207], v[206:207], v[166:167]
    v_cvt_pk_bf16_f32 v60, v200, v201
    v_cvt_pk_bf16_f32 v61, v202, v203
    v_cvt_pk_bf16_f32 v62, v204, v205
    v_cvt_pk_bf16_f32 v63, v206, v207
    ds_write_b64 v197, v[60:61] offset:5120
    ds_write_b64 v198, v[62:63] offset:5120
    v_lshlrev_b32 v200, 16, v64
    v_and_b32 v201, s95, v64
    v_lshlrev_b32 v202, 16, v65
    v_and_b32 v203, s95, v65
    v_lshlrev_b32 v204, 16, v66
    v_and_b32 v205, s95, v66
    v_lshlrev_b32 v206, 16, v67
    v_and_b32 v207, s95, v67
    s_add_u32 s14, s13, 589824
    buffer_load_dwordx4 a[112:115], v184, s[44:47], s14 offen
    v_pk_add_f32 v[200:201], v[200:201], v[160:161]
    v_pk_add_f32 v[202:203], v[202:203], v[160:161]
    v_pk_add_f32 v[204:205], v[204:205], v[160:161]
    v_pk_add_f32 v[206:207], v[206:207], v[160:161]
    v_cvt_pk_bf16_f32 v64, v200, v201
    v_cvt_pk_bf16_f32 v65, v202, v203
    v_cvt_pk_bf16_f32 v66, v204, v205
    v_cvt_pk_bf16_f32 v67, v206, v207
    v_lshlrev_b32 v200, 16, v64
    v_and_b32 v201, s95, v64
    v_lshlrev_b32 v202, 16, v65
    v_and_b32 v203, s95, v65
    v_lshlrev_b32 v204, 16, v66
    v_and_b32 v205, s95, v66
    v_lshlrev_b32 v206, 16, v67
    v_and_b32 v207, s95, v67
    s_add_u32 s14, s13, 589824
    buffer_load_dwordx4 a[116:119], v185, s[44:47], s14 offen
    v_pk_mul_f32 v[200:201], v[200:201], v[166:167]
    v_pk_mul_f32 v[202:203], v[202:203], v[166:167]
    v_pk_mul_f32 v[204:205], v[204:205], v[166:167]
    v_pk_mul_f32 v[206:207], v[206:207], v[166:167]
    v_cvt_pk_bf16_f32 v64, v200, v201
    v_cvt_pk_bf16_f32 v65, v202, v203
    v_cvt_pk_bf16_f32 v66, v204, v205
    v_cvt_pk_bf16_f32 v67, v206, v207
    ds_write_b64 v195, v[64:65] offset:6144
    ds_write_b64 v196, v[66:67] offset:6144
    v_lshlrev_b32 v200, 16, v68
    v_and_b32 v201, s95, v68
    v_lshlrev_b32 v202, 16, v69
    v_and_b32 v203, s95, v69
    v_lshlrev_b32 v204, 16, v70
    v_and_b32 v205, s95, v70
    v_lshlrev_b32 v206, 16, v71
    v_and_b32 v207, s95, v71
    s_add_u32 s14, s13, 589824
    buffer_load_dwordx4 a[120:123], v186, s[44:47], s14 offen
    v_pk_add_f32 v[200:201], v[200:201], v[160:161]
    v_pk_add_f32 v[202:203], v[202:203], v[160:161]
    v_pk_add_f32 v[204:205], v[204:205], v[160:161]
    v_pk_add_f32 v[206:207], v[206:207], v[160:161]
    v_cvt_pk_bf16_f32 v68, v200, v201
    v_cvt_pk_bf16_f32 v69, v202, v203
    v_cvt_pk_bf16_f32 v70, v204, v205
    v_cvt_pk_bf16_f32 v71, v206, v207
    v_lshlrev_b32 v200, 16, v68
    v_and_b32 v201, s95, v68
    v_lshlrev_b32 v202, 16, v69
    v_and_b32 v203, s95, v69
    v_lshlrev_b32 v204, 16, v70
    v_and_b32 v205, s95, v70
    v_lshlrev_b32 v206, 16, v71
    v_and_b32 v207, s95, v71
    s_add_u32 s14, s13, 737280
    buffer_load_dwordx4 a[124:127], v184, s[44:47], s14 offen
    v_pk_mul_f32 v[200:201], v[200:201], v[166:167]
    v_pk_mul_f32 v[202:203], v[202:203], v[166:167]
    v_pk_mul_f32 v[204:205], v[204:205], v[166:167]
    v_pk_mul_f32 v[206:207], v[206:207], v[166:167]
    v_cvt_pk_bf16_f32 v68, v200, v201
    v_cvt_pk_bf16_f32 v69, v202, v203
    v_cvt_pk_bf16_f32 v70, v204, v205
    v_cvt_pk_bf16_f32 v71, v206, v207
    ds_write_b64 v197, v[68:69] offset:6144
    ds_write_b64 v198, v[70:71] offset:6144
    v_lshlrev_b32 v200, 16, v72
    v_and_b32 v201, s95, v72
    v_lshlrev_b32 v202, 16, v73
    v_and_b32 v203, s95, v73
    v_lshlrev_b32 v204, 16, v74
    v_and_b32 v205, s95, v74
    v_lshlrev_b32 v206, 16, v75
    v_and_b32 v207, s95, v75
    s_add_u32 s14, s13, 737280
    buffer_load_dwordx4 a[128:131], v185, s[44:47], s14 offen
    v_pk_add_f32 v[200:201], v[200:201], v[160:161]
    v_pk_add_f32 v[202:203], v[202:203], v[160:161]
    v_pk_add_f32 v[204:205], v[204:205], v[160:161]
    v_pk_add_f32 v[206:207], v[206:207], v[160:161]
    v_cvt_pk_bf16_f32 v72, v200, v201
    v_cvt_pk_bf16_f32 v73, v202, v203
    v_cvt_pk_bf16_f32 v74, v204, v205
    v_cvt_pk_bf16_f32 v75, v206, v207
    v_lshlrev_b32 v200, 16, v72
    v_and_b32 v201, s95, v72
    v_lshlrev_b32 v202, 16, v73
    v_and_b32 v203, s95, v73
    v_lshlrev_b32 v204, 16, v74
    v_and_b32 v205, s95, v74
    v_lshlrev_b32 v206, 16, v75
    v_and_b32 v207, s95, v75
    s_add_u32 s14, s13, 737280
    buffer_load_dwordx4 a[132:135], v186, s[44:47], s14 offen
    v_pk_mul_f32 v[200:201], v[200:201], v[166:167]
    v_pk_mul_f32 v[202:203], v[202:203], v[166:167]
    v_pk_mul_f32 v[204:205], v[204:205], v[166:167]
    v_pk_mul_f32 v[206:207], v[206:207], v[166:167]
    v_cvt_pk_bf16_f32 v72, v200, v201
    v_cvt_pk_bf16_f32 v73, v202, v203
    v_cvt_pk_bf16_f32 v74, v204, v205
    v_cvt_pk_bf16_f32 v75, v206, v207
    ds_write_b64 v195, v[72:73] offset:7168
    ds_write_b64 v196, v[74:75] offset:7168
    v_lshlrev_b32 v200, 16, v76
    v_and_b32 v201, s95, v76
    v_lshlrev_b32 v202, 16, v77
    v_and_b32 v203, s95, v77
    v_lshlrev_b32 v204, 16, v78
    v_and_b32 v205, s95, v78
    v_lshlrev_b32 v206, 16, v79
    v_and_b32 v207, s95, v79
    s_add_u32 s14, s13, 884736
    buffer_load_dwordx4 a[136:139], v184, s[44:47], s14 offen
    v_pk_add_f32 v[200:201], v[200:201], v[160:161]
    v_pk_add_f32 v[202:203], v[202:203], v[160:161]
    v_pk_add_f32 v[204:205], v[204:205], v[160:161]
    v_pk_add_f32 v[206:207], v[206:207], v[160:161]
    v_cvt_pk_bf16_f32 v76, v200, v201
    v_cvt_pk_bf16_f32 v77, v202, v203
    v_cvt_pk_bf16_f32 v78, v204, v205
    v_cvt_pk_bf16_f32 v79, v206, v207
    v_lshlrev_b32 v200, 16, v76
    v_and_b32 v201, s95, v76
    v_lshlrev_b32 v202, 16, v77
    v_and_b32 v203, s95, v77
    v_lshlrev_b32 v204, 16, v78
    v_and_b32 v205, s95, v78
    v_lshlrev_b32 v206, 16, v79
    v_and_b32 v207, s95, v79
    s_add_u32 s14, s13, 884736
    buffer_load_dwordx4 a[140:143], v185, s[44:47], s14 offen
    v_pk_mul_f32 v[200:201], v[200:201], v[166:167]
    v_pk_mul_f32 v[202:203], v[202:203], v[166:167]
    v_pk_mul_f32 v[204:205], v[204:205], v[166:167]
    v_pk_mul_f32 v[206:207], v[206:207], v[166:167]
    v_cvt_pk_bf16_f32 v76, v200, v201
    v_cvt_pk_bf16_f32 v77, v202, v203
    v_cvt_pk_bf16_f32 v78, v204, v205
    v_cvt_pk_bf16_f32 v79, v206, v207
    ds_write_b64 v197, v[76:77] offset:7168
    ds_write_b64 v198, v[78:79] offset:7168
    v_lshlrev_b32 v200, 16, v80
    v_and_b32 v201, s95, v80
    v_lshlrev_b32 v202, 16, v81
    v_and_b32 v203, s95, v81
    v_lshlrev_b32 v204, 16, v82
    v_and_b32 v205, s95, v82
    v_lshlrev_b32 v206, 16, v83
    v_and_b32 v207, s95, v83
    s_add_u32 s14, s13, 884736
    buffer_load_dwordx4 a[144:147], v186, s[44:47], s14 offen
    v_pk_add_f32 v[200:201], v[200:201], v[160:161]
    v_pk_add_f32 v[202:203], v[202:203], v[160:161]
    v_pk_add_f32 v[204:205], v[204:205], v[160:161]
    v_pk_add_f32 v[206:207], v[206:207], v[160:161]
    v_cvt_pk_bf16_f32 v80, v200, v201
    v_cvt_pk_bf16_f32 v81, v202, v203
    v_cvt_pk_bf16_f32 v82, v204, v205
    v_cvt_pk_bf16_f32 v83, v206, v207
    v_lshlrev_b32 v200, 16, v80
    v_and_b32 v201, s95, v80
    v_lshlrev_b32 v202, 16, v81
    v_and_b32 v203, s95, v81
    v_lshlrev_b32 v204, 16, v82
    v_and_b32 v205, s95, v82
    v_lshlrev_b32 v206, 16, v83
    v_and_b32 v207, s95, v83
    s_add_u32 s14, s13, 1032192
    buffer_load_dwordx4 a[148:151], v184, s[44:47], s14 offen
    v_pk_mul_f32 v[200:201], v[200:201], v[166:167]
    v_pk_mul_f32 v[202:203], v[202:203], v[166:167]
    v_pk_mul_f32 v[204:205], v[204:205], v[166:167]
    v_pk_mul_f32 v[206:207], v[206:207], v[166:167]
    v_cvt_pk_bf16_f32 v80, v200, v201
    v_cvt_pk_bf16_f32 v81, v202, v203
    v_cvt_pk_bf16_f32 v82, v204, v205
    v_cvt_pk_bf16_f32 v83, v206, v207
    ds_write_b64 v195, v[80:81] offset:8192
    ds_write_b64 v196, v[82:83] offset:8192
    v_lshlrev_b32 v200, 16, v84
    v_and_b32 v201, s95, v84
    v_lshlrev_b32 v202, 16, v85
    v_and_b32 v203, s95, v85
    v_lshlrev_b32 v204, 16, v86
    v_and_b32 v205, s95, v86
    v_lshlrev_b32 v206, 16, v87
    v_and_b32 v207, s95, v87
    s_add_u32 s14, s13, 1032192
    buffer_load_dwordx4 a[152:155], v185, s[44:47], s14 offen
    v_pk_add_f32 v[200:201], v[200:201], v[160:161]
    v_pk_add_f32 v[202:203], v[202:203], v[160:161]
    v_pk_add_f32 v[204:205], v[204:205], v[160:161]
    v_pk_add_f32 v[206:207], v[206:207], v[160:161]
    v_cvt_pk_bf16_f32 v84, v200, v201
    v_cvt_pk_bf16_f32 v85, v202, v203
    v_cvt_pk_bf16_f32 v86, v204, v205
    v_cvt_pk_bf16_f32 v87, v206, v207
    v_lshlrev_b32 v200, 16, v84
    v_and_b32 v201, s95, v84
    v_lshlrev_b32 v202, 16, v85
    v_and_b32 v203, s95, v85
    v_lshlrev_b32 v204, 16, v86
    v_and_b32 v205, s95, v86
    v_lshlrev_b32 v206, 16, v87
    v_and_b32 v207, s95, v87
    s_add_u32 s14, s13, 1032192
    buffer_load_dwordx4 a[156:159], v186, s[44:47], s14 offen
    v_pk_mul_f32 v[200:201], v[200:201], v[166:167]
    v_pk_mul_f32 v[202:203], v[202:203], v[166:167]
    v_pk_mul_f32 v[204:205], v[204:205], v[166:167]
    v_pk_mul_f32 v[206:207], v[206:207], v[166:167]
    v_cvt_pk_bf16_f32 v84, v200, v201
    v_cvt_pk_bf16_f32 v85, v202, v203
    v_cvt_pk_bf16_f32 v86, v204, v205
    v_cvt_pk_bf16_f32 v87, v206, v207
    ds_write_b64 v197, v[84:85] offset:8192
    ds_write_b64 v198, v[86:87] offset:8192
    s_waitcnt vmcnt(24)
    ds_read_b128 v[16:19], v193 offset:18432
    ds_read_b128 v[20:23], v194 offset:18432
    ds_read_b128 v[24:27], v193 offset:19456
    ds_read_b128 v[28:31], v194 offset:19456
    ds_read_b128 v[32:35], v193 offset:20480
    ds_read_b128 v[36:39], v194 offset:20480
    ds_read_b128 v[40:43], v193 offset:21504
    ds_read_b128 v[44:47], v194 offset:21504
    ds_read_b128 v[48:51], v193 offset:22528
    ds_read_b128 v[52:55], v194 offset:22528
    ds_read_b128 v[56:59], v193 offset:23552
    ds_read_b128 v[60:63], v194 offset:23552
    ds_read_b128 v[64:67], v193 offset:24576
    ds_read_b128 v[68:71], v194 offset:24576
    ds_read_b128 v[72:75], v193 offset:25600
    ds_read_b128 v[76:79], v194 offset:25600
    ds_read_b128 v[80:83], v193 offset:26624
    ds_read_b128 v[84:87], v194 offset:26624
    s_waitcnt lgkmcnt(15)
    v_mfma_f32_16x16x32_bf16 v[160:163], v[176:179], v[16:19], 0
    v_mfma_f32_16x16x32_bf16 v[164:167], v[16:19], v[16:19], 0
    v_mfma_f32_16x16x32_bf16 v[160:163], v[176:179], v[20:23], v[160:163]
    v_mfma_f32_16x16x32_bf16 v[164:167], v[20:23], v[20:23], v[164:167]
    v_mfma_f32_16x16x32_bf16 v[160:163], v[176:179], v[24:27], v[160:163]
    v_mfma_f32_16x16x32_bf16 v[164:167], v[24:27], v[24:27], v[164:167]
    s_add_u32 s14, s13, 1179648
    buffer_load_dwordx4 a[160:163], v184, s[44:47], s14 offen
    s_waitcnt lgkmcnt(14)
    v_mfma_f32_16x16x32_bf16 v[160:163], v[176:179], v[28:31], v[160:163]
    v_mfma_f32_16x16x32_bf16 v[164:167], v[28:31], v[28:31], v[164:167]
    s_waitcnt lgkmcnt(13)
    v_mfma_f32_16x16x32_bf16 v[160:163], v[176:179], v[32:35], v[160:163]
    v_mfma_f32_16x16x32_bf16 v[164:167], v[32:35], v[32:35], v[164:167]
    s_waitcnt lgkmcnt(12)
    v_mfma_f32_16x16x32_bf16 v[160:163], v[176:179], v[36:39], v[160:163]
    v_mfma_f32_16x16x32_bf16 v[164:167], v[36:39], v[36:39], v[164:167]
    s_add_u32 s14, s13, 1179648
    buffer_load_dwordx4 a[164:167], v185, s[44:47], s14 offen
    s_waitcnt lgkmcnt(11)
    v_mfma_f32_16x16x32_bf16 v[160:163], v[176:179], v[40:43], v[160:163]
    v_mfma_f32_16x16x32_bf16 v[164:167], v[40:43], v[40:43], v[164:167]
    s_waitcnt lgkmcnt(10)
    v_mfma_f32_16x16x32_bf16 v[160:163], v[176:179], v[44:47], v[160:163]
    v_mfma_f32_16x16x32_bf16 v[164:167], v[44:47], v[44:47], v[164:167]
    s_waitcnt lgkmcnt(9)
    v_mfma_f32_16x16x32_bf16 v[160:163], v[176:179], v[48:51], v[160:163]
    v_mfma_f32_16x16x32_bf16 v[164:167], v[48:51], v[48:51], v[164:167]
    s_add_u32 s14, s13, 1179648
    buffer_load_dwordx4 a[168:171], v186, s[44:47], s14 offen
    s_waitcnt lgkmcnt(8)
    v_mfma_f32_16x16x32_bf16 v[160:163], v[176:179], v[52:55], v[160:163]
    v_mfma_f32_16x16x32_bf16 v[164:167], v[52:55], v[52:55], v[164:167]
    s_waitcnt lgkmcnt(7)
    v_mfma_f32_16x16x32_bf16 v[160:163], v[176:179], v[56:59], v[160:163]
    v_mfma_f32_16x16x32_bf16 v[164:167], v[56:59], v[56:59], v[164:167]
    s_waitcnt lgkmcnt(6)
    v_mfma_f32_16x16x32_bf16 v[160:163], v[176:179], v[60:63], v[160:163]
    v_mfma_f32_16x16x32_bf16 v[164:167], v[60:63], v[60:63], v[164:167]
    s_add_u32 s14, s13, 1327104
    buffer_load_dwordx4 a[172:175], v184, s[44:47], s14 offen
    s_waitcnt lgkmcnt(5)
    v_mfma_f32_16x16x32_bf16 v[160:163], v[176:179], v[64:67], v[160:163]
    v_mfma_f32_16x16x32_bf16 v[164:167], v[64:67], v[64:67], v[164:167]
    s_waitcnt lgkmcnt(4)
    v_mfma_f32_16x16x32_bf16 v[160:163], v[176:179], v[68:71], v[160:163]
    v_mfma_f32_16x16x32_bf16 v[164:167], v[68:71], v[68:71], v[164:167]
    s_waitcnt lgkmcnt(3)
    v_mfma_f32_16x16x32_bf16 v[160:163], v[176:179], v[72:75], v[160:163]
    v_mfma_f32_16x16x32_bf16 v[164:167], v[72:75], v[72:75], v[164:167]
    s_add_u32 s14, s13, 1327104
    buffer_load_dwordx4 a[176:179], v185, s[44:47], s14 offen
    s_waitcnt lgkmcnt(2)
    v_mfma_f32_16x16x32_bf16 v[160:163], v[176:179], v[76:79], v[160:163]
    v_mfma_f32_16x16x32_bf16 v[164:167], v[76:79], v[76:79], v[164:167]
    s_waitcnt lgkmcnt(1)
    v_mfma_f32_16x16x32_bf16 v[160:163], v[176:179], v[80:83], v[160:163]
    v_mfma_f32_16x16x32_bf16 v[164:167], v[80:83], v[80:83], v[164:167]
    s_waitcnt lgkmcnt(0)
    v_mfma_f32_16x16x32_bf16 v[160:163], v[176:179], v[84:87], v[160:163]
    v_mfma_f32_16x16x32_bf16 v[164:167], v[84:87], v[84:87], v[164:167]
    s_add_u32 s14, s13, 1327104
    buffer_load_dwordx4 a[180:183], v186, s[44:47], s14 offen
    s_nop 15
    v_cndmask_b32 v164, v164, v165, s[64:65]
    v_cndmask_b32 v164, v164, v166, s[66:67]
    v_cndmask_b32 v164, v164, v167, s[68:69]
    ds_bpermute_b32 v165, v199, v164
    s_waitcnt lgkmcnt(0)
    v_mul_f32 v160, s70, v160
    v_mul_f32 v165, s70, v165
    v_fma_f32 v165, -v160, v160, v165
    v_max_f32 v165, 0, v165
    v_cvt_pk_bf16_f32 v164, v160, v165
    v_lshlrev_b32 v160, 16, v164
    v_and_b32 v165, s95, v164
    v_add_f32 v165, s71, v165
    v_cvt_pk_bf16_f32 v165, v165, v165
    v_and_b32 v165, s95, v165
    v_sqrt_f32 v165, v165
    s_nop 0
    v_cvt_pk_bf16_f32 v165, v165, v165
    v_and_b32 v165, s95, v165
    v_rcp_f32 v166, v165
    s_nop 0
    v_fma_f32 v167, -v165, v166, 1.0
    v_fma_f32 v166, v167, v166, v166
    v_mov_b32 v167, v166
    v_sub_f32 v160, 0, v160
    v_mov_b32 v161, v160
    v_lshlrev_b32 v200, 16, v16
    v_and_b32 v201, s95, v16
    v_lshlrev_b32 v202, 16, v17
    v_and_b32 v203, s95, v17
    v_lshlrev_b32 v204, 16, v18
    v_and_b32 v205, s95, v18
    v_lshlrev_b32 v206, 16, v19
    v_and_b32 v207, s95, v19
    s_add_u32 s14, s13, 1474560
    buffer_load_dwordx4 a[184:187], v184, s[44:47], s14 offen
    v_pk_add_f32 v[200:201], v[200:201], v[160:161]
    v_pk_add_f32 v[202:203], v[202:203], v[160:161]
    v_pk_add_f32 v[204:205], v[204:205], v[160:161]
    v_pk_add_f32 v[206:207], v[206:207], v[160:161]
    v_cvt_pk_bf16_f32 v16, v200, v201
    v_cvt_pk_bf16_f32 v17, v202, v203
    v_cvt_pk_bf16_f32 v18, v204, v205
    v_cvt_pk_bf16_f32 v19, v206, v207
    v_lshlrev_b32 v200, 16, v16
    v_and_b32 v201, s95, v16
    v_lshlrev_b32 v202, 16, v17
    v_and_b32 v203, s95, v17
    v_lshlrev_b32 v204, 16, v18
    v_and_b32 v205, s95, v18
    v_lshlrev_b32 v206, 16, v19
    v_and_b32 v207, s95, v19
    s_add_u32 s14, s13, 1474560
    buffer_load_dwordx4 a[188:191], v185, s[44:47], s14 offen
    v_pk_mul_f32 v[200:201], v[200:201], v[166:167]
    v_pk_mul_f32 v[202:203], v[202:203], v[166:167]
    v_pk_mul_f32 v[204:205], v[204:205], v[166:167]
    v_pk_mul_f32 v[206:207], v[206:207], v[166:167]
    v_cvt_pk_bf16_f32 v16, v200, v201
    v_cvt_pk_bf16_f32 v17, v202, v203
    v_cvt_pk_bf16_f32 v18, v204, v205
    v_cvt_pk_bf16_f32 v19, v206, v207
    ds_write_b64 v195, v[16:17] offset:18432
    ds_write_b64 v196, v[18:19] offset:18432
    v_lshlrev_b32 v200, 16, v20
    v_and_b32 v201, s95, v20
    v_lshlrev_b32 v202, 16, v21
    v_and_b32 v203, s95, v21
    v_lshlrev_b32 v204, 16, v22
    v_and_b32 v205, s95, v22
    v_lshlrev_b32 v206, 16, v23
    v_and_b32 v207, s95, v23
    s_add_u32 s14, s13, 1474560
    buffer_load_dwordx4 a[192:195], v186, s[44:47], s14 offen
    v_pk_add_f32 v[200:201], v[200:201], v[160:161]
    v_pk_add_f32 v[202:203], v[202:203], v[160:161]
    v_pk_add_f32 v[204:205], v[204:205], v[160:161]
    v_pk_add_f32 v[206:207], v[206:207], v[160:161]
    v_cvt_pk_bf16_f32 v20, v200, v201
    v_cvt_pk_bf16_f32 v21, v202, v203
    v_cvt_pk_bf16_f32 v22, v204, v205
    v_cvt_pk_bf16_f32 v23, v206, v207
    v_lshlrev_b32 v200, 16, v20
    v_and_b32 v201, s95, v20
    v_lshlrev_b32 v202, 16, v21
    v_and_b32 v203, s95, v21
    v_lshlrev_b32 v204, 16, v22
    v_and_b32 v205, s95, v22
    v_lshlrev_b32 v206, 16, v23
    v_and_b32 v207, s95, v23
    s_add_u32 s14, s13, 1622016
    buffer_load_dwordx4 a[196:199], v184, s[44:47], s14 offen
    v_pk_mul_f32 v[200:201], v[200:201], v[166:167]
    v_pk_mul_f32 v[202:203], v[202:203], v[166:167]
    v_pk_mul_f32 v[204:205], v[204:205], v[166:167]
    v_pk_mul_f32 v[206:207], v[206:207], v[166:167]
    v_cvt_pk_bf16_f32 v20, v200, v201
    v_cvt_pk_bf16_f32 v21, v202, v203
    v_cvt_pk_bf16_f32 v22, v204, v205
    v_cvt_pk_bf16_f32 v23, v206, v207
    ds_write_b64 v197, v[20:21] offset:18432
    ds_write_b64 v198, v[22:23] offset:18432
    v_lshlrev_b32 v200, 16, v24
    v_and_b32 v201, s95, v24
    v_lshlrev_b32 v202, 16, v25
    v_and_b32 v203, s95, v25
    v_lshlrev_b32 v204, 16, v26
    v_and_b32 v205, s95, v26
    v_lshlrev_b32 v206, 16, v27
    v_and_b32 v207, s95, v27
    s_add_u32 s14, s13, 1622016
    buffer_load_dwordx4 a[200:203], v185, s[44:47], s14 offen
    v_pk_add_f32 v[200:201], v[200:201], v[160:161]
    v_pk_add_f32 v[202:203], v[202:203], v[160:161]
    v_pk_add_f32 v[204:205], v[204:205], v[160:161]
    v_pk_add_f32 v[206:207], v[206:207], v[160:161]
    v_cvt_pk_bf16_f32 v24, v200, v201
    v_cvt_pk_bf16_f32 v25, v202, v203
    v_cvt_pk_bf16_f32 v26, v204, v205
    v_cvt_pk_bf16_f32 v27, v206, v207
    v_lshlrev_b32 v200, 16, v24
    v_and_b32 v201, s95, v24
    v_lshlrev_b32 v202, 16, v25
    v_and_b32 v203, s95, v25
    v_lshlrev_b32 v204, 16, v26
    v_and_b32 v205, s95, v26
    v_lshlrev_b32 v206, 16, v27
    v_and_b32 v207, s95, v27
    s_add_u32 s14, s13, 1622016
    buffer_load_dwordx4 a[204:207], v186, s[44:47], s14 offen
    v_pk_mul_f32 v[200:201], v[200:201], v[166:167]
    v_pk_mul_f32 v[202:203], v[202:203], v[166:167]
    v_pk_mul_f32 v[204:205], v[204:205], v[166:167]
    v_pk_mul_f32 v[206:207], v[206:207], v[166:167]
    v_cvt_pk_bf16_f32 v24, v200, v201
    v_cvt_pk_bf16_f32 v25, v202, v203
    v_cvt_pk_bf16_f32 v26, v204, v205
    v_cvt_pk_bf16_f32 v27, v206, v207
    ds_write_b64 v195, v[24:25] offset:19456
    ds_write_b64 v196, v[26:27] offset:19456
    v_lshlrev_b32 v200, 16, v28
    v_and_b32 v201, s95, v28
    v_lshlrev_b32 v202, 16, v29
    v_and_b32 v203, s95, v29
    v_lshlrev_b32 v204, 16, v30
    v_and_b32 v205, s95, v30
    v_lshlrev_b32 v206, 16, v31
    v_and_b32 v207, s95, v31
    s_xor_b32 s10, s38, 1
    s_lshl_b32 s10, s10, 15
    s_add_u32 s10, s10, s56
    buffer_store_dwordx4 v[12:15], v8, s[52:55], s10 offen offset:0 sc1
    v_pk_add_f32 v[200:201], v[200:201], v[160:161]
    v_pk_add_f32 v[202:203], v[202:203], v[160:161]
    v_pk_add_f32 v[204:205], v[204:205], v[160:161]
    v_pk_add_f32 v[206:207], v[206:207], v[160:161]
    v_cvt_pk_bf16_f32 v28, v200, v201
    v_cvt_pk_bf16_f32 v29, v202, v203
    v_cvt_pk_bf16_f32 v30, v204, v205
    v_cvt_pk_bf16_f32 v31, v206, v207
    v_lshlrev_b32 v200, 16, v28
    v_and_b32 v201, s95, v28
    v_lshlrev_b32 v202, 16, v29
    v_and_b32 v203, s95, v29
    v_lshlrev_b32 v204, 16, v30
    v_and_b32 v205, s95, v30
    v_lshlrev_b32 v206, 16, v31
    v_and_b32 v207, s95, v31
    s_xor_b32 s10, s38, 1
    s_lshl_b32 s10, s10, 15
    s_add_u32 s10, s10, s56
    buffer_store_dwordx4 v[12:15], v8, s[52:55], s10 offen offset:1024 sc1
    v_pk_mul_f32 v[200:201], v[200:201], v[166:167]
    v_pk_mul_f32 v[202:203], v[202:203], v[166:167]
    v_pk_mul_f32 v[204:205], v[204:205], v[166:167]
    v_pk_mul_f32 v[206:207], v[206:207], v[166:167]
    v_cvt_pk_bf16_f32 v28, v200, v201
    v_cvt_pk_bf16_f32 v29, v202, v203
    v_cvt_pk_bf16_f32 v30, v204, v205
    v_cvt_pk_bf16_f32 v31, v206, v207
    ds_write_b64 v197, v[28:29] offset:19456
    ds_write_b64 v198, v[30:31] offset:19456
    v_lshlrev_b32 v200, 16, v32
    v_and_b32 v201, s95, v32
    v_lshlrev_b32 v202, 16, v33
    v_and_b32 v203, s95, v33
    v_lshlrev_b32 v204, 16, v34
    v_and_b32 v205, s95, v34
    v_lshlrev_b32 v206, 16, v35
    v_and_b32 v207, s95, v35
    s_xor_b32 s10, s38, 1
    s_lshl_b32 s10, s10, 12
    s_add_u32 s10, s10, s63
    buffer_store_dwordx4 v[12:15], v8, s[52:55], s10 offen sc1
    v_pk_add_f32 v[200:201], v[200:201], v[160:161]
    v_pk_add_f32 v[202:203], v[202:203], v[160:161]
    v_pk_add_f32 v[204:205], v[204:205], v[160:161]
    v_pk_add_f32 v[206:207], v[206:207], v[160:161]
    v_cvt_pk_bf16_f32 v32, v200, v201
    v_cvt_pk_bf16_f32 v33, v202, v203
    v_cvt_pk_bf16_f32 v34, v204, v205
    v_cvt_pk_bf16_f32 v35, v206, v207
    v_lshlrev_b32 v200, 16, v32
    v_and_b32 v201, s95, v32
    v_lshlrev_b32 v202, 16, v33
    v_and_b32 v203, s95, v33
    v_lshlrev_b32 v204, 16, v34
    v_and_b32 v205, s95, v34
    v_lshlrev_b32 v206, 16, v35
    v_and_b32 v207, s95, v35
    s_xor_b32 s10, s38, 2
    s_lshl_b32 s10, s10, 15
    s_add_u32 s10, s10, s56
    buffer_store_dwordx4 v[12:15], v8, s[52:55], s10 offen offset:0 sc1
    v_pk_mul_f32 v[200:201], v[200:201], v[166:167]
    v_pk_mul_f32 v[202:203], v[202:203], v[166:167]
    v_pk_mul_f32 v[204:205], v[204:205], v[166:167]
    v_pk_mul_f32 v[206:207], v[206:207], v[166:167]
    v_cvt_pk_bf16_f32 v32, v200, v201
    v_cvt_pk_bf16_f32 v33, v202, v203
    v_cvt_pk_bf16_f32 v34, v204, v205
    v_cvt_pk_bf16_f32 v35, v206, v207
    ds_write_b64 v195, v[32:33] offset:20480
    ds_write_b64 v196, v[34:35] offset:20480
    v_lshlrev_b32 v200, 16, v36
    v_and_b32 v201, s95, v36
    v_lshlrev_b32 v202, 16, v37
    v_and_b32 v203, s95, v37
    v_lshlrev_b32 v204, 16, v38
    v_and_b32 v205, s95, v38
    v_lshlrev_b32 v206, 16, v39
    v_and_b32 v207, s95, v39
    s_xor_b32 s10, s38, 2
    s_lshl_b32 s10, s10, 15
    s_add_u32 s10, s10, s56
    buffer_store_dwordx4 v[12:15], v8, s[52:55], s10 offen offset:1024 sc1
    v_pk_add_f32 v[200:201], v[200:201], v[160:161]
    v_pk_add_f32 v[202:203], v[202:203], v[160:161]
    v_pk_add_f32 v[204:205], v[204:205], v[160:161]
    v_pk_add_f32 v[206:207], v[206:207], v[160:161]
    v_cvt_pk_bf16_f32 v36, v200, v201
    v_cvt_pk_bf16_f32 v37, v202, v203
    v_cvt_pk_bf16_f32 v38, v204, v205
    v_cvt_pk_bf16_f32 v39, v206, v207
    v_lshlrev_b32 v200, 16, v36
    v_and_b32 v201, s95, v36
    v_lshlrev_b32 v202, 16, v37
    v_and_b32 v203, s95, v37
    v_lshlrev_b32 v204, 16, v38
    v_and_b32 v205, s95, v38
    v_lshlrev_b32 v206, 16, v39
    v_and_b32 v207, s95, v39
    s_xor_b32 s10, s38, 2
    s_lshl_b32 s10, s10, 12
    s_add_u32 s10, s10, s63
    buffer_store_dwordx4 v[12:15], v8, s[52:55], s10 offen sc1
    v_pk_mul_f32 v[200:201], v[200:201], v[166:167]
    v_pk_mul_f32 v[202:203], v[202:203], v[166:167]
    v_pk_mul_f32 v[204:205], v[204:205], v[166:167]
    v_pk_mul_f32 v[206:207], v[206:207], v[166:167]
    v_cvt_pk_bf16_f32 v36, v200, v201
    v_cvt_pk_bf16_f32 v37, v202, v203
    v_cvt_pk_bf16_f32 v38, v204, v205
    v_cvt_pk_bf16_f32 v39, v206, v207
    ds_write_b64 v197, v[36:37] offset:20480
    ds_write_b64 v198, v[38:39] offset:20480
    v_lshlrev_b32 v200, 16, v40
    v_and_b32 v201, s95, v40
    v_lshlrev_b32 v202, 16, v41
    v_and_b32 v203, s95, v41
    v_lshlrev_b32 v204, 16, v42
    v_and_b32 v205, s95, v42
    v_lshlrev_b32 v206, 16, v43
    v_and_b32 v207, s95, v43
    s_xor_b32 s10, s38, 3
    s_lshl_b32 s10, s10, 15
    s_add_u32 s10, s10, s56
    buffer_store_dwordx4 v[12:15], v8, s[52:55], s10 offen offset:0 sc1
    v_pk_add_f32 v[200:201], v[200:201], v[160:161]
    v_pk_add_f32 v[202:203], v[202:203], v[160:161]
    v_pk_add_f32 v[204:205], v[204:205], v[160:161]
    v_pk_add_f32 v[206:207], v[206:207], v[160:161]
    v_cvt_pk_bf16_f32 v40, v200, v201
    v_cvt_pk_bf16_f32 v41, v202, v203
    v_cvt_pk_bf16_f32 v42, v204, v205
    v_cvt_pk_bf16_f32 v43, v206, v207
    v_lshlrev_b32 v200, 16, v40
    v_and_b32 v201, s95, v40
    v_lshlrev_b32 v202, 16, v41
    v_and_b32 v203, s95, v41
    v_lshlrev_b32 v204, 16, v42
    v_and_b32 v205, s95, v42
    v_lshlrev_b32 v206, 16, v43
    v_and_b32 v207, s95, v43
    s_xor_b32 s10, s38, 3
    s_lshl_b32 s10, s10, 15
    s_add_u32 s10, s10, s56
    buffer_store_dwordx4 v[12:15], v8, s[52:55], s10 offen offset:1024 sc1
    v_pk_mul_f32 v[200:201], v[200:201], v[166:167]
    v_pk_mul_f32 v[202:203], v[202:203], v[166:167]
    v_pk_mul_f32 v[204:205], v[204:205], v[166:167]
    v_pk_mul_f32 v[206:207], v[206:207], v[166:167]
    v_cvt_pk_bf16_f32 v40, v200, v201
    v_cvt_pk_bf16_f32 v41, v202, v203
    v_cvt_pk_bf16_f32 v42, v204, v205
    v_cvt_pk_bf16_f32 v43, v206, v207
    ds_write_b64 v195, v[40:41] offset:21504
    ds_write_b64 v196, v[42:43] offset:21504
    v_lshlrev_b32 v200, 16, v44
    v_and_b32 v201, s95, v44
    v_lshlrev_b32 v202, 16, v45
    v_and_b32 v203, s95, v45
    v_lshlrev_b32 v204, 16, v46
    v_and_b32 v205, s95, v46
    v_lshlrev_b32 v206, 16, v47
    v_and_b32 v207, s95, v47
    s_xor_b32 s10, s38, 3
    s_lshl_b32 s10, s10, 12
    s_add_u32 s10, s10, s63
    buffer_store_dwordx4 v[12:15], v8, s[52:55], s10 offen sc1
    v_pk_add_f32 v[200:201], v[200:201], v[160:161]
    v_pk_add_f32 v[202:203], v[202:203], v[160:161]
    v_pk_add_f32 v[204:205], v[204:205], v[160:161]
    v_pk_add_f32 v[206:207], v[206:207], v[160:161]
    v_cvt_pk_bf16_f32 v44, v200, v201
    v_cvt_pk_bf16_f32 v45, v202, v203
    v_cvt_pk_bf16_f32 v46, v204, v205
    v_cvt_pk_bf16_f32 v47, v206, v207
    v_lshlrev_b32 v200, 16, v44
    v_and_b32 v201, s95, v44
    v_lshlrev_b32 v202, 16, v45
    v_and_b32 v203, s95, v45
    v_lshlrev_b32 v204, 16, v46
    v_and_b32 v205, s95, v46
    v_lshlrev_b32 v206, 16, v47
    v_and_b32 v207, s95, v47
    v_pk_mul_f32 v[200:201], v[200:201], v[166:167]
    v_pk_mul_f32 v[202:203], v[202:203], v[166:167]
    v_pk_mul_f32 v[204:205], v[204:205], v[166:167]
    v_pk_mul_f32 v[206:207], v[206:207], v[166:167]
    v_cvt_pk_bf16_f32 v44, v200, v201
    v_cvt_pk_bf16_f32 v45, v202, v203
    v_cvt_pk_bf16_f32 v46, v204, v205
    v_cvt_pk_bf16_f32 v47, v206, v207
    ds_write_b64 v197, v[44:45] offset:21504
    ds_write_b64 v198, v[46:47] offset:21504
    v_lshlrev_b32 v200, 16, v48
    v_and_b32 v201, s95, v48
    v_lshlrev_b32 v202, 16, v49
    v_and_b32 v203, s95, v49
    v_lshlrev_b32 v204, 16, v50
    v_and_b32 v205, s95, v50
    v_lshlrev_b32 v206, 16, v51
    v_and_b32 v207, s95, v51
    v_pk_add_f32 v[200:201], v[200:201], v[160:161]
    v_pk_add_f32 v[202:203], v[202:203], v[160:161]
    v_pk_add_f32 v[204:205], v[204:205], v[160:161]
    v_pk_add_f32 v[206:207], v[206:207], v[160:161]
    v_cvt_pk_bf16_f32 v48, v200, v201
    v_cvt_pk_bf16_f32 v49, v202, v203
    v_cvt_pk_bf16_f32 v50, v204, v205
    v_cvt_pk_bf16_f32 v51, v206, v207
    v_lshlrev_b32 v200, 16, v48
    v_and_b32 v201, s95, v48
    v_lshlrev_b32 v202, 16, v49
    v_and_b32 v203, s95, v49
    v_lshlrev_b32 v204, 16, v50
    v_and_b32 v205, s95, v50
    v_lshlrev_b32 v206, 16, v51
    v_and_b32 v207, s95, v51
    v_pk_mul_f32 v[200:201], v[200:201], v[166:167]
    v_pk_mul_f32 v[202:203], v[202:203], v[166:167]
    v_pk_mul_f32 v[204:205], v[204:205], v[166:167]
    v_pk_mul_f32 v[206:207], v[206:207], v[166:167]
    v_cvt_pk_bf16_f32 v48, v200, v201
    v_cvt_pk_bf16_f32 v49, v202, v203
    v_cvt_pk_bf16_f32 v50, v204, v205
    v_cvt_pk_bf16_f32 v51, v206, v207
    ds_write_b64 v195, v[48:49] offset:22528
    ds_write_b64 v196, v[50:51] offset:22528
    v_lshlrev_b32 v200, 16, v52
    v_and_b32 v201, s95, v52
    v_lshlrev_b32 v202, 16, v53
    v_and_b32 v203, s95, v53
    v_lshlrev_b32 v204, 16, v54
    v_and_b32 v205, s95, v54
    v_lshlrev_b32 v206, 16, v55
    v_and_b32 v207, s95, v55
    v_pk_add_f32 v[200:201], v[200:201], v[160:161]
    v_pk_add_f32 v[202:203], v[202:203], v[160:161]
    v_pk_add_f32 v[204:205], v[204:205], v[160:161]
    v_pk_add_f32 v[206:207], v[206:207], v[160:161]
    v_cvt_pk_bf16_f32 v52, v200, v201
    v_cvt_pk_bf16_f32 v53, v202, v203
    v_cvt_pk_bf16_f32 v54, v204, v205
    v_cvt_pk_bf16_f32 v55, v206, v207
    v_lshlrev_b32 v200, 16, v52
    v_and_b32 v201, s95, v52
    v_lshlrev_b32 v202, 16, v53
    v_and_b32 v203, s95, v53
    v_lshlrev_b32 v204, 16, v54
    v_and_b32 v205, s95, v54
    v_lshlrev_b32 v206, 16, v55
    v_and_b32 v207, s95, v55
    v_pk_mul_f32 v[200:201], v[200:201], v[166:167]
    v_pk_mul_f32 v[202:203], v[202:203], v[166:167]
    v_pk_mul_f32 v[204:205], v[204:205], v[166:167]
    v_pk_mul_f32 v[206:207], v[206:207], v[166:167]
    v_cvt_pk_bf16_f32 v52, v200, v201
    v_cvt_pk_bf16_f32 v53, v202, v203
    v_cvt_pk_bf16_f32 v54, v204, v205
    v_cvt_pk_bf16_f32 v55, v206, v207
    ds_write_b64 v197, v[52:53] offset:22528
    ds_write_b64 v198, v[54:55] offset:22528
    v_lshlrev_b32 v200, 16, v56
    v_and_b32 v201, s95, v56
    v_lshlrev_b32 v202, 16, v57
    v_and_b32 v203, s95, v57
    v_lshlrev_b32 v204, 16, v58
    v_and_b32 v205, s95, v58
    v_lshlrev_b32 v206, 16, v59
    v_and_b32 v207, s95, v59
    v_pk_add_f32 v[200:201], v[200:201], v[160:161]
    v_pk_add_f32 v[202:203], v[202:203], v[160:161]
    v_pk_add_f32 v[204:205], v[204:205], v[160:161]
    v_pk_add_f32 v[206:207], v[206:207], v[160:161]
    v_cvt_pk_bf16_f32 v56, v200, v201
    v_cvt_pk_bf16_f32 v57, v202, v203
    v_cvt_pk_bf16_f32 v58, v204, v205
    v_cvt_pk_bf16_f32 v59, v206, v207
    v_lshlrev_b32 v200, 16, v56
    v_and_b32 v201, s95, v56
    v_lshlrev_b32 v202, 16, v57
    v_and_b32 v203, s95, v57
    v_lshlrev_b32 v204, 16, v58
    v_and_b32 v205, s95, v58
    v_lshlrev_b32 v206, 16, v59
    v_and_b32 v207, s95, v59
    v_pk_mul_f32 v[200:201], v[200:201], v[166:167]
    v_pk_mul_f32 v[202:203], v[202:203], v[166:167]
    v_pk_mul_f32 v[204:205], v[204:205], v[166:167]
    v_pk_mul_f32 v[206:207], v[206:207], v[166:167]
    v_cvt_pk_bf16_f32 v56, v200, v201
    v_cvt_pk_bf16_f32 v57, v202, v203
    v_cvt_pk_bf16_f32 v58, v204, v205
    v_cvt_pk_bf16_f32 v59, v206, v207
    ds_write_b64 v195, v[56:57] offset:23552
    ds_write_b64 v196, v[58:59] offset:23552
    v_lshlrev_b32 v200, 16, v60
    v_and_b32 v201, s95, v60
    v_lshlrev_b32 v202, 16, v61
    v_and_b32 v203, s95, v61
    v_lshlrev_b32 v204, 16, v62
    v_and_b32 v205, s95, v62
    v_lshlrev_b32 v206, 16, v63
    v_and_b32 v207, s95, v63
    v_pk_add_f32 v[200:201], v[200:201], v[160:161]
    v_pk_add_f32 v[202:203], v[202:203], v[160:161]
    v_pk_add_f32 v[204:205], v[204:205], v[160:161]
    v_pk_add_f32 v[206:207], v[206:207], v[160:161]
    v_cvt_pk_bf16_f32 v60, v200, v201
    v_cvt_pk_bf16_f32 v61, v202, v203
    v_cvt_pk_bf16_f32 v62, v204, v205
    v_cvt_pk_bf16_f32 v63, v206, v207
    v_lshlrev_b32 v200, 16, v60
    v_and_b32 v201, s95, v60
    v_lshlrev_b32 v202, 16, v61
    v_and_b32 v203, s95, v61
    v_lshlrev_b32 v204, 16, v62
    v_and_b32 v205, s95, v62
    v_lshlrev_b32 v206, 16, v63
    v_and_b32 v207, s95, v63
    v_pk_mul_f32 v[200:201], v[200:201], v[166:167]
    v_pk_mul_f32 v[202:203], v[202:203], v[166:167]
    v_pk_mul_f32 v[204:205], v[204:205], v[166:167]
    v_pk_mul_f32 v[206:207], v[206:207], v[166:167]
    v_cvt_pk_bf16_f32 v60, v200, v201
    v_cvt_pk_bf16_f32 v61, v202, v203
    v_cvt_pk_bf16_f32 v62, v204, v205
    v_cvt_pk_bf16_f32 v63, v206, v207
    ds_write_b64 v197, v[60:61] offset:23552
    ds_write_b64 v198, v[62:63] offset:23552
    v_lshlrev_b32 v200, 16, v64
    v_and_b32 v201, s95, v64
    v_lshlrev_b32 v202, 16, v65
    v_and_b32 v203, s95, v65
    v_lshlrev_b32 v204, 16, v66
    v_and_b32 v205, s95, v66
    v_lshlrev_b32 v206, 16, v67
    v_and_b32 v207, s95, v67
    v_pk_add_f32 v[200:201], v[200:201], v[160:161]
    v_pk_add_f32 v[202:203], v[202:203], v[160:161]
    v_pk_add_f32 v[204:205], v[204:205], v[160:161]
    v_pk_add_f32 v[206:207], v[206:207], v[160:161]
    v_cvt_pk_bf16_f32 v64, v200, v201
    v_cvt_pk_bf16_f32 v65, v202, v203
    v_cvt_pk_bf16_f32 v66, v204, v205
    v_cvt_pk_bf16_f32 v67, v206, v207
    v_lshlrev_b32 v200, 16, v64
    v_and_b32 v201, s95, v64
    v_lshlrev_b32 v202, 16, v65
    v_and_b32 v203, s95, v65
    v_lshlrev_b32 v204, 16, v66
    v_and_b32 v205, s95, v66
    v_lshlrev_b32 v206, 16, v67
    v_and_b32 v207, s95, v67
    v_pk_mul_f32 v[200:201], v[200:201], v[166:167]
    v_pk_mul_f32 v[202:203], v[202:203], v[166:167]
    v_pk_mul_f32 v[204:205], v[204:205], v[166:167]
    v_pk_mul_f32 v[206:207], v[206:207], v[166:167]
    v_cvt_pk_bf16_f32 v64, v200, v201
    v_cvt_pk_bf16_f32 v65, v202, v203
    v_cvt_pk_bf16_f32 v66, v204, v205
    v_cvt_pk_bf16_f32 v67, v206, v207
    ds_write_b64 v195, v[64:65] offset:24576
    ds_write_b64 v196, v[66:67] offset:24576
    v_lshlrev_b32 v200, 16, v68
    v_and_b32 v201, s95, v68
    v_lshlrev_b32 v202, 16, v69
    v_and_b32 v203, s95, v69
    v_lshlrev_b32 v204, 16, v70
    v_and_b32 v205, s95, v70
    v_lshlrev_b32 v206, 16, v71
    v_and_b32 v207, s95, v71
    v_pk_add_f32 v[200:201], v[200:201], v[160:161]
    v_pk_add_f32 v[202:203], v[202:203], v[160:161]
    v_pk_add_f32 v[204:205], v[204:205], v[160:161]
    v_pk_add_f32 v[206:207], v[206:207], v[160:161]
    v_cvt_pk_bf16_f32 v68, v200, v201
    v_cvt_pk_bf16_f32 v69, v202, v203
    v_cvt_pk_bf16_f32 v70, v204, v205
    v_cvt_pk_bf16_f32 v71, v206, v207
    v_lshlrev_b32 v200, 16, v68
    v_and_b32 v201, s95, v68
    v_lshlrev_b32 v202, 16, v69
    v_and_b32 v203, s95, v69
    v_lshlrev_b32 v204, 16, v70
    v_and_b32 v205, s95, v70
    v_lshlrev_b32 v206, 16, v71
    v_and_b32 v207, s95, v71
    v_pk_mul_f32 v[200:201], v[200:201], v[166:167]
    v_pk_mul_f32 v[202:203], v[202:203], v[166:167]
    v_pk_mul_f32 v[204:205], v[204:205], v[166:167]
    v_pk_mul_f32 v[206:207], v[206:207], v[166:167]
    v_cvt_pk_bf16_f32 v68, v200, v201
    v_cvt_pk_bf16_f32 v69, v202, v203
    v_cvt_pk_bf16_f32 v70, v204, v205
    v_cvt_pk_bf16_f32 v71, v206, v207
    ds_write_b64 v197, v[68:69] offset:24576
    ds_write_b64 v198, v[70:71] offset:24576
    v_lshlrev_b32 v200, 16, v72
    v_and_b32 v201, s95, v72
    v_lshlrev_b32 v202, 16, v73
    v_and_b32 v203, s95, v73
    v_lshlrev_b32 v204, 16, v74
    v_and_b32 v205, s95, v74
    v_lshlrev_b32 v206, 16, v75
    v_and_b32 v207, s95, v75
    v_pk_add_f32 v[200:201], v[200:201], v[160:161]
    v_pk_add_f32 v[202:203], v[202:203], v[160:161]
    v_pk_add_f32 v[204:205], v[204:205], v[160:161]
    v_pk_add_f32 v[206:207], v[206:207], v[160:161]
    v_cvt_pk_bf16_f32 v72, v200, v201
    v_cvt_pk_bf16_f32 v73, v202, v203
    v_cvt_pk_bf16_f32 v74, v204, v205
    v_cvt_pk_bf16_f32 v75, v206, v207
    v_lshlrev_b32 v200, 16, v72
    v_and_b32 v201, s95, v72
    v_lshlrev_b32 v202, 16, v73
    v_and_b32 v203, s95, v73
    v_lshlrev_b32 v204, 16, v74
    v_and_b32 v205, s95, v74
    v_lshlrev_b32 v206, 16, v75
    v_and_b32 v207, s95, v75
    v_pk_mul_f32 v[200:201], v[200:201], v[166:167]
    v_pk_mul_f32 v[202:203], v[202:203], v[166:167]
    v_pk_mul_f32 v[204:205], v[204:205], v[166:167]
    v_pk_mul_f32 v[206:207], v[206:207], v[166:167]
    v_cvt_pk_bf16_f32 v72, v200, v201
    v_cvt_pk_bf16_f32 v73, v202, v203
    v_cvt_pk_bf16_f32 v74, v204, v205
    v_cvt_pk_bf16_f32 v75, v206, v207
    ds_write_b64 v195, v[72:73] offset:25600
    ds_write_b64 v196, v[74:75] offset:25600
    v_lshlrev_b32 v200, 16, v76
    v_and_b32 v201, s95, v76
    v_lshlrev_b32 v202, 16, v77
    v_and_b32 v203, s95, v77
    v_lshlrev_b32 v204, 16, v78
    v_and_b32 v205, s95, v78
    v_lshlrev_b32 v206, 16, v79
    v_and_b32 v207, s95, v79
    v_pk_add_f32 v[200:201], v[200:201], v[160:161]
    v_pk_add_f32 v[202:203], v[202:203], v[160:161]
    v_pk_add_f32 v[204:205], v[204:205], v[160:161]
    v_pk_add_f32 v[206:207], v[206:207], v[160:161]
    v_cvt_pk_bf16_f32 v76, v200, v201
    v_cvt_pk_bf16_f32 v77, v202, v203
    v_cvt_pk_bf16_f32 v78, v204, v205
    v_cvt_pk_bf16_f32 v79, v206, v207
    v_lshlrev_b32 v200, 16, v76
    v_and_b32 v201, s95, v76
    v_lshlrev_b32 v202, 16, v77
    v_and_b32 v203, s95, v77
    v_lshlrev_b32 v204, 16, v78
    v_and_b32 v205, s95, v78
    v_lshlrev_b32 v206, 16, v79
    v_and_b32 v207, s95, v79
    v_pk_mul_f32 v[200:201], v[200:201], v[166:167]
    v_pk_mul_f32 v[202:203], v[202:203], v[166:167]
    v_pk_mul_f32 v[204:205], v[204:205], v[166:167]
    v_pk_mul_f32 v[206:207], v[206:207], v[166:167]
    v_cvt_pk_bf16_f32 v76, v200, v201
    v_cvt_pk_bf16_f32 v77, v202, v203
    v_cvt_pk_bf16_f32 v78, v204, v205
    v_cvt_pk_bf16_f32 v79, v206, v207
    ds_write_b64 v197, v[76:77] offset:25600
    ds_write_b64 v198, v[78:79] offset:25600
    v_lshlrev_b32 v200, 16, v80
    v_and_b32 v201, s95, v80
    v_lshlrev_b32 v202, 16, v81
    v_and_b32 v203, s95, v81
    v_lshlrev_b32 v204, 16, v82
    v_and_b32 v205, s95, v82
    v_lshlrev_b32 v206, 16, v83
    v_and_b32 v207, s95, v83
    v_pk_add_f32 v[200:201], v[200:201], v[160:161]
    v_pk_add_f32 v[202:203], v[202:203], v[160:161]
    v_pk_add_f32 v[204:205], v[204:205], v[160:161]
    v_pk_add_f32 v[206:207], v[206:207], v[160:161]
    v_cvt_pk_bf16_f32 v80, v200, v201
    v_cvt_pk_bf16_f32 v81, v202, v203
    v_cvt_pk_bf16_f32 v82, v204, v205
    v_cvt_pk_bf16_f32 v83, v206, v207
    v_lshlrev_b32 v200, 16, v80
    v_and_b32 v201, s95, v80
    v_lshlrev_b32 v202, 16, v81
    v_and_b32 v203, s95, v81
    v_lshlrev_b32 v204, 16, v82
    v_and_b32 v205, s95, v82
    v_lshlrev_b32 v206, 16, v83
    v_and_b32 v207, s95, v83
    v_pk_mul_f32 v[200:201], v[200:201], v[166:167]
    v_pk_mul_f32 v[202:203], v[202:203], v[166:167]
    v_pk_mul_f32 v[204:205], v[204:205], v[166:167]
    v_pk_mul_f32 v[206:207], v[206:207], v[166:167]
    v_cvt_pk_bf16_f32 v80, v200, v201
    v_cvt_pk_bf16_f32 v81, v202, v203
    v_cvt_pk_bf16_f32 v82, v204, v205
    v_cvt_pk_bf16_f32 v83, v206, v207
    ds_write_b64 v195, v[80:81] offset:26624
    ds_write_b64 v196, v[82:83] offset:26624
    v_lshlrev_b32 v200, 16, v84
    v_and_b32 v201, s95, v84
    v_lshlrev_b32 v202, 16, v85
    v_and_b32 v203, s95, v85
    v_lshlrev_b32 v204, 16, v86
    v_and_b32 v205, s95, v86
    v_lshlrev_b32 v206, 16, v87
    v_and_b32 v207, s95, v87
    v_pk_add_f32 v[200:201], v[200:201], v[160:161]
    v_pk_add_f32 v[202:203], v[202:203], v[160:161]
    v_pk_add_f32 v[204:205], v[204:205], v[160:161]
    v_pk_add_f32 v[206:207], v[206:207], v[160:161]
    v_cvt_pk_bf16_f32 v84, v200, v201
    v_cvt_pk_bf16_f32 v85, v202, v203
    v_cvt_pk_bf16_f32 v86, v204, v205
    v_cvt_pk_bf16_f32 v87, v206, v207
    v_lshlrev_b32 v200, 16, v84
    v_and_b32 v201, s95, v84
    v_lshlrev_b32 v202, 16, v85
    v_and_b32 v203, s95, v85
    v_lshlrev_b32 v204, 16, v86
    v_and_b32 v205, s95, v86
    v_lshlrev_b32 v206, 16, v87
    v_and_b32 v207, s95, v87
    v_pk_mul_f32 v[200:201], v[200:201], v[166:167]
    v_pk_mul_f32 v[202:203], v[202:203], v[166:167]
    v_pk_mul_f32 v[204:205], v[204:205], v[166:167]
    v_pk_mul_f32 v[206:207], v[206:207], v[166:167]
    v_cvt_pk_bf16_f32 v84, v200, v201
    v_cvt_pk_bf16_f32 v85, v202, v203
    v_cvt_pk_bf16_f32 v86, v204, v205
    v_cvt_pk_bf16_f32 v87, v206, v207
    ds_write_b64 v197, v[84:85] offset:26624
    ds_write_b64 v198, v[86:87] offset:26624
    v_mov_b32 v4, v192
    v_xor_b32 v5, 64, v192
    v_add_u32 v6, 55296, v4
    v_add_u32 v7, 55296, v5
    v_add_u32 v8, 110592, v4
    v_add_u32 v9, 110592, v5
    v_mov_b32 v10, v184
    v_mov_b32 v13, v187
    v_mov_b32 v11, v185
    v_mov_b32 v14, v188
    v_mov_b32 v12, v186
    v_mov_b32 v15, v189
    v_mov_b32 v2, v190
    s_waitcnt vmcnt(44)
    ds_write_b128 v13, a[64:67]
    s_waitcnt vmcnt(43)
    ds_write_b128 v14, a[68:71]
    s_waitcnt vmcnt(42)
    ds_write_b128 v15, a[72:75]
    ds_read_b64_tr_b16 v[208:209], v2 offset:0
    ds_read_b64_tr_b16 v[212:213], v2 offset:544
    ds_read_b64_tr_b16 v[216:217], v2 offset:1088
    ds_read_b64_tr_b16 v[220:221], v2 offset:1632
    ds_read_b64_tr_b16 v[224:225], v2 offset:2176
    ds_read_b64_tr_b16 v[228:229], v2 offset:2720
    s_waitcnt vmcnt(41)
    ds_write_b128 v13, a[76:79]
    s_waitcnt vmcnt(40)
    ds_write_b128 v14, a[80:83]
    s_waitcnt vmcnt(39)
    ds_write_b128 v15, a[84:87]
    ds_read_b64_tr_b16 v[210:211], v2 offset:0
    ds_read_b64_tr_b16 v[214:215], v2 offset:544
    ds_read_b64_tr_b16 v[218:219], v2 offset:1088
    ds_read_b64_tr_b16 v[222:223], v2 offset:1632
    ds_read_b64_tr_b16 v[226:227], v2 offset:2176
    ds_read_b64_tr_b16 v[230:231], v2 offset:2720
    s_waitcnt lgkmcnt(0)
    s_barrier
    ds_read_b128 a[0:3], v4 offset:0
    ds_read_b128 a[4:7], v4 offset:18432
    ds_read_b128 a[8:11], v4 offset:36864
    ds_read_b128 a[12:15], v6 offset:0
    ds_read_b128 a[16:19], v6 offset:18432
    ds_read_b128 a[20:23], v6 offset:36864
    ds_read_b128 a[24:27], v8 offset:0
    ds_read_b128 a[28:31], v8 offset:18432
    s_waitcnt lgkmcnt(7)
    v_mfma_f32_16x16x32_bf16 v[16:19], v[208:211], a[0:3], 0
    s_waitcnt lgkmcnt(6)
    v_mfma_f32_16x16x32_bf16 v[40:43], v[208:211], a[4:7], 0
    s_waitcnt vmcnt(38)
    ds_write_b128 v13, a[88:91]
    s_waitcnt lgkmcnt(6)
    v_mfma_f32_16x16x32_bf16 v[64:67], v[208:211], a[8:11], 0
    s_add_u32 s14, s13, 1769472
    buffer_load_dwordx4 a[64:67], v10, s[44:47], s14 offen
    s_waitcnt lgkmcnt(5)
    v_mfma_f32_16x16x32_bf16 v[88:91], v[208:211], a[12:15], 0
    ds_read_b128 a[32:35], v5 offset:0
    s_waitcnt lgkmcnt(5)
    v_mfma_f32_16x16x32_bf16 v[112:115], v[208:211], a[16:19], 0
    ds_read_b128 a[36:39], v5 offset:18432
    s_waitcnt lgkmcnt(5)
    v_mfma_f32_16x16x32_bf16 v[136:139], v[208:211], a[20:23], 0
    s_waitcnt vmcnt(38)
    ds_write_b128 v14, a[92:95]
    s_waitcnt lgkmcnt(5)
    v_mfma_f32_16x16x32_bf16 v[160:163], v[208:211], a[24:27], 0
    s_add_u32 s14, s13, 1769472
    buffer_load_dwordx4 a[68:71], v11, s[44:47], s14 offen
    s_waitcnt lgkmcnt(4)
    v_mfma_f32_16x16x32_bf16 v[184:187], v[208:211], a[28:31], 0
    ds_read_b128 a[40:43], v5 offset:36864
    v_mfma_f32_16x16x32_bf16 v[20:23], v[212:215], a[0:3], 0
    ds_read_b128 a[44:47], v7 offset:0
    v_mfma_f32_16x16x32_bf16 v[44:47], v[212:215], a[4:7], 0
    s_waitcnt vmcnt(38)
    ds_write_b128 v15, a[96:99]
    v_mfma_f32_16x16x32_bf16 v[68:71], v[212:215], a[8:11], 0
    ds_read_b64_tr_b16 v[232:233], v2 offset:0
    v_mfma_f32_16x16x32_bf16 v[92:95], v[212:215], a[12:15], 0
    ds_read_b64_tr_b16 v[236:237], v2 offset:544
    v_mfma_f32_16x16x32_bf16 v[116:119], v[212:215], a[16:19], 0
    ds_read_b64_tr_b16 v[240:241], v2 offset:1088
    v_mfma_f32_16x16x32_bf16 v[140:143], v[212:215], a[20:23], 0
    ds_read_b64_tr_b16 v[244:245], v2 offset:1632
    v_mfma_f32_16x16x32_bf16 v[164:167], v[212:215], a[24:27], 0
    ds_read_b64_tr_b16 v[248:249], v2 offset:2176
    v_mfma_f32_16x16x32_bf16 v[188:191], v[212:215], a[28:31], 0
    ds_read_b64_tr_b16 v[252:253], v2 offset:2720
    v_mfma_f32_16x16x32_bf16 v[24:27], v[216:219], a[0:3], 0
    s_waitcnt vmcnt(37)
    ds_write_b128 v13, a[100:103]
    v_mfma_f32_16x16x32_bf16 v[48:51], v[216:219], a[4:7], 0
    s_add_u32 s14, s13, 1769472
    buffer_load_dwordx4 a[72:75], v12, s[44:47], s14 offen
    v_mfma_f32_16x16x32_bf16 v[72:75], v[216:219], a[8:11], 0
    ds_read_b128 a[48:51], v7 offset:18432
    v_mfma_f32_16x16x32_bf16 v[96:99], v[216:219], a[12:15], 0
    ds_read_b128 a[52:55], v7 offset:36864
    v_mfma_f32_16x16x32_bf16 v[120:123], v[216:219], a[16:19], 0
    s_waitcnt vmcnt(37)
    ds_write_b128 v14, a[104:107]
    v_mfma_f32_16x16x32_bf16 v[144:147], v[216:219], a[20:23], 0
    s_add_u32 s14, s13, 1916928
    buffer_load_dwordx4 a[76:79], v10, s[44:47], s14 offen
    v_mfma_f32_16x16x32_bf16 v[168:171], v[216:219], a[24:27], 0
    ds_read_b128 a[56:59], v9 offset:0
    v_mfma_f32_16x16x32_bf16 v[192:195], v[216:219], a[28:31], 0
    ds_read_b128 a[60:63], v9 offset:18432
    v_mfma_f32_16x16x32_bf16 v[28:31], v[220:223], a[0:3], 0
    s_waitcnt vmcnt(37)
    ds_write_b128 v15, a[108:111]
    v_mfma_f32_16x16x32_bf16 v[52:55], v[220:223], a[4:7], 0
    ds_read_b64_tr_b16 v[234:235], v2 offset:0
    v_mfma_f32_16x16x32_bf16 v[76:79], v[220:223], a[8:11], 0
    ds_read_b64_tr_b16 v[238:239], v2 offset:544
    v_mfma_f32_16x16x32_bf16 v[100:103], v[220:223], a[12:15], 0
    ds_read_b64_tr_b16 v[242:243], v2 offset:1088
    v_mfma_f32_16x16x32_bf16 v[124:127], v[220:223], a[16:19], 0
    ds_read_b64_tr_b16 v[246:247], v2 offset:1632
    v_mfma_f32_16x16x32_bf16 v[148:151], v[220:223], a[20:23], 0
    ds_read_b64_tr_b16 v[250:251], v2 offset:2176
    v_mfma_f32_16x16x32_bf16 v[172:175], v[220:223], a[24:27], 0
    ds_read_b64_tr_b16 v[254:255], v2 offset:2720
    v_mfma_f32_16x16x32_bf16 v[196:199], v[220:223], a[28:31], 0
    s_add_u32 s14, s13, 1916928
    buffer_load_dwordx4 a[80:83], v11, s[44:47], s14 offen
    v_mfma_f32_16x16x32_bf16 v[32:35], v[224:227], a[0:3], 0
    v_mfma_f32_16x16x32_bf16 v[56:59], v[224:227], a[4:7], 0
    v_mfma_f32_16x16x32_bf16 v[80:83], v[224:227], a[8:11], 0
    v_mfma_f32_16x16x32_bf16 v[104:107], v[224:227], a[12:15], 0
    s_add_u32 s14, s13, 1916928
    buffer_load_dwordx4 a[84:87], v12, s[44:47], s14 offen
    v_mfma_f32_16x16x32_bf16 v[128:131], v[224:227], a[16:19], 0
    v_mfma_f32_16x16x32_bf16 v[152:155], v[224:227], a[20:23], 0
    v_mfma_f32_16x16x32_bf16 v[176:179], v[224:227], a[24:27], 0
    v_mfma_f32_16x16x32_bf16 v[200:203], v[224:227], a[28:31], 0
    s_add_u32 s14, s13, 2064384
    buffer_load_dwordx4 a[88:91], v10, s[44:47], s14 offen
    v_mfma_f32_16x16x32_bf16 v[36:39], v[228:231], a[0:3], 0
    v_mfma_f32_16x16x32_bf16 v[60:63], v[228:231], a[4:7], 0
    v_mfma_f32_16x16x32_bf16 v[84:87], v[228:231], a[8:11], 0
    v_mfma_f32_16x16x32_bf16 v[108:111], v[228:231], a[12:15], 0
    s_add_u32 s14, s13, 2064384
    buffer_load_dwordx4 a[92:95], v11, s[44:47], s14 offen
    v_mfma_f32_16x16x32_bf16 v[132:135], v[228:231], a[16:19], 0
    v_mfma_f32_16x16x32_bf16 v[156:159], v[228:231], a[20:23], 0
    v_mfma_f32_16x16x32_bf16 v[180:183], v[228:231], a[24:27], 0
    v_mfma_f32_16x16x32_bf16 v[204:207], v[228:231], a[28:31], 0
    s_add_u32 s14, s13, 2064384
    buffer_load_dwordx4 a[96:99], v12, s[44:47], s14 offen
    s_waitcnt lgkmcnt(5)
    v_mfma_f32_16x16x32_bf16 v[16:19], v[232:235], a[32:35], v[16:19]
    v_mfma_f32_16x16x32_bf16 v[40:43], v[232:235], a[36:39], v[40:43]
    s_waitcnt vmcnt(41)
    ds_write_b128 v13, a[112:115]
    v_mfma_f32_16x16x32_bf16 v[64:67], v[232:235], a[40:43], v[64:67]
    ds_read_b128 a[0:3], v4 offset:1024
    v_mfma_f32_16x16x32_bf16 v[88:91], v[232:235], a[44:47], v[88:91]
    s_add_u32 s14, s13, 2211840
    buffer_load_dwordx4 a[100:103], v10, s[44:47], s14 offen
    v_mfma_f32_16x16x32_bf16 v[112:115], v[232:235], a[48:51], v[112:115]
    ds_read_b128 a[4:7], v4 offset:19456
    v_mfma_f32_16x16x32_bf16 v[136:139], v[232:235], a[52:55], v[136:139]
    s_waitcnt vmcnt(41)
    ds_write_b128 v14, a[116:119]
    v_mfma_f32_16x16x32_bf16 v[160:163], v[232:235], a[56:59], v[160:163]
    ds_read_b128 a[8:11], v4 offset:37888
    v_mfma_f32_16x16x32_bf16 v[184:187], v[232:235], a[60:63], v[184:187]
    s_add_u32 s14, s13, 2211840
    buffer_load_dwordx4 a[104:107], v11, s[44:47], s14 offen
    s_waitcnt lgkmcnt(9)
    v_mfma_f32_16x16x32_bf16 v[20:23], v[236:239], a[32:35], v[20:23]
    ds_read_b128 a[12:15], v6 offset:1024
    v_mfma_f32_16x16x32_bf16 v[44:47], v[236:239], a[36:39], v[44:47]
    s_waitcnt vmcnt(41)
    ds_write_b128 v15, a[120:123]
    v_mfma_f32_16x16x32_bf16 v[68:71], v[236:239], a[40:43], v[68:71]
    ds_read_b64_tr_b16 v[208:209], v2 offset:0
    v_mfma_f32_16x16x32_bf16 v[92:95], v[236:239], a[44:47], v[92:95]
    ds_read_b64_tr_b16 v[212:213], v2 offset:544
    v_mfma_f32_16x16x32_bf16 v[116:119], v[236:239], a[48:51], v[116:119]
    ds_read_b64_tr_b16 v[216:217], v2 offset:1088
    v_mfma_f32_16x16x32_bf16 v[140:143], v[236:239], a[52:55], v[140:143]
    ds_read_b64_tr_b16 v[220:221], v2 offset:1632
    v_mfma_f32_16x16x32_bf16 v[164:167], v[236:239], a[56:59], v[164:167]
    ds_read_b64_tr_b16 v[224:225], v2 offset:2176
    v_mfma_f32_16x16x32_bf16 v[188:191], v[236:239], a[60:63], v[188:191]
    ds_read_b64_tr_b16 v[228:229], v2 offset:2720
    s_waitcnt lgkmcnt(15)
    v_mfma_f32_16x16x32_bf16 v[24:27], v[240:243], a[32:35], v[24:27]
    s_waitcnt vmcnt(40)
    ds_write_b128 v13, a[124:127]
    v_mfma_f32_16x16x32_bf16 v[48:51], v[240:243], a[36:39], v[48:51]
    s_add_u32 s14, s13, 2211840
    buffer_load_dwordx4 a[108:111], v12, s[44:47], s14 offen
    v_mfma_f32_16x16x32_bf16 v[72:75], v[240:243], a[40:43], v[72:75]
    ds_read_b128 a[16:19], v6 offset:19456
    v_mfma_f32_16x16x32_bf16 v[96:99], v[240:243], a[44:47], v[96:99]
    ds_read_b128 a[20:23], v6 offset:37888
    v_mfma_f32_16x16x32_bf16 v[120:123], v[240:243], a[48:51], v[120:123]
    s_waitcnt vmcnt(40)
    ds_write_b128 v14, a[128:131]
    v_mfma_f32_16x16x32_bf16 v[144:147], v[240:243], a[52:55], v[144:147]
    s_add_u32 s14, s13, 2359296
    buffer_load_dwordx4 a[112:115], v10, s[44:47], s14 offen
    v_mfma_f32_16x16x32_bf16 v[168:171], v[240:243], a[56:59], v[168:171]
    ds_read_b128 a[24:27], v8 offset:1024
    v_mfma_f32_16x16x32_bf16 v[192:195], v[240:243], a[60:63], v[192:195]
    ds_read_b128 a[28:31], v8 offset:19456
    v_mfma_f32_16x16x32_bf16 v[28:31], v[244:247], a[32:35], v[28:31]
    s_waitcnt vmcnt(40)
    ds_write_b128 v15, a[132:135]
    v_mfma_f32_16x16x32_bf16 v[52:55], v[244:247], a[36:39], v[52:55]
    ds_read_b64_tr_b16 v[210:211], v2 offset:0
    v_mfma_f32_16x16x32_bf16 v[76:79], v[244:247], a[40:43], v[76:79]
    ds_read_b64_tr_b16 v[214:215], v2 offset:544
    v_mfma_f32_16x16x32_bf16 v[100:103], v[244:247], a[44:47], v[100:103]
    ds_read_b64_tr_b16 v[218:219], v2 offset:1088
    v_mfma_f32_16x16x32_bf16 v[124:127], v[244:247], a[48:51], v[124:127]
    ds_read_b64_tr_b16 v[222:223], v2 offset:1632
    v_mfma_f32_16x16x32_bf16 v[148:151], v[244:247], a[52:55], v[148:151]
    ds_read_b64_tr_b16 v[226:227], v2 offset:2176
    v_mfma_f32_16x16x32_bf16 v[172:175], v[244:247], a[56:59], v[172:175]
    ds_read_b64_tr_b16 v[230:231], v2 offset:2720
    v_mfma_f32_16x16x32_bf16 v[196:199], v[244:247], a[60:63], v[196:199]
    s_add_u32 s14, s13, 2359296
    buffer_load_dwordx4 a[116:119], v11, s[44:47], s14 offen
    s_waitcnt lgkmcnt(15)
    v_mfma_f32_16x16x32_bf16 v[32:35], v[248:251], a[32:35], v[32:35]
    v_mfma_f32_16x16x32_bf16 v[56:59], v[248:251], a[36:39], v[56:59]
    v_mfma_f32_16x16x32_bf16 v[80:83], v[248:251], a[40:43], v[80:83]
    v_mfma_f32_16x16x32_bf16 v[104:107], v[248:251], a[44:47], v[104:107]
    s_add_u32 s14, s13, 2359296
    buffer_load_dwordx4 a[120:123], v12, s[44:47], s14 offen
    v_mfma_f32_16x16x32_bf16 v[128:131], v[248:251], a[48:51], v[128:131]
    v_mfma_f32_16x16x32_bf16 v[152:155], v[248:251], a[52:55], v[152:155]
    v_mfma_f32_16x16x32_bf16 v[176:179], v[248:251], a[56:59], v[176:179]
    v_mfma_f32_16x16x32_bf16 v[200:203], v[248:251], a[60:63], v[200:203]
    s_add_u32 s14, s13, 2506752
    buffer_load_dwordx4 a[124:127], v10, s[44:47], s14 offen
    v_mfma_f32_16x16x32_bf16 v[36:39], v[252:255], a[32:35], v[36:39]
    v_mfma_f32_16x16x32_bf16 v[60:63], v[252:255], a[36:39], v[60:63]
    v_mfma_f32_16x16x32_bf16 v[84:87], v[252:255], a[40:43], v[84:87]
    v_mfma_f32_16x16x32_bf16 v[108:111], v[252:255], a[44:47], v[108:111]
    s_add_u32 s14, s13, 2506752
    buffer_load_dwordx4 a[128:131], v11, s[44:47], s14 offen
    v_mfma_f32_16x16x32_bf16 v[132:135], v[252:255], a[48:51], v[132:135]
    v_mfma_f32_16x16x32_bf16 v[156:159], v[252:255], a[52:55], v[156:159]
    v_mfma_f32_16x16x32_bf16 v[180:183], v[252:255], a[56:59], v[180:183]
    v_mfma_f32_16x16x32_bf16 v[204:207], v[252:255], a[60:63], v[204:207]
    s_add_u32 s14, s13, 2506752
    buffer_load_dwordx4 a[132:135], v12, s[44:47], s14 offen
    s_waitcnt lgkmcnt(5)
    v_mfma_f32_16x16x32_bf16 v[16:19], v[208:211], a[0:3], v[16:19]
    v_mfma_f32_16x16x32_bf16 v[40:43], v[208:211], a[4:7], v[40:43]
    s_waitcnt vmcnt(44)
    ds_write_b128 v13, a[136:139]
    v_mfma_f32_16x16x32_bf16 v[64:67], v[208:211], a[8:11], v[64:67]
    ds_read_b128 a[32:35], v5 offset:1024
    v_mfma_f32_16x16x32_bf16 v[88:91], v[208:211], a[12:15], v[88:91]
    s_add_u32 s14, s13, 2654208
    buffer_load_dwordx4 a[136:139], v10, s[44:47], s14 offen
    v_mfma_f32_16x16x32_bf16 v[112:115], v[208:211], a[16:19], v[112:115]
    ds_read_b128 a[36:39], v5 offset:19456
    v_mfma_f32_16x16x32_bf16 v[136:139], v[208:211], a[20:23], v[136:139]
    s_waitcnt vmcnt(44)
    ds_write_b128 v14, a[140:143]
    v_mfma_f32_16x16x32_bf16 v[160:163], v[208:211], a[24:27], v[160:163]
    ds_read_b128 a[40:43], v5 offset:37888
    v_mfma_f32_16x16x32_bf16 v[184:187], v[208:211], a[28:31], v[184:187]
    s_add_u32 s14, s13, 2654208
    buffer_load_dwordx4 a[140:143], v11, s[44:47], s14 offen
    s_waitcnt lgkmcnt(9)
    v_mfma_f32_16x16x32_bf16 v[20:23], v[212:215], a[0:3], v[20:23]
    ds_read_b128 a[44:47], v7 offset:1024
    v_mfma_f32_16x16x32_bf16 v[44:47], v[212:215], a[4:7], v[44:47]
    s_waitcnt vmcnt(44)
    ds_write_b128 v15, a[144:147]
    v_mfma_f32_16x16x32_bf16 v[68:71], v[212:215], a[8:11], v[68:71]
    ds_read_b64_tr_b16 v[232:233], v2 offset:0
    v_mfma_f32_16x16x32_bf16 v[92:95], v[212:215], a[12:15], v[92:95]
    ds_read_b64_tr_b16 v[236:237], v2 offset:544
    v_mfma_f32_16x16x32_bf16 v[116:119], v[212:215], a[16:19], v[116:119]
    ds_read_b64_tr_b16 v[240:241], v2 offset:1088
    v_mfma_f32_16x16x32_bf16 v[140:143], v[212:215], a[20:23], v[140:143]
    ds_read_b64_tr_b16 v[244:245], v2 offset:1632
    v_mfma_f32_16x16x32_bf16 v[164:167], v[212:215], a[24:27], v[164:167]
    ds_read_b64_tr_b16 v[248:249], v2 offset:2176
    v_mfma_f32_16x16x32_bf16 v[188:191], v[212:215], a[28:31], v[188:191]
    ds_read_b64_tr_b16 v[252:253], v2 offset:2720
    s_waitcnt lgkmcnt(15)
    v_mfma_f32_16x16x32_bf16 v[24:27], v[216:219], a[0:3], v[24:27]
    s_waitcnt vmcnt(43)
    ds_write_b128 v13, a[148:151]
    v_mfma_f32_16x16x32_bf16 v[48:51], v[216:219], a[4:7], v[48:51]
    s_add_u32 s14, s13, 2654208
    buffer_load_dwordx4 a[144:147], v12, s[44:47], s14 offen
    v_mfma_f32_16x16x32_bf16 v[72:75], v[216:219], a[8:11], v[72:75]
    ds_read_b128 a[48:51], v7 offset:19456
    v_mfma_f32_16x16x32_bf16 v[96:99], v[216:219], a[12:15], v[96:99]
    ds_read_b128 a[52:55], v7 offset:37888
    v_mfma_f32_16x16x32_bf16 v[120:123], v[216:219], a[16:19], v[120:123]
    s_waitcnt vmcnt(43)
    ds_write_b128 v14, a[152:155]
    v_mfma_f32_16x16x32_bf16 v[144:147], v[216:219], a[20:23], v[144:147]
    s_add_u32 s14, s13, 2801664
    buffer_load_dwordx4 a[148:151], v10, s[44:47], s14 offen
    v_mfma_f32_16x16x32_bf16 v[168:171], v[216:219], a[24:27], v[168:171]
    ds_read_b128 a[56:59], v9 offset:1024
    v_mfma_f32_16x16x32_bf16 v[192:195], v[216:219], a[28:31], v[192:195]
    ds_read_b128 a[60:63], v9 offset:19456
    v_mfma_f32_16x16x32_bf16 v[28:31], v[220:223], a[0:3], v[28:31]
    s_waitcnt vmcnt(43)
    ds_write_b128 v15, a[156:159]
    v_mfma_f32_16x16x32_bf16 v[52:55], v[220:223], a[4:7], v[52:55]
    ds_read_b64_tr_b16 v[234:235], v2 offset:0
    v_mfma_f32_16x16x32_bf16 v[76:79], v[220:223], a[8:11], v[76:79]
    ds_read_b64_tr_b16 v[238:239], v2 offset:544
    v_mfma_f32_16x16x32_bf16 v[100:103], v[220:223], a[12:15], v[100:103]
    ds_read_b64_tr_b16 v[242:243], v2 offset:1088
    v_mfma_f32_16x16x32_bf16 v[124:127], v[220:223], a[16:19], v[124:127]
    ds_read_b64_tr_b16 v[246:247], v2 offset:1632
    v_mfma_f32_16x16x32_bf16 v[148:151], v[220:223], a[20:23], v[148:151]
    ds_read_b64_tr_b16 v[250:251], v2 offset:2176
    v_mfma_f32_16x16x32_bf16 v[172:175], v[220:223], a[24:27], v[172:175]
    ds_read_b64_tr_b16 v[254:255], v2 offset:2720
    v_mfma_f32_16x16x32_bf16 v[196:199], v[220:223], a[28:31], v[196:199]
    s_add_u32 s14, s13, 2801664
    buffer_load_dwordx4 a[152:155], v11, s[44:47], s14 offen
    s_waitcnt lgkmcnt(15)
    v_mfma_f32_16x16x32_bf16 v[32:35], v[224:227], a[0:3], v[32:35]
    v_mfma_f32_16x16x32_bf16 v[56:59], v[224:227], a[4:7], v[56:59]
    v_mfma_f32_16x16x32_bf16 v[80:83], v[224:227], a[8:11], v[80:83]
    v_mfma_f32_16x16x32_bf16 v[104:107], v[224:227], a[12:15], v[104:107]
    s_add_u32 s14, s13, 2801664
    buffer_load_dwordx4 a[156:159], v12, s[44:47], s14 offen
    v_mfma_f32_16x16x32_bf16 v[128:131], v[224:227], a[16:19], v[128:131]
    v_mfma_f32_16x16x32_bf16 v[152:155], v[224:227], a[20:23], v[152:155]
    v_mfma_f32_16x16x32_bf16 v[176:179], v[224:227], a[24:27], v[176:179]
    v_mfma_f32_16x16x32_bf16 v[200:203], v[224:227], a[28:31], v[200:203]
    v_mfma_f32_16x16x32_bf16 v[36:39], v[228:231], a[0:3], v[36:39]
    s_add_u32 s10, s58, 0
    buffer_load_dword a251, v0, s[76:79], s10 offen
    v_mfma_f32_16x16x32_bf16 v[60:63], v[228:231], a[4:7], v[60:63]
    v_mfma_f32_16x16x32_bf16 v[84:87], v[228:231], a[8:11], v[84:87]
    v_mfma_f32_16x16x32_bf16 v[108:111], v[228:231], a[12:15], v[108:111]
    v_mfma_f32_16x16x32_bf16 v[132:135], v[228:231], a[16:19], v[132:135]
    v_mfma_f32_16x16x32_bf16 v[156:159], v[228:231], a[20:23], v[156:159]
    s_add_u32 s10, s58, 0
    buffer_load_dword a251, v0, s[72:75], s10 offen
    v_mfma_f32_16x16x32_bf16 v[180:183], v[228:231], a[24:27], v[180:183]
    v_mfma_f32_16x16x32_bf16 v[204:207], v[228:231], a[28:31], v[204:207]
    s_waitcnt lgkmcnt(5)
    v_mfma_f32_16x16x32_bf16 v[16:19], v[232:235], a[32:35], v[16:19]
    v_mfma_f32_16x16x32_bf16 v[40:43], v[232:235], a[36:39], v[40:43]
    s_waitcnt vmcnt(46)
    ds_write_b128 v13, a[160:163]
    v_mfma_f32_16x16x32_bf16 v[64:67], v[232:235], a[40:43], v[64:67]
    s_add_u32 s14, s13, 2949120
    buffer_load_dwordx4 a[160:163], v10, s[44:47], s14 offen
    v_mfma_f32_16x16x32_bf16 v[88:91], v[232:235], a[44:47], v[88:91]
    ds_read_b128 a[0:3], v4 offset:2048
    v_mfma_f32_16x16x32_bf16 v[112:115], v[232:235], a[48:51], v[112:115]
    ds_read_b128 a[4:7], v4 offset:20480
    v_mfma_f32_16x16x32_bf16 v[136:139], v[232:235], a[52:55], v[136:139]
    s_waitcnt vmcnt(46)
    ds_write_b128 v14, a[164:167]
    v_mfma_f32_16x16x32_bf16 v[160:163], v[232:235], a[56:59], v[160:163]
    s_add_u32 s14, s13, 2949120
    buffer_load_dwordx4 a[164:167], v11, s[44:47], s14 offen
    v_mfma_f32_16x16x32_bf16 v[184:187], v[232:235], a[60:63], v[184:187]
    ds_read_b128 a[8:11], v4 offset:38912
    s_waitcnt lgkmcnt(9)
    v_mfma_f32_16x16x32_bf16 v[20:23], v[236:239], a[32:35], v[20:23]
    ds_read_b128 a[12:15], v6 offset:2048
    v_mfma_f32_16x16x32_bf16 v[44:47], v[236:239], a[36:39], v[44:47]
    s_waitcnt vmcnt(46)
    ds_write_b128 v15, a[168:171]
    v_mfma_f32_16x16x32_bf16 v[68:71], v[236:239], a[40:43], v[68:71]
    ds_read_b64_tr_b16 v[208:209], v2 offset:0
    v_mfma_f32_16x16x32_bf16 v[92:95], v[236:239], a[44:47], v[92:95]
    ds_read_b64_tr_b16 v[212:213], v2 offset:544
    v_mfma_f32_16x16x32_bf16 v[116:119], v[236:239], a[48:51], v[116:119]
    ds_read_b64_tr_b16 v[216:217], v2 offset:1088
    v_mfma_f32_16x16x32_bf16 v[140:143], v[236:239], a[52:55], v[140:143]
    ds_read_b64_tr_b16 v[220:221], v2 offset:1632
    v_mfma_f32_16x16x32_bf16 v[164:167], v[236:239], a[56:59], v[164:167]
    ds_read_b64_tr_b16 v[224:225], v2 offset:2176
    v_mfma_f32_16x16x32_bf16 v[188:191], v[236:239], a[60:63], v[188:191]
    ds_read_b64_tr_b16 v[228:229], v2 offset:2720
    s_waitcnt lgkmcnt(15)
    v_mfma_f32_16x16x32_bf16 v[24:27], v[240:243], a[32:35], v[24:27]
    s_waitcnt vmcnt(45)
    ds_write_b128 v13, a[172:175]
    v_mfma_f32_16x16x32_bf16 v[48:51], v[240:243], a[36:39], v[48:51]
    s_add_u32 s14, s13, 2949120
    buffer_load_dwordx4 a[168:171], v12, s[44:47], s14 offen
    v_mfma_f32_16x16x32_bf16 v[72:75], v[240:243], a[40:43], v[72:75]
    ds_read_b128 a[16:19], v6 offset:20480
    v_mfma_f32_16x16x32_bf16 v[96:99], v[240:243], a[44:47], v[96:99]
    ds_read_b128 a[20:23], v6 offset:38912
    v_mfma_f32_16x16x32_bf16 v[120:123], v[240:243], a[48:51], v[120:123]
    s_waitcnt vmcnt(45)
    ds_write_b128 v14, a[176:179]
    v_mfma_f32_16x16x32_bf16 v[144:147], v[240:243], a[52:55], v[144:147]
    s_add_u32 s14, s13, 3096576
    buffer_load_dwordx4 a[172:175], v10, s[44:47], s14 offen
    v_mfma_f32_16x16x32_bf16 v[168:171], v[240:243], a[56:59], v[168:171]
    ds_read_b128 a[24:27], v8 offset:2048
    v_mfma_f32_16x16x32_bf16 v[192:195], v[240:243], a[60:63], v[192:195]
    ds_read_b128 a[28:31], v8 offset:20480
    v_mfma_f32_16x16x32_bf16 v[28:31], v[244:247], a[32:35], v[28:31]
    s_waitcnt vmcnt(45)
    ds_write_b128 v15, a[180:183]
    v_mfma_f32_16x16x32_bf16 v[52:55], v[244:247], a[36:39], v[52:55]
    ds_read_b64_tr_b16 v[210:211], v2 offset:0
    v_mfma_f32_16x16x32_bf16 v[76:79], v[244:247], a[40:43], v[76:79]
    ds_read_b64_tr_b16 v[214:215], v2 offset:544
    v_mfma_f32_16x16x32_bf16 v[100:103], v[244:247], a[44:47], v[100:103]
    ds_read_b64_tr_b16 v[218:219], v2 offset:1088
    v_mfma_f32_16x16x32_bf16 v[124:127], v[244:247], a[48:51], v[124:127]
    ds_read_b64_tr_b16 v[222:223], v2 offset:1632
    v_mfma_f32_16x16x32_bf16 v[148:151], v[244:247], a[52:55], v[148:151]
    ds_read_b64_tr_b16 v[226:227], v2 offset:2176
    v_mfma_f32_16x16x32_bf16 v[172:175], v[244:247], a[56:59], v[172:175]
    ds_read_b64_tr_b16 v[230:231], v2 offset:2720
    v_mfma_f32_16x16x32_bf16 v[196:199], v[244:247], a[60:63], v[196:199]
    s_add_u32 s14, s13, 3096576
    buffer_load_dwordx4 a[176:179], v11, s[44:47], s14 offen
    s_waitcnt lgkmcnt(15)
    v_mfma_f32_16x16x32_bf16 v[32:35], v[248:251], a[32:35], v[32:35]
    v_mfma_f32_16x16x32_bf16 v[56:59], v[248:251], a[36:39], v[56:59]
    v_mfma_f32_16x16x32_bf16 v[80:83], v[248:251], a[40:43], v[80:83]
    v_mfma_f32_16x16x32_bf16 v[104:107], v[248:251], a[44:47], v[104:107]
    s_add_u32 s14, s13, 3096576
    buffer_load_dwordx4 a[180:183], v12, s[44:47], s14 offen
    v_mfma_f32_16x16x32_bf16 v[128:131], v[248:251], a[48:51], v[128:131]
    v_mfma_f32_16x16x32_bf16 v[152:155], v[248:251], a[52:55], v[152:155]
    v_mfma_f32_16x16x32_bf16 v[176:179], v[248:251], a[56:59], v[176:179]
    v_mfma_f32_16x16x32_bf16 v[200:203], v[248:251], a[60:63], v[200:203]
    v_mfma_f32_16x16x32_bf16 v[36:39], v[252:255], a[32:35], v[36:39]
    s_add_u32 s10, s58, 1572864
    buffer_load_dword a251, v0, s[76:79], s10 offen
    v_mfma_f32_16x16x32_bf16 v[60:63], v[252:255], a[36:39], v[60:63]
    v_mfma_f32_16x16x32_bf16 v[84:87], v[252:255], a[40:43], v[84:87]
    v_mfma_f32_16x16x32_bf16 v[108:111], v[252:255], a[44:47], v[108:111]
    v_mfma_f32_16x16x32_bf16 v[132:135], v[252:255], a[48:51], v[132:135]
    v_mfma_f32_16x16x32_bf16 v[156:159], v[252:255], a[52:55], v[156:159]
    s_add_u32 s10, s58, 1572864
    buffer_load_dword a251, v0, s[72:75], s10 offen
    v_mfma_f32_16x16x32_bf16 v[180:183], v[252:255], a[56:59], v[180:183]
    v_mfma_f32_16x16x32_bf16 v[204:207], v[252:255], a[60:63], v[204:207]
    s_waitcnt lgkmcnt(5)
    v_mfma_f32_16x16x32_bf16 v[16:19], v[208:211], a[0:3], v[16:19]
    v_mfma_f32_16x16x32_bf16 v[40:43], v[208:211], a[4:7], v[40:43]
    s_waitcnt vmcnt(48)
    ds_write_b128 v13, a[184:187]
    v_mfma_f32_16x16x32_bf16 v[64:67], v[208:211], a[8:11], v[64:67]
    s_add_u32 s14, s13, 3244032
    buffer_load_dwordx4 a[184:187], v10, s[44:47], s14 offen
    v_mfma_f32_16x16x32_bf16 v[88:91], v[208:211], a[12:15], v[88:91]
    ds_read_b128 a[32:35], v5 offset:2048
    v_mfma_f32_16x16x32_bf16 v[112:115], v[208:211], a[16:19], v[112:115]
    ds_read_b128 a[36:39], v5 offset:20480
    v_mfma_f32_16x16x32_bf16 v[136:139], v[208:211], a[20:23], v[136:139]
    s_waitcnt vmcnt(48)
    ds_write_b128 v14, a[188:191]
    v_mfma_f32_16x16x32_bf16 v[160:163], v[208:211], a[24:27], v[160:163]
    s_add_u32 s14, s13, 3244032
    buffer_load_dwordx4 a[188:191], v11, s[44:47], s14 offen
    v_mfma_f32_16x16x32_bf16 v[184:187], v[208:211], a[28:31], v[184:187]
    ds_read_b128 a[40:43], v5 offset:38912
    s_waitcnt lgkmcnt(9)
    v_mfma_f32_16x16x32_bf16 v[20:23], v[212:215], a[0:3], v[20:23]
    ds_read_b128 a[44:47], v7 offset:2048
    v_mfma_f32_16x16x32_bf16 v[44:47], v[212:215], a[4:7], v[44:47]
    s_waitcnt vmcnt(48)
    ds_write_b128 v15, a[192:195]
    v_mfma_f32_16x16x32_bf16 v[68:71], v[212:215], a[8:11], v[68:71]
    ds_read_b64_tr_b16 v[232:233], v2 offset:0
    v_mfma_f32_16x16x32_bf16 v[92:95], v[212:215], a[12:15], v[92:95]
    ds_read_b64_tr_b16 v[236:237], v2 offset:544
    v_mfma_f32_16x16x32_bf16 v[116:119], v[212:215], a[16:19], v[116:119]
    ds_read_b64_tr_b16 v[240:241], v2 offset:1088
    v_mfma_f32_16x16x32_bf16 v[140:143], v[212:215], a[20:23], v[140:143]
    ds_read_b64_tr_b16 v[244:245], v2 offset:1632
    v_mfma_f32_16x16x32_bf16 v[164:167], v[212:215], a[24:27], v[164:167]
    ds_read_b64_tr_b16 v[248:249], v2 offset:2176
    v_mfma_f32_16x16x32_bf16 v[188:191], v[212:215], a[28:31], v[188:191]
    ds_read_b64_tr_b16 v[252:253], v2 offset:2720
    s_waitcnt lgkmcnt(15)
    v_mfma_f32_16x16x32_bf16 v[24:27], v[216:219], a[0:3], v[24:27]
    s_waitcnt vmcnt(47)
    ds_write_b128 v13, a[196:199]
    v_mfma_f32_16x16x32_bf16 v[48:51], v[216:219], a[4:7], v[48:51]
    s_add_u32 s14, s13, 3244032
    buffer_load_dwordx4 a[192:195], v12, s[44:47], s14 offen
    v_mfma_f32_16x16x32_bf16 v[72:75], v[216:219], a[8:11], v[72:75]
    ds_read_b128 a[48:51], v7 offset:20480
    v_mfma_f32_16x16x32_bf16 v[96:99], v[216:219], a[12:15], v[96:99]
    ds_read_b128 a[52:55], v7 offset:38912
    v_mfma_f32_16x16x32_bf16 v[120:123], v[216:219], a[16:19], v[120:123]
    s_waitcnt vmcnt(47)
    ds_write_b128 v14, a[200:203]
    v_mfma_f32_16x16x32_bf16 v[144:147], v[216:219], a[20:23], v[144:147]
    s_add_u32 s14, s13, 3391488
    buffer_load_dwordx4 a[196:199], v10, s[44:47], s14 offen
    v_mfma_f32_16x16x32_bf16 v[168:171], v[216:219], a[24:27], v[168:171]
    ds_read_b128 a[56:59], v9 offset:2048
    v_mfma_f32_16x16x32_bf16 v[192:195], v[216:219], a[28:31], v[192:195]
    ds_read_b128 a[60:63], v9 offset:20480
    v_mfma_f32_16x16x32_bf16 v[28:31], v[220:223], a[0:3], v[28:31]
    s_waitcnt vmcnt(47)
    ds_write_b128 v15, a[204:207]
    v_mfma_f32_16x16x32_bf16 v[52:55], v[220:223], a[4:7], v[52:55]
    ds_read_b64_tr_b16 v[234:235], v2 offset:0
    v_mfma_f32_16x16x32_bf16 v[76:79], v[220:223], a[8:11], v[76:79]
    ds_read_b64_tr_b16 v[238:239], v2 offset:544
    v_mfma_f32_16x16x32_bf16 v[100:103], v[220:223], a[12:15], v[100:103]
    ds_read_b64_tr_b16 v[242:243], v2 offset:1088
    v_mfma_f32_16x16x32_bf16 v[124:127], v[220:223], a[16:19], v[124:127]
    ds_read_b64_tr_b16 v[246:247], v2 offset:1632
    v_mfma_f32_16x16x32_bf16 v[148:151], v[220:223], a[20:23], v[148:151]
    ds_read_b64_tr_b16 v[250:251], v2 offset:2176
    v_mfma_f32_16x16x32_bf16 v[172:175], v[220:223], a[24:27], v[172:175]
    ds_read_b64_tr_b16 v[254:255], v2 offset:2720
    v_mfma_f32_16x16x32_bf16 v[196:199], v[220:223], a[28:31], v[196:199]
    s_add_u32 s14, s13, 3391488
    buffer_load_dwordx4 a[200:203], v11, s[44:47], s14 offen
    s_waitcnt lgkmcnt(15)
    v_mfma_f32_16x16x32_bf16 v[32:35], v[224:227], a[0:3], v[32:35]
    v_mfma_f32_16x16x32_bf16 v[56:59], v[224:227], a[4:7], v[56:59]
    v_mfma_f32_16x16x32_bf16 v[80:83], v[224:227], a[8:11], v[80:83]
    v_mfma_f32_16x16x32_bf16 v[104:107], v[224:227], a[12:15], v[104:107]
    s_add_u32 s14, s13, 3391488
    buffer_load_dwordx4 a[204:207], v12, s[44:47], s14 offen
    v_mfma_f32_16x16x32_bf16 v[128:131], v[224:227], a[16:19], v[128:131]
    v_mfma_f32_16x16x32_bf16 v[152:155], v[224:227], a[20:23], v[152:155]
    v_mfma_f32_16x16x32_bf16 v[176:179], v[224:227], a[24:27], v[176:179]
    v_mfma_f32_16x16x32_bf16 v[200:203], v[224:227], a[28:31], v[200:203]
    v_mfma_f32_16x16x32_bf16 v[36:39], v[228:231], a[0:3], v[36:39]
    s_add_u32 s10, s58, 3145728
    buffer_load_dword a251, v0, s[76:79], s10 offen
    v_mfma_f32_16x16x32_bf16 v[60:63], v[228:231], a[4:7], v[60:63]
    v_mfma_f32_16x16x32_bf16 v[84:87], v[228:231], a[8:11], v[84:87]
    v_mfma_f32_16x16x32_bf16 v[108:111], v[228:231], a[12:15], v[108:111]
    v_mfma_f32_16x16x32_bf16 v[132:135], v[228:231], a[16:19], v[132:135]
    v_mfma_f32_16x16x32_bf16 v[156:159], v[228:231], a[20:23], v[156:159]
    v_mfma_f32_16x16x32_bf16 v[180:183], v[228:231], a[24:27], v[180:183]
    v_mfma_f32_16x16x32_bf16 v[204:207], v[228:231], a[28:31], v[204:207]
    s_waitcnt lgkmcnt(5)
    v_mfma_f32_16x16x32_bf16 v[16:19], v[232:235], a[32:35], v[16:19]
    v_mfma_f32_16x16x32_bf16 v[40:43], v[232:235], a[36:39], v[40:43]
    s_waitcnt vmcnt(40)
    ds_write_b128 v13, a[64:67]
    v_mfma_f32_16x16x32_bf16 v[64:67], v[232:235], a[40:43], v[64:67]
    s_add_u32 s14, s13, 3538944
    buffer_load_dwordx4 a[64:67], v10, s[44:47], s14 offen
    v_mfma_f32_16x16x32_bf16 v[88:91], v[232:235], a[44:47], v[88:91]
    ds_read_b128 a[0:3], v4 offset:3072
    v_mfma_f32_16x16x32_bf16 v[112:115], v[232:235], a[48:51], v[112:115]
    ds_read_b128 a[4:7], v4 offset:21504
    v_mfma_f32_16x16x32_bf16 v[136:139], v[232:235], a[52:55], v[136:139]
    s_waitcnt vmcnt(40)
    ds_write_b128 v14, a[68:71]
    v_mfma_f32_16x16x32_bf16 v[160:163], v[232:235], a[56:59], v[160:163]
    s_add_u32 s14, s13, 3538944
    buffer_load_dwordx4 a[68:71], v11, s[44:47], s14 offen
    v_mfma_f32_16x16x32_bf16 v[184:187], v[232:235], a[60:63], v[184:187]
    ds_read_b128 a[8:11], v4 offset:39936
    s_waitcnt lgkmcnt(9)
    v_mfma_f32_16x16x32_bf16 v[20:23], v[236:239], a[32:35], v[20:23]
    ds_read_b128 a[12:15], v6 offset:3072
    v_mfma_f32_16x16x32_bf16 v[44:47], v[236:239], a[36:39], v[44:47]
    s_waitcnt vmcnt(40)
    ds_write_b128 v15, a[72:75]
    v_mfma_f32_16x16x32_bf16 v[68:71], v[236:239], a[40:43], v[68:71]
    ds_read_b64_tr_b16 v[208:209], v2 offset:0
    v_mfma_f32_16x16x32_bf16 v[92:95], v[236:239], a[44:47], v[92:95]
    ds_read_b64_tr_b16 v[212:213], v2 offset:544
    v_mfma_f32_16x16x32_bf16 v[116:119], v[236:239], a[48:51], v[116:119]
    ds_read_b64_tr_b16 v[216:217], v2 offset:1088
    v_mfma_f32_16x16x32_bf16 v[140:143], v[236:239], a[52:55], v[140:143]
    ds_read_b64_tr_b16 v[220:221], v2 offset:1632
    v_mfma_f32_16x16x32_bf16 v[164:167], v[236:239], a[56:59], v[164:167]
    ds_read_b64_tr_b16 v[224:225], v2 offset:2176
    v_mfma_f32_16x16x32_bf16 v[188:191], v[236:239], a[60:63], v[188:191]
    ds_read_b64_tr_b16 v[228:229], v2 offset:2720
    s_waitcnt lgkmcnt(15)
    v_mfma_f32_16x16x32_bf16 v[24:27], v[240:243], a[32:35], v[24:27]
    s_waitcnt vmcnt(39)
    ds_write_b128 v13, a[76:79]
    v_mfma_f32_16x16x32_bf16 v[48:51], v[240:243], a[36:39], v[48:51]
    s_add_u32 s14, s13, 3538944
    buffer_load_dwordx4 a[72:75], v12, s[44:47], s14 offen
    v_mfma_f32_16x16x32_bf16 v[72:75], v[240:243], a[40:43], v[72:75]
    ds_read_b128 a[16:19], v6 offset:21504
    v_mfma_f32_16x16x32_bf16 v[96:99], v[240:243], a[44:47], v[96:99]
    ds_read_b128 a[20:23], v6 offset:39936
    v_mfma_f32_16x16x32_bf16 v[120:123], v[240:243], a[48:51], v[120:123]
    s_waitcnt vmcnt(39)
    ds_write_b128 v14, a[80:83]
    v_mfma_f32_16x16x32_bf16 v[144:147], v[240:243], a[52:55], v[144:147]
    s_add_u32 s14, s13, 3686400
    buffer_load_dwordx4 a[76:79], v10, s[44:47], s14 offen
    v_mfma_f32_16x16x32_bf16 v[168:171], v[240:243], a[56:59], v[168:171]
    ds_read_b128 a[24:27], v8 offset:3072
    v_mfma_f32_16x16x32_bf16 v[192:195], v[240:243], a[60:63], v[192:195]
    ds_read_b128 a[28:31], v8 offset:21504
    v_mfma_f32_16x16x32_bf16 v[28:31], v[244:247], a[32:35], v[28:31]
    s_waitcnt vmcnt(39)
    ds_write_b128 v15, a[84:87]
    v_mfma_f32_16x16x32_bf16 v[52:55], v[244:247], a[36:39], v[52:55]
    ds_read_b64_tr_b16 v[210:211], v2 offset:0
    v_mfma_f32_16x16x32_bf16 v[76:79], v[244:247], a[40:43], v[76:79]
    ds_read_b64_tr_b16 v[214:215], v2 offset:544
    v_mfma_f32_16x16x32_bf16 v[100:103], v[244:247], a[44:47], v[100:103]
    ds_read_b64_tr_b16 v[218:219], v2 offset:1088
    v_mfma_f32_16x16x32_bf16 v[124:127], v[244:247], a[48:51], v[124:127]
    ds_read_b64_tr_b16 v[222:223], v2 offset:1632
    v_mfma_f32_16x16x32_bf16 v[148:151], v[244:247], a[52:55], v[148:151]
    ds_read_b64_tr_b16 v[226:227], v2 offset:2176
    v_mfma_f32_16x16x32_bf16 v[172:175], v[244:247], a[56:59], v[172:175]
    ds_read_b64_tr_b16 v[230:231], v2 offset:2720
    v_mfma_f32_16x16x32_bf16 v[196:199], v[244:247], a[60:63], v[196:199]
    s_add_u32 s14, s13, 3686400
    buffer_load_dwordx4 a[80:83], v11, s[44:47], s14 offen
    s_waitcnt lgkmcnt(15)
    v_mfma_f32_16x16x32_bf16 v[32:35], v[248:251], a[32:35], v[32:35]
    v_mfma_f32_16x16x32_bf16 v[56:59], v[248:251], a[36:39], v[56:59]
    v_mfma_f32_16x16x32_bf16 v[80:83], v[248:251], a[40:43], v[80:83]
    v_mfma_f32_16x16x32_bf16 v[104:107], v[248:251], a[44:47], v[104:107]
    s_add_u32 s14, s13, 3686400
    buffer_load_dwordx4 a[84:87], v12, s[44:47], s14 offen
    v_mfma_f32_16x16x32_bf16 v[128:131], v[248:251], a[48:51], v[128:131]
    v_mfma_f32_16x16x32_bf16 v[152:155], v[248:251], a[52:55], v[152:155]
    v_mfma_f32_16x16x32_bf16 v[176:179], v[248:251], a[56:59], v[176:179]
    v_mfma_f32_16x16x32_bf16 v[200:203], v[248:251], a[60:63], v[200:203]
    v_mfma_f32_16x16x32_bf16 v[36:39], v[252:255], a[32:35], v[36:39]
    s_add_u32 s10, s58, 3145728
    buffer_load_dword a251, v0, s[72:75], s10 offen
    v_mfma_f32_16x16x32_bf16 v[60:63], v[252:255], a[36:39], v[60:63]
    v_mfma_f32_16x16x32_bf16 v[84:87], v[252:255], a[40:43], v[84:87]
    v_mfma_f32_16x16x32_bf16 v[108:111], v[252:255], a[44:47], v[108:111]
    v_mfma_f32_16x16x32_bf16 v[132:135], v[252:255], a[48:51], v[132:135]
    v_mfma_f32_16x16x32_bf16 v[156:159], v[252:255], a[52:55], v[156:159]
    v_mfma_f32_16x16x32_bf16 v[180:183], v[252:255], a[56:59], v[180:183]
    v_mfma_f32_16x16x32_bf16 v[204:207], v[252:255], a[60:63], v[204:207]
    s_waitcnt lgkmcnt(5)
    v_mfma_f32_16x16x32_bf16 v[16:19], v[208:211], a[0:3], v[16:19]
    v_mfma_f32_16x16x32_bf16 v[40:43], v[208:211], a[4:7], v[40:43]
    s_waitcnt vmcnt(41)
    ds_write_b128 v13, a[88:91]
    v_mfma_f32_16x16x32_bf16 v[64:67], v[208:211], a[8:11], v[64:67]
    s_add_u32 s14, s13, 3833856
    buffer_load_dwordx4 a[88:91], v10, s[44:47], s14 offen
    v_mfma_f32_16x16x32_bf16 v[88:91], v[208:211], a[12:15], v[88:91]
    ds_read_b128 a[32:35], v5 offset:3072
    v_mfma_f32_16x16x32_bf16 v[112:115], v[208:211], a[16:19], v[112:115]
    ds_read_b128 a[36:39], v5 offset:21504
    v_mfma_f32_16x16x32_bf16 v[136:139], v[208:211], a[20:23], v[136:139]
    s_waitcnt vmcnt(41)
    ds_write_b128 v14, a[92:95]
    v_mfma_f32_16x16x32_bf16 v[160:163], v[208:211], a[24:27], v[160:163]
    s_add_u32 s14, s13, 3833856
    buffer_load_dwordx4 a[92:95], v11, s[44:47], s14 offen
    v_mfma_f32_16x16x32_bf16 v[184:187], v[208:211], a[28:31], v[184:187]
    ds_read_b128 a[40:43], v5 offset:39936
    s_waitcnt lgkmcnt(9)
    v_mfma_f32_16x16x32_bf16 v[20:23], v[212:215], a[0:3], v[20:23]
    ds_read_b128 a[44:47], v7 offset:3072
    v_mfma_f32_16x16x32_bf16 v[44:47], v[212:215], a[4:7], v[44:47]
    s_waitcnt vmcnt(41)
    ds_write_b128 v15, a[96:99]
    v_mfma_f32_16x16x32_bf16 v[68:71], v[212:215], a[8:11], v[68:71]
    ds_read_b64_tr_b16 v[232:233], v2 offset:0
    v_mfma_f32_16x16x32_bf16 v[92:95], v[212:215], a[12:15], v[92:95]
    ds_read_b64_tr_b16 v[236:237], v2 offset:544
    v_mfma_f32_16x16x32_bf16 v[116:119], v[212:215], a[16:19], v[116:119]
    ds_read_b64_tr_b16 v[240:241], v2 offset:1088
    v_mfma_f32_16x16x32_bf16 v[140:143], v[212:215], a[20:23], v[140:143]
    ds_read_b64_tr_b16 v[244:245], v2 offset:1632
    v_mfma_f32_16x16x32_bf16 v[164:167], v[212:215], a[24:27], v[164:167]
    ds_read_b64_tr_b16 v[248:249], v2 offset:2176
    v_mfma_f32_16x16x32_bf16 v[188:191], v[212:215], a[28:31], v[188:191]
    ds_read_b64_tr_b16 v[252:253], v2 offset:2720
    s_waitcnt lgkmcnt(15)
    v_mfma_f32_16x16x32_bf16 v[24:27], v[216:219], a[0:3], v[24:27]
    s_waitcnt vmcnt(40)
    ds_write_b128 v13, a[100:103]
    v_mfma_f32_16x16x32_bf16 v[48:51], v[216:219], a[4:7], v[48:51]
    s_add_u32 s14, s13, 3833856
    buffer_load_dwordx4 a[96:99], v12, s[44:47], s14 offen
    v_mfma_f32_16x16x32_bf16 v[72:75], v[216:219], a[8:11], v[72:75]
    ds_read_b128 a[48:51], v7 offset:21504
    v_mfma_f32_16x16x32_bf16 v[96:99], v[216:219], a[12:15], v[96:99]
    ds_read_b128 a[52:55], v7 offset:39936
    v_mfma_f32_16x16x32_bf16 v[120:123], v[216:219], a[16:19], v[120:123]
    s_waitcnt vmcnt(40)
    ds_write_b128 v14, a[104:107]
    v_mfma_f32_16x16x32_bf16 v[144:147], v[216:219], a[20:23], v[144:147]
    s_add_u32 s14, s13, 3981312
    buffer_load_dwordx4 a[100:103], v10, s[44:47], s14 offen
    v_mfma_f32_16x16x32_bf16 v[168:171], v[216:219], a[24:27], v[168:171]
    ds_read_b128 a[56:59], v9 offset:3072
    v_mfma_f32_16x16x32_bf16 v[192:195], v[216:219], a[28:31], v[192:195]
    ds_read_b128 a[60:63], v9 offset:21504
    v_mfma_f32_16x16x32_bf16 v[28:31], v[220:223], a[0:3], v[28:31]
    s_waitcnt vmcnt(40)
    ds_write_b128 v15, a[108:111]
    v_mfma_f32_16x16x32_bf16 v[52:55], v[220:223], a[4:7], v[52:55]
    ds_read_b64_tr_b16 v[234:235], v2 offset:0
    v_mfma_f32_16x16x32_bf16 v[76:79], v[220:223], a[8:11], v[76:79]
    ds_read_b64_tr_b16 v[238:239], v2 offset:544
    v_mfma_f32_16x16x32_bf16 v[100:103], v[220:223], a[12:15], v[100:103]
    ds_read_b64_tr_b16 v[242:243], v2 offset:1088
    v_mfma_f32_16x16x32_bf16 v[124:127], v[220:223], a[16:19], v[124:127]
    ds_read_b64_tr_b16 v[246:247], v2 offset:1632
    v_mfma_f32_16x16x32_bf16 v[148:151], v[220:223], a[20:23], v[148:151]
    ds_read_b64_tr_b16 v[250:251], v2 offset:2176
    v_mfma_f32_16x16x32_bf16 v[172:175], v[220:223], a[24:27], v[172:175]
    ds_read_b64_tr_b16 v[254:255], v2 offset:2720
    v_mfma_f32_16x16x32_bf16 v[196:199], v[220:223], a[28:31], v[196:199]
    s_add_u32 s14, s13, 3981312
    buffer_load_dwordx4 a[104:107], v11, s[44:47], s14 offen
    s_waitcnt lgkmcnt(15)
    v_mfma_f32_16x16x32_bf16 v[32:35], v[224:227], a[0:3], v[32:35]
    v_mfma_f32_16x16x32_bf16 v[56:59], v[224:227], a[4:7], v[56:59]
    v_mfma_f32_16x16x32_bf16 v[80:83], v[224:227], a[8:11], v[80:83]
    v_mfma_f32_16x16x32_bf16 v[104:107], v[224:227], a[12:15], v[104:107]
    s_add_u32 s14, s13, 3981312
    buffer_load_dwordx4 a[108:111], v12, s[44:47], s14 offen
    v_mfma_f32_16x16x32_bf16 v[128:131], v[224:227], a[16:19], v[128:131]
    v_mfma_f32_16x16x32_bf16 v[152:155], v[224:227], a[20:23], v[152:155]
    v_mfma_f32_16x16x32_bf16 v[176:179], v[224:227], a[24:27], v[176:179]
    v_mfma_f32_16x16x32_bf16 v[200:203], v[224:227], a[28:31], v[200:203]
    v_mfma_f32_16x16x32_bf16 v[36:39], v[228:231], a[0:3], v[36:39]
    s_add_u32 s10, s58, 4718592
    buffer_load_dword a251, v0, s[76:79], s10 offen
    v_mfma_f32_16x16x32_bf16 v[60:63], v[228:231], a[4:7], v[60:63]
    v_mfma_f32_16x16x32_bf16 v[84:87], v[228:231], a[8:11], v[84:87]
    v_mfma_f32_16x16x32_bf16 v[108:111], v[228:231], a[12:15], v[108:111]
    v_mfma_f32_16x16x32_bf16 v[132:135], v[228:231], a[16:19], v[132:135]
    v_mfma_f32_16x16x32_bf16 v[156:159], v[228:231], a[20:23], v[156:159]
    v_mfma_f32_16x16x32_bf16 v[180:183], v[228:231], a[24:27], v[180:183]
    v_mfma_f32_16x16x32_bf16 v[204:207], v[228:231], a[28:31], v[204:207]
    s_waitcnt lgkmcnt(5)
    v_mfma_f32_16x16x32_bf16 v[16:19], v[232:235], a[32:35], v[16:19]
    v_mfma_f32_16x16x32_bf16 v[40:43], v[232:235], a[36:39], v[40:43]
    s_waitcnt vmcnt(42)
    ds_write_b128 v13, a[112:115]
    v_mfma_f32_16x16x32_bf16 v[64:67], v[232:235], a[40:43], v[64:67]
    s_add_u32 s14, s13, 4128768
    buffer_load_dwordx4 a[112:115], v10, s[44:47], s14 offen
    v_mfma_f32_16x16x32_bf16 v[88:91], v[232:235], a[44:47], v[88:91]
    ds_read_b128 a[0:3], v4 offset:4096
    v_mfma_f32_16x16x32_bf16 v[112:115], v[232:235], a[48:51], v[112:115]
    ds_read_b128 a[4:7], v4 offset:22528
    v_mfma_f32_16x16x32_bf16 v[136:139], v[232:235], a[52:55], v[136:139]
    s_waitcnt vmcnt(42)
    ds_write_b128 v14, a[116:119]
    v_mfma_f32_16x16x32_bf16 v[160:163], v[232:235], a[56:59], v[160:163]
    s_add_u32 s14, s13, 4128768
    buffer_load_dwordx4 a[116:119], v11, s[44:47], s14 offen
    v_mfma_f32_16x16x32_bf16 v[184:187], v[232:235], a[60:63], v[184:187]
    ds_read_b128 a[8:11], v4 offset:40960
    s_waitcnt lgkmcnt(9)
    v_mfma_f32_16x16x32_bf16 v[20:23], v[236:239], a[32:35], v[20:23]
    ds_read_b128 a[12:15], v6 offset:4096
    v_mfma_f32_16x16x32_bf16 v[44:47], v[236:239], a[36:39], v[44:47]
    s_waitcnt vmcnt(42)
    ds_write_b128 v15, a[120:123]
    v_mfma_f32_16x16x32_bf16 v[68:71], v[236:239], a[40:43], v[68:71]
    ds_read_b64_tr_b16 v[208:209], v2 offset:0
    v_mfma_f32_16x16x32_bf16 v[92:95], v[236:239], a[44:47], v[92:95]
    ds_read_b64_tr_b16 v[212:213], v2 offset:544
    v_mfma_f32_16x16x32_bf16 v[116:119], v[236:239], a[48:51], v[116:119]
    ds_read_b64_tr_b16 v[216:217], v2 offset:1088
    v_mfma_f32_16x16x32_bf16 v[140:143], v[236:239], a[52:55], v[140:143]
    ds_read_b64_tr_b16 v[220:221], v2 offset:1632
    v_mfma_f32_16x16x32_bf16 v[164:167], v[236:239], a[56:59], v[164:167]
    ds_read_b64_tr_b16 v[224:225], v2 offset:2176
    v_mfma_f32_16x16x32_bf16 v[188:191], v[236:239], a[60:63], v[188:191]
    ds_read_b64_tr_b16 v[228:229], v2 offset:2720
    s_waitcnt lgkmcnt(15)
    v_mfma_f32_16x16x32_bf16 v[24:27], v[240:243], a[32:35], v[24:27]
    s_waitcnt vmcnt(41)
    ds_write_b128 v13, a[124:127]
    v_mfma_f32_16x16x32_bf16 v[48:51], v[240:243], a[36:39], v[48:51]
    s_add_u32 s14, s13, 4128768
    buffer_load_dwordx4 a[120:123], v12, s[44:47], s14 offen
    v_mfma_f32_16x16x32_bf16 v[72:75], v[240:243], a[40:43], v[72:75]
    ds_read_b128 a[16:19], v6 offset:22528
    v_mfma_f32_16x16x32_bf16 v[96:99], v[240:243], a[44:47], v[96:99]
    ds_read_b128 a[20:23], v6 offset:40960
    v_mfma_f32_16x16x32_bf16 v[120:123], v[240:243], a[48:51], v[120:123]
    s_waitcnt vmcnt(41)
    ds_write_b128 v14, a[128:131]
    v_mfma_f32_16x16x32_bf16 v[144:147], v[240:243], a[52:55], v[144:147]
    s_add_u32 s14, s13, 4276224
    buffer_load_dwordx4 a[124:127], v10, s[44:47], s14 offen
    v_mfma_f32_16x16x32_bf16 v[168:171], v[240:243], a[56:59], v[168:171]
    ds_read_b128 a[24:27], v8 offset:4096
    v_mfma_f32_16x16x32_bf16 v[192:195], v[240:243], a[60:63], v[192:195]
    ds_read_b128 a[28:31], v8 offset:22528
    v_mfma_f32_16x16x32_bf16 v[28:31], v[244:247], a[32:35], v[28:31]
    s_waitcnt vmcnt(41)
    ds_write_b128 v15, a[132:135]
    v_mfma_f32_16x16x32_bf16 v[52:55], v[244:247], a[36:39], v[52:55]
    ds_read_b64_tr_b16 v[210:211], v2 offset:0
    v_mfma_f32_16x16x32_bf16 v[76:79], v[244:247], a[40:43], v[76:79]
    ds_read_b64_tr_b16 v[214:215], v2 offset:544
    v_mfma_f32_16x16x32_bf16 v[100:103], v[244:247], a[44:47], v[100:103]
    ds_read_b64_tr_b16 v[218:219], v2 offset:1088
    v_mfma_f32_16x16x32_bf16 v[124:127], v[244:247], a[48:51], v[124:127]
    ds_read_b64_tr_b16 v[222:223], v2 offset:1632
    v_mfma_f32_16x16x32_bf16 v[148:151], v[244:247], a[52:55], v[148:151]
    ds_read_b64_tr_b16 v[226:227], v2 offset:2176
    v_mfma_f32_16x16x32_bf16 v[172:175], v[244:247], a[56:59], v[172:175]
    ds_read_b64_tr_b16 v[230:231], v2 offset:2720
    v_mfma_f32_16x16x32_bf16 v[196:199], v[244:247], a[60:63], v[196:199]
    s_add_u32 s14, s13, 4276224
    buffer_load_dwordx4 a[128:131], v11, s[44:47], s14 offen
    s_waitcnt lgkmcnt(15)
    v_mfma_f32_16x16x32_bf16 v[32:35], v[248:251], a[32:35], v[32:35]
    v_mfma_f32_16x16x32_bf16 v[56:59], v[248:251], a[36:39], v[56:59]
    v_mfma_f32_16x16x32_bf16 v[80:83], v[248:251], a[40:43], v[80:83]
    v_mfma_f32_16x16x32_bf16 v[104:107], v[248:251], a[44:47], v[104:107]
    s_add_u32 s14, s13, 4276224
    buffer_load_dwordx4 a[132:135], v12, s[44:47], s14 offen
    v_mfma_f32_16x16x32_bf16 v[128:131], v[248:251], a[48:51], v[128:131]
    v_mfma_f32_16x16x32_bf16 v[152:155], v[248:251], a[52:55], v[152:155]
    v_mfma_f32_16x16x32_bf16 v[176:179], v[248:251], a[56:59], v[176:179]
    v_mfma_f32_16x16x32_bf16 v[200:203], v[248:251], a[60:63], v[200:203]
    v_mfma_f32_16x16x32_bf16 v[36:39], v[252:255], a[32:35], v[36:39]
    s_add_u32 s10, s58, 4718592
    buffer_load_dword a251, v0, s[72:75], s10 offen
    v_mfma_f32_16x16x32_bf16 v[60:63], v[252:255], a[36:39], v[60:63]
    v_mfma_f32_16x16x32_bf16 v[84:87], v[252:255], a[40:43], v[84:87]
    v_mfma_f32_16x16x32_bf16 v[108:111], v[252:255], a[44:47], v[108:111]
    v_mfma_f32_16x16x32_bf16 v[132:135], v[252:255], a[48:51], v[132:135]
    v_mfma_f32_16x16x32_bf16 v[156:159], v[252:255], a[52:55], v[156:159]
    v_mfma_f32_16x16x32_bf16 v[180:183], v[252:255], a[56:59], v[180:183]
    v_mfma_f32_16x16x32_bf16 v[204:207], v[252:255], a[60:63], v[204:207]
    s_waitcnt lgkmcnt(5)
    v_mfma_f32_16x16x32_bf16 v[16:19], v[208:211], a[0:3], v[16:19]
    v_mfma_f32_16x16x32_bf16 v[40:43], v[208:211], a[4:7], v[40:43]
    s_waitcnt vmcnt(43)
    ds_write_b128 v13, a[136:139]
    v_mfma_f32_16x16x32_bf16 v[64:67], v[208:211], a[8:11], v[64:67]
    s_add_u32 s14, s13, 4423680
    buffer_load_dwordx4 a[136:139], v10, s[44:47], s14 offen
    v_mfma_f32_16x16x32_bf16 v[88:91], v[208:211], a[12:15], v[88:91]
    ds_read_b128 a[32:35], v5 offset:4096
    v_mfma_f32_16x16x32_bf16 v[112:115], v[208:211], a[16:19], v[112:115]
    ds_read_b128 a[36:39], v5 offset:22528
    v_mfma_f32_16x16x32_bf16 v[136:139], v[208:211], a[20:23], v[136:139]
    s_waitcnt vmcnt(43)
    ds_write_b128 v14, a[140:143]
    v_mfma_f32_16x16x32_bf16 v[160:163], v[208:211], a[24:27], v[160:163]
    s_add_u32 s14, s13, 4423680
    buffer_load_dwordx4 a[140:143], v11, s[44:47], s14 offen
    v_mfma_f32_16x16x32_bf16 v[184:187], v[208:211], a[28:31], v[184:187]
    ds_read_b128 a[40:43], v5 offset:40960
    s_waitcnt lgkmcnt(9)
    v_mfma_f32_16x16x32_bf16 v[20:23], v[212:215], a[0:3], v[20:23]
    ds_read_b128 a[44:47], v7 offset:4096
    v_mfma_f32_16x16x32_bf16 v[44:47], v[212:215], a[4:7], v[44:47]
    s_waitcnt vmcnt(43)
    ds_write_b128 v15, a[144:147]
    v_mfma_f32_16x16x32_bf16 v[68:71], v[212:215], a[8:11], v[68:71]
    ds_read_b64_tr_b16 v[232:233], v2 offset:0
    v_mfma_f32_16x16x32_bf16 v[92:95], v[212:215], a[12:15], v[92:95]
    ds_read_b64_tr_b16 v[236:237], v2 offset:544
    v_mfma_f32_16x16x32_bf16 v[116:119], v[212:215], a[16:19], v[116:119]
    ds_read_b64_tr_b16 v[240:241], v2 offset:1088
    v_mfma_f32_16x16x32_bf16 v[140:143], v[212:215], a[20:23], v[140:143]
    ds_read_b64_tr_b16 v[244:245], v2 offset:1632
    v_mfma_f32_16x16x32_bf16 v[164:167], v[212:215], a[24:27], v[164:167]
    ds_read_b64_tr_b16 v[248:249], v2 offset:2176
    v_mfma_f32_16x16x32_bf16 v[188:191], v[212:215], a[28:31], v[188:191]
    ds_read_b64_tr_b16 v[252:253], v2 offset:2720
    s_waitcnt lgkmcnt(15)
    v_mfma_f32_16x16x32_bf16 v[24:27], v[216:219], a[0:3], v[24:27]
    s_waitcnt vmcnt(42)
    ds_write_b128 v13, a[148:151]
    v_mfma_f32_16x16x32_bf16 v[48:51], v[216:219], a[4:7], v[48:51]
    s_add_u32 s14, s13, 4423680
    buffer_load_dwordx4 a[144:147], v12, s[44:47], s14 offen
    v_mfma_f32_16x16x32_bf16 v[72:75], v[216:219], a[8:11], v[72:75]
    ds_read_b128 a[48:51], v7 offset:22528
    v_mfma_f32_16x16x32_bf16 v[96:99], v[216:219], a[12:15], v[96:99]
    ds_read_b128 a[52:55], v7 offset:40960
    v_mfma_f32_16x16x32_bf16 v[120:123], v[216:219], a[16:19], v[120:123]
    s_waitcnt vmcnt(42)
    ds_write_b128 v14, a[152:155]
    v_mfma_f32_16x16x32_bf16 v[144:147], v[216:219], a[20:23], v[144:147]
    s_add_u32 s14, s13, 4571136
    buffer_load_dwordx4 a[148:151], v10, s[44:47], s14 offen
    v_mfma_f32_16x16x32_bf16 v[168:171], v[216:219], a[24:27], v[168:171]
    ds_read_b128 a[56:59], v9 offset:4096
    v_mfma_f32_16x16x32_bf16 v[192:195], v[216:219], a[28:31], v[192:195]
    ds_read_b128 a[60:63], v9 offset:22528
    v_mfma_f32_16x16x32_bf16 v[28:31], v[220:223], a[0:3], v[28:31]
    s_waitcnt vmcnt(42)
    ds_write_b128 v15, a[156:159]
    v_mfma_f32_16x16x32_bf16 v[52:55], v[220:223], a[4:7], v[52:55]
    ds_read_b64_tr_b16 v[234:235], v2 offset:0
    v_mfma_f32_16x16x32_bf16 v[76:79], v[220:223], a[8:11], v[76:79]
    ds_read_b64_tr_b16 v[238:239], v2 offset:544
    v_mfma_f32_16x16x32_bf16 v[100:103], v[220:223], a[12:15], v[100:103]
    ds_read_b64_tr_b16 v[242:243], v2 offset:1088
    v_mfma_f32_16x16x32_bf16 v[124:127], v[220:223], a[16:19], v[124:127]
    ds_read_b64_tr_b16 v[246:247], v2 offset:1632
    v_mfma_f32_16x16x32_bf16 v[148:151], v[220:223], a[20:23], v[148:151]
    ds_read_b64_tr_b16 v[250:251], v2 offset:2176
    v_mfma_f32_16x16x32_bf16 v[172:175], v[220:223], a[24:27], v[172:175]
    ds_read_b64_tr_b16 v[254:255], v2 offset:2720
    v_mfma_f32_16x16x32_bf16 v[196:199], v[220:223], a[28:31], v[196:199]
    s_add_u32 s14, s13, 4571136
    buffer_load_dwordx4 a[152:155], v11, s[44:47], s14 offen
    s_waitcnt lgkmcnt(15)
    v_mfma_f32_16x16x32_bf16 v[32:35], v[224:227], a[0:3], v[32:35]
    v_mfma_f32_16x16x32_bf16 v[56:59], v[224:227], a[4:7], v[56:59]
    v_mfma_f32_16x16x32_bf16 v[80:83], v[224:227], a[8:11], v[80:83]
    v_mfma_f32_16x16x32_bf16 v[104:107], v[224:227], a[12:15], v[104:107]
    s_add_u32 s14, s13, 4571136
    buffer_load_dwordx4 a[156:159], v12, s[44:47], s14 offen
    v_mfma_f32_16x16x32_bf16 v[128:131], v[224:227], a[16:19], v[128:131]
    v_mfma_f32_16x16x32_bf16 v[152:155], v[224:227], a[20:23], v[152:155]
    v_mfma_f32_16x16x32_bf16 v[176:179], v[224:227], a[24:27], v[176:179]
    v_mfma_f32_16x16x32_bf16 v[200:203], v[224:227], a[28:31], v[200:203]
    v_mfma_f32_16x16x32_bf16 v[36:39], v[228:231], a[0:3], v[36:39]
    s_add_u32 s10, s58, 6291456
    buffer_load_dword a251, v0, s[76:79], s10 offen
    v_mfma_f32_16x16x32_bf16 v[60:63], v[228:231], a[4:7], v[60:63]
    v_mfma_f32_16x16x32_bf16 v[84:87], v[228:231], a[8:11], v[84:87]
    v_mfma_f32_16x16x32_bf16 v[108:111], v[228:231], a[12:15], v[108:111]
    v_mfma_f32_16x16x32_bf16 v[132:135], v[228:231], a[16:19], v[132:135]
    v_mfma_f32_16x16x32_bf16 v[156:159], v[228:231], a[20:23], v[156:159]
    v_mfma_f32_16x16x32_bf16 v[180:183], v[228:231], a[24:27], v[180:183]
    v_mfma_f32_16x16x32_bf16 v[204:207], v[228:231], a[28:31], v[204:207]
    s_waitcnt lgkmcnt(5)
    v_mfma_f32_16x16x32_bf16 v[16:19], v[232:235], a[32:35], v[16:19]
    v_mfma_f32_16x16x32_bf16 v[40:43], v[232:235], a[36:39], v[40:43]
    s_waitcnt vmcnt(42)
    ds_write_b128 v13, a[160:163]
    v_mfma_f32_16x16x32_bf16 v[64:67], v[232:235], a[40:43], v[64:67]
    s_add_u32 s14, s13, 4718592
    buffer_load_dwordx4 a[160:163], v10, s[44:47], s14 offen
    v_mfma_f32_16x16x32_bf16 v[88:91], v[232:235], a[44:47], v[88:91]
    ds_read_b128 a[0:3], v4 offset:5120
    v_mfma_f32_16x16x32_bf16 v[112:115], v[232:235], a[48:51], v[112:115]
    ds_read_b128 a[4:7], v4 offset:23552
    v_mfma_f32_16x16x32_bf16 v[136:139], v[232:235], a[52:55], v[136:139]
    s_waitcnt vmcnt(42)
    ds_write_b128 v14, a[164:167]
    v_mfma_f32_16x16x32_bf16 v[160:163], v[232:235], a[56:59], v[160:163]
    s_add_u32 s14, s13, 4718592
    buffer_load_dwordx4 a[164:167], v11, s[44:47], s14 offen
    v_mfma_f32_16x16x32_bf16 v[184:187], v[232:235], a[60:63], v[184:187]
    ds_read_b128 a[8:11], v4 offset:41984
    s_waitcnt lgkmcnt(9)
    v_mfma_f32_16x16x32_bf16 v[20:23], v[236:239], a[32:35], v[20:23]
    ds_read_b128 a[12:15], v6 offset:5120
    v_mfma_f32_16x16x32_bf16 v[44:47], v[236:239], a[36:39], v[44:47]
    s_waitcnt vmcnt(42)
    ds_write_b128 v15, a[168:171]
    v_mfma_f32_16x16x32_bf16 v[68:71], v[236:239], a[40:43], v[68:71]
    ds_read_b64_tr_b16 v[208:209], v2 offset:0
    v_mfma_f32_16x16x32_bf16 v[92:95], v[236:239], a[44:47], v[92:95]
    ds_read_b64_tr_b16 v[212:213], v2 offset:544
    v_mfma_f32_16x16x32_bf16 v[116:119], v[236:239], a[48:51], v[116:119]
    ds_read_b64_tr_b16 v[216:217], v2 offset:1088
    v_mfma_f32_16x16x32_bf16 v[140:143], v[236:239], a[52:55], v[140:143]
    ds_read_b64_tr_b16 v[220:221], v2 offset:1632
    v_mfma_f32_16x16x32_bf16 v[164:167], v[236:239], a[56:59], v[164:167]
    ds_read_b64_tr_b16 v[224:225], v2 offset:2176
    v_mfma_f32_16x16x32_bf16 v[188:191], v[236:239], a[60:63], v[188:191]
    ds_read_b64_tr_b16 v[228:229], v2 offset:2720
    s_waitcnt lgkmcnt(15)
    v_mfma_f32_16x16x32_bf16 v[24:27], v[240:243], a[32:35], v[24:27]
    s_waitcnt vmcnt(41)
    ds_write_b128 v13, a[172:175]
    v_mfma_f32_16x16x32_bf16 v[48:51], v[240:243], a[36:39], v[48:51]
    s_add_u32 s14, s13, 4718592
    buffer_load_dwordx4 a[168:171], v12, s[44:47], s14 offen
    v_mfma_f32_16x16x32_bf16 v[72:75], v[240:243], a[40:43], v[72:75]
    ds_read_b128 a[16:19], v6 offset:23552
    v_mfma_f32_16x16x32_bf16 v[96:99], v[240:243], a[44:47], v[96:99]
    ds_read_b128 a[20:23], v6 offset:41984
    v_mfma_f32_16x16x32_bf16 v[120:123], v[240:243], a[48:51], v[120:123]
    s_waitcnt vmcnt(41)
    ds_write_b128 v14, a[176:179]
    v_mfma_f32_16x16x32_bf16 v[144:147], v[240:243], a[52:55], v[144:147]
    s_add_u32 s14, s13, 4866048
    buffer_load_dwordx4 a[172:175], v10, s[44:47], s14 offen
    v_mfma_f32_16x16x32_bf16 v[168:171], v[240:243], a[56:59], v[168:171]
    ds_read_b128 a[24:27], v8 offset:5120
    v_mfma_f32_16x16x32_bf16 v[192:195], v[240:243], a[60:63], v[192:195]
    ds_read_b128 a[28:31], v8 offset:23552
    v_mfma_f32_16x16x32_bf16 v[28:31], v[244:247], a[32:35], v[28:31]
    s_waitcnt vmcnt(41)
    ds_write_b128 v15, a[180:183]
    v_mfma_f32_16x16x32_bf16 v[52:55], v[244:247], a[36:39], v[52:55]
    ds_read_b64_tr_b16 v[210:211], v2 offset:0
    v_mfma_f32_16x16x32_bf16 v[76:79], v[244:247], a[40:43], v[76:79]
    ds_read_b64_tr_b16 v[214:215], v2 offset:544
    v_mfma_f32_16x16x32_bf16 v[100:103], v[244:247], a[44:47], v[100:103]
    ds_read_b64_tr_b16 v[218:219], v2 offset:1088
    v_mfma_f32_16x16x32_bf16 v[124:127], v[244:247], a[48:51], v[124:127]
    ds_read_b64_tr_b16 v[222:223], v2 offset:1632
    v_mfma_f32_16x16x32_bf16 v[148:151], v[244:247], a[52:55], v[148:151]
    ds_read_b64_tr_b16 v[226:227], v2 offset:2176
    v_mfma_f32_16x16x32_bf16 v[172:175], v[244:247], a[56:59], v[172:175]
    ds_read_b64_tr_b16 v[230:231], v2 offset:2720
    v_mfma_f32_16x16x32_bf16 v[196:199], v[244:247], a[60:63], v[196:199]
    s_add_u32 s14, s13, 4866048
    buffer_load_dwordx4 a[176:179], v11, s[44:47], s14 offen
    s_waitcnt lgkmcnt(15)
    v_mfma_f32_16x16x32_bf16 v[32:35], v[248:251], a[32:35], v[32:35]
    v_mfma_f32_16x16x32_bf16 v[56:59], v[248:251], a[36:39], v[56:59]
    v_mfma_f32_16x16x32_bf16 v[80:83], v[248:251], a[40:43], v[80:83]
    v_mfma_f32_16x16x32_bf16 v[104:107], v[248:251], a[44:47], v[104:107]
    s_add_u32 s14, s13, 4866048
    buffer_load_dwordx4 a[180:183], v12, s[44:47], s14 offen
    v_mfma_f32_16x16x32_bf16 v[128:131], v[248:251], a[48:51], v[128:131]
    v_mfma_f32_16x16x32_bf16 v[152:155], v[248:251], a[52:55], v[152:155]
    v_mfma_f32_16x16x32_bf16 v[176:179], v[248:251], a[56:59], v[176:179]
    v_mfma_f32_16x16x32_bf16 v[200:203], v[248:251], a[60:63], v[200:203]
    v_mfma_f32_16x16x32_bf16 v[36:39], v[252:255], a[32:35], v[36:39]
    s_add_u32 s10, s58, 6291456
    buffer_load_dword a251, v0, s[72:75], s10 offen
    v_mfma_f32_16x16x32_bf16 v[60:63], v[252:255], a[36:39], v[60:63]
    v_mfma_f32_16x16x32_bf16 v[84:87], v[252:255], a[40:43], v[84:87]
    v_mfma_f32_16x16x32_bf16 v[108:111], v[252:255], a[44:47], v[108:111]
    v_mfma_f32_16x16x32_bf16 v[132:135], v[252:255], a[48:51], v[132:135]
    v_mfma_f32_16x16x32_bf16 v[156:159], v[252:255], a[52:55], v[156:159]
    v_mfma_f32_16x16x32_bf16 v[180:183], v[252:255], a[56:59], v[180:183]
    v_mfma_f32_16x16x32_bf16 v[204:207], v[252:255], a[60:63], v[204:207]
    s_waitcnt lgkmcnt(5)
    v_mfma_f32_16x16x32_bf16 v[16:19], v[208:211], a[0:3], v[16:19]
    v_mfma_f32_16x16x32_bf16 v[40:43], v[208:211], a[4:7], v[40:43]
    s_waitcnt vmcnt(41)
    ds_write_b128 v13, a[184:187]
    v_mfma_f32_16x16x32_bf16 v[64:67], v[208:211], a[8:11], v[64:67]
    s_add_u32 s14, s13, 5013504
    buffer_load_dwordx4 a[184:187], v10, s[44:47], s14 offen
    v_mfma_f32_16x16x32_bf16 v[88:91], v[208:211], a[12:15], v[88:91]
    ds_read_b128 a[32:35], v5 offset:5120
    v_mfma_f32_16x16x32_bf16 v[112:115], v[208:211], a[16:19], v[112:115]
    ds_read_b128 a[36:39], v5 offset:23552
    v_mfma_f32_16x16x32_bf16 v[136:139], v[208:211], a[20:23], v[136:139]
    s_waitcnt vmcnt(41)
    ds_write_b128 v14, a[188:191]
    v_mfma_f32_16x16x32_bf16 v[160:163], v[208:211], a[24:27], v[160:163]
    s_add_u32 s14, s13, 5013504
    buffer_load_dwordx4 a[188:191], v11, s[44:47], s14 offen
    v_mfma_f32_16x16x32_bf16 v[184:187], v[208:211], a[28:31], v[184:187]
    ds_read_b128 a[40:43], v5 offset:41984
    s_waitcnt lgkmcnt(9)
    v_mfma_f32_16x16x32_bf16 v[20:23], v[212:215], a[0:3], v[20:23]
    ds_read_b128 a[44:47], v7 offset:5120
    v_mfma_f32_16x16x32_bf16 v[44:47], v[212:215], a[4:7], v[44:47]
    s_waitcnt vmcnt(41)
    ds_write_b128 v15, a[192:195]
    v_mfma_f32_16x16x32_bf16 v[68:71], v[212:215], a[8:11], v[68:71]
    ds_read_b64_tr_b16 v[232:233], v2 offset:0
    v_mfma_f32_16x16x32_bf16 v[92:95], v[212:215], a[12:15], v[92:95]
    ds_read_b64_tr_b16 v[236:237], v2 offset:544
    v_mfma_f32_16x16x32_bf16 v[116:119], v[212:215], a[16:19], v[116:119]
    ds_read_b64_tr_b16 v[240:241], v2 offset:1088
    v_mfma_f32_16x16x32_bf16 v[140:143], v[212:215], a[20:23], v[140:143]
    ds_read_b64_tr_b16 v[244:245], v2 offset:1632
    v_mfma_f32_16x16x32_bf16 v[164:167], v[212:215], a[24:27], v[164:167]
    ds_read_b64_tr_b16 v[248:249], v2 offset:2176
    v_mfma_f32_16x16x32_bf16 v[188:191], v[212:215], a[28:31], v[188:191]
    ds_read_b64_tr_b16 v[252:253], v2 offset:2720
    s_waitcnt lgkmcnt(15)
    v_mfma_f32_16x16x32_bf16 v[24:27], v[216:219], a[0:3], v[24:27]
    s_waitcnt vmcnt(40)
    ds_write_b128 v13, a[196:199]
    v_mfma_f32_16x16x32_bf16 v[48:51], v[216:219], a[4:7], v[48:51]
    s_add_u32 s14, s13, 5013504
    buffer_load_dwordx4 a[192:195], v12, s[44:47], s14 offen
    v_mfma_f32_16x16x32_bf16 v[72:75], v[216:219], a[8:11], v[72:75]
    ds_read_b128 a[48:51], v7 offset:23552
    v_mfma_f32_16x16x32_bf16 v[96:99], v[216:219], a[12:15], v[96:99]
    ds_read_b128 a[52:55], v7 offset:41984
    v_mfma_f32_16x16x32_bf16 v[120:123], v[216:219], a[16:19], v[120:123]
    s_waitcnt vmcnt(40)
    ds_write_b128 v14, a[200:203]
    v_mfma_f32_16x16x32_bf16 v[144:147], v[216:219], a[20:23], v[144:147]
    s_add_u32 s14, s13, 5160960
    buffer_load_dwordx4 a[196:199], v10, s[44:47], s14 offen
    v_mfma_f32_16x16x32_bf16 v[168:171], v[216:219], a[24:27], v[168:171]
    ds_read_b128 a[56:59], v9 offset:5120
    v_mfma_f32_16x16x32_bf16 v[192:195], v[216:219], a[28:31], v[192:195]
    ds_read_b128 a[60:63], v9 offset:23552
    v_mfma_f32_16x16x32_bf16 v[28:31], v[220:223], a[0:3], v[28:31]
    s_waitcnt vmcnt(40)
    ds_write_b128 v15, a[204:207]
    v_mfma_f32_16x16x32_bf16 v[52:55], v[220:223], a[4:7], v[52:55]
    ds_read_b64_tr_b16 v[234:235], v2 offset:0
    v_mfma_f32_16x16x32_bf16 v[76:79], v[220:223], a[8:11], v[76:79]
    ds_read_b64_tr_b16 v[238:239], v2 offset:544
    v_mfma_f32_16x16x32_bf16 v[100:103], v[220:223], a[12:15], v[100:103]
    ds_read_b64_tr_b16 v[242:243], v2 offset:1088
    v_mfma_f32_16x16x32_bf16 v[124:127], v[220:223], a[16:19], v[124:127]
    ds_read_b64_tr_b16 v[246:247], v2 offset:1632
    v_mfma_f32_16x16x32_bf16 v[148:151], v[220:223], a[20:23], v[148:151]
    ds_read_b64_tr_b16 v[250:251], v2 offset:2176
    v_mfma_f32_16x16x32_bf16 v[172:175], v[220:223], a[24:27], v[172:175]
    ds_read_b64_tr_b16 v[254:255], v2 offset:2720
    v_mfma_f32_16x16x32_bf16 v[196:199], v[220:223], a[28:31], v[196:199]
    s_add_u32 s14, s13, 5160960
    buffer_load_dwordx4 a[200:203], v11, s[44:47], s14 offen
    s_waitcnt lgkmcnt(15)
    v_mfma_f32_16x16x32_bf16 v[32:35], v[224:227], a[0:3], v[32:35]
    v_mfma_f32_16x16x32_bf16 v[56:59], v[224:227], a[4:7], v[56:59]
    v_mfma_f32_16x16x32_bf16 v[80:83], v[224:227], a[8:11], v[80:83]
    v_mfma_f32_16x16x32_bf16 v[104:107], v[224:227], a[12:15], v[104:107]
    s_add_u32 s14, s13, 5160960
    buffer_load_dwordx4 a[204:207], v12, s[44:47], s14 offen
    v_mfma_f32_16x16x32_bf16 v[128:131], v[224:227], a[16:19], v[128:131]
    v_mfma_f32_16x16x32_bf16 v[152:155], v[224:227], a[20:23], v[152:155]
    v_mfma_f32_16x16x32_bf16 v[176:179], v[224:227], a[24:27], v[176:179]
    v_mfma_f32_16x16x32_bf16 v[200:203], v[224:227], a[28:31], v[200:203]
    v_mfma_f32_16x16x32_bf16 v[36:39], v[228:231], a[0:3], v[36:39]
    s_add_u32 s10, s58, 7864320
    buffer_load_dword a251, v0, s[76:79], s10 offen
    v_mfma_f32_16x16x32_bf16 v[60:63], v[228:231], a[4:7], v[60:63]
    v_mfma_f32_16x16x32_bf16 v[84:87], v[228:231], a[8:11], v[84:87]
    v_mfma_f32_16x16x32_bf16 v[108:111], v[228:231], a[12:15], v[108:111]
    v_mfma_f32_16x16x32_bf16 v[132:135], v[228:231], a[16:19], v[132:135]
    v_mfma_f32_16x16x32_bf16 v[156:159], v[228:231], a[20:23], v[156:159]
    v_mfma_f32_16x16x32_bf16 v[180:183], v[228:231], a[24:27], v[180:183]
    v_mfma_f32_16x16x32_bf16 v[204:207], v[228:231], a[28:31], v[204:207]
    s_waitcnt lgkmcnt(5)
    v_mfma_f32_16x16x32_bf16 v[16:19], v[232:235], a[32:35], v[16:19]
    v_mfma_f32_16x16x32_bf16 v[40:43], v[232:235], a[36:39], v[40:43]
    s_waitcnt vmcnt(41)
    ds_write_b128 v13, a[64:67]
    v_mfma_f32_16x16x32_bf16 v[64:67], v[232:235], a[40:43], v[64:67]
    ds_read_b128 a[0:3], v4 offset:6144
    v_mfma_f32_16x16x32_bf16 v[88:91], v[232:235], a[44:47], v[88:91]
    ds_read_b128 a[4:7], v4 offset:24576
    v_mfma_f32_16x16x32_bf16 v[112:115], v[232:235], a[48:51], v[112:115]
    ds_read_b128 a[8:11], v4 offset:43008
    v_mfma_f32_16x16x32_bf16 v[136:139], v[232:235], a[52:55], v[136:139]
    s_waitcnt vmcnt(40)
    ds_write_b128 v14, a[68:71]
    v_mfma_f32_16x16x32_bf16 v[160:163], v[232:235], a[56:59], v[160:163]
    ds_read_b128 a[12:15], v6 offset:6144
    v_mfma_f32_16x16x32_bf16 v[184:187], v[232:235], a[60:63], v[184:187]
    ds_read_b128 a[16:19], v6 offset:24576
    s_waitcnt lgkmcnt(11)
    v_mfma_f32_16x16x32_bf16 v[20:23], v[236:239], a[32:35], v[20:23]
    ds_read_b128 a[20:23], v6 offset:43008
    v_mfma_f32_16x16x32_bf16 v[44:47], v[236:239], a[36:39], v[44:47]
    s_waitcnt vmcnt(39)
    ds_write_b128 v15, a[72:75]
    v_mfma_f32_16x16x32_bf16 v[68:71], v[236:239], a[40:43], v[68:71]
    ds_read_b64_tr_b16 v[208:209], v2 offset:0
    v_mfma_f32_16x16x32_bf16 v[92:95], v[236:239], a[44:47], v[92:95]
    ds_read_b64_tr_b16 v[212:213], v2 offset:544
    v_mfma_f32_16x16x32_bf16 v[116:119], v[236:239], a[48:51], v[116:119]
    ds_read_b64_tr_b16 v[216:217], v2 offset:1088
    v_mfma_f32_16x16x32_bf16 v[140:143], v[236:239], a[52:55], v[140:143]
    ds_read_b64_tr_b16 v[220:221], v2 offset:1632
    v_mfma_f32_16x16x32_bf16 v[164:167], v[236:239], a[56:59], v[164:167]
    ds_read_b64_tr_b16 v[224:225], v2 offset:2176
    v_mfma_f32_16x16x32_bf16 v[188:191], v[236:239], a[60:63], v[188:191]
    ds_read_b64_tr_b16 v[228:229], v2 offset:2720
    s_waitcnt lgkmcnt(15)
    v_mfma_f32_16x16x32_bf16 v[24:27], v[240:243], a[32:35], v[24:27]
    s_waitcnt vmcnt(38)
    ds_write_b128 v13, a[76:79]
    v_mfma_f32_16x16x32_bf16 v[48:51], v[240:243], a[36:39], v[48:51]
    ds_read_b128 a[24:27], v8 offset:6144
    v_mfma_f32_16x16x32_bf16 v[72:75], v[240:243], a[40:43], v[72:75]
    ds_read_b128 a[28:31], v8 offset:24576
    v_mfma_f32_16x16x32_bf16 v[96:99], v[240:243], a[44:47], v[96:99]
    s_add_u32 s10, s58, 7864320
    buffer_load_dword a251, v0, s[72:75], s10 offen
    v_mfma_f32_16x16x32_bf16 v[120:123], v[240:243], a[48:51], v[120:123]
    s_waitcnt vmcnt(38)
    ds_write_b128 v14, a[80:83]
    v_mfma_f32_16x16x32_bf16 v[144:147], v[240:243], a[52:55], v[144:147]
    v_mfma_f32_16x16x32_bf16 v[168:171], v[240:243], a[56:59], v[168:171]
    v_mfma_f32_16x16x32_bf16 v[192:195], v[240:243], a[60:63], v[192:195]
    v_mfma_f32_16x16x32_bf16 v[28:31], v[244:247], a[32:35], v[28:31]
    s_waitcnt vmcnt(37)
    ds_write_b128 v15, a[84:87]
    v_mfma_f32_16x16x32_bf16 v[52:55], v[244:247], a[36:39], v[52:55]
    ds_read_b64_tr_b16 v[210:211], v2 offset:0
    v_mfma_f32_16x16x32_bf16 v[76:79], v[244:247], a[40:43], v[76:79]
    ds_read_b64_tr_b16 v[214:215], v2 offset:544
    v_mfma_f32_16x16x32_bf16 v[100:103], v[244:247], a[44:47], v[100:103]
    ds_read_b64_tr_b16 v[218:219], v2 offset:1088
    v_mfma_f32_16x16x32_bf16 v[124:127], v[244:247], a[48:51], v[124:127]
    ds_read_b64_tr_b16 v[222:223], v2 offset:1632
    v_mfma_f32_16x16x32_bf16 v[148:151], v[244:247], a[52:55], v[148:151]
    ds_read_b64_tr_b16 v[226:227], v2 offset:2176
    v_mfma_f32_16x16x32_bf16 v[172:175], v[244:247], a[56:59], v[172:175]
    ds_read_b64_tr_b16 v[230:231], v2 offset:2720
    v_mfma_f32_16x16x32_bf16 v[196:199], v[244:247], a[60:63], v[196:199]
    v_mfma_f32_16x16x32_bf16 v[32:35], v[248:251], a[32:35], v[32:35]
    v_mfma_f32_16x16x32_bf16 v[56:59], v[248:251], a[36:39], v[56:59]
    v_mfma_f32_16x16x32_bf16 v[80:83], v[248:251], a[40:43], v[80:83]
    v_mfma_f32_16x16x32_bf16 v[104:107], v[248:251], a[44:47], v[104:107]
    v_mfma_f32_16x16x32_bf16 v[128:131], v[248:251], a[48:51], v[128:131]
    v_mfma_f32_16x16x32_bf16 v[152:155], v[248:251], a[52:55], v[152:155]
    v_mfma_f32_16x16x32_bf16 v[176:179], v[248:251], a[56:59], v[176:179]
    v_mfma_f32_16x16x32_bf16 v[200:203], v[248:251], a[60:63], v[200:203]
    v_mfma_f32_16x16x32_bf16 v[36:39], v[252:255], a[32:35], v[36:39]
    v_mfma_f32_16x16x32_bf16 v[60:63], v[252:255], a[36:39], v[60:63]
    v_mfma_f32_16x16x32_bf16 v[84:87], v[252:255], a[40:43], v[84:87]
    v_mfma_f32_16x16x32_bf16 v[108:111], v[252:255], a[44:47], v[108:111]
    v_mfma_f32_16x16x32_bf16 v[132:135], v[252:255], a[48:51], v[132:135]
    v_mfma_f32_16x16x32_bf16 v[156:159], v[252:255], a[52:55], v[156:159]
    v_mfma_f32_16x16x32_bf16 v[180:183], v[252:255], a[56:59], v[180:183]
    v_mfma_f32_16x16x32_bf16 v[204:207], v[252:255], a[60:63], v[204:207]
    s_waitcnt lgkmcnt(5)
    v_mfma_f32_16x16x32_bf16 v[16:19], v[208:211], a[0:3], v[16:19]
    v_mfma_f32_16x16x32_bf16 v[40:43], v[208:211], a[4:7], v[40:43]
    s_waitcnt vmcnt(35)
    ds_write_b128 v13, a[88:91]
    v_mfma_f32_16x16x32_bf16 v[64:67], v[208:211], a[8:11], v[64:67]
    ds_read_b128 a[32:35], v5 offset:6144
    v_mfma_f32_16x16x32_bf16 v[88:91], v[208:211], a[12:15], v[88:91]
    ds_read_b128 a[36:39], v5 offset:24576
    v_mfma_f32_16x16x32_bf16 v[112:115], v[208:211], a[16:19], v[112:115]
    ds_read_b128 a[40:43], v5 offset:43008
    v_mfma_f32_16x16x32_bf16 v[136:139], v[208:211], a[20:23], v[136:139]
    s_waitcnt vmcnt(34)
    ds_write_b128 v14, a[92:95]
    v_mfma_f32_16x16x32_bf16 v[160:163], v[208:211], a[24:27], v[160:163]
    ds_read_b128 a[44:47], v7 offset:6144
    v_mfma_f32_16x16x32_bf16 v[184:187], v[208:211], a[28:31], v[184:187]
    ds_read_b128 a[48:51], v7 offset:24576
    s_waitcnt lgkmcnt(11)
    v_mfma_f32_16x16x32_bf16 v[20:23], v[212:215], a[0:3], v[20:23]
    ds_read_b128 a[52:55], v7 offset:43008
    v_mfma_f32_16x16x32_bf16 v[44:47], v[212:215], a[4:7], v[44:47]
    s_waitcnt vmcnt(33)
    ds_write_b128 v15, a[96:99]
    v_mfma_f32_16x16x32_bf16 v[68:71], v[212:215], a[8:11], v[68:71]
    ds_read_b64_tr_b16 v[232:233], v2 offset:0
    v_mfma_f32_16x16x32_bf16 v[92:95], v[212:215], a[12:15], v[92:95]
    ds_read_b64_tr_b16 v[236:237], v2 offset:544
    v_mfma_f32_16x16x32_bf16 v[116:119], v[212:215], a[16:19], v[116:119]
    ds_read_b64_tr_b16 v[240:241], v2 offset:1088
    v_mfma_f32_16x16x32_bf16 v[140:143], v[212:215], a[20:23], v[140:143]
    ds_read_b64_tr_b16 v[244:245], v2 offset:1632
    v_mfma_f32_16x16x32_bf16 v[164:167], v[212:215], a[24:27], v[164:167]
    ds_read_b64_tr_b16 v[248:249], v2 offset:2176
    v_mfma_f32_16x16x32_bf16 v[188:191], v[212:215], a[28:31], v[188:191]
    ds_read_b64_tr_b16 v[252:253], v2 offset:2720
    s_waitcnt lgkmcnt(15)
    v_mfma_f32_16x16x32_bf16 v[24:27], v[216:219], a[0:3], v[24:27]
    s_waitcnt vmcnt(32)
    ds_write_b128 v13, a[100:103]
    v_mfma_f32_16x16x32_bf16 v[48:51], v[216:219], a[4:7], v[48:51]
    ds_read_b128 a[56:59], v9 offset:6144
    v_mfma_f32_16x16x32_bf16 v[72:75], v[216:219], a[8:11], v[72:75]
    ds_read_b128 a[60:63], v9 offset:24576
    v_mfma_f32_16x16x32_bf16 v[96:99], v[216:219], a[12:15], v[96:99]
    v_mfma_f32_16x16x32_bf16 v[120:123], v[216:219], a[16:19], v[120:123]
    s_waitcnt vmcnt(31)
    ds_write_b128 v14, a[104:107]
    v_mfma_f32_16x16x32_bf16 v[144:147], v[216:219], a[20:23], v[144:147]
    v_mfma_f32_16x16x32_bf16 v[168:171], v[216:219], a[24:27], v[168:171]
    v_mfma_f32_16x16x32_bf16 v[192:195], v[216:219], a[28:31], v[192:195]
    v_mfma_f32_16x16x32_bf16 v[28:31], v[220:223], a[0:3], v[28:31]
    s_waitcnt vmcnt(30)
    ds_write_b128 v15, a[108:111]
    v_mfma_f32_16x16x32_bf16 v[52:55], v[220:223], a[4:7], v[52:55]
    ds_read_b64_tr_b16 v[234:235], v2 offset:0
    v_mfma_f32_16x16x32_bf16 v[76:79], v[220:223], a[8:11], v[76:79]
    ds_read_b64_tr_b16 v[238:239], v2 offset:544
    v_mfma_f32_16x16x32_bf16 v[100:103], v[220:223], a[12:15], v[100:103]
    ds_read_b64_tr_b16 v[242:243], v2 offset:1088
    v_mfma_f32_16x16x32_bf16 v[124:127], v[220:223], a[16:19], v[124:127]
    ds_read_b64_tr_b16 v[246:247], v2 offset:1632
    v_mfma_f32_16x16x32_bf16 v[148:151], v[220:223], a[20:23], v[148:151]
    ds_read_b64_tr_b16 v[250:251], v2 offset:2176
    v_mfma_f32_16x16x32_bf16 v[172:175], v[220:223], a[24:27], v[172:175]
    ds_read_b64_tr_b16 v[254:255], v2 offset:2720
    v_mfma_f32_16x16x32_bf16 v[196:199], v[220:223], a[28:31], v[196:199]
    v_mfma_f32_16x16x32_bf16 v[32:35], v[224:227], a[0:3], v[32:35]
    v_mfma_f32_16x16x32_bf16 v[56:59], v[224:227], a[4:7], v[56:59]
    v_mfma_f32_16x16x32_bf16 v[80:83], v[224:227], a[8:11], v[80:83]
    v_mfma_f32_16x16x32_bf16 v[104:107], v[224:227], a[12:15], v[104:107]
    v_mfma_f32_16x16x32_bf16 v[128:131], v[224:227], a[16:19], v[128:131]
    v_mfma_f32_16x16x32_bf16 v[152:155], v[224:227], a[20:23], v[152:155]
    v_mfma_f32_16x16x32_bf16 v[176:179], v[224:227], a[24:27], v[176:179]
    v_mfma_f32_16x16x32_bf16 v[200:203], v[224:227], a[28:31], v[200:203]
    v_mfma_f32_16x16x32_bf16 v[36:39], v[228:231], a[0:3], v[36:39]
    v_mfma_f32_16x16x32_bf16 v[60:63], v[228:231], a[4:7], v[60:63]
    v_mfma_f32_16x16x32_bf16 v[84:87], v[228:231], a[8:11], v[84:87]
    v_mfma_f32_16x16x32_bf16 v[108:111], v[228:231], a[12:15], v[108:111]
    v_mfma_f32_16x16x32_bf16 v[132:135], v[228:231], a[16:19], v[132:135]
    v_mfma_f32_16x16x32_bf16 v[156:159], v[228:231], a[20:23], v[156:159]
    v_mfma_f32_16x16x32_bf16 v[180:183], v[228:231], a[24:27], v[180:183]
    v_mfma_f32_16x16x32_bf16 v[204:207], v[228:231], a[28:31], v[204:207]
    s_waitcnt lgkmcnt(5)
    v_mfma_f32_16x16x32_bf16 v[16:19], v[232:235], a[32:35], v[16:19]
    v_mfma_f32_16x16x32_bf16 v[40:43], v[232:235], a[36:39], v[40:43]
    s_waitcnt vmcnt(28)
    ds_write_b128 v13, a[112:115]
    v_mfma_f32_16x16x32_bf16 v[64:67], v[232:235], a[40:43], v[64:67]
    ds_read_b128 a[0:3], v4 offset:7168
    v_mfma_f32_16x16x32_bf16 v[88:91], v[232:235], a[44:47], v[88:91]
    ds_read_b128 a[4:7], v4 offset:25600
    v_mfma_f32_16x16x32_bf16 v[112:115], v[232:235], a[48:51], v[112:115]
    ds_read_b128 a[8:11], v4 offset:44032
    v_mfma_f32_16x16x32_bf16 v[136:139], v[232:235], a[52:55], v[136:139]
    s_waitcnt vmcnt(27)
    ds_write_b128 v14, a[116:119]
    v_mfma_f32_16x16x32_bf16 v[160:163], v[232:235], a[56:59], v[160:163]
    ds_read_b128 a[12:15], v6 offset:7168
    v_mfma_f32_16x16x32_bf16 v[184:187], v[232:235], a[60:63], v[184:187]
    ds_read_b128 a[16:19], v6 offset:25600
    s_waitcnt lgkmcnt(11)
    v_mfma_f32_16x16x32_bf16 v[20:23], v[236:239], a[32:35], v[20:23]
    ds_read_b128 a[20:23], v6 offset:44032
    v_mfma_f32_16x16x32_bf16 v[44:47], v[236:239], a[36:39], v[44:47]
    s_waitcnt vmcnt(26)
    ds_write_b128 v15, a[120:123]
    v_mfma_f32_16x16x32_bf16 v[68:71], v[236:239], a[40:43], v[68:71]
    ds_read_b64_tr_b16 v[208:209], v2 offset:0
    v_mfma_f32_16x16x32_bf16 v[92:95], v[236:239], a[44:47], v[92:95]
    ds_read_b64_tr_b16 v[212:213], v2 offset:544
    v_mfma_f32_16x16x32_bf16 v[116:119], v[236:239], a[48:51], v[116:119]
    ds_read_b64_tr_b16 v[216:217], v2 offset:1088
    v_mfma_f32_16x16x32_bf16 v[140:143], v[236:239], a[52:55], v[140:143]
    ds_read_b64_tr_b16 v[220:221], v2 offset:1632
    v_mfma_f32_16x16x32_bf16 v[164:167], v[236:239], a[56:59], v[164:167]
    ds_read_b64_tr_b16 v[224:225], v2 offset:2176
    v_mfma_f32_16x16x32_bf16 v[188:191], v[236:239], a[60:63], v[188:191]
    ds_read_b64_tr_b16 v[228:229], v2 offset:2720
    s_waitcnt lgkmcnt(15)
    v_mfma_f32_16x16x32_bf16 v[24:27], v[240:243], a[32:35], v[24:27]
    s_waitcnt vmcnt(25)
    ds_write_b128 v13, a[124:127]
    v_mfma_f32_16x16x32_bf16 v[48:51], v[240:243], a[36:39], v[48:51]
    ds_read_b128 a[24:27], v8 offset:7168
    v_mfma_f32_16x16x32_bf16 v[72:75], v[240:243], a[40:43], v[72:75]
    ds_read_b128 a[28:31], v8 offset:25600
    v_mfma_f32_16x16x32_bf16 v[96:99], v[240:243], a[44:47], v[96:99]
    v_mfma_f32_16x16x32_bf16 v[120:123], v[240:243], a[48:51], v[120:123]
    s_waitcnt vmcnt(24)
    ds_write_b128 v14, a[128:131]
    v_mfma_f32_16x16x32_bf16 v[144:147], v[240:243], a[52:55], v[144:147]
    v_mfma_f32_16x16x32_bf16 v[168:171], v[240:243], a[56:59], v[168:171]
    v_mfma_f32_16x16x32_bf16 v[192:195], v[240:243], a[60:63], v[192:195]
    v_mfma_f32_16x16x32_bf16 v[28:31], v[244:247], a[32:35], v[28:31]
    s_waitcnt vmcnt(23)
    ds_write_b128 v15, a[132:135]
    v_mfma_f32_16x16x32_bf16 v[52:55], v[244:247], a[36:39], v[52:55]
    ds_read_b64_tr_b16 v[210:211], v2 offset:0
    v_mfma_f32_16x16x32_bf16 v[76:79], v[244:247], a[40:43], v[76:79]
    ds_read_b64_tr_b16 v[214:215], v2 offset:544
    v_mfma_f32_16x16x32_bf16 v[100:103], v[244:247], a[44:47], v[100:103]
    ds_read_b64_tr_b16 v[218:219], v2 offset:1088
    v_mfma_f32_16x16x32_bf16 v[124:127], v[244:247], a[48:51], v[124:127]
    ds_read_b64_tr_b16 v[222:223], v2 offset:1632
    v_mfma_f32_16x16x32_bf16 v[148:151], v[244:247], a[52:55], v[148:151]
    ds_read_b64_tr_b16 v[226:227], v2 offset:2176
    v_mfma_f32_16x16x32_bf16 v[172:175], v[244:247], a[56:59], v[172:175]
    ds_read_b64_tr_b16 v[230:231], v2 offset:2720
    v_mfma_f32_16x16x32_bf16 v[196:199], v[244:247], a[60:63], v[196:199]
    v_mfma_f32_16x16x32_bf16 v[32:35], v[248:251], a[32:35], v[32:35]
    v_mfma_f32_16x16x32_bf16 v[56:59], v[248:251], a[36:39], v[56:59]
    v_mfma_f32_16x16x32_bf16 v[80:83], v[248:251], a[40:43], v[80:83]
    v_mfma_f32_16x16x32_bf16 v[104:107], v[248:251], a[44:47], v[104:107]
    v_mfma_f32_16x16x32_bf16 v[128:131], v[248:251], a[48:51], v[128:131]
    v_mfma_f32_16x16x32_bf16 v[152:155], v[248:251], a[52:55], v[152:155]
    v_mfma_f32_16x16x32_bf16 v[176:179], v[248:251], a[56:59], v[176:179]
    v_mfma_f32_16x16x32_bf16 v[200:203], v[248:251], a[60:63], v[200:203]
    v_mfma_f32_16x16x32_bf16 v[36:39], v[252:255], a[32:35], v[36:39]
    v_mfma_f32_16x16x32_bf16 v[60:63], v[252:255], a[36:39], v[60:63]
    v_mfma_f32_16x16x32_bf16 v[84:87], v[252:255], a[40:43], v[84:87]
    v_mfma_f32_16x16x32_bf16 v[108:111], v[252:255], a[44:47], v[108:111]
    v_mfma_f32_16x16x32_bf16 v[132:135], v[252:255], a[48:51], v[132:135]
    v_mfma_f32_16x16x32_bf16 v[156:159], v[252:255], a[52:55], v[156:159]
    v_mfma_f32_16x16x32_bf16 v[180:183], v[252:255], a[56:59], v[180:183]
    v_mfma_f32_16x16x32_bf16 v[204:207], v[252:255], a[60:63], v[204:207]
    s_waitcnt lgkmcnt(5)
    v_mfma_f32_16x16x32_bf16 v[16:19], v[208:211], a[0:3], v[16:19]
    v_mfma_f32_16x16x32_bf16 v[40:43], v[208:211], a[4:7], v[40:43]
    s_waitcnt vmcnt(21)
    ds_write_b128 v13, a[136:139]
    v_mfma_f32_16x16x32_bf16 v[64:67], v[208:211], a[8:11], v[64:67]
    ds_read_b128 a[32:35], v5 offset:7168
    v_mfma_f32_16x16x32_bf16 v[88:91], v[208:211], a[12:15], v[88:91]
    ds_read_b128 a[36:39], v5 offset:25600
    v_mfma_f32_16x16x32_bf16 v[112:115], v[208:211], a[16:19], v[112:115]
    ds_read_b128 a[40:43], v5 offset:44032
    v_mfma_f32_16x16x32_bf16 v[136:139], v[208:211], a[20:23], v[136:139]
    s_waitcnt vmcnt(20)
    ds_write_b128 v14, a[140:143]
    v_mfma_f32_16x16x32_bf16 v[160:163], v[208:211], a[24:27], v[160:163]
    ds_read_b128 a[44:47], v7 offset:7168
    v_mfma_f32_16x16x32_bf16 v[184:187], v[208:211], a[28:31], v[184:187]
    ds_read_b128 a[48:51], v7 offset:25600
    s_waitcnt lgkmcnt(11)
    v_mfma_f32_16x16x32_bf16 v[20:23], v[212:215], a[0:3], v[20:23]
    ds_read_b128 a[52:55], v7 offset:44032
    v_mfma_f32_16x16x32_bf16 v[44:47], v[212:215], a[4:7], v[44:47]
    s_waitcnt vmcnt(19)
    ds_write_b128 v15, a[144:147]
    v_mfma_f32_16x16x32_bf16 v[68:71], v[212:215], a[8:11], v[68:71]
    ds_read_b64_tr_b16 v[232:233], v2 offset:0
    v_mfma_f32_16x16x32_bf16 v[92:95], v[212:215], a[12:15], v[92:95]
    ds_read_b64_tr_b16 v[236:237], v2 offset:544
    v_mfma_f32_16x16x32_bf16 v[116:119], v[212:215], a[16:19], v[116:119]
    ds_read_b64_tr_b16 v[240:241], v2 offset:1088
    v_mfma_f32_16x16x32_bf16 v[140:143], v[212:215], a[20:23], v[140:143]
    ds_read_b64_tr_b16 v[244:245], v2 offset:1632
    v_mfma_f32_16x16x32_bf16 v[164:167], v[212:215], a[24:27], v[164:167]
    ds_read_b64_tr_b16 v[248:249], v2 offset:2176
    v_mfma_f32_16x16x32_bf16 v[188:191], v[212:215], a[28:31], v[188:191]
    ds_read_b64_tr_b16 v[252:253], v2 offset:2720
    s_waitcnt lgkmcnt(15)
    v_mfma_f32_16x16x32_bf16 v[24:27], v[216:219], a[0:3], v[24:27]
    s_waitcnt vmcnt(18)
    ds_write_b128 v13, a[148:151]
    v_mfma_f32_16x16x32_bf16 v[48:51], v[216:219], a[4:7], v[48:51]
    ds_read_b128 a[56:59], v9 offset:7168
    v_mfma_f32_16x16x32_bf16 v[72:75], v[216:219], a[8:11], v[72:75]
    ds_read_b128 a[60:63], v9 offset:25600
    v_mfma_f32_16x16x32_bf16 v[96:99], v[216:219], a[12:15], v[96:99]
    v_mfma_f32_16x16x32_bf16 v[120:123], v[216:219], a[16:19], v[120:123]
    s_waitcnt vmcnt(17)
    ds_write_b128 v14, a[152:155]
    v_mfma_f32_16x16x32_bf16 v[144:147], v[216:219], a[20:23], v[144:147]
    v_mfma_f32_16x16x32_bf16 v[168:171], v[216:219], a[24:27], v[168:171]
    v_mfma_f32_16x16x32_bf16 v[192:195], v[216:219], a[28:31], v[192:195]
    v_mfma_f32_16x16x32_bf16 v[28:31], v[220:223], a[0:3], v[28:31]
    s_waitcnt vmcnt(16)
    ds_write_b128 v15, a[156:159]
    v_mfma_f32_16x16x32_bf16 v[52:55], v[220:223], a[4:7], v[52:55]
    ds_read_b64_tr_b16 v[234:235], v2 offset:0
    v_mfma_f32_16x16x32_bf16 v[76:79], v[220:223], a[8:11], v[76:79]
    ds_read_b64_tr_b16 v[238:239], v2 offset:544
    v_mfma_f32_16x16x32_bf16 v[100:103], v[220:223], a[12:15], v[100:103]
    ds_read_b64_tr_b16 v[242:243], v2 offset:1088
    v_mfma_f32_16x16x32_bf16 v[124:127], v[220:223], a[16:19], v[124:127]
    ds_read_b64_tr_b16 v[246:247], v2 offset:1632
    v_mfma_f32_16x16x32_bf16 v[148:151], v[220:223], a[20:23], v[148:151]
    ds_read_b64_tr_b16 v[250:251], v2 offset:2176
    v_mfma_f32_16x16x32_bf16 v[172:175], v[220:223], a[24:27], v[172:175]
    ds_read_b64_tr_b16 v[254:255], v2 offset:2720
    v_mfma_f32_16x16x32_bf16 v[196:199], v[220:223], a[28:31], v[196:199]
    v_mfma_f32_16x16x32_bf16 v[32:35], v[224:227], a[0:3], v[32:35]
    v_mfma_f32_16x16x32_bf16 v[56:59], v[224:227], a[4:7], v[56:59]
    v_mfma_f32_16x16x32_bf16 v[80:83], v[224:227], a[8:11], v[80:83]
    v_mfma_f32_16x16x32_bf16 v[104:107], v[224:227], a[12:15], v[104:107]
    v_mfma_f32_16x16x32_bf16 v[128:131], v[224:227], a[16:19], v[128:131]
    v_mfma_f32_16x16x32_bf16 v[152:155], v[224:227], a[20:23], v[152:155]
    v_mfma_f32_16x16x32_bf16 v[176:179], v[224:227], a[24:27], v[176:179]
    v_mfma_f32_16x16x32_bf16 v[200:203], v[224:227], a[28:31], v[200:203]
    v_mfma_f32_16x16x32_bf16 v[36:39], v[228:231], a[0:3], v[36:39]
    v_mfma_f32_16x16x32_bf16 v[60:63], v[228:231], a[4:7], v[60:63]
    v_mfma_f32_16x16x32_bf16 v[84:87], v[228:231], a[8:11], v[84:87]
    v_mfma_f32_16x16x32_bf16 v[108:111], v[228:231], a[12:15], v[108:111]
    v_mfma_f32_16x16x32_bf16 v[132:135], v[228:231], a[16:19], v[132:135]
    v_mfma_f32_16x16x32_bf16 v[156:159], v[228:231], a[20:23], v[156:159]
    v_mfma_f32_16x16x32_bf16 v[180:183], v[228:231], a[24:27], v[180:183]
    v_mfma_f32_16x16x32_bf16 v[204:207], v[228:231], a[28:31], v[204:207]
    s_waitcnt lgkmcnt(5)
    v_mfma_f32_16x16x32_bf16 v[16:19], v[232:235], a[32:35], v[16:19]
    v_mfma_f32_16x16x32_bf16 v[40:43], v[232:235], a[36:39], v[40:43]
    s_waitcnt vmcnt(14)
    ds_write_b128 v13, a[160:163]
    v_mfma_f32_16x16x32_bf16 v[64:67], v[232:235], a[40:43], v[64:67]
    ds_read_b128 a[0:3], v4 offset:8192
    v_mfma_f32_16x16x32_bf16 v[88:91], v[232:235], a[44:47], v[88:91]
    ds_read_b128 a[4:7], v4 offset:26624
    v_mfma_f32_16x16x32_bf16 v[112:115], v[232:235], a[48:51], v[112:115]
    ds_read_b128 a[8:11], v4 offset:45056
    v_mfma_f32_16x16x32_bf16 v[136:139], v[232:235], a[52:55], v[136:139]
    s_waitcnt vmcnt(13)
    ds_write_b128 v14, a[164:167]
    v_mfma_f32_16x16x32_bf16 v[160:163], v[232:235], a[56:59], v[160:163]
    ds_read_b128 a[12:15], v6 offset:8192
    v_mfma_f32_16x16x32_bf16 v[184:187], v[232:235], a[60:63], v[184:187]
    ds_read_b128 a[16:19], v6 offset:26624
    s_waitcnt lgkmcnt(11)
    v_mfma_f32_16x16x32_bf16 v[20:23], v[236:239], a[32:35], v[20:23]
    ds_read_b128 a[20:23], v6 offset:45056
    v_mfma_f32_16x16x32_bf16 v[44:47], v[236:239], a[36:39], v[44:47]
    s_waitcnt vmcnt(12)
    ds_write_b128 v15, a[168:171]
    v_mfma_f32_16x16x32_bf16 v[68:71], v[236:239], a[40:43], v[68:71]
    ds_read_b64_tr_b16 v[208:209], v2 offset:0
    v_mfma_f32_16x16x32_bf16 v[92:95], v[236:239], a[44:47], v[92:95]
    ds_read_b64_tr_b16 v[212:213], v2 offset:544
    v_mfma_f32_16x16x32_bf16 v[116:119], v[236:239], a[48:51], v[116:119]
    ds_read_b64_tr_b16 v[216:217], v2 offset:1088
    v_mfma_f32_16x16x32_bf16 v[140:143], v[236:239], a[52:55], v[140:143]
    ds_read_b64_tr_b16 v[220:221], v2 offset:1632
    v_mfma_f32_16x16x32_bf16 v[164:167], v[236:239], a[56:59], v[164:167]
    ds_read_b64_tr_b16 v[224:225], v2 offset:2176
    v_mfma_f32_16x16x32_bf16 v[188:191], v[236:239], a[60:63], v[188:191]
    ds_read_b64_tr_b16 v[228:229], v2 offset:2720
    s_waitcnt lgkmcnt(15)
    v_mfma_f32_16x16x32_bf16 v[24:27], v[240:243], a[32:35], v[24:27]
    s_waitcnt vmcnt(11)
    ds_write_b128 v13, a[172:175]
    v_mfma_f32_16x16x32_bf16 v[48:51], v[240:243], a[36:39], v[48:51]
    ds_read_b128 a[24:27], v8 offset:8192
    v_mfma_f32_16x16x32_bf16 v[72:75], v[240:243], a[40:43], v[72:75]
    ds_read_b128 a[28:31], v8 offset:26624
    v_mfma_f32_16x16x32_bf16 v[96:99], v[240:243], a[44:47], v[96:99]
    v_mfma_f32_16x16x32_bf16 v[120:123], v[240:243], a[48:51], v[120:123]
    s_waitcnt vmcnt(10)
    ds_write_b128 v14, a[176:179]
    v_mfma_f32_16x16x32_bf16 v[144:147], v[240:243], a[52:55], v[144:147]
    v_mfma_f32_16x16x32_bf16 v[168:171], v[240:243], a[56:59], v[168:171]
    v_mfma_f32_16x16x32_bf16 v[192:195], v[240:243], a[60:63], v[192:195]
    v_mfma_f32_16x16x32_bf16 v[28:31], v[244:247], a[32:35], v[28:31]
    s_waitcnt vmcnt(9)
    ds_write_b128 v15, a[180:183]
    v_mfma_f32_16x16x32_bf16 v[52:55], v[244:247], a[36:39], v[52:55]
    ds_read_b64_tr_b16 v[210:211], v2 offset:0
    v_mfma_f32_16x16x32_bf16 v[76:79], v[244:247], a[40:43], v[76:79]
    ds_read_b64_tr_b16 v[214:215], v2 offset:544
    v_mfma_f32_16x16x32_bf16 v[100:103], v[244:247], a[44:47], v[100:103]
    ds_read_b64_tr_b16 v[218:219], v2 offset:1088
    v_mfma_f32_16x16x32_bf16 v[124:127], v[244:247], a[48:51], v[124:127]
    ds_read_b64_tr_b16 v[222:223], v2 offset:1632
    v_mfma_f32_16x16x32_bf16 v[148:151], v[244:247], a[52:55], v[148:151]
    ds_read_b64_tr_b16 v[226:227], v2 offset:2176
    v_mfma_f32_16x16x32_bf16 v[172:175], v[244:247], a[56:59], v[172:175]
    ds_read_b64_tr_b16 v[230:231], v2 offset:2720
    v_mfma_f32_16x16x32_bf16 v[196:199], v[244:247], a[60:63], v[196:199]
    v_mfma_f32_16x16x32_bf16 v[32:35], v[248:251], a[32:35], v[32:35]
    v_mfma_f32_16x16x32_bf16 v[56:59], v[248:251], a[36:39], v[56:59]
    v_mfma_f32_16x16x32_bf16 v[80:83], v[248:251], a[40:43], v[80:83]
    v_mfma_f32_16x16x32_bf16 v[104:107], v[248:251], a[44:47], v[104:107]
    v_mfma_f32_16x16x32_bf16 v[128:131], v[248:251], a[48:51], v[128:131]
    v_mfma_f32_16x16x32_bf16 v[152:155], v[248:251], a[52:55], v[152:155]
    v_mfma_f32_16x16x32_bf16 v[176:179], v[248:251], a[56:59], v[176:179]
    v_mfma_f32_16x16x32_bf16 v[200:203], v[248:251], a[60:63], v[200:203]
    v_mfma_f32_16x16x32_bf16 v[36:39], v[252:255], a[32:35], v[36:39]
    v_mfma_f32_16x16x32_bf16 v[60:63], v[252:255], a[36:39], v[60:63]
    v_mfma_f32_16x16x32_bf16 v[84:87], v[252:255], a[40:43], v[84:87]
    v_mfma_f32_16x16x32_bf16 v[108:111], v[252:255], a[44:47], v[108:111]
    v_mfma_f32_16x16x32_bf16 v[132:135], v[252:255], a[48:51], v[132:135]
    v_mfma_f32_16x16x32_bf16 v[156:159], v[252:255], a[52:55], v[156:159]
    v_mfma_f32_16x16x32_bf16 v[180:183], v[252:255], a[56:59], v[180:183]
    v_mfma_f32_16x16x32_bf16 v[204:207], v[252:255], a[60:63], v[204:207]
    s_waitcnt lgkmcnt(5)
    v_mfma_f32_16x16x32_bf16 v[16:19], v[208:211], a[0:3], v[16:19]
    v_mfma_f32_16x16x32_bf16 v[40:43], v[208:211], a[4:7], v[40:43]
    s_waitcnt vmcnt(7)
    ds_write_b128 v13, a[184:187]
    v_mfma_f32_16x16x32_bf16 v[64:67], v[208:211], a[8:11], v[64:67]
    ds_read_b128 a[32:35], v5 offset:8192
    v_mfma_f32_16x16x32_bf16 v[88:91], v[208:211], a[12:15], v[88:91]
    ds_read_b128 a[36:39], v5 offset:26624
    v_mfma_f32_16x16x32_bf16 v[112:115], v[208:211], a[16:19], v[112:115]
    ds_read_b128 a[40:43], v5 offset:45056
    v_mfma_f32_16x16x32_bf16 v[136:139], v[208:211], a[20:23], v[136:139]
    s_waitcnt vmcnt(6)
    ds_write_b128 v14, a[188:191]
    v_mfma_f32_16x16x32_bf16 v[160:163], v[208:211], a[24:27], v[160:163]
    ds_read_b128 a[44:47], v7 offset:8192
    v_mfma_f32_16x16x32_bf16 v[184:187], v[208:211], a[28:31], v[184:187]
    ds_read_b128 a[48:51], v7 offset:26624
    s_waitcnt lgkmcnt(11)
    v_mfma_f32_16x16x32_bf16 v[20:23], v[212:215], a[0:3], v[20:23]
    ds_read_b128 a[52:55], v7 offset:45056
    v_mfma_f32_16x16x32_bf16 v[44:47], v[212:215], a[4:7], v[44:47]
    s_waitcnt vmcnt(5)
    ds_write_b128 v15, a[192:195]
    v_mfma_f32_16x16x32_bf16 v[68:71], v[212:215], a[8:11], v[68:71]
    ds_read_b64_tr_b16 v[232:233], v2 offset:0
    v_mfma_f32_16x16x32_bf16 v[92:95], v[212:215], a[12:15], v[92:95]
    ds_read_b64_tr_b16 v[236:237], v2 offset:544
    v_mfma_f32_16x16x32_bf16 v[116:119], v[212:215], a[16:19], v[116:119]
    ds_read_b64_tr_b16 v[240:241], v2 offset:1088
    v_mfma_f32_16x16x32_bf16 v[140:143], v[212:215], a[20:23], v[140:143]
    ds_read_b64_tr_b16 v[244:245], v2 offset:1632
    v_mfma_f32_16x16x32_bf16 v[164:167], v[212:215], a[24:27], v[164:167]
    ds_read_b64_tr_b16 v[248:249], v2 offset:2176
    v_mfma_f32_16x16x32_bf16 v[188:191], v[212:215], a[28:31], v[188:191]
    ds_read_b64_tr_b16 v[252:253], v2 offset:2720
    s_waitcnt lgkmcnt(15)
    v_mfma_f32_16x16x32_bf16 v[24:27], v[216:219], a[0:3], v[24:27]
    s_waitcnt vmcnt(4)
    ds_write_b128 v13, a[196:199]
    v_mfma_f32_16x16x32_bf16 v[48:51], v[216:219], a[4:7], v[48:51]
    ds_read_b128 a[56:59], v9 offset:8192
    v_mfma_f32_16x16x32_bf16 v[72:75], v[216:219], a[8:11], v[72:75]
    ds_read_b128 a[60:63], v9 offset:26624
    v_mfma_f32_16x16x32_bf16 v[96:99], v[216:219], a[12:15], v[96:99]
    v_mfma_f32_16x16x32_bf16 v[120:123], v[216:219], a[16:19], v[120:123]
    s_waitcnt vmcnt(3)
    ds_write_b128 v14, a[200:203]
    v_mfma_f32_16x16x32_bf16 v[144:147], v[216:219], a[20:23], v[144:147]
    v_mfma_f32_16x16x32_bf16 v[168:171], v[216:219], a[24:27], v[168:171]
    v_mfma_f32_16x16x32_bf16 v[192:195], v[216:219], a[28:31], v[192:195]
    v_mfma_f32_16x16x32_bf16 v[28:31], v[220:223], a[0:3], v[28:31]
    s_waitcnt vmcnt(2)
    ds_write_b128 v15, a[204:207]
    v_mfma_f32_16x16x32_bf16 v[52:55], v[220:223], a[4:7], v[52:55]
    ds_read_b64_tr_b16 v[234:235], v2 offset:0
    v_mfma_f32_16x16x32_bf16 v[76:79], v[220:223], a[8:11], v[76:79]
    ds_read_b64_tr_b16 v[238:239], v2 offset:544
    v_mfma_f32_16x16x32_bf16 v[100:103], v[220:223], a[12:15], v[100:103]
    ds_read_b64_tr_b16 v[242:243], v2 offset:1088
    v_mfma_f32_16x16x32_bf16 v[124:127], v[220:223], a[16:19], v[124:127]
    ds_read_b64_tr_b16 v[246:247], v2 offset:1632
    v_mfma_f32_16x16x32_bf16 v[148:151], v[220:223], a[20:23], v[148:151]
    ds_read_b64_tr_b16 v[250:251], v2 offset:2176
    v_mfma_f32_16x16x32_bf16 v[172:175], v[220:223], a[24:27], v[172:175]
    ds_read_b64_tr_b16 v[254:255], v2 offset:2720
    v_mfma_f32_16x16x32_bf16 v[196:199], v[220:223], a[28:31], v[196:199]
    v_mfma_f32_16x16x32_bf16 v[32:35], v[224:227], a[0:3], v[32:35]
    v_mfma_f32_16x16x32_bf16 v[56:59], v[224:227], a[4:7], v[56:59]
    v_mfma_f32_16x16x32_bf16 v[80:83], v[224:227], a[8:11], v[80:83]
    v_mfma_f32_16x16x32_bf16 v[104:107], v[224:227], a[12:15], v[104:107]
    v_mfma_f32_16x16x32_bf16 v[128:131], v[224:227], a[16:19], v[128:131]
    v_mfma_f32_16x16x32_bf16 v[152:155], v[224:227], a[20:23], v[152:155]
    v_mfma_f32_16x16x32_bf16 v[176:179], v[224:227], a[24:27], v[176:179]
    v_mfma_f32_16x16x32_bf16 v[200:203], v[224:227], a[28:31], v[200:203]
    v_mfma_f32_16x16x32_bf16 v[36:39], v[228:231], a[0:3], v[36:39]
    v_mfma_f32_16x16x32_bf16 v[60:63], v[228:231], a[4:7], v[60:63]
    v_mfma_f32_16x16x32_bf16 v[84:87], v[228:231], a[8:11], v[84:87]
    v_mfma_f32_16x16x32_bf16 v[108:111], v[228:231], a[12:15], v[108:111]
    v_mfma_f32_16x16x32_bf16 v[132:135], v[228:231], a[16:19], v[132:135]
    v_mfma_f32_16x16x32_bf16 v[156:159], v[228:231], a[20:23], v[156:159]
    v_mfma_f32_16x16x32_bf16 v[180:183], v[228:231], a[24:27], v[180:183]
    v_mfma_f32_16x16x32_bf16 v[204:207], v[228:231], a[28:31], v[204:207]
    s_waitcnt lgkmcnt(5)
    v_mfma_f32_16x16x32_bf16 v[16:19], v[232:235], a[32:35], v[16:19]
    v_mfma_f32_16x16x32_bf16 v[40:43], v[232:235], a[36:39], v[40:43]
    v_mfma_f32_16x16x32_bf16 v[64:67], v[232:235], a[40:43], v[64:67]
    v_mfma_f32_16x16x32_bf16 v[88:91], v[232:235], a[44:47], v[88:91]
    v_mfma_f32_16x16x32_bf16 v[112:115], v[232:235], a[48:51], v[112:115]
    v_mfma_f32_16x16x32_bf16 v[136:139], v[232:235], a[52:55], v[136:139]
    v_mfma_f32_16x16x32_bf16 v[160:163], v[232:235], a[56:59], v[160:163]
    v_mfma_f32_16x16x32_bf16 v[184:187], v[232:235], a[60:63], v[184:187]
    s_waitcnt lgkmcnt(4)
    v_mfma_f32_16x16x32_bf16 v[20:23], v[236:239], a[32:35], v[20:23]
    v_mfma_f32_16x16x32_bf16 v[44:47], v[236:239], a[36:39], v[44:47]
    v_mfma_f32_16x16x32_bf16 v[68:71], v[236:239], a[40:43], v[68:71]
    v_mfma_f32_16x16x32_bf16 v[92:95], v[236:239], a[44:47], v[92:95]
    v_mfma_f32_16x16x32_bf16 v[116:119], v[236:239], a[48:51], v[116:119]
    v_mfma_f32_16x16x32_bf16 v[140:143], v[236:239], a[52:55], v[140:143]
    v_mfma_f32_16x16x32_bf16 v[164:167], v[236:239], a[56:59], v[164:167]
    v_mfma_f32_16x16x32_bf16 v[188:191], v[236:239], a[60:63], v[188:191]
    s_waitcnt lgkmcnt(3)
    v_mfma_f32_16x16x32_bf16 v[24:27], v[240:243], a[32:35], v[24:27]
    v_mfma_f32_16x16x32_bf16 v[48:51], v[240:243], a[36:39], v[48:51]
    v_mfma_f32_16x16x32_bf16 v[72:75], v[240:243], a[40:43], v[72:75]
    v_mfma_f32_16x16x32_bf16 v[96:99], v[240:243], a[44:47], v[96:99]
    v_mfma_f32_16x16x32_bf16 v[120:123], v[240:243], a[48:51], v[120:123]
    v_mfma_f32_16x16x32_bf16 v[144:147], v[240:243], a[52:55], v[144:147]
    v_mfma_f32_16x16x32_bf16 v[168:171], v[240:243], a[56:59], v[168:171]
    v_mfma_f32_16x16x32_bf16 v[192:195], v[240:243], a[60:63], v[192:195]
    s_waitcnt lgkmcnt(2)
    v_mfma_f32_16x16x32_bf16 v[28:31], v[244:247], a[32:35], v[28:31]
    v_mfma_f32_16x16x32_bf16 v[52:55], v[244:247], a[36:39], v[52:55]
    v_mfma_f32_16x16x32_bf16 v[76:79], v[244:247], a[40:43], v[76:79]
    v_mfma_f32_16x16x32_bf16 v[100:103], v[244:247], a[44:47], v[100:103]
    v_mfma_f32_16x16x32_bf16 v[124:127], v[244:247], a[48:51], v[124:127]
    v_mfma_f32_16x16x32_bf16 v[148:151], v[244:247], a[52:55], v[148:151]
    v_mfma_f32_16x16x32_bf16 v[172:175], v[244:247], a[56:59], v[172:175]
    v_mfma_f32_16x16x32_bf16 v[196:199], v[244:247], a[60:63], v[196:199]
    s_waitcnt lgkmcnt(1)
    v_mfma_f32_16x16x32_bf16 v[32:35], v[248:251], a[32:35], v[32:35]
    v_mfma_f32_16x16x32_bf16 v[56:59], v[248:251], a[36:39], v[56:59]
    v_mfma_f32_16x16x32_bf16 v[80:83], v[248:251], a[40:43], v[80:83]
    v_mfma_f32_16x16x32_bf16 v[104:107], v[248:251], a[44:47], v[104:107]
    v_mfma_f32_16x16x32_bf16 v[128:131], v[248:251], a[48:51], v[128:131]
    v_mfma_f32_16x16x32_bf16 v[152:155], v[248:251], a[52:55], v[152:155]
    v_mfma_f32_16x16x32_bf16 v[176:179], v[248:251], a[56:59], v[176:179]
    v_mfma_f32_16x16x32_bf16 v[200:203], v[248:251], a[60:63], v[200:203]
    s_waitcnt lgkmcnt(0)
    v_mfma_f32_16x16x32_bf16 v[36:39], v[252:255], a[32:35], v[36:39]
    v_mfma_f32_16x16x32_bf16 v[60:63], v[252:255], a[36:39], v[60:63]
    v_mfma_f32_16x16x32_bf16 v[84:87], v[252:255], a[40:43], v[84:87]
    v_mfma_f32_16x16x32_bf16 v[108:111], v[252:255], a[44:47], v[108:111]
    v_mfma_f32_16x16x32_bf16 v[132:135], v[252:255], a[48:51], v[132:135]
    v_mfma_f32_16x16x32_bf16 v[156:159], v[252:255], a[52:55], v[156:159]
    v_mfma_f32_16x16x32_bf16 v[180:183], v[252:255], a[56:59], v[180:183]
    v_mfma_f32_16x16x32_bf16 v[204:207], v[252:255], a[60:63], v[204:207]
    s_nop 15
    v_and_b32 v2, 15, v1
    v_lshrrev_b32 v3, 4, v1
    v_lshrrev_b32 v4, 1, v3
    v_and_b32 v5, 1, v3
    v_lshl_add_u32 v4, v5, 1, v4
    v_lshl_add_u32 v4, v4, 4, v2
    v_lshlrev_b32 v4, 4, v4
    s_mov_b32 s51, 0x20000
    s_add_u32 s48, s36, 5242880
    s_addc_u32 s49, s37, 0
    s_mov_b32 s50, 18874368
    s_mul_i32 s10, s4, 1152
    s_sub_u32 s11, s5, 3
    s_mul_i32 s11, s11, 12
    s_add_u32 s10, s10, s11
    s_mul_i32 s11, s3, 3
    s_add_u32 s10, s10, s11
    s_lshl_b32 s10, s10, 10
    v_cvt_pk_bf16_f32 v208, v16, v17
    v_cvt_pk_bf16_f32 v209, v18, v19
    v_cvt_pk_bf16_f32 v210, v20, v21
    v_cvt_pk_bf16_f32 v211, v22, v23
    v_pk_max_i16 v208, v208, 0
    v_pk_max_i16 v209, v209, 0
    v_pk_max_i16 v210, v210, 0
    v_pk_max_i16 v211, v211, 0
    s_nop 1
    v_permlane16_swap_b32 v208, v210
    v_permlane16_swap_b32 v209, v211
    buffer_store_dwordx4 v[208:211], v4, s[48:51], s10 offen offset:0 sc1
    v_cvt_pk_bf16_f32 v212, v24, v25
    v_cvt_pk_bf16_f32 v213, v26, v27
    v_cvt_pk_bf16_f32 v214, v28, v29
    v_cvt_pk_bf16_f32 v215, v30, v31
    v_pk_max_i16 v212, v212, 0
    v_pk_max_i16 v213, v213, 0
    v_pk_max_i16 v214, v214, 0
    v_pk_max_i16 v215, v215, 0
    s_nop 1
    v_permlane16_swap_b32 v212, v214
    v_permlane16_swap_b32 v213, v215
    buffer_store_dwordx4 v[212:215], v4, s[48:51], s10 offen offset:1024 sc1
    v_cvt_pk_bf16_f32 v216, v32, v33
    v_cvt_pk_bf16_f32 v217, v34, v35
    v_cvt_pk_bf16_f32 v218, v36, v37
    v_cvt_pk_bf16_f32 v219, v38, v39
    v_pk_max_i16 v216, v216, 0
    v_pk_max_i16 v217, v217, 0
    v_pk_max_i16 v218, v218, 0
    v_pk_max_i16 v219, v219, 0
    s_nop 1
    v_permlane16_swap_b32 v216, v218
    v_permlane16_swap_b32 v217, v219
    buffer_store_dwordx4 v[216:219], v4, s[48:51], s10 offen offset:2048 sc1
    s_add_u32 s10, s10, 147456
    v_cvt_pk_bf16_f32 v224, v40, v41
    v_cvt_pk_bf16_f32 v225, v42, v43
    v_cvt_pk_bf16_f32 v226, v44, v45
    v_cvt_pk_bf16_f32 v227, v46, v47
    v_pk_max_i16 v224, v224, 0
    v_pk_max_i16 v225, v225, 0
    v_pk_max_i16 v226, v226, 0
    v_pk_max_i16 v227, v227, 0
    s_nop 1
    v_permlane16_swap_b32 v224, v226
    v_permlane16_swap_b32 v225, v227
    buffer_store_dwordx4 v[224:227], v4, s[48:51], s10 offen offset:0 sc1
    v_cvt_pk_bf16_f32 v228, v48, v49
    v_cvt_pk_bf16_f32 v229, v50, v51
    v_cvt_pk_bf16_f32 v230, v52, v53
    v_cvt_pk_bf16_f32 v231, v54, v55
    v_pk_max_i16 v228, v228, 0
    v_pk_max_i16 v229, v229, 0
    v_pk_max_i16 v230, v230, 0
    v_pk_max_i16 v231, v231, 0
    s_nop 1
    v_permlane16_swap_b32 v228, v230
    v_permlane16_swap_b32 v229, v231
    buffer_store_dwordx4 v[228:231], v4, s[48:51], s10 offen offset:1024 sc1
    v_cvt_pk_bf16_f32 v232, v56, v57
    v_cvt_pk_bf16_f32 v233, v58, v59
    v_cvt_pk_bf16_f32 v234, v60, v61
    v_cvt_pk_bf16_f32 v235, v62, v63
    v_pk_max_i16 v232, v232, 0
    v_pk_max_i16 v233, v233, 0
    v_pk_max_i16 v234, v234, 0
    v_pk_max_i16 v235, v235, 0
    s_nop 1
    v_permlane16_swap_b32 v232, v234
    v_permlane16_swap_b32 v233, v235
    buffer_store_dwordx4 v[232:235], v4, s[48:51], s10 offen offset:2048 sc1
    s_add_u32 s10, s10, 147456
    v_cvt_pk_bf16_f32 v240, v64, v65
    v_cvt_pk_bf16_f32 v241, v66, v67
    v_cvt_pk_bf16_f32 v242, v68, v69
    v_cvt_pk_bf16_f32 v243, v70, v71
    v_pk_max_i16 v240, v240, 0
    v_pk_max_i16 v241, v241, 0
    v_pk_max_i16 v242, v242, 0
    v_pk_max_i16 v243, v243, 0
    s_nop 1
    v_permlane16_swap_b32 v240, v242
    v_permlane16_swap_b32 v241, v243
    buffer_store_dwordx4 v[240:243], v4, s[48:51], s10 offen offset:0 sc1
    v_cvt_pk_bf16_f32 v244, v72, v73
    v_cvt_pk_bf16_f32 v245, v74, v75
    v_cvt_pk_bf16_f32 v246, v76, v77
    v_cvt_pk_bf16_f32 v247, v78, v79
    v_pk_max_i16 v244, v244, 0
    v_pk_max_i16 v245, v245, 0
    v_pk_max_i16 v246, v246, 0
    v_pk_max_i16 v247, v247, 0
    s_nop 1
    v_permlane16_swap_b32 v244, v246
    v_permlane16_swap_b32 v245, v247
    buffer_store_dwordx4 v[244:247], v4, s[48:51], s10 offen offset:1024 sc1
    v_cvt_pk_bf16_f32 v248, v80, v81
    v_cvt_pk_bf16_f32 v249, v82, v83
    v_cvt_pk_bf16_f32 v250, v84, v85
    v_cvt_pk_bf16_f32 v251, v86, v87
    v_pk_max_i16 v248, v248, 0
    v_pk_max_i16 v249, v249, 0
    v_pk_max_i16 v250, v250, 0
    v_pk_max_i16 v251, v251, 0
    s_nop 1
    v_permlane16_swap_b32 v248, v250
    v_permlane16_swap_b32 v249, v251
    buffer_store_dwordx4 v[248:251], v4, s[48:51], s10 offen offset:2048 sc1
    s_add_u32 s10, s10, 147456
    v_cvt_pk_bf16_f32 v208, v88, v89
    v_cvt_pk_bf16_f32 v209, v90, v91
    v_cvt_pk_bf16_f32 v210, v92, v93
    v_cvt_pk_bf16_f32 v211, v94, v95
    v_pk_max_i16 v208, v208, 0
    v_pk_max_i16 v209, v209, 0
    v_pk_max_i16 v210, v210, 0
    v_pk_max_i16 v211, v211, 0
    s_nop 1
    v_permlane16_swap_b32 v208, v210
    v_permlane16_swap_b32 v209, v211
    buffer_store_dwordx4 v[208:211], v4, s[48:51], s10 offen offset:0 sc1
    v_cvt_pk_bf16_f32 v212, v96, v97
    v_cvt_pk_bf16_f32 v213, v98, v99
    v_cvt_pk_bf16_f32 v214, v100, v101
    v_cvt_pk_bf16_f32 v215, v102, v103
    v_pk_max_i16 v212, v212, 0
    v_pk_max_i16 v213, v213, 0
    v_pk_max_i16 v214, v214, 0
    v_pk_max_i16 v215, v215, 0
    s_nop 1
    v_permlane16_swap_b32 v212, v214
    v_permlane16_swap_b32 v213, v215
    buffer_store_dwordx4 v[212:215], v4, s[48:51], s10 offen offset:1024 sc1
    v_cvt_pk_bf16_f32 v216, v104, v105
    v_cvt_pk_bf16_f32 v217, v106, v107
    v_cvt_pk_bf16_f32 v218, v108, v109
    v_cvt_pk_bf16_f32 v219, v110, v111
    v_pk_max_i16 v216, v216, 0
    v_pk_max_i16 v217, v217, 0
    v_pk_max_i16 v218, v218, 0
    v_pk_max_i16 v219, v219, 0
    s_nop 1
    v_permlane16_swap_b32 v216, v218
    v_permlane16_swap_b32 v217, v219
    buffer_store_dwordx4 v[216:219], v4, s[48:51], s10 offen offset:2048 sc1
    s_add_u32 s10, s10, 147456
    v_cvt_pk_bf16_f32 v224, v112, v113
    v_cvt_pk_bf16_f32 v225, v114, v115
    v_cvt_pk_bf16_f32 v226, v116, v117
    v_cvt_pk_bf16_f32 v227, v118, v119
    v_pk_max_i16 v224, v224, 0
    v_pk_max_i16 v225, v225, 0
    v_pk_max_i16 v226, v226, 0
    v_pk_max_i16 v227, v227, 0
    s_nop 1
    v_permlane16_swap_b32 v224, v226
    v_permlane16_swap_b32 v225, v227
    buffer_store_dwordx4 v[224:227], v4, s[48:51], s10 offen offset:0 sc1
    v_cvt_pk_bf16_f32 v228, v120, v121
    v_cvt_pk_bf16_f32 v229, v122, v123
    v_cvt_pk_bf16_f32 v230, v124, v125
    v_cvt_pk_bf16_f32 v231, v126, v127
    v_pk_max_i16 v228, v228, 0
    v_pk_max_i16 v229, v229, 0
    v_pk_max_i16 v230, v230, 0
    v_pk_max_i16 v231, v231, 0
    s_nop 1
    v_permlane16_swap_b32 v228, v230
    v_permlane16_swap_b32 v229, v231
    buffer_store_dwordx4 v[228:231], v4, s[48:51], s10 offen offset:1024 sc1
    v_cvt_pk_bf16_f32 v232, v128, v129
    v_cvt_pk_bf16_f32 v233, v130, v131
    v_cvt_pk_bf16_f32 v234, v132, v133
    v_cvt_pk_bf16_f32 v235, v134, v135
    v_pk_max_i16 v232, v232, 0
    v_pk_max_i16 v233, v233, 0
    v_pk_max_i16 v234, v234, 0
    v_pk_max_i16 v235, v235, 0
    s_nop 1
    v_permlane16_swap_b32 v232, v234
    v_permlane16_swap_b32 v233, v235
    buffer_store_dwordx4 v[232:235], v4, s[48:51], s10 offen offset:2048 sc1
    s_add_u32 s10, s10, 147456
    v_cvt_pk_bf16_f32 v240, v136, v137
    v_cvt_pk_bf16_f32 v241, v138, v139
    v_cvt_pk_bf16_f32 v242, v140, v141
    v_cvt_pk_bf16_f32 v243, v142, v143
    v_pk_max_i16 v240, v240, 0
    v_pk_max_i16 v241, v241, 0
    v_pk_max_i16 v242, v242, 0
    v_pk_max_i16 v243, v243, 0
    s_nop 1
    v_permlane16_swap_b32 v240, v242
    v_permlane16_swap_b32 v241, v243
    buffer_store_dwordx4 v[240:243], v4, s[48:51], s10 offen offset:0 sc1
    v_cvt_pk_bf16_f32 v244, v144, v145
    v_cvt_pk_bf16_f32 v245, v146, v147
    v_cvt_pk_bf16_f32 v246, v148, v149
    v_cvt_pk_bf16_f32 v247, v150, v151
    v_pk_max_i16 v244, v244, 0
    v_pk_max_i16 v245, v245, 0
    v_pk_max_i16 v246, v246, 0
    v_pk_max_i16 v247, v247, 0
    s_nop 1
    v_permlane16_swap_b32 v244, v246
    v_permlane16_swap_b32 v245, v247
    buffer_store_dwordx4 v[244:247], v4, s[48:51], s10 offen offset:1024 sc1
    v_cvt_pk_bf16_f32 v248, v152, v153
    v_cvt_pk_bf16_f32 v249, v154, v155
    v_cvt_pk_bf16_f32 v250, v156, v157
    v_cvt_pk_bf16_f32 v251, v158, v159
    v_pk_max_i16 v248, v248, 0
    v_pk_max_i16 v249, v249, 0
    v_pk_max_i16 v250, v250, 0
    v_pk_max_i16 v251, v251, 0
    s_nop 1
    v_permlane16_swap_b32 v248, v250
    v_permlane16_swap_b32 v249, v251
    buffer_store_dwordx4 v[248:251], v4, s[48:51], s10 offen offset:2048 sc1
    s_add_u32 s10, s10, 147456
    v_cvt_pk_bf16_f32 v208, v160, v161
    v_cvt_pk_bf16_f32 v209, v162, v163
    v_cvt_pk_bf16_f32 v210, v164, v165
    v_cvt_pk_bf16_f32 v211, v166, v167
    v_pk_max_i16 v208, v208, 0
    v_pk_max_i16 v209, v209, 0
    v_pk_max_i16 v210, v210, 0
    v_pk_max_i16 v211, v211, 0
    s_nop 1
    v_permlane16_swap_b32 v208, v210
    v_permlane16_swap_b32 v209, v211
    buffer_store_dwordx4 v[208:211], v4, s[48:51], s10 offen offset:0 sc1
    v_cvt_pk_bf16_f32 v212, v168, v169
    v_cvt_pk_bf16_f32 v213, v170, v171
    v_cvt_pk_bf16_f32 v214, v172, v173
    v_cvt_pk_bf16_f32 v215, v174, v175
    v_pk_max_i16 v212, v212, 0
    v_pk_max_i16 v213, v213, 0
    v_pk_max_i16 v214, v214, 0
    v_pk_max_i16 v215, v215, 0
    s_nop 1
    v_permlane16_swap_b32 v212, v214
    v_permlane16_swap_b32 v213, v215
    buffer_store_dwordx4 v[212:215], v4, s[48:51], s10 offen offset:1024 sc1
    v_cvt_pk_bf16_f32 v216, v176, v177
    v_cvt_pk_bf16_f32 v217, v178, v179
    v_cvt_pk_bf16_f32 v218, v180, v181
    v_cvt_pk_bf16_f32 v219, v182, v183
    v_pk_max_i16 v216, v216, 0
    v_pk_max_i16 v217, v217, 0
    v_pk_max_i16 v218, v218, 0
    v_pk_max_i16 v219, v219, 0
    s_nop 1
    v_permlane16_swap_b32 v216, v218
    v_permlane16_swap_b32 v217, v219
    buffer_store_dwordx4 v[216:219], v4, s[48:51], s10 offen offset:2048 sc1
    s_add_u32 s10, s10, 147456
    v_cvt_pk_bf16_f32 v224, v184, v185
    v_cvt_pk_bf16_f32 v225, v186, v187
    v_cvt_pk_bf16_f32 v226, v188, v189
    v_cvt_pk_bf16_f32 v227, v190, v191
    v_pk_max_i16 v224, v224, 0
    v_pk_max_i16 v225, v225, 0
    v_pk_max_i16 v226, v226, 0
    v_pk_max_i16 v227, v227, 0
    s_nop 1
    v_permlane16_swap_b32 v224, v226
    v_permlane16_swap_b32 v225, v227
    buffer_store_dwordx4 v[224:227], v4, s[48:51], s10 offen offset:0 sc1
    v_cvt_pk_bf16_f32 v228, v192, v193
    v_cvt_pk_bf16_f32 v229, v194, v195
    v_cvt_pk_bf16_f32 v230, v196, v197
    v_cvt_pk_bf16_f32 v231, v198, v199
    v_pk_max_i16 v228, v228, 0
    v_pk_max_i16 v229, v229, 0
    v_pk_max_i16 v230, v230, 0
    v_pk_max_i16 v231, v231, 0
    s_nop 1
    v_permlane16_swap_b32 v228, v230
    v_permlane16_swap_b32 v229, v231
    buffer_store_dwordx4 v[228:231], v4, s[48:51], s10 offen offset:1024 sc1
    v_cvt_pk_bf16_f32 v232, v200, v201
    v_cvt_pk_bf16_f32 v233, v202, v203
    v_cvt_pk_bf16_f32 v234, v204, v205
    v_cvt_pk_bf16_f32 v235, v206, v207
    v_pk_max_i16 v232, v232, 0
    v_pk_max_i16 v233, v233, 0
    v_pk_max_i16 v234, v234, 0
    v_pk_max_i16 v235, v235, 0
    s_nop 1
    v_permlane16_swap_b32 v232, v234
    v_permlane16_swap_b32 v233, v235
    buffer_store_dwordx4 v[232:235], v4, s[48:51], s10 offen offset:2048 sc1
    s_add_u32 s10, s10, 147456
    s_waitcnt vmcnt(0)
    s_branch K1_end
K1_ab:
    s_lshl_b32 s12, s3, 12
    s_add_u32 s12, s12, 147456
    s_mul_i32 s13, s5, 384
    s_mul_i32 s14, s3, 96
    s_add_u32 s13, s13, s14
    s_cmp_ge_u32 s13, 576
    s_cselect_b32 s44, s24, s22
    s_cselect_b32 s45, s25, s23
    s_cselect_b32 s15, 576, 0
    s_cselect_b32 s60, 2359296, 0
    s_cselect_b32 s61, 0x80008000, 0
    s_mov_b32 s46, 663552
    s_mov_b32 s47, 0x20000
    s_sub_u32 s62, s13, s15
    s_mul_i32 s13, s62, 1152
    v_mul_u32_u24 v182, 1152, v5
    v_lshl_add_u32 v184, v4, 4, v182
    v_xor_b32 v182, v4, v5
    v_lshlrev_b32 v182, 4, v182
    v_lshl_add_u32 v182, v5, 7, v182
    v_add_u32 v187, s12, v182
    v_xor_b32 v188, 16, v187
    v_and_b32 v180, 7, v2
    v_lshrrev_b32 v181, 3, v2
    v_xor_b32 v180, v180, v181
    v_lshrrev_b32 v181, 1, v3
    v_xor_b32 v180, v180, v181
    v_lshlrev_b32 v180, 4, v180
    v_lshl_add_u32 v180, v2, 7, v180
    v_and_b32 v181, 1, v3
    v_lshl_add_u32 v180, v181, 3, v180
    v_add_u32 v190, s12, v180
    s_add_u32 s52, s36, 25165824
    s_addc_u32 s53, s37, 0
    s_mov_b32 s54, 9437184
    s_mov_b32 s55, 0x20000
    s_bfe_u32 s38, s2, 0x20001
    s_and_b32 s56, s2, 1
    s_lshl_b32 s56, s56, 3
    s_lshr_b32 s59, s2, 5
    s_add_u32 s56, s56, s59
    s_lshl_b32 s56, s56, 2
    s_bfe_u32 s59, s2, 0x20003
    s_add_u32 s56, s56, s59
    s_lshl_b32 s63, s56, 14
    s_add_u32 s63, s63, 8388608
    s_lshl_b32 s59, s38, 10
    s_add_u32 s63, s63, s59
    s_lshl_b32 s56, s56, 17
    s_lshl_b32 s59, s3, 13
    s_add_u32 s56, s56, s59
    s_add_u32 s59, s3, s38
    s_and_b32 s59, s59, 3
    s_lshl_b32 s59, s59, 11
    s_add_u32 s56, s56, s59
    s_mov_b32 s76, s18
    s_mov_b32 s77, s19
    s_mov_b32 s78, 8388608
    s_mov_b32 s79, 0x20000
    s_mov_b32 s72, s20
    s_mov_b32 s73, s21
    s_mov_b32 s74, 8388608
    s_mov_b32 s75, 0x20000
    s_lshl_b32 s57, s9, 13
    s_lshl_b32 s58, s39, 11
    v_and_b32 v180, 7, v2
    v_lshrrev_b32 v181, 3, v2
    v_mul_u32_u24 v181, 9216, v181
    v_lshl_add_u32 v181, v180, 7, v181
    v_xor_b32 v182, v3, v180
    v_lshl_add_u32 v192, v182, 4, v181
    v_add_u32 v193, s6, v192
    v_xor_b32 v194, 64, v193
    v_and_b32 v182, 1, v3
    v_lshlrev_b32 v182, 1, v182
    v_xor_b32 v182, v182, v180
    v_lshl_add_u32 v182, v182, 4, v181
    v_lshrrev_b32 v183, 1, v3
    v_lshl_add_u32 v182, v183, 3, v182
    v_add_u32 v195, s6, v182
    v_xor_b32 v196, 16, v195
    v_xor_b32 v197, 64, v195
    v_xor_b32 v198, 80, v195
    v_lshrrev_b32 v182, 2, v2
    v_lshl_add_u32 v182, v182, 4, v2
    v_lshlrev_b32 v199, 2, v182
    v_and_b32 v182, 3, v1
    v_cmp_eq_u32 s[64:65], 1, v182
    v_cmp_eq_u32 s[66:67], 2, v182
    v_cmp_eq_u32 s[68:69], 3, v182
    v_mov_b32 v176, 0x3f803f80
    v_mov_b32 v177, 0x3f803f80
    v_mov_b32 v178, 0x3f803f80
    v_mov_b32 v179, 0x3f803f80
    s_mov_b32 s70, 0x3ae38e39
    s_mov_b32 s71, 0x3727c5ac
    v_lshrrev_b32 v0, 2, v1
    v_lshlrev_b32 v0, 7, v0
    v_mov_b32 v12, -1
    v_mov_b32 v13, -1
    v_mov_b32 v14, -1
    v_mov_b32 v15, -1
    v_lshlrev_b32 v8, 4, v1
    s_waitcnt vmcnt(0)
    ds_read_b128 v[16:19], v193 offset:0
    ds_read_b128 v[20:23], v194 offset:0
    ds_read_b128 v[24:27], v193 offset:1024
    ds_read_b128 v[28:31], v194 offset:1024
    ds_read_b128 v[32:35], v193 offset:2048
    ds_read_b128 v[36:39], v194 offset:2048
    ds_read_b128 v[40:43], v193 offset:3072
    ds_read_b128 v[44:47], v194 offset:3072
    ds_read_b128 v[48:51], v193 offset:4096
    ds_read_b128 v[52:55], v194 offset:4096
    ds_read_b128 v[56:59], v193 offset:5120
    ds_read_b128 v[60:63], v194 offset:5120
    ds_read_b128 v[64:67], v193 offset:6144
    ds_read_b128 v[68:71], v194 offset:6144
    ds_read_b128 v[72:75], v193 offset:7168
    ds_read_b128 v[76:79], v194 offset:7168
    ds_read_b128 v[80:83], v193 offset:8192
    ds_read_b128 v[84:87], v194 offset:8192
    s_waitcnt lgkmcnt(15)
    v_mfma_f32_16x16x32_bf16 v[160:163], v[176:179], v[16:19], 0
    v_mfma_f32_16x16x32_bf16 v[164:167], v[16:19], v[16:19], 0
    v_mfma_f32_16x16x32_bf16 v[160:163], v[176:179], v[20:23], v[160:163]
    v_mfma_f32_16x16x32_bf16 v[164:167], v[20:23], v[20:23], v[164:167]
    v_mfma_f32_16x16x32_bf16 v[160:163], v[176:179], v[24:27], v[160:163]
    v_mfma_f32_16x16x32_bf16 v[164:167], v[24:27], v[24:27], v[164:167]
    s_add_u32 m0, s6, 18432
    s_add_u32 s11, s7, 18432
    buffer_load_dwordx4 v6, s[40:43], s11 offen lds
    s_waitcnt lgkmcnt(14)
    v_mfma_f32_16x16x32_bf16 v[160:163], v[176:179], v[28:31], v[160:163]
    v_mfma_f32_16x16x32_bf16 v[164:167], v[28:31], v[28:31], v[164:167]
    s_waitcnt lgkmcnt(13)
    v_mfma_f32_16x16x32_bf16 v[160:163], v[176:179], v[32:35], v[160:163]
    v_mfma_f32_16x16x32_bf16 v[164:167], v[32:35], v[32:35], v[164:167]
    s_waitcnt lgkmcnt(12)
    v_mfma_f32_16x16x32_bf16 v[160:163], v[176:179], v[36:39], v[160:163]
    v_mfma_f32_16x16x32_bf16 v[164:167], v[36:39], v[36:39], v[164:167]
    s_add_u32 m0, s6, 19456
    s_add_u32 s11, s7, 18560
    buffer_load_dwordx4 v6, s[40:43], s11 offen lds
    s_waitcnt lgkmcnt(11)
    v_mfma_f32_16x16x32_bf16 v[160:163], v[176:179], v[40:43], v[160:163]
    v_mfma_f32_16x16x32_bf16 v[164:167], v[40:43], v[40:43], v[164:167]
    s_waitcnt lgkmcnt(10)
    v_mfma_f32_16x16x32_bf16 v[160:163], v[176:179], v[44:47], v[160:163]
    v_mfma_f32_16x16x32_bf16 v[164:167], v[44:47], v[44:47], v[164:167]
    s_waitcnt lgkmcnt(9)
    v_mfma_f32_16x16x32_bf16 v[160:163], v[176:179], v[48:51], v[160:163]
    v_mfma_f32_16x16x32_bf16 v[164:167], v[48:51], v[48:51], v[164:167]
    s_add_u32 m0, s6, 20480
    s_add_u32 s11, s7, 18688
    buffer_load_dwordx4 v6, s[40:43], s11 offen lds
    s_waitcnt lgkmcnt(8)
    v_mfma_f32_16x16x32_bf16 v[160:163], v[176:179], v[52:55], v[160:163]
    v_mfma_f32_16x16x32_bf16 v[164:167], v[52:55], v[52:55], v[164:167]
    s_waitcnt lgkmcnt(7)
    v_mfma_f32_16x16x32_bf16 v[160:163], v[176:179], v[56:59], v[160:163]
    v_mfma_f32_16x16x32_bf16 v[164:167], v[56:59], v[56:59], v[164:167]
    s_waitcnt lgkmcnt(6)
    v_mfma_f32_16x16x32_bf16 v[160:163], v[176:179], v[60:63], v[160:163]
    v_mfma_f32_16x16x32_bf16 v[164:167], v[60:63], v[60:63], v[164:167]
    s_add_u32 m0, s6, 21504
    s_add_u32 s11, s7, 18816
    buffer_load_dwordx4 v6, s[40:43], s11 offen lds
    s_waitcnt lgkmcnt(5)
    v_mfma_f32_16x16x32_bf16 v[160:163], v[176:179], v[64:67], v[160:163]
    v_mfma_f32_16x16x32_bf16 v[164:167], v[64:67], v[64:67], v[164:167]
    s_waitcnt lgkmcnt(4)
    v_mfma_f32_16x16x32_bf16 v[160:163], v[176:179], v[68:71], v[160:163]
    v_mfma_f32_16x16x32_bf16 v[164:167], v[68:71], v[68:71], v[164:167]
    s_waitcnt lgkmcnt(3)
    v_mfma_f32_16x16x32_bf16 v[160:163], v[176:179], v[72:75], v[160:163]
    v_mfma_f32_16x16x32_bf16 v[164:167], v[72:75], v[72:75], v[164:167]
    s_add_u32 m0, s6, 22528
    s_add_u32 s11, s7, 18944
    buffer_load_dwordx4 v6, s[40:43], s11 offen lds
    s_waitcnt lgkmcnt(2)
    v_mfma_f32_16x16x32_bf16 v[160:163], v[176:179], v[76:79], v[160:163]
    v_mfma_f32_16x16x32_bf16 v[164:167], v[76:79], v[76:79], v[164:167]
    s_waitcnt lgkmcnt(1)
    v_mfma_f32_16x16x32_bf16 v[160:163], v[176:179], v[80:83], v[160:163]
    v_mfma_f32_16x16x32_bf16 v[164:167], v[80:83], v[80:83], v[164:167]
    s_waitcnt lgkmcnt(0)
    v_mfma_f32_16x16x32_bf16 v[160:163], v[176:179], v[84:87], v[160:163]
    v_mfma_f32_16x16x32_bf16 v[164:167], v[84:87], v[84:87], v[164:167]
    s_add_u32 m0, s6, 23552
    s_add_u32 s11, s7, 19072
    buffer_load_dwordx4 v6, s[40:43], s11 offen lds
    s_nop 15
    v_cndmask_b32 v164, v164, v165, s[64:65]
    v_cndmask_b32 v164, v164, v166, s[66:67]
    v_cndmask_b32 v164, v164, v167, s[68:69]
    ds_bpermute_b32 v165, v199, v164
    s_waitcnt lgkmcnt(0)
    v_mul_f32 v160, s70, v160
    v_mul_f32 v165, s70, v165
    v_fma_f32 v165, -v160, v160, v165
    v_max_f32 v165, 0, v165
    v_cvt_pk_bf16_f32 v164, v160, v165
    v_lshlrev_b32 v160, 16, v164
    v_and_b32 v165, s95, v164
    v_add_f32 v165, s71, v165
    v_cvt_pk_bf16_f32 v165, v165, v165
    v_and_b32 v165, s95, v165
    v_sqrt_f32 v165, v165
    s_nop 0
    v_cvt_pk_bf16_f32 v165, v165, v165
    v_and_b32 v165, s95, v165
    v_rcp_f32 v166, v165
    s_nop 0
    v_fma_f32 v167, -v165, v166, 1.0
    v_fma_f32 v166, v167, v166, v166
    v_mov_b32 v167, v166
    v_sub_f32 v160, 0, v160
    v_mov_b32 v161, v160
    v_lshlrev_b32 v200, 16, v16
    v_and_b32 v201, s95, v16
    v_lshlrev_b32 v202, 16, v17
    v_and_b32 v203, s95, v17
    v_lshlrev_b32 v204, 16, v18
    v_and_b32 v205, s95, v18
    v_lshlrev_b32 v206, 16, v19
    v_and_b32 v207, s95, v19
    s_add_u32 m0, s6, 24576
    s_add_u32 s11, s7, 19200
    buffer_load_dwordx4 v6, s[40:43], s11 offen lds
    v_pk_add_f32 v[200:201], v[200:201], v[160:161]
    v_pk_add_f32 v[202:203], v[202:203], v[160:161]
    v_pk_add_f32 v[204:205], v[204:205], v[160:161]
    v_pk_add_f32 v[206:207], v[206:207], v[160:161]
    v_cvt_pk_bf16_f32 v16, v200, v201
    v_cvt_pk_bf16_f32 v17, v202, v203
    v_cvt_pk_bf16_f32 v18, v204, v205
    v_cvt_pk_bf16_f32 v19, v206, v207
    v_lshlrev_b32 v200, 16, v16
    v_and_b32 v201, s95, v16
    v_lshlrev_b32 v202, 16, v17
    v_and_b32 v203, s95, v17
    v_lshlrev_b32 v204, 16, v18
    v_and_b32 v205, s95, v18
    v_lshlrev_b32 v206, 16, v19
    v_and_b32 v207, s95, v19
    s_add_u32 m0, s6, 25600
    s_add_u32 s11, s7, 19328
    buffer_load_dwordx4 v6, s[40:43], s11 offen lds
    v_pk_mul_f32 v[200:201], v[200:201], v[166:167]
    v_pk_mul_f32 v[202:203], v[202:203], v[166:167]
    v_pk_mul_f32 v[204:205], v[204:205], v[166:167]
    v_pk_mul_f32 v[206:207], v[206:207], v[166:167]
    v_cvt_pk_bf16_f32 v16, v200, v201
    v_cvt_pk_bf16_f32 v17, v202, v203
    v_cvt_pk_bf16_f32 v18, v204, v205
    v_cvt_pk_bf16_f32 v19, v206, v207
    ds_write_b64 v195, v[16:17] offset:0
    ds_write_b64 v196, v[18:19] offset:0
    v_lshlrev_b32 v200, 16, v20
    v_and_b32 v201, s95, v20
    v_lshlrev_b32 v202, 16, v21
    v_and_b32 v203, s95, v21
    v_lshlrev_b32 v204, 16, v22
    v_and_b32 v205, s95, v22
    v_lshlrev_b32 v206, 16, v23
    v_and_b32 v207, s95, v23
    s_add_u32 m0, s6, 26624
    s_add_u32 s11, s7, 19456
    buffer_load_dwordx4 v6, s[40:43], s11 offen lds
    v_pk_add_f32 v[200:201], v[200:201], v[160:161]
    v_pk_add_f32 v[202:203], v[202:203], v[160:161]
    v_pk_add_f32 v[204:205], v[204:205], v[160:161]
    v_pk_add_f32 v[206:207], v[206:207], v[160:161]
    v_cvt_pk_bf16_f32 v20, v200, v201
    v_cvt_pk_bf16_f32 v21, v202, v203
    v_cvt_pk_bf16_f32 v22, v204, v205
    v_cvt_pk_bf16_f32 v23, v206, v207
    v_lshlrev_b32 v200, 16, v20
    v_and_b32 v201, s95, v20
    v_lshlrev_b32 v202, 16, v21
    v_and_b32 v203, s95, v21
    v_lshlrev_b32 v204, 16, v22
    v_and_b32 v205, s95, v22
    v_lshlrev_b32 v206, 16, v23
    v_and_b32 v207, s95, v23
    s_add_u32 m0, s6, 27648
    s_add_u32 s11, s7, 27648
    buffer_load_dwordx4 v6, s[40:43], s11 offen lds
    v_pk_mul_f32 v[200:201], v[200:201], v[166:167]
    v_pk_mul_f32 v[202:203], v[202:203], v[166:167]
    v_pk_mul_f32 v[204:205], v[204:205], v[166:167]
    v_pk_mul_f32 v[206:207], v[206:207], v[166:167]
    v_cvt_pk_bf16_f32 v20, v200, v201
    v_cvt_pk_bf16_f32 v21, v202, v203
    v_cvt_pk_bf16_f32 v22, v204, v205
    v_cvt_pk_bf16_f32 v23, v206, v207
    ds_write_b64 v197, v[20:21] offset:0
    ds_write_b64 v198, v[22:23] offset:0
    v_lshlrev_b32 v200, 16, v24
    v_and_b32 v201, s95, v24
    v_lshlrev_b32 v202, 16, v25
    v_and_b32 v203, s95, v25
    v_lshlrev_b32 v204, 16, v26
    v_and_b32 v205, s95, v26
    v_lshlrev_b32 v206, 16, v27
    v_and_b32 v207, s95, v27
    s_add_u32 m0, s6, 28672
    s_add_u32 s11, s7, 27776
    buffer_load_dwordx4 v6, s[40:43], s11 offen lds
    v_pk_add_f32 v[200:201], v[200:201], v[160:161]
    v_pk_add_f32 v[202:203], v[202:203], v[160:161]
    v_pk_add_f32 v[204:205], v[204:205], v[160:161]
    v_pk_add_f32 v[206:207], v[206:207], v[160:161]
    v_cvt_pk_bf16_f32 v24, v200, v201
    v_cvt_pk_bf16_f32 v25, v202, v203
    v_cvt_pk_bf16_f32 v26, v204, v205
    v_cvt_pk_bf16_f32 v27, v206, v207
    v_lshlrev_b32 v200, 16, v24
    v_and_b32 v201, s95, v24
    v_lshlrev_b32 v202, 16, v25
    v_and_b32 v203, s95, v25
    v_lshlrev_b32 v204, 16, v26
    v_and_b32 v205, s95, v26
    v_lshlrev_b32 v206, 16, v27
    v_and_b32 v207, s95, v27
    s_add_u32 m0, s6, 29696
    s_add_u32 s11, s7, 27904
    buffer_load_dwordx4 v6, s[40:43], s11 offen lds
    v_pk_mul_f32 v[200:201], v[200:201], v[166:167]
    v_pk_mul_f32 v[202:203], v[202:203], v[166:167]
    v_pk_mul_f32 v[204:205], v[204:205], v[166:167]
    v_pk_mul_f32 v[206:207], v[206:207], v[166:167]
    v_cvt_pk_bf16_f32 v24, v200, v201
    v_cvt_pk_bf16_f32 v25, v202, v203
    v_cvt_pk_bf16_f32 v26, v204, v205
    v_cvt_pk_bf16_f32 v27, v206, v207
    ds_write_b64 v195, v[24:25] offset:1024
    ds_write_b64 v196, v[26:27] offset:1024
    v_lshlrev_b32 v200, 16, v28
    v_and_b32 v201, s95, v28
    v_lshlrev_b32 v202, 16, v29
    v_and_b32 v203, s95, v29
    v_lshlrev_b32 v204, 16, v30
    v_and_b32 v205, s95, v30
    v_lshlrev_b32 v206, 16, v31
    v_and_b32 v207, s95, v31
    s_add_u32 m0, s6, 30720
    s_add_u32 s11, s7, 28032
    buffer_load_dwordx4 v6, s[40:43], s11 offen lds
    v_pk_add_f32 v[200:201], v[200:201], v[160:161]
    v_pk_add_f32 v[202:203], v[202:203], v[160:161]
    v_pk_add_f32 v[204:205], v[204:205], v[160:161]
    v_pk_add_f32 v[206:207], v[206:207], v[160:161]
    v_cvt_pk_bf16_f32 v28, v200, v201
    v_cvt_pk_bf16_f32 v29, v202, v203
    v_cvt_pk_bf16_f32 v30, v204, v205
    v_cvt_pk_bf16_f32 v31, v206, v207
    v_lshlrev_b32 v200, 16, v28
    v_and_b32 v201, s95, v28
    v_lshlrev_b32 v202, 16, v29
    v_and_b32 v203, s95, v29
    v_lshlrev_b32 v204, 16, v30
    v_and_b32 v205, s95, v30
    v_lshlrev_b32 v206, 16, v31
    v_and_b32 v207, s95, v31
    s_add_u32 m0, s6, 31744
    s_add_u32 s11, s7, 28160
    buffer_load_dwordx4 v6, s[40:43], s11 offen lds
    v_pk_mul_f32 v[200:201], v[200:201], v[166:167]
    v_pk_mul_f32 v[202:203], v[202:203], v[166:167]
    v_pk_mul_f32 v[204:205], v[204:205], v[166:167]
    v_pk_mul_f32 v[206:207], v[206:207], v[166:167]
    v_cvt_pk_bf16_f32 v28, v200, v201
    v_cvt_pk_bf16_f32 v29, v202, v203
    v_cvt_pk_bf16_f32 v30, v204, v205
    v_cvt_pk_bf16_f32 v31, v206, v207
    ds_write_b64 v197, v[28:29] offset:1024
    ds_write_b64 v198, v[30:31] offset:1024
    v_lshlrev_b32 v200, 16, v32
    v_and_b32 v201, s95, v32
    v_lshlrev_b32 v202, 16, v33
    v_and_b32 v203, s95, v33
    v_lshlrev_b32 v204, 16, v34
    v_and_b32 v205, s95, v34
    v_lshlrev_b32 v206, 16, v35
    v_and_b32 v207, s95, v35
    s_add_u32 m0, s6, 32768
    s_add_u32 s11, s7, 28288
    buffer_load_dwordx4 v6, s[40:43], s11 offen lds
    v_pk_add_f32 v[200:201], v[200:201], v[160:161]
    v_pk_add_f32 v[202:203], v[202:203], v[160:161]
    v_pk_add_f32 v[204:205], v[204:205], v[160:161]
    v_pk_add_f32 v[206:207], v[206:207], v[160:161]
    v_cvt_pk_bf16_f32 v32, v200, v201
    v_cvt_pk_bf16_f32 v33, v202, v203
    v_cvt_pk_bf16_f32 v34, v204, v205
    v_cvt_pk_bf16_f32 v35, v206, v207
    v_lshlrev_b32 v200, 16, v32
    v_and_b32 v201, s95, v32
    v_lshlrev_b32 v202, 16, v33
    v_and_b32 v203, s95, v33
    v_lshlrev_b32 v204, 16, v34
    v_and_b32 v205, s95, v34
    v_lshlrev_b32 v206, 16, v35
    v_and_b32 v207, s95, v35
    s_add_u32 m0, s6, 33792
    s_add_u32 s11, s7, 28416
    buffer_load_dwordx4 v6, s[40:43], s11 offen lds
    v_pk_mul_f32 v[200:201], v[200:201], v[166:167]
    v_pk_mul_f32 v[202:203], v[202:203], v[166:167]
    v_pk_mul_f32 v[204:205], v[204:205], v[166:167]
    v_pk_mul_f32 v[206:207], v[206:207], v[166:167]
    v_cvt_pk_bf16_f32 v32, v200, v201
    v_cvt_pk_bf16_f32 v33, v202, v203
    v_cvt_pk_bf16_f32 v34, v204, v205
    v_cvt_pk_bf16_f32 v35, v206, v207
    ds_write_b64 v195, v[32:33] offset:2048
    ds_write_b64 v196, v[34:35] offset:2048
    v_lshlrev_b32 v200, 16, v36
    v_and_b32 v201, s95, v36
    v_lshlrev_b32 v202, 16, v37
    v_and_b32 v203, s95, v37
    v_lshlrev_b32 v204, 16, v38
    v_and_b32 v205, s95, v38
    v_lshlrev_b32 v206, 16, v39
    v_and_b32 v207, s95, v39
    s_add_u32 m0, s6, 34816
    s_add_u32 s11, s7, 28544
    buffer_load_dwordx4 v6, s[40:43], s11 offen lds
    v_pk_add_f32 v[200:201], v[200:201], v[160:161]
    v_pk_add_f32 v[202:203], v[202:203], v[160:161]
    v_pk_add_f32 v[204:205], v[204:205], v[160:161]
    v_pk_add_f32 v[206:207], v[206:207], v[160:161]
    v_cvt_pk_bf16_f32 v36, v200, v201
    v_cvt_pk_bf16_f32 v37, v202, v203
    v_cvt_pk_bf16_f32 v38, v204, v205
    v_cvt_pk_bf16_f32 v39, v206, v207
    v_lshlrev_b32 v200, 16, v36
    v_and_b32 v201, s95, v36
    v_lshlrev_b32 v202, 16, v37
    v_and_b32 v203, s95, v37
    v_lshlrev_b32 v204, 16, v38
    v_and_b32 v205, s95, v38
    v_lshlrev_b32 v206, 16, v39
    v_and_b32 v207, s95, v39
    s_add_u32 m0, s6, 35840
    s_add_u32 s11, s7, 28672
    buffer_load_dwordx4 v6, s[40:43], s11 offen lds
    v_pk_mul_f32 v[200:201], v[200:201], v[166:167]
    v_pk_mul_f32 v[202:203], v[202:203], v[166:167]
    v_pk_mul_f32 v[204:205], v[204:205], v[166:167]
    v_pk_mul_f32 v[206:207], v[206:207], v[166:167]
    v_cvt_pk_bf16_f32 v36, v200, v201
    v_cvt_pk_bf16_f32 v37, v202, v203
    v_cvt_pk_bf16_f32 v38, v204, v205
    v_cvt_pk_bf16_f32 v39, v206, v207
    ds_write_b64 v197, v[36:37] offset:2048
    ds_write_b64 v198, v[38:39] offset:2048
    v_lshlrev_b32 v200, 16, v40
    v_and_b32 v201, s95, v40
    v_lshlrev_b32 v202, 16, v41
    v_and_b32 v203, s95, v41
    v_lshlrev_b32 v204, 16, v42
    v_and_b32 v205, s95, v42
    v_lshlrev_b32 v206, 16, v43
    v_and_b32 v207, s95, v43
    s_add_u32 s14, s13, 0
    buffer_load_dwordx4 a[64:67], v184, s[44:47], s14 offen offset:0
    v_pk_add_f32 v[200:201], v[200:201], v[160:161]
    v_pk_add_f32 v[202:203], v[202:203], v[160:161]
    v_pk_add_f32 v[204:205], v[204:205], v[160:161]
    v_pk_add_f32 v[206:207], v[206:207], v[160:161]
    v_cvt_pk_bf16_f32 v40, v200, v201
    v_cvt_pk_bf16_f32 v41, v202, v203
    v_cvt_pk_bf16_f32 v42, v204, v205
    v_cvt_pk_bf16_f32 v43, v206, v207
    v_lshlrev_b32 v200, 16, v40
    v_and_b32 v201, s95, v40
    v_lshlrev_b32 v202, 16, v41
    v_and_b32 v203, s95, v41
    v_lshlrev_b32 v204, 16, v42
    v_and_b32 v205, s95, v42
    v_lshlrev_b32 v206, 16, v43
    v_and_b32 v207, s95, v43
    s_add_u32 s14, s13, 9216
    buffer_load_dwordx4 a[68:71], v184, s[44:47], s14 offen offset:0
    v_pk_mul_f32 v[200:201], v[200:201], v[166:167]
    v_pk_mul_f32 v[202:203], v[202:203], v[166:167]
    v_pk_mul_f32 v[204:205], v[204:205], v[166:167]
    v_pk_mul_f32 v[206:207], v[206:207], v[166:167]
    v_cvt_pk_bf16_f32 v40, v200, v201
    v_cvt_pk_bf16_f32 v41, v202, v203
    v_cvt_pk_bf16_f32 v42, v204, v205
    v_cvt_pk_bf16_f32 v43, v206, v207
    ds_write_b64 v195, v[40:41] offset:3072
    ds_write_b64 v196, v[42:43] offset:3072
    v_lshlrev_b32 v200, 16, v44
    v_and_b32 v201, s95, v44
    v_lshlrev_b32 v202, 16, v45
    v_and_b32 v203, s95, v45
    v_lshlrev_b32 v204, 16, v46
    v_and_b32 v205, s95, v46
    v_lshlrev_b32 v206, 16, v47
    v_and_b32 v207, s95, v47
    s_add_u32 s14, s13, 18432
    buffer_load_dwordx4 a[72:75], v184, s[44:47], s14 offen offset:0
    v_pk_add_f32 v[200:201], v[200:201], v[160:161]
    v_pk_add_f32 v[202:203], v[202:203], v[160:161]
    v_pk_add_f32 v[204:205], v[204:205], v[160:161]
    v_pk_add_f32 v[206:207], v[206:207], v[160:161]
    v_cvt_pk_bf16_f32 v44, v200, v201
    v_cvt_pk_bf16_f32 v45, v202, v203
    v_cvt_pk_bf16_f32 v46, v204, v205
    v_cvt_pk_bf16_f32 v47, v206, v207
    v_lshlrev_b32 v200, 16, v44
    v_and_b32 v201, s95, v44
    v_lshlrev_b32 v202, 16, v45
    v_and_b32 v203, s95, v45
    v_lshlrev_b32 v204, 16, v46
    v_and_b32 v205, s95, v46
    v_lshlrev_b32 v206, 16, v47
    v_and_b32 v207, s95, v47
    s_add_u32 s14, s13, 27648
    buffer_load_dwordx4 a[76:79], v184, s[44:47], s14 offen offset:0
    v_pk_mul_f32 v[200:201], v[200:201], v[166:167]
    v_pk_mul_f32 v[202:203], v[202:203], v[166:167]
    v_pk_mul_f32 v[204:205], v[204:205], v[166:167]
    v_pk_mul_f32 v[206:207], v[206:207], v[166:167]
    v_cvt_pk_bf16_f32 v44, v200, v201
    v_cvt_pk_bf16_f32 v45, v202, v203
    v_cvt_pk_bf16_f32 v46, v204, v205
    v_cvt_pk_bf16_f32 v47, v206, v207
    ds_write_b64 v197, v[44:45] offset:3072
    ds_write_b64 v198, v[46:47] offset:3072
    v_lshlrev_b32 v200, 16, v48
    v_and_b32 v201, s95, v48
    v_lshlrev_b32 v202, 16, v49
    v_and_b32 v203, s95, v49
    v_lshlrev_b32 v204, 16, v50
    v_and_b32 v205, s95, v50
    v_lshlrev_b32 v206, 16, v51
    v_and_b32 v207, s95, v51
    s_add_u32 s14, s13, 36864
    buffer_load_dwordx4 a[80:83], v184, s[44:47], s14 offen offset:0
    v_pk_add_f32 v[200:201], v[200:201], v[160:161]
    v_pk_add_f32 v[202:203], v[202:203], v[160:161]
    v_pk_add_f32 v[204:205], v[204:205], v[160:161]
    v_pk_add_f32 v[206:207], v[206:207], v[160:161]
    v_cvt_pk_bf16_f32 v48, v200, v201
    v_cvt_pk_bf16_f32 v49, v202, v203
    v_cvt_pk_bf16_f32 v50, v204, v205
    v_cvt_pk_bf16_f32 v51, v206, v207
    v_lshlrev_b32 v200, 16, v48
    v_and_b32 v201, s95, v48
    v_lshlrev_b32 v202, 16, v49
    v_and_b32 v203, s95, v49
    v_lshlrev_b32 v204, 16, v50
    v_and_b32 v205, s95, v50
    v_lshlrev_b32 v206, 16, v51
    v_and_b32 v207, s95, v51
    s_add_u32 s14, s13, 46080
    buffer_load_dwordx4 a[84:87], v184, s[44:47], s14 offen offset:0
    v_pk_mul_f32 v[200:201], v[200:201], v[166:167]
    v_pk_mul_f32 v[202:203], v[202:203], v[166:167]
    v_pk_mul_f32 v[204:205], v[204:205], v[166:167]
    v_pk_mul_f32 v[206:207], v[206:207], v[166:167]
    v_cvt_pk_bf16_f32 v48, v200, v201
    v_cvt_pk_bf16_f32 v49, v202, v203
    v_cvt_pk_bf16_f32 v50, v204, v205
    v_cvt_pk_bf16_f32 v51, v206, v207
    ds_write_b64 v195, v[48:49] offset:4096
    ds_write_b64 v196, v[50:51] offset:4096
    v_lshlrev_b32 v200, 16, v52
    v_and_b32 v201, s95, v52
    v_lshlrev_b32 v202, 16, v53
    v_and_b32 v203, s95, v53
    v_lshlrev_b32 v204, 16, v54
    v_and_b32 v205, s95, v54
    v_lshlrev_b32 v206, 16, v55
    v_and_b32 v207, s95, v55
    s_add_u32 s14, s13, 55296
    buffer_load_dwordx4 a[88:91], v184, s[44:47], s14 offen offset:0
    v_pk_add_f32 v[200:201], v[200:201], v[160:161]
    v_pk_add_f32 v[202:203], v[202:203], v[160:161]
    v_pk_add_f32 v[204:205], v[204:205], v[160:161]
    v_pk_add_f32 v[206:207], v[206:207], v[160:161]
    v_cvt_pk_bf16_f32 v52, v200, v201
    v_cvt_pk_bf16_f32 v53, v202, v203
    v_cvt_pk_bf16_f32 v54, v204, v205
    v_cvt_pk_bf16_f32 v55, v206, v207
    v_lshlrev_b32 v200, 16, v52
    v_and_b32 v201, s95, v52
    v_lshlrev_b32 v202, 16, v53
    v_and_b32 v203, s95, v53
    v_lshlrev_b32 v204, 16, v54
    v_and_b32 v205, s95, v54
    v_lshlrev_b32 v206, 16, v55
    v_and_b32 v207, s95, v55
    s_add_u32 s14, s13, 64512
    buffer_load_dwordx4 a[92:95], v184, s[44:47], s14 offen offset:0
    v_pk_mul_f32 v[200:201], v[200:201], v[166:167]
    v_pk_mul_f32 v[202:203], v[202:203], v[166:167]
    v_pk_mul_f32 v[204:205], v[204:205], v[166:167]
    v_pk_mul_f32 v[206:207], v[206:207], v[166:167]
    v_cvt_pk_bf16_f32 v52, v200, v201
    v_cvt_pk_bf16_f32 v53, v202, v203
    v_cvt_pk_bf16_f32 v54, v204, v205
    v_cvt_pk_bf16_f32 v55, v206, v207
    ds_write_b64 v197, v[52:53] offset:4096
    ds_write_b64 v198, v[54:55] offset:4096
    v_lshlrev_b32 v200, 16, v56
    v_and_b32 v201, s95, v56
    v_lshlrev_b32 v202, 16, v57
    v_and_b32 v203, s95, v57
    v_lshlrev_b32 v204, 16, v58
    v_and_b32 v205, s95, v58
    v_lshlrev_b32 v206, 16, v59
    v_and_b32 v207, s95, v59
    s_add_u32 s14, s13, 73728
    buffer_load_dwordx4 a[96:99], v184, s[44:47], s14 offen offset:0
    v_pk_add_f32 v[200:201], v[200:201], v[160:161]
    v_pk_add_f32 v[202:203], v[202:203], v[160:161]
    v_pk_add_f32 v[204:205], v[204:205], v[160:161]
    v_pk_add_f32 v[206:207], v[206:207], v[160:161]
    v_cvt_pk_bf16_f32 v56, v200, v201
    v_cvt_pk_bf16_f32 v57, v202, v203
    v_cvt_pk_bf16_f32 v58, v204, v205
    v_cvt_pk_bf16_f32 v59, v206, v207
    v_lshlrev_b32 v200, 16, v56
    v_and_b32 v201, s95, v56
    v_lshlrev_b32 v202, 16, v57
    v_and_b32 v203, s95, v57
    v_lshlrev_b32 v204, 16, v58
    v_and_b32 v205, s95, v58
    v_lshlrev_b32 v206, 16, v59
    v_and_b32 v207, s95, v59
    s_add_u32 s14, s13, 82944
    buffer_load_dwordx4 a[100:103], v184, s[44:47], s14 offen offset:0
    v_pk_mul_f32 v[200:201], v[200:201], v[166:167]
    v_pk_mul_f32 v[202:203], v[202:203], v[166:167]
    v_pk_mul_f32 v[204:205], v[204:205], v[166:167]
    v_pk_mul_f32 v[206:207], v[206:207], v[166:167]
    v_cvt_pk_bf16_f32 v56, v200, v201
    v_cvt_pk_bf16_f32 v57, v202, v203
    v_cvt_pk_bf16_f32 v58, v204, v205
    v_cvt_pk_bf16_f32 v59, v206, v207
    ds_write_b64 v195, v[56:57] offset:5120
    ds_write_b64 v196, v[58:59] offset:5120
    v_lshlrev_b32 v200, 16, v60
    v_and_b32 v201, s95, v60
    v_lshlrev_b32 v202, 16, v61
    v_and_b32 v203, s95, v61
    v_lshlrev_b32 v204, 16, v62
    v_and_b32 v205, s95, v62
    v_lshlrev_b32 v206, 16, v63
    v_and_b32 v207, s95, v63
    s_add_u32 s14, s13, 92160
    buffer_load_dwordx4 a[104:107], v184, s[44:47], s14 offen offset:0
    v_pk_add_f32 v[200:201], v[200:201], v[160:161]
    v_pk_add_f32 v[202:203], v[202:203], v[160:161]
    v_pk_add_f32 v[204:205], v[204:205], v[160:161]
    v_pk_add_f32 v[206:207], v[206:207], v[160:161]
    v_cvt_pk_bf16_f32 v60, v200, v201
    v_cvt_pk_bf16_f32 v61, v202, v203
    v_cvt_pk_bf16_f32 v62, v204, v205
    v_cvt_pk_bf16_f32 v63, v206, v207
    v_lshlrev_b32 v200, 16, v60
    v_and_b32 v201, s95, v60
    v_lshlrev_b32 v202, 16, v61
    v_and_b32 v203, s95, v61
    v_lshlrev_b32 v204, 16, v62
    v_and_b32 v205, s95, v62
    v_lshlrev_b32 v206, 16, v63
    v_and_b32 v207, s95, v63
    s_add_u32 s14, s13, 101376
    buffer_load_dwordx4 a[108:111], v184, s[44:47], s14 offen offset:0
    v_pk_mul_f32 v[200:201], v[200:201], v[166:167]
    v_pk_mul_f32 v[202:203], v[202:203], v[166:167]
    v_pk_mul_f32 v[204:205], v[204:205], v[166:167]
    v_pk_mul_f32 v[206:207], v[206:207], v[166:167]
    v_cvt_pk_bf16_f32 v60, v200, v201
    v_cvt_pk_bf16_f32 v61, v202, v203
    v_cvt_pk_bf16_f32 v62, v204, v205
    v_cvt_pk_bf16_f32 v63, v206, v207
    ds_write_b64 v197, v[60:61] offset:5120
    ds_write_b64 v198, v[62:63] offset:5120
    v_lshlrev_b32 v200, 16, v64
    v_and_b32 v201, s95, v64
    v_lshlrev_b32 v202, 16, v65
    v_and_b32 v203, s95, v65
    v_lshlrev_b32 v204, 16, v66
    v_and_b32 v205, s95, v66
    v_lshlrev_b32 v206, 16, v67
    v_and_b32 v207, s95, v67
    s_add_u32 s14, s13, 0
    buffer_load_dwordx4 a[112:115], v184, s[44:47], s14 offen offset:128
    v_pk_add_f32 v[200:201], v[200:201], v[160:161]
    v_pk_add_f32 v[202:203], v[202:203], v[160:161]
    v_pk_add_f32 v[204:205], v[204:205], v[160:161]
    v_pk_add_f32 v[206:207], v[206:207], v[160:161]
    v_cvt_pk_bf16_f32 v64, v200, v201
    v_cvt_pk_bf16_f32 v65, v202, v203
    v_cvt_pk_bf16_f32 v66, v204, v205
    v_cvt_pk_bf16_f32 v67, v206, v207
    v_lshlrev_b32 v200, 16, v64
    v_and_b32 v201, s95, v64
    v_lshlrev_b32 v202, 16, v65
    v_and_b32 v203, s95, v65
    v_lshlrev_b32 v204, 16, v66
    v_and_b32 v205, s95, v66
    v_lshlrev_b32 v206, 16, v67
    v_and_b32 v207, s95, v67
    s_add_u32 s14, s13, 9216
    buffer_load_dwordx4 a[116:119], v184, s[44:47], s14 offen offset:128
    v_pk_mul_f32 v[200:201], v[200:201], v[166:167]
    v_pk_mul_f32 v[202:203], v[202:203], v[166:167]
    v_pk_mul_f32 v[204:205], v[204:205], v[166:167]
    v_pk_mul_f32 v[206:207], v[206:207], v[166:167]
    v_cvt_pk_bf16_f32 v64, v200, v201
    v_cvt_pk_bf16_f32 v65, v202, v203
    v_cvt_pk_bf16_f32 v66, v204, v205
    v_cvt_pk_bf16_f32 v67, v206, v207
    ds_write_b64 v195, v[64:65] offset:6144
    ds_write_b64 v196, v[66:67] offset:6144
    v_lshlrev_b32 v200, 16, v68
    v_and_b32 v201, s95, v68
    v_lshlrev_b32 v202, 16, v69
    v_and_b32 v203, s95, v69
    v_lshlrev_b32 v204, 16, v70
    v_and_b32 v205, s95, v70
    v_lshlrev_b32 v206, 16, v71
    v_and_b32 v207, s95, v71
    s_add_u32 s14, s13, 18432
    buffer_load_dwordx4 a[120:123], v184, s[44:47], s14 offen offset:128
    v_pk_add_f32 v[200:201], v[200:201], v[160:161]
    v_pk_add_f32 v[202:203], v[202:203], v[160:161]
    v_pk_add_f32 v[204:205], v[204:205], v[160:161]
    v_pk_add_f32 v[206:207], v[206:207], v[160:161]
    v_cvt_pk_bf16_f32 v68, v200, v201
    v_cvt_pk_bf16_f32 v69, v202, v203
    v_cvt_pk_bf16_f32 v70, v204, v205
    v_cvt_pk_bf16_f32 v71, v206, v207
    v_lshlrev_b32 v200, 16, v68
    v_and_b32 v201, s95, v68
    v_lshlrev_b32 v202, 16, v69
    v_and_b32 v203, s95, v69
    v_lshlrev_b32 v204, 16, v70
    v_and_b32 v205, s95, v70
    v_lshlrev_b32 v206, 16, v71
    v_and_b32 v207, s95, v71
    s_add_u32 s14, s13, 27648
    buffer_load_dwordx4 a[124:127], v184, s[44:47], s14 offen offset:128
    v_pk_mul_f32 v[200:201], v[200:201], v[166:167]
    v_pk_mul_f32 v[202:203], v[202:203], v[166:167]
    v_pk_mul_f32 v[204:205], v[204:205], v[166:167]
    v_pk_mul_f32 v[206:207], v[206:207], v[166:167]
    v_cvt_pk_bf16_f32 v68, v200, v201
    v_cvt_pk_bf16_f32 v69, v202, v203
    v_cvt_pk_bf16_f32 v70, v204, v205
    v_cvt_pk_bf16_f32 v71, v206, v207
    ds_write_b64 v197, v[68:69] offset:6144
    ds_write_b64 v198, v[70:71] offset:6144
    v_lshlrev_b32 v200, 16, v72
    v_and_b32 v201, s95, v72
    v_lshlrev_b32 v202, 16, v73
    v_and_b32 v203, s95, v73
    v_lshlrev_b32 v204, 16, v74
    v_and_b32 v205, s95, v74
    v_lshlrev_b32 v206, 16, v75
    v_and_b32 v207, s95, v75
    s_add_u32 s14, s13, 36864
    buffer_load_dwordx4 a[128:131], v184, s[44:47], s14 offen offset:128
    v_pk_add_f32 v[200:201], v[200:201], v[160:161]
    v_pk_add_f32 v[202:203], v[202:203], v[160:161]
    v_pk_add_f32 v[204:205], v[204:205], v[160:161]
    v_pk_add_f32 v[206:207], v[206:207], v[160:161]
    v_cvt_pk_bf16_f32 v72, v200, v201
    v_cvt_pk_bf16_f32 v73, v202, v203
    v_cvt_pk_bf16_f32 v74, v204, v205
    v_cvt_pk_bf16_f32 v75, v206, v207
    v_lshlrev_b32 v200, 16, v72
    v_and_b32 v201, s95, v72
    v_lshlrev_b32 v202, 16, v73
    v_and_b32 v203, s95, v73
    v_lshlrev_b32 v204, 16, v74
    v_and_b32 v205, s95, v74
    v_lshlrev_b32 v206, 16, v75
    v_and_b32 v207, s95, v75
    s_add_u32 s14, s13, 46080
    buffer_load_dwordx4 a[132:135], v184, s[44:47], s14 offen offset:128
    v_pk_mul_f32 v[200:201], v[200:201], v[166:167]
    v_pk_mul_f32 v[202:203], v[202:203], v[166:167]
    v_pk_mul_f32 v[204:205], v[204:205], v[166:167]
    v_pk_mul_f32 v[206:207], v[206:207], v[166:167]
    v_cvt_pk_bf16_f32 v72, v200, v201
    v_cvt_pk_bf16_f32 v73, v202, v203
    v_cvt_pk_bf16_f32 v74, v204, v205
    v_cvt_pk_bf16_f32 v75, v206, v207
    ds_write_b64 v195, v[72:73] offset:7168
    ds_write_b64 v196, v[74:75] offset:7168
    v_lshlrev_b32 v200, 16, v76
    v_and_b32 v201, s95, v76
    v_lshlrev_b32 v202, 16, v77
    v_and_b32 v203, s95, v77
    v_lshlrev_b32 v204, 16, v78
    v_and_b32 v205, s95, v78
    v_lshlrev_b32 v206, 16, v79
    v_and_b32 v207, s95, v79
    s_add_u32 s14, s13, 55296
    buffer_load_dwordx4 a[136:139], v184, s[44:47], s14 offen offset:128
    v_pk_add_f32 v[200:201], v[200:201], v[160:161]
    v_pk_add_f32 v[202:203], v[202:203], v[160:161]
    v_pk_add_f32 v[204:205], v[204:205], v[160:161]
    v_pk_add_f32 v[206:207], v[206:207], v[160:161]
    v_cvt_pk_bf16_f32 v76, v200, v201
    v_cvt_pk_bf16_f32 v77, v202, v203
    v_cvt_pk_bf16_f32 v78, v204, v205
    v_cvt_pk_bf16_f32 v79, v206, v207
    v_lshlrev_b32 v200, 16, v76
    v_and_b32 v201, s95, v76
    v_lshlrev_b32 v202, 16, v77
    v_and_b32 v203, s95, v77
    v_lshlrev_b32 v204, 16, v78
    v_and_b32 v205, s95, v78
    v_lshlrev_b32 v206, 16, v79
    v_and_b32 v207, s95, v79
    s_add_u32 s14, s13, 64512
    buffer_load_dwordx4 a[140:143], v184, s[44:47], s14 offen offset:128
    v_pk_mul_f32 v[200:201], v[200:201], v[166:167]
    v_pk_mul_f32 v[202:203], v[202:203], v[166:167]
    v_pk_mul_f32 v[204:205], v[204:205], v[166:167]
    v_pk_mul_f32 v[206:207], v[206:207], v[166:167]
    v_cvt_pk_bf16_f32 v76, v200, v201
    v_cvt_pk_bf16_f32 v77, v202, v203
    v_cvt_pk_bf16_f32 v78, v204, v205
    v_cvt_pk_bf16_f32 v79, v206, v207
    ds_write_b64 v197, v[76:77] offset:7168
    ds_write_b64 v198, v[78:79] offset:7168
    v_lshlrev_b32 v200, 16, v80
    v_and_b32 v201, s95, v80
    v_lshlrev_b32 v202, 16, v81
    v_and_b32 v203, s95, v81
    v_lshlrev_b32 v204, 16, v82
    v_and_b32 v205, s95, v82
    v_lshlrev_b32 v206, 16, v83
    v_and_b32 v207, s95, v83
    s_add_u32 s14, s13, 73728
    buffer_load_dwordx4 a[144:147], v184, s[44:47], s14 offen offset:128
    v_pk_add_f32 v[200:201], v[200:201], v[160:161]
    v_pk_add_f32 v[202:203], v[202:203], v[160:161]
    v_pk_add_f32 v[204:205], v[204:205], v[160:161]
    v_pk_add_f32 v[206:207], v[206:207], v[160:161]
    v_cvt_pk_bf16_f32 v80, v200, v201
    v_cvt_pk_bf16_f32 v81, v202, v203
    v_cvt_pk_bf16_f32 v82, v204, v205
    v_cvt_pk_bf16_f32 v83, v206, v207
    v_lshlrev_b32 v200, 16, v80
    v_and_b32 v201, s95, v80
    v_lshlrev_b32 v202, 16, v81
    v_and_b32 v203, s95, v81
    v_lshlrev_b32 v204, 16, v82
    v_and_b32 v205, s95, v82
    v_lshlrev_b32 v206, 16, v83
    v_and_b32 v207, s95, v83
    s_add_u32 s14, s13, 82944
    buffer_load_dwordx4 a[148:151], v184, s[44:47], s14 offen offset:128
    v_pk_mul_f32 v[200:201], v[200:201], v[166:167]
    v_pk_mul_f32 v[202:203], v[202:203], v[166:167]
    v_pk_mul_f32 v[204:205], v[204:205], v[166:167]
    v_pk_mul_f32 v[206:207], v[206:207], v[166:167]
    v_cvt_pk_bf16_f32 v80, v200, v201
    v_cvt_pk_bf16_f32 v81, v202, v203
    v_cvt_pk_bf16_f32 v82, v204, v205
    v_cvt_pk_bf16_f32 v83, v206, v207
    ds_write_b64 v195, v[80:81] offset:8192
    ds_write_b64 v196, v[82:83] offset:8192
    v_lshlrev_b32 v200, 16, v84
    v_and_b32 v201, s95, v84
    v_lshlrev_b32 v202, 16, v85
    v_and_b32 v203, s95, v85
    v_lshlrev_b32 v204, 16, v86
    v_and_b32 v205, s95, v86
    v_lshlrev_b32 v206, 16, v87
    v_and_b32 v207, s95, v87
    s_add_u32 s14, s13, 92160
    buffer_load_dwordx4 a[152:155], v184, s[44:47], s14 offen offset:128
    v_pk_add_f32 v[200:201], v[200:201], v[160:161]
    v_pk_add_f32 v[202:203], v[202:203], v[160:161]
    v_pk_add_f32 v[204:205], v[204:205], v[160:161]
    v_pk_add_f32 v[206:207], v[206:207], v[160:161]
    v_cvt_pk_bf16_f32 v84, v200, v201
    v_cvt_pk_bf16_f32 v85, v202, v203
    v_cvt_pk_bf16_f32 v86, v204, v205
    v_cvt_pk_bf16_f32 v87, v206, v207
    v_lshlrev_b32 v200, 16, v84
    v_and_b32 v201, s95, v84
    v_lshlrev_b32 v202, 16, v85
    v_and_b32 v203, s95, v85
    v_lshlrev_b32 v204, 16, v86
    v_and_b32 v205, s95, v86
    v_lshlrev_b32 v206, 16, v87
    v_and_b32 v207, s95, v87
    s_add_u32 s14, s13, 101376
    buffer_load_dwordx4 a[156:159], v184, s[44:47], s14 offen offset:128
    v_pk_mul_f32 v[200:201], v[200:201], v[166:167]
    v_pk_mul_f32 v[202:203], v[202:203], v[166:167]
    v_pk_mul_f32 v[204:205], v[204:205], v[166:167]
    v_pk_mul_f32 v[206:207], v[206:207], v[166:167]
    v_cvt_pk_bf16_f32 v84, v200, v201
    v_cvt_pk_bf16_f32 v85, v202, v203
    v_cvt_pk_bf16_f32 v86, v204, v205
    v_cvt_pk_bf16_f32 v87, v206, v207
    ds_write_b64 v197, v[84:85] offset:8192
    ds_write_b64 v198, v[86:87] offset:8192
    s_waitcnt vmcnt(24)
    ds_read_b128 v[16:19], v193 offset:18432
    ds_read_b128 v[20:23], v194 offset:18432
    ds_read_b128 v[24:27], v193 offset:19456
    ds_read_b128 v[28:31], v194 offset:19456
    ds_read_b128 v[32:35], v193 offset:20480
    ds_read_b128 v[36:39], v194 offset:20480
    ds_read_b128 v[40:43], v193 offset:21504
    ds_read_b128 v[44:47], v194 offset:21504
    ds_read_b128 v[48:51], v193 offset:22528
    ds_read_b128 v[52:55], v194 offset:22528
    ds_read_b128 v[56:59], v193 offset:23552
    ds_read_b128 v[60:63], v194 offset:23552
    ds_read_b128 v[64:67], v193 offset:24576
    ds_read_b128 v[68:71], v194 offset:24576
    ds_read_b128 v[72:75], v193 offset:25600
    ds_read_b128 v[76:79], v194 offset:25600
    ds_read_b128 v[80:83], v193 offset:26624
    ds_read_b128 v[84:87], v194 offset:26624
    s_waitcnt lgkmcnt(15)
    v_mfma_f32_16x16x32_bf16 v[160:163], v[176:179], v[16:19], 0
    v_mfma_f32_16x16x32_bf16 v[164:167], v[16:19], v[16:19], 0
    v_mfma_f32_16x16x32_bf16 v[160:163], v[176:179], v[20:23], v[160:163]
    v_mfma_f32_16x16x32_bf16 v[164:167], v[20:23], v[20:23], v[164:167]
    v_mfma_f32_16x16x32_bf16 v[160:163], v[176:179], v[24:27], v[160:163]
    v_mfma_f32_16x16x32_bf16 v[164:167], v[24:27], v[24:27], v[164:167]
    s_add_u32 s14, s13, 0
    buffer_load_dwordx4 a[160:163], v184, s[44:47], s14 offen offset:256
    s_waitcnt lgkmcnt(14)
    v_mfma_f32_16x16x32_bf16 v[160:163], v[176:179], v[28:31], v[160:163]
    v_mfma_f32_16x16x32_bf16 v[164:167], v[28:31], v[28:31], v[164:167]
    s_waitcnt lgkmcnt(13)
    v_mfma_f32_16x16x32_bf16 v[160:163], v[176:179], v[32:35], v[160:163]
    v_mfma_f32_16x16x32_bf16 v[164:167], v[32:35], v[32:35], v[164:167]
    s_waitcnt lgkmcnt(12)
    v_mfma_f32_16x16x32_bf16 v[160:163], v[176:179], v[36:39], v[160:163]
    v_mfma_f32_16x16x32_bf16 v[164:167], v[36:39], v[36:39], v[164:167]
    s_add_u32 s14, s13, 9216
    buffer_load_dwordx4 a[164:167], v184, s[44:47], s14 offen offset:256
    s_waitcnt lgkmcnt(11)
    v_mfma_f32_16x16x32_bf16 v[160:163], v[176:179], v[40:43], v[160:163]
    v_mfma_f32_16x16x32_bf16 v[164:167], v[40:43], v[40:43], v[164:167]
    s_waitcnt lgkmcnt(10)
    v_mfma_f32_16x16x32_bf16 v[160:163], v[176:179], v[44:47], v[160:163]
    v_mfma_f32_16x16x32_bf16 v[164:167], v[44:47], v[44:47], v[164:167]
    s_waitcnt lgkmcnt(9)
    v_mfma_f32_16x16x32_bf16 v[160:163], v[176:179], v[48:51], v[160:163]
    v_mfma_f32_16x16x32_bf16 v[164:167], v[48:51], v[48:51], v[164:167]
    s_add_u32 s14, s13, 18432
    buffer_load_dwordx4 a[168:171], v184, s[44:47], s14 offen offset:256
    s_waitcnt lgkmcnt(8)
    v_mfma_f32_16x16x32_bf16 v[160:163], v[176:179], v[52:55], v[160:163]
    v_mfma_f32_16x16x32_bf16 v[164:167], v[52:55], v[52:55], v[164:167]
    s_waitcnt lgkmcnt(7)
    v_mfma_f32_16x16x32_bf16 v[160:163], v[176:179], v[56:59], v[160:163]
    v_mfma_f32_16x16x32_bf16 v[164:167], v[56:59], v[56:59], v[164:167]
    s_waitcnt lgkmcnt(6)
    v_mfma_f32_16x16x32_bf16 v[160:163], v[176:179], v[60:63], v[160:163]
    v_mfma_f32_16x16x32_bf16 v[164:167], v[60:63], v[60:63], v[164:167]
    s_add_u32 s14, s13, 27648
    buffer_load_dwordx4 a[172:175], v184, s[44:47], s14 offen offset:256
    s_waitcnt lgkmcnt(5)
    v_mfma_f32_16x16x32_bf16 v[160:163], v[176:179], v[64:67], v[160:163]
    v_mfma_f32_16x16x32_bf16 v[164:167], v[64:67], v[64:67], v[164:167]
    s_waitcnt lgkmcnt(4)
    v_mfma_f32_16x16x32_bf16 v[160:163], v[176:179], v[68:71], v[160:163]
    v_mfma_f32_16x16x32_bf16 v[164:167], v[68:71], v[68:71], v[164:167]
    s_waitcnt lgkmcnt(3)
    v_mfma_f32_16x16x32_bf16 v[160:163], v[176:179], v[72:75], v[160:163]
    v_mfma_f32_16x16x32_bf16 v[164:167], v[72:75], v[72:75], v[164:167]
    s_add_u32 s14, s13, 36864
    buffer_load_dwordx4 a[176:179], v184, s[44:47], s14 offen offset:256
    s_waitcnt lgkmcnt(2)
    v_mfma_f32_16x16x32_bf16 v[160:163], v[176:179], v[76:79], v[160:163]
    v_mfma_f32_16x16x32_bf16 v[164:167], v[76:79], v[76:79], v[164:167]
    s_waitcnt lgkmcnt(1)
    v_mfma_f32_16x16x32_bf16 v[160:163], v[176:179], v[80:83], v[160:163]
    v_mfma_f32_16x16x32_bf16 v[164:167], v[80:83], v[80:83], v[164:167]
    s_waitcnt lgkmcnt(0)
    v_mfma_f32_16x16x32_bf16 v[160:163], v[176:179], v[84:87], v[160:163]
    v_mfma_f32_16x16x32_bf16 v[164:167], v[84:87], v[84:87], v[164:167]
    s_add_u32 s14, s13, 46080
    buffer_load_dwordx4 a[180:183], v184, s[44:47], s14 offen offset:256
    s_nop 15
    v_cndmask_b32 v164, v164, v165, s[64:65]
    v_cndmask_b32 v164, v164, v166, s[66:67]
    v_cndmask_b32 v164, v164, v167, s[68:69]
    ds_bpermute_b32 v165, v199, v164
    s_waitcnt lgkmcnt(0)
    v_mul_f32 v160, s70, v160
    v_mul_f32 v165, s70, v165
    v_fma_f32 v165, -v160, v160, v165
    v_max_f32 v165, 0, v165
    v_cvt_pk_bf16_f32 v164, v160, v165
    v_lshlrev_b32 v160, 16, v164
    v_and_b32 v165, s95, v164
    v_add_f32 v165, s71, v165
    v_cvt_pk_bf16_f32 v165, v165, v165
    v_and_b32 v165, s95, v165
    v_sqrt_f32 v165, v165
    s_nop 0
    v_cvt_pk_bf16_f32 v165, v165, v165
    v_and_b32 v165, s95, v165
    v_rcp_f32 v166, v165
    s_nop 0
    v_fma_f32 v167, -v165, v166, 1.0
    v_fma_f32 v166, v167, v166, v166
    v_mov_b32 v167, v166
    v_sub_f32 v160, 0, v160
    v_mov_b32 v161, v160
    v_lshlrev_b32 v200, 16, v16
    v_and_b32 v201, s95, v16
    v_lshlrev_b32 v202, 16, v17
    v_and_b32 v203, s95, v17
    v_lshlrev_b32 v204, 16, v18
    v_and_b32 v205, s95, v18
    v_lshlrev_b32 v206, 16, v19
    v_and_b32 v207, s95, v19
    s_add_u32 s14, s13, 55296
    buffer_load_dwordx4 a[184:187], v184, s[44:47], s14 offen offset:256
    v_pk_add_f32 v[200:201], v[200:201], v[160:161]
    v_pk_add_f32 v[202:203], v[202:203], v[160:161]
    v_pk_add_f32 v[204:205], v[204:205], v[160:161]
    v_pk_add_f32 v[206:207], v[206:207], v[160:161]
    v_cvt_pk_bf16_f32 v16, v200, v201
    v_cvt_pk_bf16_f32 v17, v202, v203
    v_cvt_pk_bf16_f32 v18, v204, v205
    v_cvt_pk_bf16_f32 v19, v206, v207
    v_lshlrev_b32 v200, 16, v16
    v_and_b32 v201, s95, v16
    v_lshlrev_b32 v202, 16, v17
    v_and_b32 v203, s95, v17
    v_lshlrev_b32 v204, 16, v18
    v_and_b32 v205, s95, v18
    v_lshlrev_b32 v206, 16, v19
    v_and_b32 v207, s95, v19
    s_add_u32 s14, s13, 64512
    buffer_load_dwordx4 a[188:191], v184, s[44:47], s14 offen offset:256
    v_pk_mul_f32 v[200:201], v[200:201], v[166:167]
    v_pk_mul_f32 v[202:203], v[202:203], v[166:167]
    v_pk_mul_f32 v[204:205], v[204:205], v[166:167]
    v_pk_mul_f32 v[206:207], v[206:207], v[166:167]
    v_cvt_pk_bf16_f32 v16, v200, v201
    v_cvt_pk_bf16_f32 v17, v202, v203
    v_cvt_pk_bf16_f32 v18, v204, v205
    v_cvt_pk_bf16_f32 v19, v206, v207
    ds_write_b64 v195, v[16:17] offset:18432
    ds_write_b64 v196, v[18:19] offset:18432
    v_lshlrev_b32 v200, 16, v20
    v_and_b32 v201, s95, v20
    v_lshlrev_b32 v202, 16, v21
    v_and_b32 v203, s95, v21
    v_lshlrev_b32 v204, 16, v22
    v_and_b32 v205, s95, v22
    v_lshlrev_b32 v206, 16, v23
    v_and_b32 v207, s95, v23
    s_add_u32 s14, s13, 73728
    buffer_load_dwordx4 a[192:195], v184, s[44:47], s14 offen offset:256
    v_pk_add_f32 v[200:201], v[200:201], v[160:161]
    v_pk_add_f32 v[202:203], v[202:203], v[160:161]
    v_pk_add_f32 v[204:205], v[204:205], v[160:161]
    v_pk_add_f32 v[206:207], v[206:207], v[160:161]
    v_cvt_pk_bf16_f32 v20, v200, v201
    v_cvt_pk_bf16_f32 v21, v202, v203
    v_cvt_pk_bf16_f32 v22, v204, v205
    v_cvt_pk_bf16_f32 v23, v206, v207
    v_lshlrev_b32 v200, 16, v20
    v_and_b32 v201, s95, v20
    v_lshlrev_b32 v202, 16, v21
    v_and_b32 v203, s95, v21
    v_lshlrev_b32 v204, 16, v22
    v_and_b32 v205, s95, v22
    v_lshlrev_b32 v206, 16, v23
    v_and_b32 v207, s95, v23
    s_add_u32 s14, s13, 82944
    buffer_load_dwordx4 a[196:199], v184, s[44:47], s14 offen offset:256
    v_pk_mul_f32 v[200:201], v[200:201], v[166:167]
    v_pk_mul_f32 v[202:203], v[202:203], v[166:167]
    v_pk_mul_f32 v[204:205], v[204:205], v[166:167]
    v_pk_mul_f32 v[206:207], v[206:207], v[166:167]
    v_cvt_pk_bf16_f32 v20, v200, v201
    v_cvt_pk_bf16_f32 v21, v202, v203
    v_cvt_pk_bf16_f32 v22, v204, v205
    v_cvt_pk_bf16_f32 v23, v206, v207
    ds_write_b64 v197, v[20:21] offset:18432
    ds_write_b64 v198, v[22:23] offset:18432
    v_lshlrev_b32 v200, 16, v24
    v_and_b32 v201, s95, v24
    v_lshlrev_b32 v202, 16, v25
    v_and_b32 v203, s95, v25
    v_lshlrev_b32 v204, 16, v26
    v_and_b32 v205, s95, v26
    v_lshlrev_b32 v206, 16, v27
    v_and_b32 v207, s95, v27
    s_add_u32 s14, s13, 92160
    buffer_load_dwordx4 a[200:203], v184, s[44:47], s14 offen offset:256
    v_pk_add_f32 v[200:201], v[200:201], v[160:161]
    v_pk_add_f32 v[202:203], v[202:203], v[160:161]
    v_pk_add_f32 v[204:205], v[204:205], v[160:161]
    v_pk_add_f32 v[206:207], v[206:207], v[160:161]
    v_cvt_pk_bf16_f32 v24, v200, v201
    v_cvt_pk_bf16_f32 v25, v202, v203
    v_cvt_pk_bf16_f32 v26, v204, v205
    v_cvt_pk_bf16_f32 v27, v206, v207
    v_lshlrev_b32 v200, 16, v24
    v_and_b32 v201, s95, v24
    v_lshlrev_b32 v202, 16, v25
    v_and_b32 v203, s95, v25
    v_lshlrev_b32 v204, 16, v26
    v_and_b32 v205, s95, v26
    v_lshlrev_b32 v206, 16, v27
    v_and_b32 v207, s95, v27
    s_add_u32 s14, s13, 101376
    buffer_load_dwordx4 a[204:207], v184, s[44:47], s14 offen offset:256
    v_pk_mul_f32 v[200:201], v[200:201], v[166:167]
    v_pk_mul_f32 v[202:203], v[202:203], v[166:167]
    v_pk_mul_f32 v[204:205], v[204:205], v[166:167]
    v_pk_mul_f32 v[206:207], v[206:207], v[166:167]
    v_cvt_pk_bf16_f32 v24, v200, v201
    v_cvt_pk_bf16_f32 v25, v202, v203
    v_cvt_pk_bf16_f32 v26, v204, v205
    v_cvt_pk_bf16_f32 v27, v206, v207
    ds_write_b64 v195, v[24:25] offset:19456
    ds_write_b64 v196, v[26:27] offset:19456
    v_lshlrev_b32 v200, 16, v28
    v_and_b32 v201, s95, v28
    v_lshlrev_b32 v202, 16, v29
    v_and_b32 v203, s95, v29
    v_lshlrev_b32 v204, 16, v30
    v_and_b32 v205, s95, v30
    v_lshlrev_b32 v206, 16, v31
    v_and_b32 v207, s95, v31
    s_xor_b32 s10, s38, 1
    s_lshl_b32 s10, s10, 15
    s_add_u32 s10, s10, s56
    buffer_store_dwordx4 v[12:15], v8, s[52:55], s10 offen offset:0 sc1
    v_pk_add_f32 v[200:201], v[200:201], v[160:161]
    v_pk_add_f32 v[202:203], v[202:203], v[160:161]
    v_pk_add_f32 v[204:205], v[204:205], v[160:161]
    v_pk_add_f32 v[206:207], v[206:207], v[160:161]
    v_cvt_pk_bf16_f32 v28, v200, v201
    v_cvt_pk_bf16_f32 v29, v202, v203
    v_cvt_pk_bf16_f32 v30, v204, v205
    v_cvt_pk_bf16_f32 v31, v206, v207
    v_lshlrev_b32 v200, 16, v28
    v_and_b32 v201, s95, v28
    v_lshlrev_b32 v202, 16, v29
    v_and_b32 v203, s95, v29
    v_lshlrev_b32 v204, 16, v30
    v_and_b32 v205, s95, v30
    v_lshlrev_b32 v206, 16, v31
    v_and_b32 v207, s95, v31
    s_xor_b32 s10, s38, 1
    s_lshl_b32 s10, s10, 15
    s_add_u32 s10, s10, s56
    buffer_store_dwordx4 v[12:15], v8, s[52:55], s10 offen offset:1024 sc1
    v_pk_mul_f32 v[200:201], v[200:201], v[166:167]
    v_pk_mul_f32 v[202:203], v[202:203], v[166:167]
    v_pk_mul_f32 v[204:205], v[204:205], v[166:167]
    v_pk_mul_f32 v[206:207], v[206:207], v[166:167]
    v_cvt_pk_bf16_f32 v28, v200, v201
    v_cvt_pk_bf16_f32 v29, v202, v203
    v_cvt_pk_bf16_f32 v30, v204, v205
    v_cvt_pk_bf16_f32 v31, v206, v207
    ds_write_b64 v197, v[28:29] offset:19456
    ds_write_b64 v198, v[30:31] offset:19456
    v_lshlrev_b32 v200, 16, v32
    v_and_b32 v201, s95, v32
    v_lshlrev_b32 v202, 16, v33
    v_and_b32 v203, s95, v33
    v_lshlrev_b32 v204, 16, v34
    v_and_b32 v205, s95, v34
    v_lshlrev_b32 v206, 16, v35
    v_and_b32 v207, s95, v35
    s_xor_b32 s10, s38, 1
    s_lshl_b32 s10, s10, 12
    s_add_u32 s10, s10, s63
    buffer_store_dwordx4 v[12:15], v8, s[52:55], s10 offen sc1
    v_pk_add_f32 v[200:201], v[200:201], v[160:161]
    v_pk_add_f32 v[202:203], v[202:203], v[160:161]
    v_pk_add_f32 v[204:205], v[204:205], v[160:161]
    v_pk_add_f32 v[206:207], v[206:207], v[160:161]
    v_cvt_pk_bf16_f32 v32, v200, v201
    v_cvt_pk_bf16_f32 v33, v202, v203
    v_cvt_pk_bf16_f32 v34, v204, v205
    v_cvt_pk_bf16_f32 v35, v206, v207
    v_lshlrev_b32 v200, 16, v32
    v_and_b32 v201, s95, v32
    v_lshlrev_b32 v202, 16, v33
    v_and_b32 v203, s95, v33
    v_lshlrev_b32 v204, 16, v34
    v_and_b32 v205, s95, v34
    v_lshlrev_b32 v206, 16, v35
    v_and_b32 v207, s95, v35
    s_xor_b32 s10, s38, 2
    s_lshl_b32 s10, s10, 15
    s_add_u32 s10, s10, s56
    buffer_store_dwordx4 v[12:15], v8, s[52:55], s10 offen offset:0 sc1
    v_pk_mul_f32 v[200:201], v[200:201], v[166:167]
    v_pk_mul_f32 v[202:203], v[202:203], v[166:167]
    v_pk_mul_f32 v[204:205], v[204:205], v[166:167]
    v_pk_mul_f32 v[206:207], v[206:207], v[166:167]
    v_cvt_pk_bf16_f32 v32, v200, v201
    v_cvt_pk_bf16_f32 v33, v202, v203
    v_cvt_pk_bf16_f32 v34, v204, v205
    v_cvt_pk_bf16_f32 v35, v206, v207
    ds_write_b64 v195, v[32:33] offset:20480
    ds_write_b64 v196, v[34:35] offset:20480
    v_lshlrev_b32 v200, 16, v36
    v_and_b32 v201, s95, v36
    v_lshlrev_b32 v202, 16, v37
    v_and_b32 v203, s95, v37
    v_lshlrev_b32 v204, 16, v38
    v_and_b32 v205, s95, v38
    v_lshlrev_b32 v206, 16, v39
    v_and_b32 v207, s95, v39
    s_xor_b32 s10, s38, 2
    s_lshl_b32 s10, s10, 15
    s_add_u32 s10, s10, s56
    buffer_store_dwordx4 v[12:15], v8, s[52:55], s10 offen offset:1024 sc1
    v_pk_add_f32 v[200:201], v[200:201], v[160:161]
    v_pk_add_f32 v[202:203], v[202:203], v[160:161]
    v_pk_add_f32 v[204:205], v[204:205], v[160:161]
    v_pk_add_f32 v[206:207], v[206:207], v[160:161]
    v_cvt_pk_bf16_f32 v36, v200, v201
    v_cvt_pk_bf16_f32 v37, v202, v203
    v_cvt_pk_bf16_f32 v38, v204, v205
    v_cvt_pk_bf16_f32 v39, v206, v207
    v_lshlrev_b32 v200, 16, v36
    v_and_b32 v201, s95, v36
    v_lshlrev_b32 v202, 16, v37
    v_and_b32 v203, s95, v37
    v_lshlrev_b32 v204, 16, v38
    v_and_b32 v205, s95, v38
    v_lshlrev_b32 v206, 16, v39
    v_and_b32 v207, s95, v39
    s_xor_b32 s10, s38, 2
    s_lshl_b32 s10, s10, 12
    s_add_u32 s10, s10, s63
    buffer_store_dwordx4 v[12:15], v8, s[52:55], s10 offen sc1
    v_pk_mul_f32 v[200:201], v[200:201], v[166:167]
    v_pk_mul_f32 v[202:203], v[202:203], v[166:167]
    v_pk_mul_f32 v[204:205], v[204:205], v[166:167]
    v_pk_mul_f32 v[206:207], v[206:207], v[166:167]
    v_cvt_pk_bf16_f32 v36, v200, v201
    v_cvt_pk_bf16_f32 v37, v202, v203
    v_cvt_pk_bf16_f32 v38, v204, v205
    v_cvt_pk_bf16_f32 v39, v206, v207
    ds_write_b64 v197, v[36:37] offset:20480
    ds_write_b64 v198, v[38:39] offset:20480
    v_lshlrev_b32 v200, 16, v40
    v_and_b32 v201, s95, v40
    v_lshlrev_b32 v202, 16, v41
    v_and_b32 v203, s95, v41
    v_lshlrev_b32 v204, 16, v42
    v_and_b32 v205, s95, v42
    v_lshlrev_b32 v206, 16, v43
    v_and_b32 v207, s95, v43
    s_xor_b32 s10, s38, 3
    s_lshl_b32 s10, s10, 15
    s_add_u32 s10, s10, s56
    buffer_store_dwordx4 v[12:15], v8, s[52:55], s10 offen offset:0 sc1
    v_pk_add_f32 v[200:201], v[200:201], v[160:161]
    v_pk_add_f32 v[202:203], v[202:203], v[160:161]
    v_pk_add_f32 v[204:205], v[204:205], v[160:161]
    v_pk_add_f32 v[206:207], v[206:207], v[160:161]
    v_cvt_pk_bf16_f32 v40, v200, v201
    v_cvt_pk_bf16_f32 v41, v202, v203
    v_cvt_pk_bf16_f32 v42, v204, v205
    v_cvt_pk_bf16_f32 v43, v206, v207
    v_lshlrev_b32 v200, 16, v40
    v_and_b32 v201, s95, v40
    v_lshlrev_b32 v202, 16, v41
    v_and_b32 v203, s95, v41
    v_lshlrev_b32 v204, 16, v42
    v_and_b32 v205, s95, v42
    v_lshlrev_b32 v206, 16, v43
    v_and_b32 v207, s95, v43
    s_xor_b32 s10, s38, 3
    s_lshl_b32 s10, s10, 15
    s_add_u32 s10, s10, s56
    buffer_store_dwordx4 v[12:15], v8, s[52:55], s10 offen offset:1024 sc1
    v_pk_mul_f32 v[200:201], v[200:201], v[166:167]
    v_pk_mul_f32 v[202:203], v[202:203], v[166:167]
    v_pk_mul_f32 v[204:205], v[204:205], v[166:167]
    v_pk_mul_f32 v[206:207], v[206:207], v[166:167]
    v_cvt_pk_bf16_f32 v40, v200, v201
    v_cvt_pk_bf16_f32 v41, v202, v203
    v_cvt_pk_bf16_f32 v42, v204, v205
    v_cvt_pk_bf16_f32 v43, v206, v207
    ds_write_b64 v195, v[40:41] offset:21504
    ds_write_b64 v196, v[42:43] offset:21504
    v_lshlrev_b32 v200, 16, v44
    v_and_b32 v201, s95, v44
    v_lshlrev_b32 v202, 16, v45
    v_and_b32 v203, s95, v45
    v_lshlrev_b32 v204, 16, v46
    v_and_b32 v205, s95, v46
    v_lshlrev_b32 v206, 16, v47
    v_and_b32 v207, s95, v47
    s_xor_b32 s10, s38, 3
    s_lshl_b32 s10, s10, 12
    s_add_u32 s10, s10, s63
    buffer_store_dwordx4 v[12:15], v8, s[52:55], s10 offen sc1
    v_pk_add_f32 v[200:201], v[200:201], v[160:161]
    v_pk_add_f32 v[202:203], v[202:203], v[160:161]
    v_pk_add_f32 v[204:205], v[204:205], v[160:161]
    v_pk_add_f32 v[206:207], v[206:207], v[160:161]
    v_cvt_pk_bf16_f32 v44, v200, v201
    v_cvt_pk_bf16_f32 v45, v202, v203
    v_cvt_pk_bf16_f32 v46, v204, v205
    v_cvt_pk_bf16_f32 v47, v206, v207
    v_lshlrev_b32 v200, 16, v44
    v_and_b32 v201, s95, v44
    v_lshlrev_b32 v202, 16, v45
    v_and_b32 v203, s95, v45
    v_lshlrev_b32 v204, 16, v46
    v_and_b32 v205, s95, v46
    v_lshlrev_b32 v206, 16, v47
    v_and_b32 v207, s95, v47
    v_pk_mul_f32 v[200:201], v[200:201], v[166:167]
    v_pk_mul_f32 v[202:203], v[202:203], v[166:167]
    v_pk_mul_f32 v[204:205], v[204:205], v[166:167]
    v_pk_mul_f32 v[206:207], v[206:207], v[166:167]
    v_cvt_pk_bf16_f32 v44, v200, v201
    v_cvt_pk_bf16_f32 v45, v202, v203
    v_cvt_pk_bf16_f32 v46, v204, v205
    v_cvt_pk_bf16_f32 v47, v206, v207
    ds_write_b64 v197, v[44:45] offset:21504
    ds_write_b64 v198, v[46:47] offset:21504
    v_lshlrev_b32 v200, 16, v48
    v_and_b32 v201, s95, v48
    v_lshlrev_b32 v202, 16, v49
    v_and_b32 v203, s95, v49
    v_lshlrev_b32 v204, 16, v50
    v_and_b32 v205, s95, v50
    v_lshlrev_b32 v206, 16, v51
    v_and_b32 v207, s95, v51
    v_pk_add_f32 v[200:201], v[200:201], v[160:161]
    v_pk_add_f32 v[202:203], v[202:203], v[160:161]
    v_pk_add_f32 v[204:205], v[204:205], v[160:161]
    v_pk_add_f32 v[206:207], v[206:207], v[160:161]
    v_cvt_pk_bf16_f32 v48, v200, v201
    v_cvt_pk_bf16_f32 v49, v202, v203
    v_cvt_pk_bf16_f32 v50, v204, v205
    v_cvt_pk_bf16_f32 v51, v206, v207
    v_lshlrev_b32 v200, 16, v48
    v_and_b32 v201, s95, v48
    v_lshlrev_b32 v202, 16, v49
    v_and_b32 v203, s95, v49
    v_lshlrev_b32 v204, 16, v50
    v_and_b32 v205, s95, v50
    v_lshlrev_b32 v206, 16, v51
    v_and_b32 v207, s95, v51
    v_pk_mul_f32 v[200:201], v[200:201], v[166:167]
    v_pk_mul_f32 v[202:203], v[202:203], v[166:167]
    v_pk_mul_f32 v[204:205], v[204:205], v[166:167]
    v_pk_mul_f32 v[206:207], v[206:207], v[166:167]
    v_cvt_pk_bf16_f32 v48, v200, v201
    v_cvt_pk_bf16_f32 v49, v202, v203
    v_cvt_pk_bf16_f32 v50, v204, v205
    v_cvt_pk_bf16_f32 v51, v206, v207
    ds_write_b64 v195, v[48:49] offset:22528
    ds_write_b64 v196, v[50:51] offset:22528
    v_lshlrev_b32 v200, 16, v52
    v_and_b32 v201, s95, v52
    v_lshlrev_b32 v202, 16, v53
    v_and_b32 v203, s95, v53
    v_lshlrev_b32 v204, 16, v54
    v_and_b32 v205, s95, v54
    v_lshlrev_b32 v206, 16, v55
    v_and_b32 v207, s95, v55
    v_pk_add_f32 v[200:201], v[200:201], v[160:161]
    v_pk_add_f32 v[202:203], v[202:203], v[160:161]
    v_pk_add_f32 v[204:205], v[204:205], v[160:161]
    v_pk_add_f32 v[206:207], v[206:207], v[160:161]
    v_cvt_pk_bf16_f32 v52, v200, v201
    v_cvt_pk_bf16_f32 v53, v202, v203
    v_cvt_pk_bf16_f32 v54, v204, v205
    v_cvt_pk_bf16_f32 v55, v206, v207
    v_lshlrev_b32 v200, 16, v52
    v_and_b32 v201, s95, v52
    v_lshlrev_b32 v202, 16, v53
    v_and_b32 v203, s95, v53
    v_lshlrev_b32 v204, 16, v54
    v_and_b32 v205, s95, v54
    v_lshlrev_b32 v206, 16, v55
    v_and_b32 v207, s95, v55
    v_pk_mul_f32 v[200:201], v[200:201], v[166:167]
    v_pk_mul_f32 v[202:203], v[202:203], v[166:167]
    v_pk_mul_f32 v[204:205], v[204:205], v[166:167]
    v_pk_mul_f32 v[206:207], v[206:207], v[166:167]
    v_cvt_pk_bf16_f32 v52, v200, v201
    v_cvt_pk_bf16_f32 v53, v202, v203
    v_cvt_pk_bf16_f32 v54, v204, v205
    v_cvt_pk_bf16_f32 v55, v206, v207
    ds_write_b64 v197, v[52:53] offset:22528
    ds_write_b64 v198, v[54:55] offset:22528
    v_lshlrev_b32 v200, 16, v56
    v_and_b32 v201, s95, v56
    v_lshlrev_b32 v202, 16, v57
    v_and_b32 v203, s95, v57
    v_lshlrev_b32 v204, 16, v58
    v_and_b32 v205, s95, v58
    v_lshlrev_b32 v206, 16, v59
    v_and_b32 v207, s95, v59
    v_pk_add_f32 v[200:201], v[200:201], v[160:161]
    v_pk_add_f32 v[202:203], v[202:203], v[160:161]
    v_pk_add_f32 v[204:205], v[204:205], v[160:161]
    v_pk_add_f32 v[206:207], v[206:207], v[160:161]
    v_cvt_pk_bf16_f32 v56, v200, v201
    v_cvt_pk_bf16_f32 v57, v202, v203
    v_cvt_pk_bf16_f32 v58, v204, v205
    v_cvt_pk_bf16_f32 v59, v206, v207
    v_lshlrev_b32 v200, 16, v56
    v_and_b32 v201, s95, v56
    v_lshlrev_b32 v202, 16, v57
    v_and_b32 v203, s95, v57
    v_lshlrev_b32 v204, 16, v58
    v_and_b32 v205, s95, v58
    v_lshlrev_b32 v206, 16, v59
    v_and_b32 v207, s95, v59
    v_pk_mul_f32 v[200:201], v[200:201], v[166:167]
    v_pk_mul_f32 v[202:203], v[202:203], v[166:167]
    v_pk_mul_f32 v[204:205], v[204:205], v[166:167]
    v_pk_mul_f32 v[206:207], v[206:207], v[166:167]
    v_cvt_pk_bf16_f32 v56, v200, v201
    v_cvt_pk_bf16_f32 v57, v202, v203
    v_cvt_pk_bf16_f32 v58, v204, v205
    v_cvt_pk_bf16_f32 v59, v206, v207
    ds_write_b64 v195, v[56:57] offset:23552
    ds_write_b64 v196, v[58:59] offset:23552
    v_lshlrev_b32 v200, 16, v60
    v_and_b32 v201, s95, v60
    v_lshlrev_b32 v202, 16, v61
    v_and_b32 v203, s95, v61
    v_lshlrev_b32 v204, 16, v62
    v_and_b32 v205, s95, v62
    v_lshlrev_b32 v206, 16, v63
    v_and_b32 v207, s95, v63
    v_pk_add_f32 v[200:201], v[200:201], v[160:161]
    v_pk_add_f32 v[202:203], v[202:203], v[160:161]
    v_pk_add_f32 v[204:205], v[204:205], v[160:161]
    v_pk_add_f32 v[206:207], v[206:207], v[160:161]
    v_cvt_pk_bf16_f32 v60, v200, v201
    v_cvt_pk_bf16_f32 v61, v202, v203
    v_cvt_pk_bf16_f32 v62, v204, v205
    v_cvt_pk_bf16_f32 v63, v206, v207
    v_lshlrev_b32 v200, 16, v60
    v_and_b32 v201, s95, v60
    v_lshlrev_b32 v202, 16, v61
    v_and_b32 v203, s95, v61
    v_lshlrev_b32 v204, 16, v62
    v_and_b32 v205, s95, v62
    v_lshlrev_b32 v206, 16, v63
    v_and_b32 v207, s95, v63
    v_pk_mul_f32 v[200:201], v[200:201], v[166:167]
    v_pk_mul_f32 v[202:203], v[202:203], v[166:167]
    v_pk_mul_f32 v[204:205], v[204:205], v[166:167]
    v_pk_mul_f32 v[206:207], v[206:207], v[166:167]
    v_cvt_pk_bf16_f32 v60, v200, v201
    v_cvt_pk_bf16_f32 v61, v202, v203
    v_cvt_pk_bf16_f32 v62, v204, v205
    v_cvt_pk_bf16_f32 v63, v206, v207
    ds_write_b64 v197, v[60:61] offset:23552
    ds_write_b64 v198, v[62:63] offset:23552
    v_lshlrev_b32 v200, 16, v64
    v_and_b32 v201, s95, v64
    v_lshlrev_b32 v202, 16, v65
    v_and_b32 v203, s95, v65
    v_lshlrev_b32 v204, 16, v66
    v_and_b32 v205, s95, v66
    v_lshlrev_b32 v206, 16, v67
    v_and_b32 v207, s95, v67
    v_pk_add_f32 v[200:201], v[200:201], v[160:161]
    v_pk_add_f32 v[202:203], v[202:203], v[160:161]
    v_pk_add_f32 v[204:205], v[204:205], v[160:161]
    v_pk_add_f32 v[206:207], v[206:207], v[160:161]
    v_cvt_pk_bf16_f32 v64, v200, v201
    v_cvt_pk_bf16_f32 v65, v202, v203
    v_cvt_pk_bf16_f32 v66, v204, v205
    v_cvt_pk_bf16_f32 v67, v206, v207
    v_lshlrev_b32 v200, 16, v64
    v_and_b32 v201, s95, v64
    v_lshlrev_b32 v202, 16, v65
    v_and_b32 v203, s95, v65
    v_lshlrev_b32 v204, 16, v66
    v_and_b32 v205, s95, v66
    v_lshlrev_b32 v206, 16, v67
    v_and_b32 v207, s95, v67
    v_pk_mul_f32 v[200:201], v[200:201], v[166:167]
    v_pk_mul_f32 v[202:203], v[202:203], v[166:167]
    v_pk_mul_f32 v[204:205], v[204:205], v[166:167]
    v_pk_mul_f32 v[206:207], v[206:207], v[166:167]
    v_cvt_pk_bf16_f32 v64, v200, v201
    v_cvt_pk_bf16_f32 v65, v202, v203
    v_cvt_pk_bf16_f32 v66, v204, v205
    v_cvt_pk_bf16_f32 v67, v206, v207
    ds_write_b64 v195, v[64:65] offset:24576
    ds_write_b64 v196, v[66:67] offset:24576
    v_lshlrev_b32 v200, 16, v68
    v_and_b32 v201, s95, v68
    v_lshlrev_b32 v202, 16, v69
    v_and_b32 v203, s95, v69
    v_lshlrev_b32 v204, 16, v70
    v_and_b32 v205, s95, v70
    v_lshlrev_b32 v206, 16, v71
    v_and_b32 v207, s95, v71
    v_pk_add_f32 v[200:201], v[200:201], v[160:161]
    v_pk_add_f32 v[202:203], v[202:203], v[160:161]
    v_pk_add_f32 v[204:205], v[204:205], v[160:161]
    v_pk_add_f32 v[206:207], v[206:207], v[160:161]
    v_cvt_pk_bf16_f32 v68, v200, v201
    v_cvt_pk_bf16_f32 v69, v202, v203
    v_cvt_pk_bf16_f32 v70, v204, v205
    v_cvt_pk_bf16_f32 v71, v206, v207
    v_lshlrev_b32 v200, 16, v68
    v_and_b32 v201, s95, v68
    v_lshlrev_b32 v202, 16, v69
    v_and_b32 v203, s95, v69
    v_lshlrev_b32 v204, 16, v70
    v_and_b32 v205, s95, v70
    v_lshlrev_b32 v206, 16, v71
    v_and_b32 v207, s95, v71
    v_pk_mul_f32 v[200:201], v[200:201], v[166:167]
    v_pk_mul_f32 v[202:203], v[202:203], v[166:167]
    v_pk_mul_f32 v[204:205], v[204:205], v[166:167]
    v_pk_mul_f32 v[206:207], v[206:207], v[166:167]
    v_cvt_pk_bf16_f32 v68, v200, v201
    v_cvt_pk_bf16_f32 v69, v202, v203
    v_cvt_pk_bf16_f32 v70, v204, v205
    v_cvt_pk_bf16_f32 v71, v206, v207
    ds_write_b64 v197, v[68:69] offset:24576
    ds_write_b64 v198, v[70:71] offset:24576
    v_lshlrev_b32 v200, 16, v72
    v_and_b32 v201, s95, v72
    v_lshlrev_b32 v202, 16, v73
    v_and_b32 v203, s95, v73
    v_lshlrev_b32 v204, 16, v74
    v_and_b32 v205, s95, v74
    v_lshlrev_b32 v206, 16, v75
    v_and_b32 v207, s95, v75
    v_pk_add_f32 v[200:201], v[200:201], v[160:161]
    v_pk_add_f32 v[202:203], v[202:203], v[160:161]
    v_pk_add_f32 v[204:205], v[204:205], v[160:161]
    v_pk_add_f32 v[206:207], v[206:207], v[160:161]
    v_cvt_pk_bf16_f32 v72, v200, v201
    v_cvt_pk_bf16_f32 v73, v202, v203
    v_cvt_pk_bf16_f32 v74, v204, v205
    v_cvt_pk_bf16_f32 v75, v206, v207
    v_lshlrev_b32 v200, 16, v72
    v_and_b32 v201, s95, v72
    v_lshlrev_b32 v202, 16, v73
    v_and_b32 v203, s95, v73
    v_lshlrev_b32 v204, 16, v74
    v_and_b32 v205, s95, v74
    v_lshlrev_b32 v206, 16, v75
    v_and_b32 v207, s95, v75
    v_pk_mul_f32 v[200:201], v[200:201], v[166:167]
    v_pk_mul_f32 v[202:203], v[202:203], v[166:167]
    v_pk_mul_f32 v[204:205], v[204:205], v[166:167]
    v_pk_mul_f32 v[206:207], v[206:207], v[166:167]
    v_cvt_pk_bf16_f32 v72, v200, v201
    v_cvt_pk_bf16_f32 v73, v202, v203
    v_cvt_pk_bf16_f32 v74, v204, v205
    v_cvt_pk_bf16_f32 v75, v206, v207
    ds_write_b64 v195, v[72:73] offset:25600
    ds_write_b64 v196, v[74:75] offset:25600
    v_lshlrev_b32 v200, 16, v76
    v_and_b32 v201, s95, v76
    v_lshlrev_b32 v202, 16, v77
    v_and_b32 v203, s95, v77
    v_lshlrev_b32 v204, 16, v78
    v_and_b32 v205, s95, v78
    v_lshlrev_b32 v206, 16, v79
    v_and_b32 v207, s95, v79
    v_pk_add_f32 v[200:201], v[200:201], v[160:161]
    v_pk_add_f32 v[202:203], v[202:203], v[160:161]
    v_pk_add_f32 v[204:205], v[204:205], v[160:161]
    v_pk_add_f32 v[206:207], v[206:207], v[160:161]
    v_cvt_pk_bf16_f32 v76, v200, v201
    v_cvt_pk_bf16_f32 v77, v202, v203
    v_cvt_pk_bf16_f32 v78, v204, v205
    v_cvt_pk_bf16_f32 v79, v206, v207
    v_lshlrev_b32 v200, 16, v76
    v_and_b32 v201, s95, v76
    v_lshlrev_b32 v202, 16, v77
    v_and_b32 v203, s95, v77
    v_lshlrev_b32 v204, 16, v78
    v_and_b32 v205, s95, v78
    v_lshlrev_b32 v206, 16, v79
    v_and_b32 v207, s95, v79
    v_pk_mul_f32 v[200:201], v[200:201], v[166:167]
    v_pk_mul_f32 v[202:203], v[202:203], v[166:167]
    v_pk_mul_f32 v[204:205], v[204:205], v[166:167]
    v_pk_mul_f32 v[206:207], v[206:207], v[166:167]
    v_cvt_pk_bf16_f32 v76, v200, v201
    v_cvt_pk_bf16_f32 v77, v202, v203
    v_cvt_pk_bf16_f32 v78, v204, v205
    v_cvt_pk_bf16_f32 v79, v206, v207
    ds_write_b64 v197, v[76:77] offset:25600
    ds_write_b64 v198, v[78:79] offset:25600
    v_lshlrev_b32 v200, 16, v80
    v_and_b32 v201, s95, v80
    v_lshlrev_b32 v202, 16, v81
    v_and_b32 v203, s95, v81
    v_lshlrev_b32 v204, 16, v82
    v_and_b32 v205, s95, v82
    v_lshlrev_b32 v206, 16, v83
    v_and_b32 v207, s95, v83
    v_pk_add_f32 v[200:201], v[200:201], v[160:161]
    v_pk_add_f32 v[202:203], v[202:203], v[160:161]
    v_pk_add_f32 v[204:205], v[204:205], v[160:161]
    v_pk_add_f32 v[206:207], v[206:207], v[160:161]
    v_cvt_pk_bf16_f32 v80, v200, v201
    v_cvt_pk_bf16_f32 v81, v202, v203
    v_cvt_pk_bf16_f32 v82, v204, v205
    v_cvt_pk_bf16_f32 v83, v206, v207
    v_lshlrev_b32 v200, 16, v80
    v_and_b32 v201, s95, v80
    v_lshlrev_b32 v202, 16, v81
    v_and_b32 v203, s95, v81
    v_lshlrev_b32 v204, 16, v82
    v_and_b32 v205, s95, v82
    v_lshlrev_b32 v206, 16, v83
    v_and_b32 v207, s95, v83
    v_pk_mul_f32 v[200:201], v[200:201], v[166:167]
    v_pk_mul_f32 v[202:203], v[202:203], v[166:167]
    v_pk_mul_f32 v[204:205], v[204:205], v[166:167]
    v_pk_mul_f32 v[206:207], v[206:207], v[166:167]
    v_cvt_pk_bf16_f32 v80, v200, v201
    v_cvt_pk_bf16_f32 v81, v202, v203
    v_cvt_pk_bf16_f32 v82, v204, v205
    v_cvt_pk_bf16_f32 v83, v206, v207
    ds_write_b64 v195, v[80:81] offset:26624
    ds_write_b64 v196, v[82:83] offset:26624
    v_lshlrev_b32 v200, 16, v84
    v_and_b32 v201, s95, v84
    v_lshlrev_b32 v202, 16, v85
    v_and_b32 v203, s95, v85
    v_lshlrev_b32 v204, 16, v86
    v_and_b32 v205, s95, v86
    v_lshlrev_b32 v206, 16, v87
    v_and_b32 v207, s95, v87
    v_pk_add_f32 v[200:201], v[200:201], v[160:161]
    v_pk_add_f32 v[202:203], v[202:203], v[160:161]
    v_pk_add_f32 v[204:205], v[204:205], v[160:161]
    v_pk_add_f32 v[206:207], v[206:207], v[160:161]
    v_cvt_pk_bf16_f32 v84, v200, v201
    v_cvt_pk_bf16_f32 v85, v202, v203
    v_cvt_pk_bf16_f32 v86, v204, v205
    v_cvt_pk_bf16_f32 v87, v206, v207
    v_lshlrev_b32 v200, 16, v84
    v_and_b32 v201, s95, v84
    v_lshlrev_b32 v202, 16, v85
    v_and_b32 v203, s95, v85
    v_lshlrev_b32 v204, 16, v86
    v_and_b32 v205, s95, v86
    v_lshlrev_b32 v206, 16, v87
    v_and_b32 v207, s95, v87
    v_pk_mul_f32 v[200:201], v[200:201], v[166:167]
    v_pk_mul_f32 v[202:203], v[202:203], v[166:167]
    v_pk_mul_f32 v[204:205], v[204:205], v[166:167]
    v_pk_mul_f32 v[206:207], v[206:207], v[166:167]
    v_cvt_pk_bf16_f32 v84, v200, v201
    v_cvt_pk_bf16_f32 v85, v202, v203
    v_cvt_pk_bf16_f32 v86, v204, v205
    v_cvt_pk_bf16_f32 v87, v206, v207
    ds_write_b64 v197, v[84:85] offset:26624
    ds_write_b64 v198, v[86:87] offset:26624
    v_mov_b32 v4, v192
    v_xor_b32 v5, 64, v192
    v_add_u32 v6, 55296, v4
    v_add_u32 v7, 55296, v5
    v_add_u32 v8, 110592, v4
    v_add_u32 v9, 110592, v5
    v_mov_b32 v10, v184
    v_mov_b32 v13, v187
    v_mov_b32 v14, v188
    v_mov_b32 v2, v190
    v_xor_b32 v3, 32, v190
    v_xor_b32 v11, 64, v190
    v_xor_b32 v12, 96, v190
    s_waitcnt vmcnt(44)
    ds_write_b128 v13, a[64:67] offset:0
    s_waitcnt vmcnt(43)
    ds_write_b128 v14, a[68:71] offset:1024
    s_waitcnt vmcnt(42)
    ds_write_b128 v13, a[72:75] offset:2048
    s_waitcnt vmcnt(41)
    ds_write_b128 v14, a[76:79] offset:3072
    ds_read_b64 v[208:209], v2 offset:0
    ds_read_b64 v[210:211], v3 offset:0
    ds_read_b64 v[212:213], v2 offset:2048
    ds_read_b64 v[214:215], v3 offset:2048
    ds_read_b64 v[232:233], v11 offset:0
    ds_read_b64 v[234:235], v12 offset:0
    ds_read_b64 v[236:237], v11 offset:2048
    ds_read_b64 v[238:239], v12 offset:2048
    s_waitcnt vmcnt(40)
    ds_write_b128 v13, a[80:83] offset:0
    s_waitcnt vmcnt(39)
    ds_write_b128 v14, a[84:87] offset:1024
    s_waitcnt vmcnt(38)
    ds_write_b128 v13, a[88:91] offset:2048
    s_waitcnt vmcnt(37)
    ds_write_b128 v14, a[92:95] offset:3072
    ds_read_b64 v[216:217], v2 offset:0
    ds_read_b64 v[218:219], v3 offset:0
    ds_read_b64 v[220:221], v2 offset:2048
    ds_read_b64 v[222:223], v3 offset:2048
    ds_read_b64 v[240:241], v11 offset:0
    ds_read_b64 v[242:243], v12 offset:0
    ds_read_b64 v[244:245], v11 offset:2048
    ds_read_b64 v[246:247], v12 offset:2048
    s_waitcnt vmcnt(36)
    ds_write_b128 v13, a[96:99] offset:0
    s_waitcnt vmcnt(35)
    ds_write_b128 v14, a[100:103] offset:1024
    s_waitcnt vmcnt(34)
    ds_write_b128 v13, a[104:107] offset:2048
    s_waitcnt vmcnt(33)
    ds_write_b128 v14, a[108:111] offset:3072
    ds_read_b64 v[224:225], v2 offset:0
    ds_read_b64 v[226:227], v3 offset:0
    ds_read_b64 v[228:229], v2 offset:2048
    ds_read_b64 v[230:231], v3 offset:2048
    ds_read_b64 v[248:249], v11 offset:0
    ds_read_b64 v[250:251], v12 offset:0
    ds_read_b64 v[252:253], v11 offset:2048
    ds_read_b64 v[254:255], v12 offset:2048
    s_waitcnt lgkmcnt(0)
    s_barrier
    ds_read_b128 a[0:3], v4 offset:0
    ds_read_b128 a[4:7], v4 offset:18432
    ds_read_b128 a[8:11], v4 offset:36864
    ds_read_b128 a[12:15], v6 offset:0
    ds_read_b128 a[16:19], v6 offset:18432
    ds_read_b128 a[20:23], v6 offset:36864
    ds_read_b128 a[24:27], v8 offset:0
    ds_read_b128 a[28:31], v8 offset:18432
    s_waitcnt lgkmcnt(7)
    v_mfma_f32_16x16x32_bf16 v[16:19], a[0:3], v[208:211], 0
    s_waitcnt lgkmcnt(6)
    v_mfma_f32_16x16x32_bf16 v[40:43], a[4:7], v[208:211], 0
    s_waitcnt vmcnt(32)
    ds_write_b128 v13, a[112:115] offset:0
    s_waitcnt lgkmcnt(6)
    v_mfma_f32_16x16x32_bf16 v[64:67], a[8:11], v[208:211], 0
    s_add_u32 s14, s13, 0
    buffer_load_dwordx4 a[64:67], v10, s[44:47], s14 offen offset:384
    s_waitcnt lgkmcnt(5)
    v_mfma_f32_16x16x32_bf16 v[88:91], a[12:15], v[208:211], 0
    ds_read_b128 a[32:35], v5 offset:0
    s_waitcnt lgkmcnt(5)
    v_mfma_f32_16x16x32_bf16 v[112:115], a[16:19], v[208:211], 0
    ds_read_b128 a[36:39], v5 offset:18432
    s_waitcnt lgkmcnt(5)
    v_mfma_f32_16x16x32_bf16 v[136:139], a[20:23], v[208:211], 0
    s_waitcnt vmcnt(32)
    ds_write_b128 v14, a[116:119] offset:1024
    s_waitcnt lgkmcnt(5)
    v_mfma_f32_16x16x32_bf16 v[160:163], a[24:27], v[208:211], 0
    s_add_u32 s14, s13, 9216
    buffer_load_dwordx4 a[68:71], v10, s[44:47], s14 offen offset:384
    s_waitcnt lgkmcnt(4)
    v_mfma_f32_16x16x32_bf16 v[184:187], a[28:31], v[208:211], 0
    ds_read_b128 a[40:43], v5 offset:36864
    v_mfma_f32_16x16x32_bf16 v[20:23], a[0:3], v[212:215], 0
    ds_read_b128 a[44:47], v7 offset:0
    v_mfma_f32_16x16x32_bf16 v[44:47], a[4:7], v[212:215], 0
    s_waitcnt vmcnt(32)
    ds_write_b128 v13, a[120:123] offset:2048
    v_mfma_f32_16x16x32_bf16 v[68:71], a[8:11], v[212:215], 0
    s_add_u32 s14, s13, 18432
    buffer_load_dwordx4 a[72:75], v10, s[44:47], s14 offen offset:384
    v_mfma_f32_16x16x32_bf16 v[92:95], a[12:15], v[212:215], 0
    ds_read_b128 a[48:51], v7 offset:18432
    v_mfma_f32_16x16x32_bf16 v[116:119], a[16:19], v[212:215], 0
    ds_read_b128 a[52:55], v7 offset:36864
    v_mfma_f32_16x16x32_bf16 v[140:143], a[20:23], v[212:215], 0
    s_waitcnt vmcnt(32)
    ds_write_b128 v14, a[124:127] offset:3072
    v_mfma_f32_16x16x32_bf16 v[164:167], a[24:27], v[212:215], 0
    ds_read_b64 a[208:209], v2 offset:0
    v_mfma_f32_16x16x32_bf16 v[188:191], a[28:31], v[212:215], 0
    ds_read_b64 a[210:211], v3 offset:0
    v_mfma_f32_16x16x32_bf16 v[24:27], a[0:3], v[216:219], 0
    ds_read_b64 a[212:213], v2 offset:2048
    v_mfma_f32_16x16x32_bf16 v[48:51], a[4:7], v[216:219], 0
    ds_read_b64 a[214:215], v3 offset:2048
    v_mfma_f32_16x16x32_bf16 v[72:75], a[8:11], v[216:219], 0
    ds_read_b64 a[232:233], v11 offset:0
    v_mfma_f32_16x16x32_bf16 v[96:99], a[12:15], v[216:219], 0
    ds_read_b64 a[234:235], v12 offset:0
    v_mfma_f32_16x16x32_bf16 v[120:123], a[16:19], v[216:219], 0
    ds_read_b64 a[236:237], v11 offset:2048
    v_mfma_f32_16x16x32_bf16 v[144:147], a[20:23], v[216:219], 0
    ds_read_b64 a[238:239], v12 offset:2048
    v_mfma_f32_16x16x32_bf16 v[168:171], a[24:27], v[216:219], 0
    s_waitcnt vmcnt(31)
    ds_write_b128 v13, a[128:131] offset:0
    v_mfma_f32_16x16x32_bf16 v[192:195], a[28:31], v[216:219], 0
    s_add_u32 s14, s13, 27648
    buffer_load_dwordx4 a[76:79], v10, s[44:47], s14 offen offset:384
    v_mfma_f32_16x16x32_bf16 v[28:31], a[0:3], v[220:223], 0
    ds_read_b128 a[56:59], v9 offset:0
    v_mfma_f32_16x16x32_bf16 v[52:55], a[4:7], v[220:223], 0
    ds_read_b128 a[60:63], v9 offset:18432
    v_mfma_f32_16x16x32_bf16 v[76:79], a[8:11], v[220:223], 0
    s_waitcnt vmcnt(31)
    ds_write_b128 v14, a[132:135] offset:1024
    v_mfma_f32_16x16x32_bf16 v[100:103], a[12:15], v[220:223], 0
    s_add_u32 s14, s13, 36864
    buffer_load_dwordx4 a[80:83], v10, s[44:47], s14 offen offset:384
    v_mfma_f32_16x16x32_bf16 v[124:127], a[16:19], v[220:223], 0
    v_mfma_f32_16x16x32_bf16 v[148:151], a[20:23], v[220:223], 0
    v_mfma_f32_16x16x32_bf16 v[172:175], a[24:27], v[220:223], 0
    s_waitcnt vmcnt(31)
    ds_write_b128 v13, a[136:139] offset:2048
    v_mfma_f32_16x16x32_bf16 v[196:199], a[28:31], v[220:223], 0
    s_add_u32 s14, s13, 46080
    buffer_load_dwordx4 a[84:87], v10, s[44:47], s14 offen offset:384
    v_mfma_f32_16x16x32_bf16 v[32:35], a[0:3], v[224:227], 0
    v_mfma_f32_16x16x32_bf16 v[56:59], a[4:7], v[224:227], 0
    v_mfma_f32_16x16x32_bf16 v[80:83], a[8:11], v[224:227], 0
    s_waitcnt vmcnt(31)
    ds_write_b128 v14, a[140:143] offset:3072
    v_mfma_f32_16x16x32_bf16 v[104:107], a[12:15], v[224:227], 0
    ds_read_b64 a[216:217], v2 offset:0
    v_mfma_f32_16x16x32_bf16 v[128:131], a[16:19], v[224:227], 0
    ds_read_b64 a[218:219], v3 offset:0
    v_mfma_f32_16x16x32_bf16 v[152:155], a[20:23], v[224:227], 0
    ds_read_b64 a[220:221], v2 offset:2048
    v_mfma_f32_16x16x32_bf16 v[176:179], a[24:27], v[224:227], 0
    ds_read_b64 a[222:223], v3 offset:2048
    v_mfma_f32_16x16x32_bf16 v[200:203], a[28:31], v[224:227], 0
    ds_read_b64 a[240:241], v11 offset:0
    v_mfma_f32_16x16x32_bf16 v[36:39], a[0:3], v[228:231], 0
    ds_read_b64 a[242:243], v12 offset:0
    v_mfma_f32_16x16x32_bf16 v[60:63], a[4:7], v[228:231], 0
    ds_read_b64 a[244:245], v11 offset:2048
    v_mfma_f32_16x16x32_bf16 v[84:87], a[8:11], v[228:231], 0
    ds_read_b64 a[246:247], v12 offset:2048
    v_mfma_f32_16x16x32_bf16 v[108:111], a[12:15], v[228:231], 0
    s_waitcnt vmcnt(30)
    ds_write_b128 v13, a[144:147] offset:0
    v_mfma_f32_16x16x32_bf16 v[132:135], a[16:19], v[228:231], 0
    s_add_u32 s14, s13, 55296
    buffer_load_dwordx4 a[88:91], v10, s[44:47], s14 offen offset:384
    v_mfma_f32_16x16x32_bf16 v[156:159], a[20:23], v[228:231], 0
    v_mfma_f32_16x16x32_bf16 v[180:183], a[24:27], v[228:231], 0
    v_mfma_f32_16x16x32_bf16 v[204:207], a[28:31], v[228:231], 0
    s_waitcnt vmcnt(30)
    ds_write_b128 v14, a[148:151] offset:1024
    s_waitcnt lgkmcnt(15)
    v_mfma_f32_16x16x32_bf16 v[16:19], a[32:35], v[232:235], v[16:19]
    v_mfma_f32_16x16x32_bf16 v[40:43], a[36:39], v[232:235], v[40:43]
    s_add_u32 s14, s13, 64512
    buffer_load_dwordx4 a[92:95], v10, s[44:47], s14 offen offset:384
    v_mfma_f32_16x16x32_bf16 v[64:67], a[40:43], v[232:235], v[64:67]
    ds_read_b128 a[0:3], v4 offset:1024
    v_mfma_f32_16x16x32_bf16 v[88:91], a[44:47], v[232:235], v[88:91]
    s_waitcnt vmcnt(30)
    ds_write_b128 v13, a[152:155] offset:2048
    v_mfma_f32_16x16x32_bf16 v[112:115], a[48:51], v[232:235], v[112:115]
    ds_read_b128 a[4:7], v4 offset:19456
    v_mfma_f32_16x16x32_bf16 v[136:139], a[52:55], v[232:235], v[136:139]
    s_add_u32 s14, s13, 73728
    buffer_load_dwordx4 a[96:99], v10, s[44:47], s14 offen offset:384
    s_waitcnt lgkmcnt(15)
    v_mfma_f32_16x16x32_bf16 v[160:163], a[56:59], v[232:235], v[160:163]
    ds_read_b128 a[8:11], v4 offset:37888
    v_mfma_f32_16x16x32_bf16 v[184:187], a[60:63], v[232:235], v[184:187]
    s_waitcnt vmcnt(30)
    ds_write_b128 v14, a[156:159] offset:3072
    v_mfma_f32_16x16x32_bf16 v[20:23], a[32:35], v[236:239], v[20:23]
    ds_read_b64 a[224:225], v2 offset:0
    v_mfma_f32_16x16x32_bf16 v[44:47], a[36:39], v[236:239], v[44:47]
    ds_read_b64 a[226:227], v3 offset:0
    v_mfma_f32_16x16x32_bf16 v[68:71], a[40:43], v[236:239], v[68:71]
    ds_read_b64 a[228:229], v2 offset:2048
    v_mfma_f32_16x16x32_bf16 v[92:95], a[44:47], v[236:239], v[92:95]
    ds_read_b64 a[230:231], v3 offset:2048
    v_mfma_f32_16x16x32_bf16 v[116:119], a[48:51], v[236:239], v[116:119]
    ds_read_b64 a[248:249], v11 offset:0
    v_mfma_f32_16x16x32_bf16 v[140:143], a[52:55], v[236:239], v[140:143]
    ds_read_b64 a[250:251], v12 offset:0
    v_mfma_f32_16x16x32_bf16 v[164:167], a[56:59], v[236:239], v[164:167]
    ds_read_b64 a[252:253], v11 offset:2048
    v_mfma_f32_16x16x32_bf16 v[188:191], a[60:63], v[236:239], v[188:191]
    ds_read_b64 a[254:255], v12 offset:2048
    v_mfma_f32_16x16x32_bf16 v[24:27], a[32:35], v[240:243], v[24:27]
    s_add_u32 s14, s13, 82944
    buffer_load_dwordx4 a[100:103], v10, s[44:47], s14 offen offset:384
    v_mfma_f32_16x16x32_bf16 v[48:51], a[36:39], v[240:243], v[48:51]
    ds_read_b128 a[12:15], v6 offset:1024
    v_mfma_f32_16x16x32_bf16 v[72:75], a[40:43], v[240:243], v[72:75]
    ds_read_b128 a[16:19], v6 offset:19456
    v_mfma_f32_16x16x32_bf16 v[96:99], a[44:47], v[240:243], v[96:99]
    ds_read_b128 a[20:23], v6 offset:37888
    v_mfma_f32_16x16x32_bf16 v[120:123], a[48:51], v[240:243], v[120:123]
    s_add_u32 s14, s13, 92160
    buffer_load_dwordx4 a[104:107], v10, s[44:47], s14 offen offset:384
    v_mfma_f32_16x16x32_bf16 v[144:147], a[52:55], v[240:243], v[144:147]
    ds_read_b128 a[24:27], v8 offset:1024
    v_mfma_f32_16x16x32_bf16 v[168:171], a[56:59], v[240:243], v[168:171]
    ds_read_b128 a[28:31], v8 offset:19456
    v_mfma_f32_16x16x32_bf16 v[192:195], a[60:63], v[240:243], v[192:195]
    v_mfma_f32_16x16x32_bf16 v[28:31], a[32:35], v[244:247], v[28:31]
    s_add_u32 s14, s13, 101376
    buffer_load_dwordx4 a[108:111], v10, s[44:47], s14 offen offset:384
    v_mfma_f32_16x16x32_bf16 v[52:55], a[36:39], v[244:247], v[52:55]
    v_mfma_f32_16x16x32_bf16 v[76:79], a[40:43], v[244:247], v[76:79]
    v_mfma_f32_16x16x32_bf16 v[100:103], a[44:47], v[244:247], v[100:103]
    v_mfma_f32_16x16x32_bf16 v[124:127], a[48:51], v[244:247], v[124:127]
    v_mfma_f32_16x16x32_bf16 v[148:151], a[52:55], v[244:247], v[148:151]
    v_mfma_f32_16x16x32_bf16 v[172:175], a[56:59], v[244:247], v[172:175]
    v_mfma_f32_16x16x32_bf16 v[196:199], a[60:63], v[244:247], v[196:199]
    v_mfma_f32_16x16x32_bf16 v[32:35], a[32:35], v[248:251], v[32:35]
    v_mfma_f32_16x16x32_bf16 v[56:59], a[36:39], v[248:251], v[56:59]
    v_mfma_f32_16x16x32_bf16 v[80:83], a[40:43], v[248:251], v[80:83]
    v_mfma_f32_16x16x32_bf16 v[104:107], a[44:47], v[248:251], v[104:107]
    v_mfma_f32_16x16x32_bf16 v[128:131], a[48:51], v[248:251], v[128:131]
    v_mfma_f32_16x16x32_bf16 v[152:155], a[52:55], v[248:251], v[152:155]
    v_mfma_f32_16x16x32_bf16 v[176:179], a[56:59], v[248:251], v[176:179]
    v_mfma_f32_16x16x32_bf16 v[200:203], a[60:63], v[248:251], v[200:203]
    v_mfma_f32_16x16x32_bf16 v[36:39], a[32:35], v[252:255], v[36:39]
    v_mfma_f32_16x16x32_bf16 v[60:63], a[36:39], v[252:255], v[60:63]
    v_mfma_f32_16x16x32_bf16 v[84:87], a[40:43], v[252:255], v[84:87]
    v_mfma_f32_16x16x32_bf16 v[108:111], a[44:47], v[252:255], v[108:111]
    v_mfma_f32_16x16x32_bf16 v[132:135], a[48:51], v[252:255], v[132:135]
    v_mfma_f32_16x16x32_bf16 v[156:159], a[52:55], v[252:255], v[156:159]
    v_mfma_f32_16x16x32_bf16 v[180:183], a[56:59], v[252:255], v[180:183]
    v_mfma_f32_16x16x32_bf16 v[204:207], a[60:63], v[252:255], v[204:207]
    s_waitcnt lgkmcnt(15)
    v_mfma_f32_16x16x32_bf16 v[16:19], a[0:3], a[208:211], v[16:19]
    v_mfma_f32_16x16x32_bf16 v[40:43], a[4:7], a[208:211], v[40:43]
    s_waitcnt vmcnt(32)
    ds_write_b128 v13, a[160:163] offset:0
    s_waitcnt lgkmcnt(15)
    v_mfma_f32_16x16x32_bf16 v[64:67], a[8:11], a[208:211], v[64:67]
    s_add_u32 s14, s13, 0
    buffer_load_dwordx4 a[112:115], v10, s[44:47], s14 offen offset:512
    s_waitcnt lgkmcnt(5)
    v_mfma_f32_16x16x32_bf16 v[88:91], a[12:15], a[208:211], v[88:91]
    ds_read_b128 a[32:35], v5 offset:1024
    s_waitcnt lgkmcnt(5)
    v_mfma_f32_16x16x32_bf16 v[112:115], a[16:19], a[208:211], v[112:115]
    ds_read_b128 a[36:39], v5 offset:19456
    s_waitcnt lgkmcnt(5)
    v_mfma_f32_16x16x32_bf16 v[136:139], a[20:23], a[208:211], v[136:139]
    s_waitcnt vmcnt(32)
    ds_write_b128 v14, a[164:167] offset:1024
    s_waitcnt lgkmcnt(5)
    v_mfma_f32_16x16x32_bf16 v[160:163], a[24:27], a[208:211], v[160:163]
    s_add_u32 s14, s13, 9216
    buffer_load_dwordx4 a[116:119], v10, s[44:47], s14 offen offset:512
    s_waitcnt lgkmcnt(4)
    v_mfma_f32_16x16x32_bf16 v[184:187], a[28:31], a[208:211], v[184:187]
    ds_read_b128 a[40:43], v5 offset:37888
    v_mfma_f32_16x16x32_bf16 v[20:23], a[0:3], a[212:215], v[20:23]
    ds_read_b128 a[44:47], v7 offset:1024
    v_mfma_f32_16x16x32_bf16 v[44:47], a[4:7], a[212:215], v[44:47]
    s_waitcnt vmcnt(32)
    ds_write_b128 v13, a[168:171] offset:2048
    v_mfma_f32_16x16x32_bf16 v[68:71], a[8:11], a[212:215], v[68:71]
    s_add_u32 s14, s13, 18432
    buffer_load_dwordx4 a[120:123], v10, s[44:47], s14 offen offset:512
    v_mfma_f32_16x16x32_bf16 v[92:95], a[12:15], a[212:215], v[92:95]
    ds_read_b128 a[48:51], v7 offset:19456
    v_mfma_f32_16x16x32_bf16 v[116:119], a[16:19], a[212:215], v[116:119]
    ds_read_b128 a[52:55], v7 offset:37888
    v_mfma_f32_16x16x32_bf16 v[140:143], a[20:23], a[212:215], v[140:143]
    s_waitcnt vmcnt(32)
    ds_write_b128 v14, a[172:175] offset:3072
    v_mfma_f32_16x16x32_bf16 v[164:167], a[24:27], a[212:215], v[164:167]
    ds_read_b64 v[208:209], v2 offset:0
    v_mfma_f32_16x16x32_bf16 v[188:191], a[28:31], a[212:215], v[188:191]
    ds_read_b64 v[210:211], v3 offset:0
    v_mfma_f32_16x16x32_bf16 v[24:27], a[0:3], a[216:219], v[24:27]
    ds_read_b64 v[212:213], v2 offset:2048
    v_mfma_f32_16x16x32_bf16 v[48:51], a[4:7], a[216:219], v[48:51]
    ds_read_b64 v[214:215], v3 offset:2048
    v_mfma_f32_16x16x32_bf16 v[72:75], a[8:11], a[216:219], v[72:75]
    ds_read_b64 v[232:233], v11 offset:0
    v_mfma_f32_16x16x32_bf16 v[96:99], a[12:15], a[216:219], v[96:99]
    ds_read_b64 v[234:235], v12 offset:0
    v_mfma_f32_16x16x32_bf16 v[120:123], a[16:19], a[216:219], v[120:123]
    ds_read_b64 v[236:237], v11 offset:2048
    v_mfma_f32_16x16x32_bf16 v[144:147], a[20:23], a[216:219], v[144:147]
    ds_read_b64 v[238:239], v12 offset:2048
    v_mfma_f32_16x16x32_bf16 v[168:171], a[24:27], a[216:219], v[168:171]
    s_waitcnt vmcnt(31)
    ds_write_b128 v13, a[176:179] offset:0
    v_mfma_f32_16x16x32_bf16 v[192:195], a[28:31], a[216:219], v[192:195]
    s_add_u32 s14, s13, 27648
    buffer_load_dwordx4 a[124:127], v10, s[44:47], s14 offen offset:512
    v_mfma_f32_16x16x32_bf16 v[28:31], a[0:3], a[220:223], v[28:31]
    ds_read_b128 a[56:59], v9 offset:1024
    v_mfma_f32_16x16x32_bf16 v[52:55], a[4:7], a[220:223], v[52:55]
    ds_read_b128 a[60:63], v9 offset:19456
    v_mfma_f32_16x16x32_bf16 v[76:79], a[8:11], a[220:223], v[76:79]
    s_waitcnt vmcnt(31)
    ds_write_b128 v14, a[180:183] offset:1024
    v_mfma_f32_16x16x32_bf16 v[100:103], a[12:15], a[220:223], v[100:103]
    s_add_u32 s14, s13, 36864
    buffer_load_dwordx4 a[128:131], v10, s[44:47], s14 offen offset:512
    v_mfma_f32_16x16x32_bf16 v[124:127], a[16:19], a[220:223], v[124:127]
    v_mfma_f32_16x16x32_bf16 v[148:151], a[20:23], a[220:223], v[148:151]
    v_mfma_f32_16x16x32_bf16 v[172:175], a[24:27], a[220:223], v[172:175]
    s_waitcnt vmcnt(31)
    ds_write_b128 v13, a[184:187] offset:2048
    v_mfma_f32_16x16x32_bf16 v[196:199], a[28:31], a[220:223], v[196:199]
    s_add_u32 s14, s13, 46080
    buffer_load_dwordx4 a[132:135], v10, s[44:47], s14 offen offset:512
    v_mfma_f32_16x16x32_bf16 v[32:35], a[0:3], a[224:227], v[32:35]
    v_mfma_f32_16x16x32_bf16 v[56:59], a[4:7], a[224:227], v[56:59]
    v_mfma_f32_16x16x32_bf16 v[80:83], a[8:11], a[224:227], v[80:83]
    s_waitcnt vmcnt(31)
    ds_write_b128 v14, a[188:191] offset:3072
    v_mfma_f32_16x16x32_bf16 v[104:107], a[12:15], a[224:227], v[104:107]
    ds_read_b64 v[216:217], v2 offset:0
    v_mfma_f32_16x16x32_bf16 v[128:131], a[16:19], a[224:227], v[128:131]
    ds_read_b64 v[218:219], v3 offset:0
    v_mfma_f32_16x16x32_bf16 v[152:155], a[20:23], a[224:227], v[152:155]
    ds_read_b64 v[220:221], v2 offset:2048
    v_mfma_f32_16x16x32_bf16 v[176:179], a[24:27], a[224:227], v[176:179]
    ds_read_b64 v[222:223], v3 offset:2048
    v_mfma_f32_16x16x32_bf16 v[200:203], a[28:31], a[224:227], v[200:203]
    ds_read_b64 v[240:241], v11 offset:0
    v_mfma_f32_16x16x32_bf16 v[36:39], a[0:3], a[228:231], v[36:39]
    ds_read_b64 v[242:243], v12 offset:0
    v_mfma_f32_16x16x32_bf16 v[60:63], a[4:7], a[228:231], v[60:63]
    ds_read_b64 v[244:245], v11 offset:2048
    v_mfma_f32_16x16x32_bf16 v[84:87], a[8:11], a[228:231], v[84:87]
    ds_read_b64 v[246:247], v12 offset:2048
    v_mfma_f32_16x16x32_bf16 v[108:111], a[12:15], a[228:231], v[108:111]
    s_waitcnt vmcnt(30)
    ds_write_b128 v13, a[192:195] offset:0
    v_mfma_f32_16x16x32_bf16 v[132:135], a[16:19], a[228:231], v[132:135]
    s_add_u32 s14, s13, 55296
    buffer_load_dwordx4 a[136:139], v10, s[44:47], s14 offen offset:512
    v_mfma_f32_16x16x32_bf16 v[156:159], a[20:23], a[228:231], v[156:159]
    v_mfma_f32_16x16x32_bf16 v[180:183], a[24:27], a[228:231], v[180:183]
    v_mfma_f32_16x16x32_bf16 v[204:207], a[28:31], a[228:231], v[204:207]
    s_waitcnt vmcnt(30)
    ds_write_b128 v14, a[196:199] offset:1024
    s_waitcnt lgkmcnt(15)
    v_mfma_f32_16x16x32_bf16 v[16:19], a[32:35], a[232:235], v[16:19]
    v_mfma_f32_16x16x32_bf16 v[40:43], a[36:39], a[232:235], v[40:43]
    s_add_u32 s14, s13, 64512
    buffer_load_dwordx4 a[140:143], v10, s[44:47], s14 offen offset:512
    v_mfma_f32_16x16x32_bf16 v[64:67], a[40:43], a[232:235], v[64:67]
    ds_read_b128 a[0:3], v4 offset:2048
    v_mfma_f32_16x16x32_bf16 v[88:91], a[44:47], a[232:235], v[88:91]
    s_waitcnt vmcnt(30)
    ds_write_b128 v13, a[200:203] offset:2048
    v_mfma_f32_16x16x32_bf16 v[112:115], a[48:51], a[232:235], v[112:115]
    ds_read_b128 a[4:7], v4 offset:20480
    v_mfma_f32_16x16x32_bf16 v[136:139], a[52:55], a[232:235], v[136:139]
    s_add_u32 s14, s13, 73728
    buffer_load_dwordx4 a[144:147], v10, s[44:47], s14 offen offset:512
    s_waitcnt lgkmcnt(15)
    v_mfma_f32_16x16x32_bf16 v[160:163], a[56:59], a[232:235], v[160:163]
    ds_read_b128 a[8:11], v4 offset:38912
    v_mfma_f32_16x16x32_bf16 v[184:187], a[60:63], a[232:235], v[184:187]
    s_waitcnt vmcnt(30)
    ds_write_b128 v14, a[204:207] offset:3072
    v_mfma_f32_16x16x32_bf16 v[20:23], a[32:35], a[236:239], v[20:23]
    ds_read_b64 v[224:225], v2 offset:0
    v_mfma_f32_16x16x32_bf16 v[44:47], a[36:39], a[236:239], v[44:47]
    ds_read_b64 v[226:227], v3 offset:0
    v_mfma_f32_16x16x32_bf16 v[68:71], a[40:43], a[236:239], v[68:71]
    ds_read_b64 v[228:229], v2 offset:2048
    v_mfma_f32_16x16x32_bf16 v[92:95], a[44:47], a[236:239], v[92:95]
    ds_read_b64 v[230:231], v3 offset:2048
    v_mfma_f32_16x16x32_bf16 v[116:119], a[48:51], a[236:239], v[116:119]
    ds_read_b64 v[248:249], v11 offset:0
    v_mfma_f32_16x16x32_bf16 v[140:143], a[52:55], a[236:239], v[140:143]
    ds_read_b64 v[250:251], v12 offset:0
    v_mfma_f32_16x16x32_bf16 v[164:167], a[56:59], a[236:239], v[164:167]
    ds_read_b64 v[252:253], v11 offset:2048
    v_mfma_f32_16x16x32_bf16 v[188:191], a[60:63], a[236:239], v[188:191]
    ds_read_b64 v[254:255], v12 offset:2048
    v_mfma_f32_16x16x32_bf16 v[24:27], a[32:35], a[240:243], v[24:27]
    s_add_u32 s14, s13, 82944
    buffer_load_dwordx4 a[148:151], v10, s[44:47], s14 offen offset:512
    v_mfma_f32_16x16x32_bf16 v[48:51], a[36:39], a[240:243], v[48:51]
    ds_read_b128 a[12:15], v6 offset:2048
    v_mfma_f32_16x16x32_bf16 v[72:75], a[40:43], a[240:243], v[72:75]
    ds_read_b128 a[16:19], v6 offset:20480
    v_mfma_f32_16x16x32_bf16 v[96:99], a[44:47], a[240:243], v[96:99]
    ds_read_b128 a[20:23], v6 offset:38912
    v_mfma_f32_16x16x32_bf16 v[120:123], a[48:51], a[240:243], v[120:123]
    s_add_u32 s14, s13, 92160
    buffer_load_dwordx4 a[152:155], v10, s[44:47], s14 offen offset:512
    v_mfma_f32_16x16x32_bf16 v[144:147], a[52:55], a[240:243], v[144:147]
    ds_read_b128 a[24:27], v8 offset:2048
    v_mfma_f32_16x16x32_bf16 v[168:171], a[56:59], a[240:243], v[168:171]
    ds_read_b128 a[28:31], v8 offset:20480
    v_mfma_f32_16x16x32_bf16 v[192:195], a[60:63], a[240:243], v[192:195]
    v_mfma_f32_16x16x32_bf16 v[28:31], a[32:35], a[244:247], v[28:31]
    s_add_u32 s14, s13, 101376
    buffer_load_dwordx4 a[156:159], v10, s[44:47], s14 offen offset:512
    v_mfma_f32_16x16x32_bf16 v[52:55], a[36:39], a[244:247], v[52:55]
    v_mfma_f32_16x16x32_bf16 v[76:79], a[40:43], a[244:247], v[76:79]
    v_mfma_f32_16x16x32_bf16 v[100:103], a[44:47], a[244:247], v[100:103]
    v_mfma_f32_16x16x32_bf16 v[124:127], a[48:51], a[244:247], v[124:127]
    v_mfma_f32_16x16x32_bf16 v[148:151], a[52:55], a[244:247], v[148:151]
    v_mfma_f32_16x16x32_bf16 v[172:175], a[56:59], a[244:247], v[172:175]
    v_mfma_f32_16x16x32_bf16 v[196:199], a[60:63], a[244:247], v[196:199]
    v_mfma_f32_16x16x32_bf16 v[32:35], a[32:35], a[248:251], v[32:35]
    v_mfma_f32_16x16x32_bf16 v[56:59], a[36:39], a[248:251], v[56:59]
    v_mfma_f32_16x16x32_bf16 v[80:83], a[40:43], a[248:251], v[80:83]
    v_mfma_f32_16x16x32_bf16 v[104:107], a[44:47], a[248:251], v[104:107]
    v_mfma_f32_16x16x32_bf16 v[128:131], a[48:51], a[248:251], v[128:131]
    v_mfma_f32_16x16x32_bf16 v[152:155], a[52:55], a[248:251], v[152:155]
    v_mfma_f32_16x16x32_bf16 v[176:179], a[56:59], a[248:251], v[176:179]
    v_mfma_f32_16x16x32_bf16 v[200:203], a[60:63], a[248:251], v[200:203]
    v_mfma_f32_16x16x32_bf16 v[36:39], a[32:35], a[252:255], v[36:39]
    v_mfma_f32_16x16x32_bf16 v[60:63], a[36:39], a[252:255], v[60:63]
    v_mfma_f32_16x16x32_bf16 v[84:87], a[40:43], a[252:255], v[84:87]
    v_mfma_f32_16x16x32_bf16 v[108:111], a[44:47], a[252:255], v[108:111]
    v_mfma_f32_16x16x32_bf16 v[132:135], a[48:51], a[252:255], v[132:135]
    v_mfma_f32_16x16x32_bf16 v[156:159], a[52:55], a[252:255], v[156:159]
    v_mfma_f32_16x16x32_bf16 v[180:183], a[56:59], a[252:255], v[180:183]
    v_mfma_f32_16x16x32_bf16 v[204:207], a[60:63], a[252:255], v[204:207]
    s_waitcnt lgkmcnt(15)
    v_mfma_f32_16x16x32_bf16 v[16:19], a[0:3], v[208:211], v[16:19]
    v_mfma_f32_16x16x32_bf16 v[40:43], a[4:7], v[208:211], v[40:43]
    s_waitcnt vmcnt(23)
    ds_write_b128 v13, a[64:67] offset:0
    s_waitcnt lgkmcnt(15)
    v_mfma_f32_16x16x32_bf16 v[64:67], a[8:11], v[208:211], v[64:67]
    s_add_u32 s14, s13, 0
    buffer_load_dwordx4 a[160:163], v10, s[44:47], s14 offen offset:640
    s_waitcnt lgkmcnt(5)
    v_mfma_f32_16x16x32_bf16 v[88:91], a[12:15], v[208:211], v[88:91]
    ds_read_b128 a[32:35], v5 offset:2048
    s_waitcnt lgkmcnt(5)
    v_mfma_f32_16x16x32_bf16 v[112:115], a[16:19], v[208:211], v[112:115]
    ds_read_b128 a[36:39], v5 offset:20480
    s_waitcnt lgkmcnt(5)
    v_mfma_f32_16x16x32_bf16 v[136:139], a[20:23], v[208:211], v[136:139]
    s_waitcnt vmcnt(23)
    ds_write_b128 v14, a[68:71] offset:1024
    s_waitcnt lgkmcnt(5)
    v_mfma_f32_16x16x32_bf16 v[160:163], a[24:27], v[208:211], v[160:163]
    s_add_u32 s14, s13, 9216
    buffer_load_dwordx4 a[164:167], v10, s[44:47], s14 offen offset:640
    s_waitcnt lgkmcnt(4)
    v_mfma_f32_16x16x32_bf16 v[184:187], a[28:31], v[208:211], v[184:187]
    ds_read_b128 a[40:43], v5 offset:38912
    v_mfma_f32_16x16x32_bf16 v[20:23], a[0:3], v[212:215], v[20:23]
    ds_read_b128 a[44:47], v7 offset:2048
    v_mfma_f32_16x16x32_bf16 v[44:47], a[4:7], v[212:215], v[44:47]
    s_waitcnt vmcnt(23)
    ds_write_b128 v13, a[72:75] offset:2048
    v_mfma_f32_16x16x32_bf16 v[68:71], a[8:11], v[212:215], v[68:71]
    s_add_u32 s14, s13, 18432
    buffer_load_dwordx4 a[168:171], v10, s[44:47], s14 offen offset:640
    v_mfma_f32_16x16x32_bf16 v[92:95], a[12:15], v[212:215], v[92:95]
    ds_read_b128 a[48:51], v7 offset:20480
    v_mfma_f32_16x16x32_bf16 v[116:119], a[16:19], v[212:215], v[116:119]
    ds_read_b128 a[52:55], v7 offset:38912
    v_mfma_f32_16x16x32_bf16 v[140:143], a[20:23], v[212:215], v[140:143]
    s_waitcnt vmcnt(23)
    ds_write_b128 v14, a[76:79] offset:3072
    v_mfma_f32_16x16x32_bf16 v[164:167], a[24:27], v[212:215], v[164:167]
    ds_read_b64 a[208:209], v2 offset:0
    v_mfma_f32_16x16x32_bf16 v[188:191], a[28:31], v[212:215], v[188:191]
    ds_read_b64 a[210:211], v3 offset:0
    v_mfma_f32_16x16x32_bf16 v[24:27], a[0:3], v[216:219], v[24:27]
    ds_read_b64 a[212:213], v2 offset:2048
    v_mfma_f32_16x16x32_bf16 v[48:51], a[4:7], v[216:219], v[48:51]
    ds_read_b64 a[214:215], v3 offset:2048
    v_mfma_f32_16x16x32_bf16 v[72:75], a[8:11], v[216:219], v[72:75]
    ds_read_b64 a[232:233], v11 offset:0
    v_mfma_f32_16x16x32_bf16 v[96:99], a[12:15], v[216:219], v[96:99]
    ds_read_b64 a[234:235], v12 offset:0
    v_mfma_f32_16x16x32_bf16 v[120:123], a[16:19], v[216:219], v[120:123]
    ds_read_b64 a[236:237], v11 offset:2048
    v_mfma_f32_16x16x32_bf16 v[144:147], a[20:23], v[216:219], v[144:147]
    ds_read_b64 a[238:239], v12 offset:2048
    v_mfma_f32_16x16x32_bf16 v[168:171], a[24:27], v[216:219], v[168:171]
    s_waitcnt vmcnt(22)
    ds_write_b128 v13, a[80:83] offset:0
    v_mfma_f32_16x16x32_bf16 v[192:195], a[28:31], v[216:219], v[192:195]
    s_add_u32 s14, s13, 27648
    buffer_load_dwordx4 a[172:175], v10, s[44:47], s14 offen offset:640
    v_mfma_f32_16x16x32_bf16 v[28:31], a[0:3], v[220:223], v[28:31]
    ds_read_b128 a[56:59], v9 offset:2048
    v_mfma_f32_16x16x32_bf16 v[52:55], a[4:7], v[220:223], v[52:55]
    ds_read_b128 a[60:63], v9 offset:20480
    v_mfma_f32_16x16x32_bf16 v[76:79], a[8:11], v[220:223], v[76:79]
    s_waitcnt vmcnt(22)
    ds_write_b128 v14, a[84:87] offset:1024
    v_mfma_f32_16x16x32_bf16 v[100:103], a[12:15], v[220:223], v[100:103]
    s_add_u32 s14, s13, 36864
    buffer_load_dwordx4 a[176:179], v10, s[44:47], s14 offen offset:640
    v_mfma_f32_16x16x32_bf16 v[124:127], a[16:19], v[220:223], v[124:127]
    v_mfma_f32_16x16x32_bf16 v[148:151], a[20:23], v[220:223], v[148:151]
    v_mfma_f32_16x16x32_bf16 v[172:175], a[24:27], v[220:223], v[172:175]
    s_waitcnt vmcnt(22)
    ds_write_b128 v13, a[88:91] offset:2048
    v_mfma_f32_16x16x32_bf16 v[196:199], a[28:31], v[220:223], v[196:199]
    s_add_u32 s14, s13, 46080
    buffer_load_dwordx4 a[180:183], v10, s[44:47], s14 offen offset:640
    v_mfma_f32_16x16x32_bf16 v[32:35], a[0:3], v[224:227], v[32:35]
    v_mfma_f32_16x16x32_bf16 v[56:59], a[4:7], v[224:227], v[56:59]
    v_mfma_f32_16x16x32_bf16 v[80:83], a[8:11], v[224:227], v[80:83]
    s_waitcnt vmcnt(22)
    ds_write_b128 v14, a[92:95] offset:3072
    v_mfma_f32_16x16x32_bf16 v[104:107], a[12:15], v[224:227], v[104:107]
    ds_read_b64 a[216:217], v2 offset:0
    v_mfma_f32_16x16x32_bf16 v[128:131], a[16:19], v[224:227], v[128:131]
    ds_read_b64 a[218:219], v3 offset:0
    v_mfma_f32_16x16x32_bf16 v[152:155], a[20:23], v[224:227], v[152:155]
    ds_read_b64 a[220:221], v2 offset:2048
    v_mfma_f32_16x16x32_bf16 v[176:179], a[24:27], v[224:227], v[176:179]
    ds_read_b64 a[222:223], v3 offset:2048
    v_mfma_f32_16x16x32_bf16 v[200:203], a[28:31], v[224:227], v[200:203]
    ds_read_b64 a[240:241], v11 offset:0
    v_mfma_f32_16x16x32_bf16 v[36:39], a[0:3], v[228:231], v[36:39]
    ds_read_b64 a[242:243], v12 offset:0
    v_mfma_f32_16x16x32_bf16 v[60:63], a[4:7], v[228:231], v[60:63]
    ds_read_b64 a[244:245], v11 offset:2048
    v_mfma_f32_16x16x32_bf16 v[84:87], a[8:11], v[228:231], v[84:87]
    ds_read_b64 a[246:247], v12 offset:2048
    v_mfma_f32_16x16x32_bf16 v[108:111], a[12:15], v[228:231], v[108:111]
    s_waitcnt vmcnt(21)
    ds_write_b128 v13, a[96:99] offset:0
    v_mfma_f32_16x16x32_bf16 v[132:135], a[16:19], v[228:231], v[132:135]
    s_add_u32 s14, s13, 55296
    buffer_load_dwordx4 a[184:187], v10, s[44:47], s14 offen offset:640
    v_mfma_f32_16x16x32_bf16 v[156:159], a[20:23], v[228:231], v[156:159]
    v_mfma_f32_16x16x32_bf16 v[180:183], a[24:27], v[228:231], v[180:183]
    v_mfma_f32_16x16x32_bf16 v[204:207], a[28:31], v[228:231], v[204:207]
    s_waitcnt vmcnt(21)
    ds_write_b128 v14, a[100:103] offset:1024
    s_waitcnt lgkmcnt(15)
    v_mfma_f32_16x16x32_bf16 v[16:19], a[32:35], v[232:235], v[16:19]
    v_mfma_f32_16x16x32_bf16 v[40:43], a[36:39], v[232:235], v[40:43]
    s_add_u32 s14, s13, 64512
    buffer_load_dwordx4 a[188:191], v10, s[44:47], s14 offen offset:640
    v_mfma_f32_16x16x32_bf16 v[64:67], a[40:43], v[232:235], v[64:67]
    ds_read_b128 a[0:3], v4 offset:3072
    v_mfma_f32_16x16x32_bf16 v[88:91], a[44:47], v[232:235], v[88:91]
    s_waitcnt vmcnt(21)
    ds_write_b128 v13, a[104:107] offset:2048
    v_mfma_f32_16x16x32_bf16 v[112:115], a[48:51], v[232:235], v[112:115]
    ds_read_b128 a[4:7], v4 offset:21504
    v_mfma_f32_16x16x32_bf16 v[136:139], a[52:55], v[232:235], v[136:139]
    s_add_u32 s14, s13, 73728
    buffer_load_dwordx4 a[192:195], v10, s[44:47], s14 offen offset:640
    s_waitcnt lgkmcnt(15)
    v_mfma_f32_16x16x32_bf16 v[160:163], a[56:59], v[232:235], v[160:163]
    ds_read_b128 a[8:11], v4 offset:39936
    v_mfma_f32_16x16x32_bf16 v[184:187], a[60:63], v[232:235], v[184:187]
    s_waitcnt vmcnt(21)
    ds_write_b128 v14, a[108:111] offset:3072
    v_mfma_f32_16x16x32_bf16 v[20:23], a[32:35], v[236:239], v[20:23]
    ds_read_b64 a[224:225], v2 offset:0
    v_mfma_f32_16x16x32_bf16 v[44:47], a[36:39], v[236:239], v[44:47]
    ds_read_b64 a[226:227], v3 offset:0
    v_mfma_f32_16x16x32_bf16 v[68:71], a[40:43], v[236:239], v[68:71]
    ds_read_b64 a[228:229], v2 offset:2048
    v_mfma_f32_16x16x32_bf16 v[92:95], a[44:47], v[236:239], v[92:95]
    ds_read_b64 a[230:231], v3 offset:2048
    v_mfma_f32_16x16x32_bf16 v[116:119], a[48:51], v[236:239], v[116:119]
    ds_read_b64 a[248:249], v11 offset:0
    v_mfma_f32_16x16x32_bf16 v[140:143], a[52:55], v[236:239], v[140:143]
    ds_read_b64 a[250:251], v12 offset:0
    v_mfma_f32_16x16x32_bf16 v[164:167], a[56:59], v[236:239], v[164:167]
    ds_read_b64 a[252:253], v11 offset:2048
    v_mfma_f32_16x16x32_bf16 v[188:191], a[60:63], v[236:239], v[188:191]
    ds_read_b64 a[254:255], v12 offset:2048
    v_mfma_f32_16x16x32_bf16 v[24:27], a[32:35], v[240:243], v[24:27]
    s_add_u32 s14, s13, 82944
    buffer_load_dwordx4 a[196:199], v10, s[44:47], s14 offen offset:640
    v_mfma_f32_16x16x32_bf16 v[48:51], a[36:39], v[240:243], v[48:51]
    ds_read_b128 a[12:15], v6 offset:3072
    v_mfma_f32_16x16x32_bf16 v[72:75], a[40:43], v[240:243], v[72:75]
    ds_read_b128 a[16:19], v6 offset:21504
    v_mfma_f32_16x16x32_bf16 v[96:99], a[44:47], v[240:243], v[96:99]
    ds_read_b128 a[20:23], v6 offset:39936
    v_mfma_f32_16x16x32_bf16 v[120:123], a[48:51], v[240:243], v[120:123]
    s_add_u32 s14, s13, 92160
    buffer_load_dwordx4 a[200:203], v10, s[44:47], s14 offen offset:640
    v_mfma_f32_16x16x32_bf16 v[144:147], a[52:55], v[240:243], v[144:147]
    ds_read_b128 a[24:27], v8 offset:3072
    v_mfma_f32_16x16x32_bf16 v[168:171], a[56:59], v[240:243], v[168:171]
    ds_read_b128 a[28:31], v8 offset:21504
    v_mfma_f32_16x16x32_bf16 v[192:195], a[60:63], v[240:243], v[192:195]
    v_mfma_f32_16x16x32_bf16 v[28:31], a[32:35], v[244:247], v[28:31]
    s_add_u32 s14, s13, 101376
    buffer_load_dwordx4 a[204:207], v10, s[44:47], s14 offen offset:640
    v_mfma_f32_16x16x32_bf16 v[52:55], a[36:39], v[244:247], v[52:55]
    v_mfma_f32_16x16x32_bf16 v[76:79], a[40:43], v[244:247], v[76:79]
    v_mfma_f32_16x16x32_bf16 v[100:103], a[44:47], v[244:247], v[100:103]
    v_mfma_f32_16x16x32_bf16 v[124:127], a[48:51], v[244:247], v[124:127]
    v_mfma_f32_16x16x32_bf16 v[148:151], a[52:55], v[244:247], v[148:151]
    v_mfma_f32_16x16x32_bf16 v[172:175], a[56:59], v[244:247], v[172:175]
    v_mfma_f32_16x16x32_bf16 v[196:199], a[60:63], v[244:247], v[196:199]
    v_mfma_f32_16x16x32_bf16 v[32:35], a[32:35], v[248:251], v[32:35]
    v_mfma_f32_16x16x32_bf16 v[56:59], a[36:39], v[248:251], v[56:59]
    v_mfma_f32_16x16x32_bf16 v[80:83], a[40:43], v[248:251], v[80:83]
    v_mfma_f32_16x16x32_bf16 v[104:107], a[44:47], v[248:251], v[104:107]
    v_mfma_f32_16x16x32_bf16 v[128:131], a[48:51], v[248:251], v[128:131]
    v_mfma_f32_16x16x32_bf16 v[152:155], a[52:55], v[248:251], v[152:155]
    v_mfma_f32_16x16x32_bf16 v[176:179], a[56:59], v[248:251], v[176:179]
    v_mfma_f32_16x16x32_bf16 v[200:203], a[60:63], v[248:251], v[200:203]
    v_mfma_f32_16x16x32_bf16 v[36:39], a[32:35], v[252:255], v[36:39]
    v_mfma_f32_16x16x32_bf16 v[60:63], a[36:39], v[252:255], v[60:63]
    v_mfma_f32_16x16x32_bf16 v[84:87], a[40:43], v[252:255], v[84:87]
    v_mfma_f32_16x16x32_bf16 v[108:111], a[44:47], v[252:255], v[108:111]
    v_mfma_f32_16x16x32_bf16 v[132:135], a[48:51], v[252:255], v[132:135]
    v_mfma_f32_16x16x32_bf16 v[156:159], a[52:55], v[252:255], v[156:159]
    v_mfma_f32_16x16x32_bf16 v[180:183], a[56:59], v[252:255], v[180:183]
    v_mfma_f32_16x16x32_bf16 v[204:207], a[60:63], v[252:255], v[204:207]
    s_waitcnt lgkmcnt(15)
    v_mfma_f32_16x16x32_bf16 v[16:19], a[0:3], a[208:211], v[16:19]
    v_mfma_f32_16x16x32_bf16 v[40:43], a[4:7], a[208:211], v[40:43]
    s_waitcnt vmcnt(23)
    ds_write_b128 v13, a[112:115] offset:0
    s_waitcnt lgkmcnt(15)
    v_mfma_f32_16x16x32_bf16 v[64:67], a[8:11], a[208:211], v[64:67]
    s_add_u32 s14, s13, 0
    buffer_load_dwordx4 a[64:67], v10, s[44:47], s14 offen offset:768
    s_waitcnt lgkmcnt(5)
    v_mfma_f32_16x16x32_bf16 v[88:91], a[12:15], a[208:211], v[88:91]
    ds_read_b128 a[32:35], v5 offset:3072
    s_waitcnt lgkmcnt(5)
    v_mfma_f32_16x16x32_bf16 v[112:115], a[16:19], a[208:211], v[112:115]
    ds_read_b128 a[36:39], v5 offset:21504
    s_waitcnt lgkmcnt(5)
    v_mfma_f32_16x16x32_bf16 v[136:139], a[20:23], a[208:211], v[136:139]
    s_waitcnt vmcnt(23)
    ds_write_b128 v14, a[116:119] offset:1024
    s_waitcnt lgkmcnt(5)
    v_mfma_f32_16x16x32_bf16 v[160:163], a[24:27], a[208:211], v[160:163]
    s_add_u32 s14, s13, 9216
    buffer_load_dwordx4 a[68:71], v10, s[44:47], s14 offen offset:768
    s_waitcnt lgkmcnt(4)
    v_mfma_f32_16x16x32_bf16 v[184:187], a[28:31], a[208:211], v[184:187]
    ds_read_b128 a[40:43], v5 offset:39936
    v_mfma_f32_16x16x32_bf16 v[20:23], a[0:3], a[212:215], v[20:23]
    ds_read_b128 a[44:47], v7 offset:3072
    v_mfma_f32_16x16x32_bf16 v[44:47], a[4:7], a[212:215], v[44:47]
    s_waitcnt vmcnt(23)
    ds_write_b128 v13, a[120:123] offset:2048
    v_mfma_f32_16x16x32_bf16 v[68:71], a[8:11], a[212:215], v[68:71]
    s_add_u32 s14, s13, 18432
    buffer_load_dwordx4 a[72:75], v10, s[44:47], s14 offen offset:768
    v_mfma_f32_16x16x32_bf16 v[92:95], a[12:15], a[212:215], v[92:95]
    ds_read_b128 a[48:51], v7 offset:21504
    v_mfma_f32_16x16x32_bf16 v[116:119], a[16:19], a[212:215], v[116:119]
    ds_read_b128 a[52:55], v7 offset:39936
    v_mfma_f32_16x16x32_bf16 v[140:143], a[20:23], a[212:215], v[140:143]
    s_waitcnt vmcnt(23)
    ds_write_b128 v14, a[124:127] offset:3072
    v_mfma_f32_16x16x32_bf16 v[164:167], a[24:27], a[212:215], v[164:167]
    ds_read_b64 v[208:209], v2 offset:0
    v_mfma_f32_16x16x32_bf16 v[188:191], a[28:31], a[212:215], v[188:191]
    ds_read_b64 v[210:211], v3 offset:0
    v_mfma_f32_16x16x32_bf16 v[24:27], a[0:3], a[216:219], v[24:27]
    ds_read_b64 v[212:213], v2 offset:2048
    v_mfma_f32_16x16x32_bf16 v[48:51], a[4:7], a[216:219], v[48:51]
    ds_read_b64 v[214:215], v3 offset:2048
    v_mfma_f32_16x16x32_bf16 v[72:75], a[8:11], a[216:219], v[72:75]
    ds_read_b64 v[232:233], v11 offset:0
    v_mfma_f32_16x16x32_bf16 v[96:99], a[12:15], a[216:219], v[96:99]
    ds_read_b64 v[234:235], v12 offset:0
    v_mfma_f32_16x16x32_bf16 v[120:123], a[16:19], a[216:219], v[120:123]
    ds_read_b64 v[236:237], v11 offset:2048
    v_mfma_f32_16x16x32_bf16 v[144:147], a[20:23], a[216:219], v[144:147]
    ds_read_b64 v[238:239], v12 offset:2048
    v_mfma_f32_16x16x32_bf16 v[168:171], a[24:27], a[216:219], v[168:171]
    s_waitcnt vmcnt(22)
    ds_write_b128 v13, a[128:131] offset:0
    v_mfma_f32_16x16x32_bf16 v[192:195], a[28:31], a[216:219], v[192:195]
    s_add_u32 s14, s13, 27648
    buffer_load_dwordx4 a[76:79], v10, s[44:47], s14 offen offset:768
    v_mfma_f32_16x16x32_bf16 v[28:31], a[0:3], a[220:223], v[28:31]
    ds_read_b128 a[56:59], v9 offset:3072
    v_mfma_f32_16x16x32_bf16 v[52:55], a[4:7], a[220:223], v[52:55]
    ds_read_b128 a[60:63], v9 offset:21504
    v_mfma_f32_16x16x32_bf16 v[76:79], a[8:11], a[220:223], v[76:79]
    s_waitcnt vmcnt(22)
    ds_write_b128 v14, a[132:135] offset:1024
    v_mfma_f32_16x16x32_bf16 v[100:103], a[12:15], a[220:223], v[100:103]
    s_add_u32 s14, s13, 36864
    buffer_load_dwordx4 a[80:83], v10, s[44:47], s14 offen offset:768
    v_mfma_f32_16x16x32_bf16 v[124:127], a[16:19], a[220:223], v[124:127]
    v_mfma_f32_16x16x32_bf16 v[148:151], a[20:23], a[220:223], v[148:151]
    v_mfma_f32_16x16x32_bf16 v[172:175], a[24:27], a[220:223], v[172:175]
    s_waitcnt vmcnt(22)
    ds_write_b128 v13, a[136:139] offset:2048
    v_mfma_f32_16x16x32_bf16 v[196:199], a[28:31], a[220:223], v[196:199]
    s_add_u32 s14, s13, 46080
    buffer_load_dwordx4 a[84:87], v10, s[44:47], s14 offen offset:768
    v_mfma_f32_16x16x32_bf16 v[32:35], a[0:3], a[224:227], v[32:35]
    v_mfma_f32_16x16x32_bf16 v[56:59], a[4:7], a[224:227], v[56:59]
    v_mfma_f32_16x16x32_bf16 v[80:83], a[8:11], a[224:227], v[80:83]
    s_waitcnt vmcnt(22)
    ds_write_b128 v14, a[140:143] offset:3072
    v_mfma_f32_16x16x32_bf16 v[104:107], a[12:15], a[224:227], v[104:107]
    ds_read_b64 v[216:217], v2 offset:0
    v_mfma_f32_16x16x32_bf16 v[128:131], a[16:19], a[224:227], v[128:131]
    ds_read_b64 v[218:219], v3 offset:0
    v_mfma_f32_16x16x32_bf16 v[152:155], a[20:23], a[224:227], v[152:155]
    ds_read_b64 v[220:221], v2 offset:2048
    v_mfma_f32_16x16x32_bf16 v[176:179], a[24:27], a[224:227], v[176:179]
    ds_read_b64 v[222:223], v3 offset:2048
    v_mfma_f32_16x16x32_bf16 v[200:203], a[28:31], a[224:227], v[200:203]
    ds_read_b64 v[240:241], v11 offset:0
    v_mfma_f32_16x16x32_bf16 v[36:39], a[0:3], a[228:231], v[36:39]
    ds_read_b64 v[242:243], v12 offset:0
    v_mfma_f32_16x16x32_bf16 v[60:63], a[4:7], a[228:231], v[60:63]
    ds_read_b64 v[244:245], v11 offset:2048
    v_mfma_f32_16x16x32_bf16 v[84:87], a[8:11], a[228:231], v[84:87]
    ds_read_b64 v[246:247], v12 offset:2048
    v_mfma_f32_16x16x32_bf16 v[108:111], a[12:15], a[228:231], v[108:111]
    s_waitcnt vmcnt(21)
    ds_write_b128 v13, a[144:147] offset:0
    v_mfma_f32_16x16x32_bf16 v[132:135], a[16:19], a[228:231], v[132:135]
    s_add_u32 s14, s13, 55296
    buffer_load_dwordx4 a[88:91], v10, s[44:47], s14 offen offset:768
    v_mfma_f32_16x16x32_bf16 v[156:159], a[20:23], a[228:231], v[156:159]
    v_mfma_f32_16x16x32_bf16 v[180:183], a[24:27], a[228:231], v[180:183]
    v_mfma_f32_16x16x32_bf16 v[204:207], a[28:31], a[228:231], v[204:207]
    s_waitcnt vmcnt(21)
    ds_write_b128 v14, a[148:151] offset:1024
    s_waitcnt lgkmcnt(15)
    v_mfma_f32_16x16x32_bf16 v[16:19], a[32:35], a[232:235], v[16:19]
    v_mfma_f32_16x16x32_bf16 v[40:43], a[36:39], a[232:235], v[40:43]
    s_add_u32 s14, s13, 64512
    buffer_load_dwordx4 a[92:95], v10, s[44:47], s14 offen offset:768
    v_mfma_f32_16x16x32_bf16 v[64:67], a[40:43], a[232:235], v[64:67]
    ds_read_b128 a[0:3], v4 offset:4096
    v_mfma_f32_16x16x32_bf16 v[88:91], a[44:47], a[232:235], v[88:91]
    s_waitcnt vmcnt(21)
    ds_write_b128 v13, a[152:155] offset:2048
    v_mfma_f32_16x16x32_bf16 v[112:115], a[48:51], a[232:235], v[112:115]
    ds_read_b128 a[4:7], v4 offset:22528
    v_mfma_f32_16x16x32_bf16 v[136:139], a[52:55], a[232:235], v[136:139]
    s_add_u32 s14, s13, 73728
    buffer_load_dwordx4 a[96:99], v10, s[44:47], s14 offen offset:768
    s_waitcnt lgkmcnt(15)
    v_mfma_f32_16x16x32_bf16 v[160:163], a[56:59], a[232:235], v[160:163]
    ds_read_b128 a[8:11], v4 offset:40960
    v_mfma_f32_16x16x32_bf16 v[184:187], a[60:63], a[232:235], v[184:187]
    s_waitcnt vmcnt(21)
    ds_write_b128 v14, a[156:159] offset:3072
    v_mfma_f32_16x16x32_bf16 v[20:23], a[32:35], a[236:239], v[20:23]
    ds_read_b64 v[224:225], v2 offset:0
    v_mfma_f32_16x16x32_bf16 v[44:47], a[36:39], a[236:239], v[44:47]
    ds_read_b64 v[226:227], v3 offset:0
    v_mfma_f32_16x16x32_bf16 v[68:71], a[40:43], a[236:239], v[68:71]
    ds_read_b64 v[228:229], v2 offset:2048
    v_mfma_f32_16x16x32_bf16 v[92:95], a[44:47], a[236:239], v[92:95]
    ds_read_b64 v[230:231], v3 offset:2048
    v_mfma_f32_16x16x32_bf16 v[116:119], a[48:51], a[236:239], v[116:119]
    ds_read_b64 v[248:249], v11 offset:0
    v_mfma_f32_16x16x32_bf16 v[140:143], a[52:55], a[236:239], v[140:143]
    ds_read_b64 v[250:251], v12 offset:0
    v_mfma_f32_16x16x32_bf16 v[164:167], a[56:59], a[236:239], v[164:167]
    ds_read_b64 v[252:253], v11 offset:2048
    v_mfma_f32_16x16x32_bf16 v[188:191], a[60:63], a[236:239], v[188:191]
    ds_read_b64 v[254:255], v12 offset:2048
    v_mfma_f32_16x16x32_bf16 v[24:27], a[32:35], a[240:243], v[24:27]
    s_add_u32 s14, s13, 82944
    buffer_load_dwordx4 a[100:103], v10, s[44:47], s14 offen offset:768
    v_mfma_f32_16x16x32_bf16 v[48:51], a[36:39], a[240:243], v[48:51]
    ds_read_b128 a[12:15], v6 offset:4096
    v_mfma_f32_16x16x32_bf16 v[72:75], a[40:43], a[240:243], v[72:75]
    ds_read_b128 a[16:19], v6 offset:22528
    v_mfma_f32_16x16x32_bf16 v[96:99], a[44:47], a[240:243], v[96:99]
    ds_read_b128 a[20:23], v6 offset:40960
    v_mfma_f32_16x16x32_bf16 v[120:123], a[48:51], a[240:243], v[120:123]
    s_add_u32 s14, s13, 92160
    buffer_load_dwordx4 a[104:107], v10, s[44:47], s14 offen offset:768
    v_mfma_f32_16x16x32_bf16 v[144:147], a[52:55], a[240:243], v[144:147]
    ds_read_b128 a[24:27], v8 offset:4096
    v_mfma_f32_16x16x32_bf16 v[168:171], a[56:59], a[240:243], v[168:171]
    ds_read_b128 a[28:31], v8 offset:22528
    v_mfma_f32_16x16x32_bf16 v[192:195], a[60:63], a[240:243], v[192:195]
    v_mfma_f32_16x16x32_bf16 v[28:31], a[32:35], a[244:247], v[28:31]
    s_add_u32 s14, s13, 101376
    buffer_load_dwordx4 a[108:111], v10, s[44:47], s14 offen offset:768
    v_mfma_f32_16x16x32_bf16 v[52:55], a[36:39], a[244:247], v[52:55]
    v_mfma_f32_16x16x32_bf16 v[76:79], a[40:43], a[244:247], v[76:79]
    v_mfma_f32_16x16x32_bf16 v[100:103], a[44:47], a[244:247], v[100:103]
    v_mfma_f32_16x16x32_bf16 v[124:127], a[48:51], a[244:247], v[124:127]
    v_mfma_f32_16x16x32_bf16 v[148:151], a[52:55], a[244:247], v[148:151]
    v_mfma_f32_16x16x32_bf16 v[172:175], a[56:59], a[244:247], v[172:175]
    v_mfma_f32_16x16x32_bf16 v[196:199], a[60:63], a[244:247], v[196:199]
    v_mfma_f32_16x16x32_bf16 v[32:35], a[32:35], a[248:251], v[32:35]
    v_mfma_f32_16x16x32_bf16 v[56:59], a[36:39], a[248:251], v[56:59]
    v_mfma_f32_16x16x32_bf16 v[80:83], a[40:43], a[248:251], v[80:83]
    v_mfma_f32_16x16x32_bf16 v[104:107], a[44:47], a[248:251], v[104:107]
    v_mfma_f32_16x16x32_bf16 v[128:131], a[48:51], a[248:251], v[128:131]
    v_mfma_f32_16x16x32_bf16 v[152:155], a[52:55], a[248:251], v[152:155]
    v_mfma_f32_16x16x32_bf16 v[176:179], a[56:59], a[248:251], v[176:179]
    v_mfma_f32_16x16x32_bf16 v[200:203], a[60:63], a[248:251], v[200:203]
    v_mfma_f32_16x16x32_bf16 v[36:39], a[32:35], a[252:255], v[36:39]
    v_mfma_f32_16x16x32_bf16 v[60:63], a[36:39], a[252:255], v[60:63]
    v_mfma_f32_16x16x32_bf16 v[84:87], a[40:43], a[252:255], v[84:87]
    v_mfma_f32_16x16x32_bf16 v[108:111], a[44:47], a[252:255], v[108:111]
    v_mfma_f32_16x16x32_bf16 v[132:135], a[48:51], a[252:255], v[132:135]
    v_mfma_f32_16x16x32_bf16 v[156:159], a[52:55], a[252:255], v[156:159]
    v_mfma_f32_16x16x32_bf16 v[180:183], a[56:59], a[252:255], v[180:183]
    v_mfma_f32_16x16x32_bf16 v[204:207], a[60:63], a[252:255], v[204:207]
    s_waitcnt lgkmcnt(15)
    v_mfma_f32_16x16x32_bf16 v[16:19], a[0:3], v[208:211], v[16:19]
    v_mfma_f32_16x16x32_bf16 v[40:43], a[4:7], v[208:211], v[40:43]
    s_waitcnt vmcnt(23)
    ds_write_b128 v13, a[160:163] offset:0
    s_waitcnt lgkmcnt(15)
    v_mfma_f32_16x16x32_bf16 v[64:67], a[8:11], v[208:211], v[64:67]
    s_add_u32 s14, s13, 0
    buffer_load_dwordx4 a[112:115], v10, s[44:47], s14 offen offset:896
    s_waitcnt lgkmcnt(5)
    v_mfma_f32_16x16x32_bf16 v[88:91], a[12:15], v[208:211], v[88:91]
    ds_read_b128 a[32:35], v5 offset:4096
    s_waitcnt lgkmcnt(5)
    v_mfma_f32_16x16x32_bf16 v[112:115], a[16:19], v[208:211], v[112:115]
    ds_read_b128 a[36:39], v5 offset:22528
    s_waitcnt lgkmcnt(5)
    v_mfma_f32_16x16x32_bf16 v[136:139], a[20:23], v[208:211], v[136:139]
    s_waitcnt vmcnt(23)
    ds_write_b128 v14, a[164:167] offset:1024
    s_waitcnt lgkmcnt(5)
    v_mfma_f32_16x16x32_bf16 v[160:163], a[24:27], v[208:211], v[160:163]
    s_add_u32 s14, s13, 9216
    buffer_load_dwordx4 a[116:119], v10, s[44:47], s14 offen offset:896
    s_waitcnt lgkmcnt(4)
    v_mfma_f32_16x16x32_bf16 v[184:187], a[28:31], v[208:211], v[184:187]
    ds_read_b128 a[40:43], v5 offset:40960
    v_mfma_f32_16x16x32_bf16 v[20:23], a[0:3], v[212:215], v[20:23]
    ds_read_b128 a[44:47], v7 offset:4096
    v_mfma_f32_16x16x32_bf16 v[44:47], a[4:7], v[212:215], v[44:47]
    s_waitcnt vmcnt(23)
    ds_write_b128 v13, a[168:171] offset:2048
    v_mfma_f32_16x16x32_bf16 v[68:71], a[8:11], v[212:215], v[68:71]
    s_add_u32 s14, s13, 18432
    buffer_load_dwordx4 a[120:123], v10, s[44:47], s14 offen offset:896
    v_mfma_f32_16x16x32_bf16 v[92:95], a[12:15], v[212:215], v[92:95]
    ds_read_b128 a[48:51], v7 offset:22528
    v_mfma_f32_16x16x32_bf16 v[116:119], a[16:19], v[212:215], v[116:119]
    ds_read_b128 a[52:55], v7 offset:40960
    v_mfma_f32_16x16x32_bf16 v[140:143], a[20:23], v[212:215], v[140:143]
    s_waitcnt vmcnt(23)
    ds_write_b128 v14, a[172:175] offset:3072
    v_mfma_f32_16x16x32_bf16 v[164:167], a[24:27], v[212:215], v[164:167]
    ds_read_b64 a[208:209], v2 offset:0
    v_mfma_f32_16x16x32_bf16 v[188:191], a[28:31], v[212:215], v[188:191]
    ds_read_b64 a[210:211], v3 offset:0
    v_mfma_f32_16x16x32_bf16 v[24:27], a[0:3], v[216:219], v[24:27]
    ds_read_b64 a[212:213], v2 offset:2048
    v_mfma_f32_16x16x32_bf16 v[48:51], a[4:7], v[216:219], v[48:51]
    ds_read_b64 a[214:215], v3 offset:2048
    v_mfma_f32_16x16x32_bf16 v[72:75], a[8:11], v[216:219], v[72:75]
    ds_read_b64 a[232:233], v11 offset:0
    v_mfma_f32_16x16x32_bf16 v[96:99], a[12:15], v[216:219], v[96:99]
    ds_read_b64 a[234:235], v12 offset:0
    v_mfma_f32_16x16x32_bf16 v[120:123], a[16:19], v[216:219], v[120:123]
    ds_read_b64 a[236:237], v11 offset:2048
    v_mfma_f32_16x16x32_bf16 v[144:147], a[20:23], v[216:219], v[144:147]
    ds_read_b64 a[238:239], v12 offset:2048
    v_mfma_f32_16x16x32_bf16 v[168:171], a[24:27], v[216:219], v[168:171]
    s_waitcnt vmcnt(22)
    ds_write_b128 v13, a[176:179] offset:0
    v_mfma_f32_16x16x32_bf16 v[192:195], a[28:31], v[216:219], v[192:195]
    s_add_u32 s14, s13, 27648
    buffer_load_dwordx4 a[124:127], v10, s[44:47], s14 offen offset:896
    v_mfma_f32_16x16x32_bf16 v[28:31], a[0:3], v[220:223], v[28:31]
    ds_read_b128 a[56:59], v9 offset:4096
    v_mfma_f32_16x16x32_bf16 v[52:55], a[4:7], v[220:223], v[52:55]
    ds_read_b128 a[60:63], v9 offset:22528
    v_mfma_f32_16x16x32_bf16 v[76:79], a[8:11], v[220:223], v[76:79]
    s_waitcnt vmcnt(22)
    ds_write_b128 v14, a[180:183] offset:1024
    v_mfma_f32_16x16x32_bf16 v[100:103], a[12:15], v[220:223], v[100:103]
    s_add_u32 s14, s13, 36864
    buffer_load_dwordx4 a[128:131], v10, s[44:47], s14 offen offset:896
    v_mfma_f32_16x16x32_bf16 v[124:127], a[16:19], v[220:223], v[124:127]
    v_mfma_f32_16x16x32_bf16 v[148:151], a[20:23], v[220:223], v[148:151]
    v_mfma_f32_16x16x32_bf16 v[172:175], a[24:27], v[220:223], v[172:175]
    s_waitcnt vmcnt(22)
    ds_write_b128 v13, a[184:187] offset:2048
    v_mfma_f32_16x16x32_bf16 v[196:199], a[28:31], v[220:223], v[196:199]
    s_add_u32 s14, s13, 46080
    buffer_load_dwordx4 a[132:135], v10, s[44:47], s14 offen offset:896
    v_mfma_f32_16x16x32_bf16 v[32:35], a[0:3], v[224:227], v[32:35]
    v_mfma_f32_16x16x32_bf16 v[56:59], a[4:7], v[224:227], v[56:59]
    v_mfma_f32_16x16x32_bf16 v[80:83], a[8:11], v[224:227], v[80:83]
    s_waitcnt vmcnt(22)
    ds_write_b128 v14, a[188:191] offset:3072
    v_mfma_f32_16x16x32_bf16 v[104:107], a[12:15], v[224:227], v[104:107]
    ds_read_b64 a[216:217], v2 offset:0
    v_mfma_f32_16x16x32_bf16 v[128:131], a[16:19], v[224:227], v[128:131]
    ds_read_b64 a[218:219], v3 offset:0
    v_mfma_f32_16x16x32_bf16 v[152:155], a[20:23], v[224:227], v[152:155]
    ds_read_b64 a[220:221], v2 offset:2048
    v_mfma_f32_16x16x32_bf16 v[176:179], a[24:27], v[224:227], v[176:179]
    ds_read_b64 a[222:223], v3 offset:2048
    v_mfma_f32_16x16x32_bf16 v[200:203], a[28:31], v[224:227], v[200:203]
    ds_read_b64 a[240:241], v11 offset:0
    v_mfma_f32_16x16x32_bf16 v[36:39], a[0:3], v[228:231], v[36:39]
    ds_read_b64 a[242:243], v12 offset:0
    v_mfma_f32_16x16x32_bf16 v[60:63], a[4:7], v[228:231], v[60:63]
    ds_read_b64 a[244:245], v11 offset:2048
    v_mfma_f32_16x16x32_bf16 v[84:87], a[8:11], v[228:231], v[84:87]
    ds_read_b64 a[246:247], v12 offset:2048
    v_mfma_f32_16x16x32_bf16 v[108:111], a[12:15], v[228:231], v[108:111]
    s_waitcnt vmcnt(21)
    ds_write_b128 v13, a[192:195] offset:0
    v_mfma_f32_16x16x32_bf16 v[132:135], a[16:19], v[228:231], v[132:135]
    s_add_u32 s14, s13, 55296
    buffer_load_dwordx4 a[136:139], v10, s[44:47], s14 offen offset:896
    v_mfma_f32_16x16x32_bf16 v[156:159], a[20:23], v[228:231], v[156:159]
    v_mfma_f32_16x16x32_bf16 v[180:183], a[24:27], v[228:231], v[180:183]
    v_mfma_f32_16x16x32_bf16 v[204:207], a[28:31], v[228:231], v[204:207]
    s_waitcnt vmcnt(21)
    ds_write_b128 v14, a[196:199] offset:1024
    s_waitcnt lgkmcnt(15)
    v_mfma_f32_16x16x32_bf16 v[16:19], a[32:35], v[232:235], v[16:19]
    v_mfma_f32_16x16x32_bf16 v[40:43], a[36:39], v[232:235], v[40:43]
    s_add_u32 s14, s13, 64512
    buffer_load_dwordx4 a[140:143], v10, s[44:47], s14 offen offset:896
    v_mfma_f32_16x16x32_bf16 v[64:67], a[40:43], v[232:235], v[64:67]
    ds_read_b128 a[0:3], v4 offset:5120
    v_mfma_f32_16x16x32_bf16 v[88:91], a[44:47], v[232:235], v[88:91]
    s_waitcnt vmcnt(21)
    ds_write_b128 v13, a[200:203] offset:2048
    v_mfma_f32_16x16x32_bf16 v[112:115], a[48:51], v[232:235], v[112:115]
    ds_read_b128 a[4:7], v4 offset:23552
    v_mfma_f32_16x16x32_bf16 v[136:139], a[52:55], v[232:235], v[136:139]
    s_add_u32 s14, s13, 73728
    buffer_load_dwordx4 a[144:147], v10, s[44:47], s14 offen offset:896
    s_waitcnt lgkmcnt(15)
    v_mfma_f32_16x16x32_bf16 v[160:163], a[56:59], v[232:235], v[160:163]
    ds_read_b128 a[8:11], v4 offset:41984
    v_mfma_f32_16x16x32_bf16 v[184:187], a[60:63], v[232:235], v[184:187]
    s_waitcnt vmcnt(21)
    ds_write_b128 v14, a[204:207] offset:3072
    v_mfma_f32_16x16x32_bf16 v[20:23], a[32:35], v[236:239], v[20:23]
    ds_read_b64 a[224:225], v2 offset:0
    v_mfma_f32_16x16x32_bf16 v[44:47], a[36:39], v[236:239], v[44:47]
    ds_read_b64 a[226:227], v3 offset:0
    v_mfma_f32_16x16x32_bf16 v[68:71], a[40:43], v[236:239], v[68:71]
    ds_read_b64 a[228:229], v2 offset:2048
    v_mfma_f32_16x16x32_bf16 v[92:95], a[44:47], v[236:239], v[92:95]
    ds_read_b64 a[230:231], v3 offset:2048
    v_mfma_f32_16x16x32_bf16 v[116:119], a[48:51], v[236:239], v[116:119]
    ds_read_b64 a[248:249], v11 offset:0
    v_mfma_f32_16x16x32_bf16 v[140:143], a[52:55], v[236:239], v[140:143]
    ds_read_b64 a[250:251], v12 offset:0
    v_mfma_f32_16x16x32_bf16 v[164:167], a[56:59], v[236:239], v[164:167]
    ds_read_b64 a[252:253], v11 offset:2048
    v_mfma_f32_16x16x32_bf16 v[188:191], a[60:63], v[236:239], v[188:191]
    ds_read_b64 a[254:255], v12 offset:2048
    v_mfma_f32_16x16x32_bf16 v[24:27], a[32:35], v[240:243], v[24:27]
    s_add_u32 s14, s13, 82944
    buffer_load_dwordx4 a[148:151], v10, s[44:47], s14 offen offset:896
    v_mfma_f32_16x16x32_bf16 v[48:51], a[36:39], v[240:243], v[48:51]
    ds_read_b128 a[12:15], v6 offset:5120
    v_mfma_f32_16x16x32_bf16 v[72:75], a[40:43], v[240:243], v[72:75]
    ds_read_b128 a[16:19], v6 offset:23552
    v_mfma_f32_16x16x32_bf16 v[96:99], a[44:47], v[240:243], v[96:99]
    ds_read_b128 a[20:23], v6 offset:41984
    v_mfma_f32_16x16x32_bf16 v[120:123], a[48:51], v[240:243], v[120:123]
    s_add_u32 s14, s13, 92160
    buffer_load_dwordx4 a[152:155], v10, s[44:47], s14 offen offset:896
    v_mfma_f32_16x16x32_bf16 v[144:147], a[52:55], v[240:243], v[144:147]
    ds_read_b128 a[24:27], v8 offset:5120
    v_mfma_f32_16x16x32_bf16 v[168:171], a[56:59], v[240:243], v[168:171]
    ds_read_b128 a[28:31], v8 offset:23552
    v_mfma_f32_16x16x32_bf16 v[192:195], a[60:63], v[240:243], v[192:195]
    v_mfma_f32_16x16x32_bf16 v[28:31], a[32:35], v[244:247], v[28:31]
    s_add_u32 s14, s13, 101376
    buffer_load_dwordx4 a[156:159], v10, s[44:47], s14 offen offset:896
    v_mfma_f32_16x16x32_bf16 v[52:55], a[36:39], v[244:247], v[52:55]
    v_mfma_f32_16x16x32_bf16 v[76:79], a[40:43], v[244:247], v[76:79]
    v_mfma_f32_16x16x32_bf16 v[100:103], a[44:47], v[244:247], v[100:103]
    v_mfma_f32_16x16x32_bf16 v[124:127], a[48:51], v[244:247], v[124:127]
    v_mfma_f32_16x16x32_bf16 v[148:151], a[52:55], v[244:247], v[148:151]
    v_mfma_f32_16x16x32_bf16 v[172:175], a[56:59], v[244:247], v[172:175]
    v_mfma_f32_16x16x32_bf16 v[196:199], a[60:63], v[244:247], v[196:199]
    v_mfma_f32_16x16x32_bf16 v[32:35], a[32:35], v[248:251], v[32:35]
    v_mfma_f32_16x16x32_bf16 v[56:59], a[36:39], v[248:251], v[56:59]
    v_mfma_f32_16x16x32_bf16 v[80:83], a[40:43], v[248:251], v[80:83]
    v_mfma_f32_16x16x32_bf16 v[104:107], a[44:47], v[248:251], v[104:107]
    v_mfma_f32_16x16x32_bf16 v[128:131], a[48:51], v[248:251], v[128:131]
    v_mfma_f32_16x16x32_bf16 v[152:155], a[52:55], v[248:251], v[152:155]
    v_mfma_f32_16x16x32_bf16 v[176:179], a[56:59], v[248:251], v[176:179]
    v_mfma_f32_16x16x32_bf16 v[200:203], a[60:63], v[248:251], v[200:203]
    v_mfma_f32_16x16x32_bf16 v[36:39], a[32:35], v[252:255], v[36:39]
    v_mfma_f32_16x16x32_bf16 v[60:63], a[36:39], v[252:255], v[60:63]
    v_mfma_f32_16x16x32_bf16 v[84:87], a[40:43], v[252:255], v[84:87]
    v_mfma_f32_16x16x32_bf16 v[108:111], a[44:47], v[252:255], v[108:111]
    v_mfma_f32_16x16x32_bf16 v[132:135], a[48:51], v[252:255], v[132:135]
    v_mfma_f32_16x16x32_bf16 v[156:159], a[52:55], v[252:255], v[156:159]
    v_mfma_f32_16x16x32_bf16 v[180:183], a[56:59], v[252:255], v[180:183]
    v_mfma_f32_16x16x32_bf16 v[204:207], a[60:63], v[252:255], v[204:207]
    s_waitcnt lgkmcnt(15)
    v_mfma_f32_16x16x32_bf16 v[16:19], a[0:3], a[208:211], v[16:19]
    v_mfma_f32_16x16x32_bf16 v[40:43], a[4:7], a[208:211], v[40:43]
    s_waitcnt vmcnt(23)
    ds_write_b128 v13, a[64:67] offset:0
    s_waitcnt lgkmcnt(15)
    v_mfma_f32_16x16x32_bf16 v[64:67], a[8:11], a[208:211], v[64:67]
    s_add_u32 s14, s13, 0
    buffer_load_dwordx4 a[160:163], v10, s[44:47], s14 offen offset:1024
    s_waitcnt lgkmcnt(5)
    v_mfma_f32_16x16x32_bf16 v[88:91], a[12:15], a[208:211], v[88:91]
    ds_read_b128 a[32:35], v5 offset:5120
    s_waitcnt lgkmcnt(5)
    v_mfma_f32_16x16x32_bf16 v[112:115], a[16:19], a[208:211], v[112:115]
    ds_read_b128 a[36:39], v5 offset:23552
    s_waitcnt lgkmcnt(5)
    v_mfma_f32_16x16x32_bf16 v[136:139], a[20:23], a[208:211], v[136:139]
    s_waitcnt vmcnt(23)
    ds_write_b128 v14, a[68:71] offset:1024
    s_waitcnt lgkmcnt(5)
    v_mfma_f32_16x16x32_bf16 v[160:163], a[24:27], a[208:211], v[160:163]
    s_add_u32 s14, s13, 9216
    buffer_load_dwordx4 a[164:167], v10, s[44:47], s14 offen offset:1024
    s_waitcnt lgkmcnt(4)
    v_mfma_f32_16x16x32_bf16 v[184:187], a[28:31], a[208:211], v[184:187]
    ds_read_b128 a[40:43], v5 offset:41984
    v_mfma_f32_16x16x32_bf16 v[20:23], a[0:3], a[212:215], v[20:23]
    ds_read_b128 a[44:47], v7 offset:5120
    v_mfma_f32_16x16x32_bf16 v[44:47], a[4:7], a[212:215], v[44:47]
    s_waitcnt vmcnt(23)
    ds_write_b128 v13, a[72:75] offset:2048
    v_mfma_f32_16x16x32_bf16 v[68:71], a[8:11], a[212:215], v[68:71]
    s_add_u32 s14, s13, 18432
    buffer_load_dwordx4 a[168:171], v10, s[44:47], s14 offen offset:1024
    v_mfma_f32_16x16x32_bf16 v[92:95], a[12:15], a[212:215], v[92:95]
    ds_read_b128 a[48:51], v7 offset:23552
    v_mfma_f32_16x16x32_bf16 v[116:119], a[16:19], a[212:215], v[116:119]
    ds_read_b128 a[52:55], v7 offset:41984
    v_mfma_f32_16x16x32_bf16 v[140:143], a[20:23], a[212:215], v[140:143]
    s_waitcnt vmcnt(23)
    ds_write_b128 v14, a[76:79] offset:3072
    v_mfma_f32_16x16x32_bf16 v[164:167], a[24:27], a[212:215], v[164:167]
    ds_read_b64 v[208:209], v2 offset:0
    v_mfma_f32_16x16x32_bf16 v[188:191], a[28:31], a[212:215], v[188:191]
    ds_read_b64 v[210:211], v3 offset:0
    v_mfma_f32_16x16x32_bf16 v[24:27], a[0:3], a[216:219], v[24:27]
    ds_read_b64 v[212:213], v2 offset:2048
    v_mfma_f32_16x16x32_bf16 v[48:51], a[4:7], a[216:219], v[48:51]
    ds_read_b64 v[214:215], v3 offset:2048
    v_mfma_f32_16x16x32_bf16 v[72:75], a[8:11], a[216:219], v[72:75]
    ds_read_b64 v[232:233], v11 offset:0
    v_mfma_f32_16x16x32_bf16 v[96:99], a[12:15], a[216:219], v[96:99]
    ds_read_b64 v[234:235], v12 offset:0
    v_mfma_f32_16x16x32_bf16 v[120:123], a[16:19], a[216:219], v[120:123]
    ds_read_b64 v[236:237], v11 offset:2048
    v_mfma_f32_16x16x32_bf16 v[144:147], a[20:23], a[216:219], v[144:147]
    ds_read_b64 v[238:239], v12 offset:2048
    v_mfma_f32_16x16x32_bf16 v[168:171], a[24:27], a[216:219], v[168:171]
    s_waitcnt vmcnt(22)
    ds_write_b128 v13, a[80:83] offset:0
    v_mfma_f32_16x16x32_bf16 v[192:195], a[28:31], a[216:219], v[192:195]
    s_add_u32 s14, s13, 27648
    buffer_load_dwordx4 a[172:175], v10, s[44:47], s14 offen offset:1024
    v_mfma_f32_16x16x32_bf16 v[28:31], a[0:3], a[220:223], v[28:31]
    ds_read_b128 a[56:59], v9 offset:5120
    v_mfma_f32_16x16x32_bf16 v[52:55], a[4:7], a[220:223], v[52:55]
    ds_read_b128 a[60:63], v9 offset:23552
    v_mfma_f32_16x16x32_bf16 v[76:79], a[8:11], a[220:223], v[76:79]
    s_waitcnt vmcnt(22)
    ds_write_b128 v14, a[84:87] offset:1024
    v_mfma_f32_16x16x32_bf16 v[100:103], a[12:15], a[220:223], v[100:103]
    s_add_u32 s14, s13, 36864
    buffer_load_dwordx4 a[176:179], v10, s[44:47], s14 offen offset:1024
    v_mfma_f32_16x16x32_bf16 v[124:127], a[16:19], a[220:223], v[124:127]
    v_mfma_f32_16x16x32_bf16 v[148:151], a[20:23], a[220:223], v[148:151]
    v_mfma_f32_16x16x32_bf16 v[172:175], a[24:27], a[220:223], v[172:175]
    s_waitcnt vmcnt(22)
    ds_write_b128 v13, a[88:91] offset:2048
    v_mfma_f32_16x16x32_bf16 v[196:199], a[28:31], a[220:223], v[196:199]
    s_add_u32 s14, s13, 46080
    buffer_load_dwordx4 a[180:183], v10, s[44:47], s14 offen offset:1024
    v_mfma_f32_16x16x32_bf16 v[32:35], a[0:3], a[224:227], v[32:35]
    v_mfma_f32_16x16x32_bf16 v[56:59], a[4:7], a[224:227], v[56:59]
    v_mfma_f32_16x16x32_bf16 v[80:83], a[8:11], a[224:227], v[80:83]
    s_waitcnt vmcnt(22)
    ds_write_b128 v14, a[92:95] offset:3072
    v_mfma_f32_16x16x32_bf16 v[104:107], a[12:15], a[224:227], v[104:107]
    ds_read_b64 v[216:217], v2 offset:0
    v_mfma_f32_16x16x32_bf16 v[128:131], a[16:19], a[224:227], v[128:131]
    ds_read_b64 v[218:219], v3 offset:0
    v_mfma_f32_16x16x32_bf16 v[152:155], a[20:23], a[224:227], v[152:155]
    ds_read_b64 v[220:221], v2 offset:2048
    v_mfma_f32_16x16x32_bf16 v[176:179], a[24:27], a[224:227], v[176:179]
    ds_read_b64 v[222:223], v3 offset:2048
    v_mfma_f32_16x16x32_bf16 v[200:203], a[28:31], a[224:227], v[200:203]
    ds_read_b64 v[240:241], v11 offset:0
    v_mfma_f32_16x16x32_bf16 v[36:39], a[0:3], a[228:231], v[36:39]
    ds_read_b64 v[242:243], v12 offset:0
    v_mfma_f32_16x16x32_bf16 v[60:63], a[4:7], a[228:231], v[60:63]
    ds_read_b64 v[244:245], v11 offset:2048
    v_mfma_f32_16x16x32_bf16 v[84:87], a[8:11], a[228:231], v[84:87]
    ds_read_b64 v[246:247], v12 offset:2048
    v_mfma_f32_16x16x32_bf16 v[108:111], a[12:15], a[228:231], v[108:111]
    s_waitcnt vmcnt(21)
    ds_write_b128 v13, a[96:99] offset:0
    v_mfma_f32_16x16x32_bf16 v[132:135], a[16:19], a[228:231], v[132:135]
    s_add_u32 s14, s13, 55296
    buffer_load_dwordx4 a[184:187], v10, s[44:47], s14 offen offset:1024
    v_mfma_f32_16x16x32_bf16 v[156:159], a[20:23], a[228:231], v[156:159]
    v_mfma_f32_16x16x32_bf16 v[180:183], a[24:27], a[228:231], v[180:183]
    v_mfma_f32_16x16x32_bf16 v[204:207], a[28:31], a[228:231], v[204:207]
    s_waitcnt vmcnt(21)
    ds_write_b128 v14, a[100:103] offset:1024
    s_waitcnt lgkmcnt(15)
    v_mfma_f32_16x16x32_bf16 v[16:19], a[32:35], a[232:235], v[16:19]
    v_mfma_f32_16x16x32_bf16 v[40:43], a[36:39], a[232:235], v[40:43]
    s_add_u32 s14, s13, 64512
    buffer_load_dwordx4 a[188:191], v10, s[44:47], s14 offen offset:1024
    v_mfma_f32_16x16x32_bf16 v[64:67], a[40:43], a[232:235], v[64:67]
    ds_read_b128 a[0:3], v4 offset:6144
    v_mfma_f32_16x16x32_bf16 v[88:91], a[44:47], a[232:235], v[88:91]
    s_waitcnt vmcnt(21)
    ds_write_b128 v13, a[104:107] offset:2048
    v_mfma_f32_16x16x32_bf16 v[112:115], a[48:51], a[232:235], v[112:115]
    ds_read_b128 a[4:7], v4 offset:24576
    v_mfma_f32_16x16x32_bf16 v[136:139], a[52:55], a[232:235], v[136:139]
    s_add_u32 s14, s13, 73728
    buffer_load_dwordx4 a[192:195], v10, s[44:47], s14 offen offset:1024
    s_waitcnt lgkmcnt(15)
    v_mfma_f32_16x16x32_bf16 v[160:163], a[56:59], a[232:235], v[160:163]
    ds_read_b128 a[8:11], v4 offset:43008
    v_mfma_f32_16x16x32_bf16 v[184:187], a[60:63], a[232:235], v[184:187]
    s_waitcnt vmcnt(21)
    ds_write_b128 v14, a[108:111] offset:3072
    v_mfma_f32_16x16x32_bf16 v[20:23], a[32:35], a[236:239], v[20:23]
    ds_read_b64 v[224:225], v2 offset:0
    v_mfma_f32_16x16x32_bf16 v[44:47], a[36:39], a[236:239], v[44:47]
    ds_read_b64 v[226:227], v3 offset:0
    v_mfma_f32_16x16x32_bf16 v[68:71], a[40:43], a[236:239], v[68:71]
    ds_read_b64 v[228:229], v2 offset:2048
    v_mfma_f32_16x16x32_bf16 v[92:95], a[44:47], a[236:239], v[92:95]
    ds_read_b64 v[230:231], v3 offset:2048
    v_mfma_f32_16x16x32_bf16 v[116:119], a[48:51], a[236:239], v[116:119]
    ds_read_b64 v[248:249], v11 offset:0
    v_mfma_f32_16x16x32_bf16 v[140:143], a[52:55], a[236:239], v[140:143]
    ds_read_b64 v[250:251], v12 offset:0
    v_mfma_f32_16x16x32_bf16 v[164:167], a[56:59], a[236:239], v[164:167]
    ds_read_b64 v[252:253], v11 offset:2048
    v_mfma_f32_16x16x32_bf16 v[188:191], a[60:63], a[236:239], v[188:191]
    ds_read_b64 v[254:255], v12 offset:2048
    v_mfma_f32_16x16x32_bf16 v[24:27], a[32:35], a[240:243], v[24:27]
    s_add_u32 s14, s13, 82944
    buffer_load_dwordx4 a[196:199], v10, s[44:47], s14 offen offset:1024
    v_mfma_f32_16x16x32_bf16 v[48:51], a[36:39], a[240:243], v[48:51]
    ds_read_b128 a[12:15], v6 offset:6144
    v_mfma_f32_16x16x32_bf16 v[72:75], a[40:43], a[240:243], v[72:75]
    ds_read_b128 a[16:19], v6 offset:24576
    v_mfma_f32_16x16x32_bf16 v[96:99], a[44:47], a[240:243], v[96:99]
    ds_read_b128 a[20:23], v6 offset:43008
    v_mfma_f32_16x16x32_bf16 v[120:123], a[48:51], a[240:243], v[120:123]
    s_add_u32 s14, s13, 92160
    buffer_load_dwordx4 a[200:203], v10, s[44:47], s14 offen offset:1024
    v_mfma_f32_16x16x32_bf16 v[144:147], a[52:55], a[240:243], v[144:147]
    ds_read_b128 a[24:27], v8 offset:6144
    v_mfma_f32_16x16x32_bf16 v[168:171], a[56:59], a[240:243], v[168:171]
    ds_read_b128 a[28:31], v8 offset:24576
    v_mfma_f32_16x16x32_bf16 v[192:195], a[60:63], a[240:243], v[192:195]
    v_mfma_f32_16x16x32_bf16 v[28:31], a[32:35], a[244:247], v[28:31]
    s_add_u32 s14, s13, 101376
    buffer_load_dwordx4 a[204:207], v10, s[44:47], s14 offen offset:1024
    v_mfma_f32_16x16x32_bf16 v[52:55], a[36:39], a[244:247], v[52:55]
    v_mfma_f32_16x16x32_bf16 v[76:79], a[40:43], a[244:247], v[76:79]
    v_mfma_f32_16x16x32_bf16 v[100:103], a[44:47], a[244:247], v[100:103]
    v_mfma_f32_16x16x32_bf16 v[124:127], a[48:51], a[244:247], v[124:127]
    v_mfma_f32_16x16x32_bf16 v[148:151], a[52:55], a[244:247], v[148:151]
    v_mfma_f32_16x16x32_bf16 v[172:175], a[56:59], a[244:247], v[172:175]
    v_mfma_f32_16x16x32_bf16 v[196:199], a[60:63], a[244:247], v[196:199]
    v_mfma_f32_16x16x32_bf16 v[32:35], a[32:35], a[248:251], v[32:35]
    v_mfma_f32_16x16x32_bf16 v[56:59], a[36:39], a[248:251], v[56:59]
    v_mfma_f32_16x16x32_bf16 v[80:83], a[40:43], a[248:251], v[80:83]
    v_mfma_f32_16x16x32_bf16 v[104:107], a[44:47], a[248:251], v[104:107]
    v_mfma_f32_16x16x32_bf16 v[128:131], a[48:51], a[248:251], v[128:131]
    v_mfma_f32_16x16x32_bf16 v[152:155], a[52:55], a[248:251], v[152:155]
    v_mfma_f32_16x16x32_bf16 v[176:179], a[56:59], a[248:251], v[176:179]
    v_mfma_f32_16x16x32_bf16 v[200:203], a[60:63], a[248:251], v[200:203]
    v_mfma_f32_16x16x32_bf16 v[36:39], a[32:35], a[252:255], v[36:39]
    v_mfma_f32_16x16x32_bf16 v[60:63], a[36:39], a[252:255], v[60:63]
    v_mfma_f32_16x16x32_bf16 v[84:87], a[40:43], a[252:255], v[84:87]
    v_mfma_f32_16x16x32_bf16 v[108:111], a[44:47], a[252:255], v[108:111]
    v_mfma_f32_16x16x32_bf16 v[132:135], a[48:51], a[252:255], v[132:135]
    v_mfma_f32_16x16x32_bf16 v[156:159], a[52:55], a[252:255], v[156:159]
    v_mfma_f32_16x16x32_bf16 v[180:183], a[56:59], a[252:255], v[180:183]
    v_mfma_f32_16x16x32_bf16 v[204:207], a[60:63], a[252:255], v[204:207]
    s_waitcnt lgkmcnt(15)
    v_mfma_f32_16x16x32_bf16 v[16:19], a[0:3], v[208:211], v[16:19]
    v_mfma_f32_16x16x32_bf16 v[40:43], a[4:7], v[208:211], v[40:43]
    s_waitcnt vmcnt(23)
    ds_write_b128 v13, a[112:115] offset:0
    s_waitcnt lgkmcnt(15)
    v_mfma_f32_16x16x32_bf16 v[64:67], a[8:11], v[208:211], v[64:67]
    ds_read_b128 a[32:35], v5 offset:6144
    s_waitcnt lgkmcnt(6)
    v_mfma_f32_16x16x32_bf16 v[88:91], a[12:15], v[208:211], v[88:91]
    ds_read_b128 a[36:39], v5 offset:24576
    s_waitcnt lgkmcnt(6)
    v_mfma_f32_16x16x32_bf16 v[112:115], a[16:19], v[208:211], v[112:115]
    ds_read_b128 a[40:43], v5 offset:43008
    s_waitcnt lgkmcnt(6)
    v_mfma_f32_16x16x32_bf16 v[136:139], a[20:23], v[208:211], v[136:139]
    s_waitcnt vmcnt(22)
    ds_write_b128 v14, a[116:119] offset:1024
    s_waitcnt lgkmcnt(6)
    v_mfma_f32_16x16x32_bf16 v[160:163], a[24:27], v[208:211], v[160:163]
    ds_read_b128 a[44:47], v7 offset:6144
    s_waitcnt lgkmcnt(6)
    v_mfma_f32_16x16x32_bf16 v[184:187], a[28:31], v[208:211], v[184:187]
    ds_read_b128 a[48:51], v7 offset:24576
    v_mfma_f32_16x16x32_bf16 v[20:23], a[0:3], v[212:215], v[20:23]
    ds_read_b128 a[52:55], v7 offset:43008
    v_mfma_f32_16x16x32_bf16 v[44:47], a[4:7], v[212:215], v[44:47]
    s_waitcnt vmcnt(21)
    ds_write_b128 v13, a[120:123] offset:2048
    v_mfma_f32_16x16x32_bf16 v[68:71], a[8:11], v[212:215], v[68:71]
    ds_read_b128 a[56:59], v9 offset:6144
    v_mfma_f32_16x16x32_bf16 v[92:95], a[12:15], v[212:215], v[92:95]
    ds_read_b128 a[60:63], v9 offset:24576
    v_mfma_f32_16x16x32_bf16 v[116:119], a[16:19], v[212:215], v[116:119]
    v_mfma_f32_16x16x32_bf16 v[140:143], a[20:23], v[212:215], v[140:143]
    s_waitcnt vmcnt(20)
    ds_write_b128 v14, a[124:127] offset:3072
    v_mfma_f32_16x16x32_bf16 v[164:167], a[24:27], v[212:215], v[164:167]
    ds_read_b64 a[208:209], v2 offset:0
    v_mfma_f32_16x16x32_bf16 v[188:191], a[28:31], v[212:215], v[188:191]
    ds_read_b64 a[210:211], v3 offset:0
    v_mfma_f32_16x16x32_bf16 v[24:27], a[0:3], v[216:219], v[24:27]
    ds_read_b64 a[212:213], v2 offset:2048
    v_mfma_f32_16x16x32_bf16 v[48:51], a[4:7], v[216:219], v[48:51]
    ds_read_b64 a[214:215], v3 offset:2048
    v_mfma_f32_16x16x32_bf16 v[72:75], a[8:11], v[216:219], v[72:75]
    ds_read_b64 a[232:233], v11 offset:0
    v_mfma_f32_16x16x32_bf16 v[96:99], a[12:15], v[216:219], v[96:99]
    ds_read_b64 a[234:235], v12 offset:0
    v_mfma_f32_16x16x32_bf16 v[120:123], a[16:19], v[216:219], v[120:123]
    ds_read_b64 a[236:237], v11 offset:2048
    v_mfma_f32_16x16x32_bf16 v[144:147], a[20:23], v[216:219], v[144:147]
    ds_read_b64 a[238:239], v12 offset:2048
    v_mfma_f32_16x16x32_bf16 v[168:171], a[24:27], v[216:219], v[168:171]
    s_waitcnt vmcnt(19)
    ds_write_b128 v13, a[128:131] offset:0
    v_mfma_f32_16x16x32_bf16 v[192:195], a[28:31], v[216:219], v[192:195]
    v_mfma_f32_16x16x32_bf16 v[28:31], a[0:3], v[220:223], v[28:31]
    v_mfma_f32_16x16x32_bf16 v[52:55], a[4:7], v[220:223], v[52:55]
    v_mfma_f32_16x16x32_bf16 v[76:79], a[8:11], v[220:223], v[76:79]
    s_waitcnt vmcnt(18)
    ds_write_b128 v14, a[132:135] offset:1024
    v_mfma_f32_16x16x32_bf16 v[100:103], a[12:15], v[220:223], v[100:103]
    v_mfma_f32_16x16x32_bf16 v[124:127], a[16:19], v[220:223], v[124:127]
    v_mfma_f32_16x16x32_bf16 v[148:151], a[20:23], v[220:223], v[148:151]
    v_mfma_f32_16x16x32_bf16 v[172:175], a[24:27], v[220:223], v[172:175]
    s_waitcnt vmcnt(17)
    ds_write_b128 v13, a[136:139] offset:2048
    v_mfma_f32_16x16x32_bf16 v[196:199], a[28:31], v[220:223], v[196:199]
    v_mfma_f32_16x16x32_bf16 v[32:35], a[0:3], v[224:227], v[32:35]
    v_mfma_f32_16x16x32_bf16 v[56:59], a[4:7], v[224:227], v[56:59]
    v_mfma_f32_16x16x32_bf16 v[80:83], a[8:11], v[224:227], v[80:83]
    s_waitcnt vmcnt(16)
    ds_write_b128 v14, a[140:143] offset:3072
    v_mfma_f32_16x16x32_bf16 v[104:107], a[12:15], v[224:227], v[104:107]
    ds_read_b64 a[216:217], v2 offset:0
    v_mfma_f32_16x16x32_bf16 v[128:131], a[16:19], v[224:227], v[128:131]
    ds_read_b64 a[218:219], v3 offset:0
    v_mfma_f32_16x16x32_bf16 v[152:155], a[20:23], v[224:227], v[152:155]
    ds_read_b64 a[220:221], v2 offset:2048
    v_mfma_f32_16x16x32_bf16 v[176:179], a[24:27], v[224:227], v[176:179]
    ds_read_b64 a[222:223], v3 offset:2048
    v_mfma_f32_16x16x32_bf16 v[200:203], a[28:31], v[224:227], v[200:203]
    ds_read_b64 a[240:241], v11 offset:0
    v_mfma_f32_16x16x32_bf16 v[36:39], a[0:3], v[228:231], v[36:39]
    ds_read_b64 a[242:243], v12 offset:0
    v_mfma_f32_16x16x32_bf16 v[60:63], a[4:7], v[228:231], v[60:63]
    ds_read_b64 a[244:245], v11 offset:2048
    v_mfma_f32_16x16x32_bf16 v[84:87], a[8:11], v[228:231], v[84:87]
    ds_read_b64 a[246:247], v12 offset:2048
    v_mfma_f32_16x16x32_bf16 v[108:111], a[12:15], v[228:231], v[108:111]
    s_waitcnt vmcnt(15)
    ds_write_b128 v13, a[144:147] offset:0
    v_mfma_f32_16x16x32_bf16 v[132:135], a[16:19], v[228:231], v[132:135]
    v_mfma_f32_16x16x32_bf16 v[156:159], a[20:23], v[228:231], v[156:159]
    v_mfma_f32_16x16x32_bf16 v[180:183], a[24:27], v[228:231], v[180:183]
    v_mfma_f32_16x16x32_bf16 v[204:207], a[28:31], v[228:231], v[204:207]
    s_waitcnt vmcnt(14)
    ds_write_b128 v14, a[148:151] offset:1024
    s_waitcnt lgkmcnt(15)
    v_mfma_f32_16x16x32_bf16 v[16:19], a[32:35], v[232:235], v[16:19]
    v_mfma_f32_16x16x32_bf16 v[40:43], a[36:39], v[232:235], v[40:43]
    ds_read_b128 a[0:3], v4 offset:7168
    v_mfma_f32_16x16x32_bf16 v[64:67], a[40:43], v[232:235], v[64:67]
    ds_read_b128 a[4:7], v4 offset:25600
    v_mfma_f32_16x16x32_bf16 v[88:91], a[44:47], v[232:235], v[88:91]
    s_waitcnt vmcnt(13)
    ds_write_b128 v13, a[152:155] offset:2048
    v_mfma_f32_16x16x32_bf16 v[112:115], a[48:51], v[232:235], v[112:115]
    ds_read_b128 a[8:11], v4 offset:44032
    v_mfma_f32_16x16x32_bf16 v[136:139], a[52:55], v[232:235], v[136:139]
    ds_read_b128 a[12:15], v6 offset:7168
    v_mfma_f32_16x16x32_bf16 v[160:163], a[56:59], v[232:235], v[160:163]
    ds_read_b128 a[16:19], v6 offset:25600
    v_mfma_f32_16x16x32_bf16 v[184:187], a[60:63], v[232:235], v[184:187]
    s_waitcnt vmcnt(12)
    ds_write_b128 v14, a[156:159] offset:3072
    v_mfma_f32_16x16x32_bf16 v[20:23], a[32:35], v[236:239], v[20:23]
    ds_read_b64 a[224:225], v2 offset:0
    v_mfma_f32_16x16x32_bf16 v[44:47], a[36:39], v[236:239], v[44:47]
    ds_read_b64 a[226:227], v3 offset:0
    v_mfma_f32_16x16x32_bf16 v[68:71], a[40:43], v[236:239], v[68:71]
    ds_read_b64 a[228:229], v2 offset:2048
    v_mfma_f32_16x16x32_bf16 v[92:95], a[44:47], v[236:239], v[92:95]
    ds_read_b64 a[230:231], v3 offset:2048
    v_mfma_f32_16x16x32_bf16 v[116:119], a[48:51], v[236:239], v[116:119]
    ds_read_b64 a[248:249], v11 offset:0
    v_mfma_f32_16x16x32_bf16 v[140:143], a[52:55], v[236:239], v[140:143]
    ds_read_b64 a[250:251], v12 offset:0
    v_mfma_f32_16x16x32_bf16 v[164:167], a[56:59], v[236:239], v[164:167]
    ds_read_b64 a[252:253], v11 offset:2048
    v_mfma_f32_16x16x32_bf16 v[188:191], a[60:63], v[236:239], v[188:191]
    ds_read_b64 a[254:255], v12 offset:2048
    v_mfma_f32_16x16x32_bf16 v[24:27], a[32:35], v[240:243], v[24:27]
    ds_read_b128 a[20:23], v6 offset:44032
    v_mfma_f32_16x16x32_bf16 v[48:51], a[36:39], v[240:243], v[48:51]
    ds_read_b128 a[24:27], v8 offset:7168
    v_mfma_f32_16x16x32_bf16 v[72:75], a[40:43], v[240:243], v[72:75]
    ds_read_b128 a[28:31], v8 offset:25600
    v_mfma_f32_16x16x32_bf16 v[96:99], a[44:47], v[240:243], v[96:99]
    v_mfma_f32_16x16x32_bf16 v[120:123], a[48:51], v[240:243], v[120:123]
    v_mfma_f32_16x16x32_bf16 v[144:147], a[52:55], v[240:243], v[144:147]
    v_mfma_f32_16x16x32_bf16 v[168:171], a[56:59], v[240:243], v[168:171]
    v_mfma_f32_16x16x32_bf16 v[192:195], a[60:63], v[240:243], v[192:195]
    v_mfma_f32_16x16x32_bf16 v[28:31], a[32:35], v[244:247], v[28:31]
    v_mfma_f32_16x16x32_bf16 v[52:55], a[36:39], v[244:247], v[52:55]
    v_mfma_f32_16x16x32_bf16 v[76:79], a[40:43], v[244:247], v[76:79]
    v_mfma_f32_16x16x32_bf16 v[100:103], a[44:47], v[244:247], v[100:103]
    v_mfma_f32_16x16x32_bf16 v[124:127], a[48:51], v[244:247], v[124:127]
    v_mfma_f32_16x16x32_bf16 v[148:151], a[52:55], v[244:247], v[148:151]
    v_mfma_f32_16x16x32_bf16 v[172:175], a[56:59], v[244:247], v[172:175]
    v_mfma_f32_16x16x32_bf16 v[196:199], a[60:63], v[244:247], v[196:199]
    v_mfma_f32_16x16x32_bf16 v[32:35], a[32:35], v[248:251], v[32:35]
    v_mfma_f32_16x16x32_bf16 v[56:59], a[36:39], v[248:251], v[56:59]
    v_mfma_f32_16x16x32_bf16 v[80:83], a[40:43], v[248:251], v[80:83]
    v_mfma_f32_16x16x32_bf16 v[104:107], a[44:47], v[248:251], v[104:107]
    v_mfma_f32_16x16x32_bf16 v[128:131], a[48:51], v[248:251], v[128:131]
    v_mfma_f32_16x16x32_bf16 v[152:155], a[52:55], v[248:251], v[152:155]
    v_mfma_f32_16x16x32_bf16 v[176:179], a[56:59], v[248:251], v[176:179]
    v_mfma_f32_16x16x32_bf16 v[200:203], a[60:63], v[248:251], v[200:203]
    v_mfma_f32_16x16x32_bf16 v[36:39], a[32:35], v[252:255], v[36:39]
    v_mfma_f32_16x16x32_bf16 v[60:63], a[36:39], v[252:255], v[60:63]
    v_mfma_f32_16x16x32_bf16 v[84:87], a[40:43], v[252:255], v[84:87]
    v_mfma_f32_16x16x32_bf16 v[108:111], a[44:47], v[252:255], v[108:111]
    v_mfma_f32_16x16x32_bf16 v[132:135], a[48:51], v[252:255], v[132:135]
    v_mfma_f32_16x16x32_bf16 v[156:159], a[52:55], v[252:255], v[156:159]
    v_mfma_f32_16x16x32_bf16 v[180:183], a[56:59], v[252:255], v[180:183]
    v_mfma_f32_16x16x32_bf16 v[204:207], a[60:63], v[252:255], v[204:207]
    s_waitcnt lgkmcnt(15)
    v_mfma_f32_16x16x32_bf16 v[16:19], a[0:3], a[208:211], v[16:19]
    v_mfma_f32_16x16x32_bf16 v[40:43], a[4:7], a[208:211], v[40:43]
    s_waitcnt vmcnt(11)
    ds_write_b128 v13, a[160:163] offset:0
    s_waitcnt lgkmcnt(15)
    v_mfma_f32_16x16x32_bf16 v[64:67], a[8:11], a[208:211], v[64:67]
    ds_read_b128 a[32:35], v5 offset:7168
    s_waitcnt lgkmcnt(15)
    v_mfma_f32_16x16x32_bf16 v[88:91], a[12:15], a[208:211], v[88:91]
    ds_read_b128 a[36:39], v5 offset:25600
    s_waitcnt lgkmcnt(15)
    v_mfma_f32_16x16x32_bf16 v[112:115], a[16:19], a[208:211], v[112:115]
    ds_read_b128 a[40:43], v5 offset:44032
    s_waitcnt lgkmcnt(6)
    v_mfma_f32_16x16x32_bf16 v[136:139], a[20:23], a[208:211], v[136:139]
    s_waitcnt vmcnt(10)
    ds_write_b128 v14, a[164:167] offset:1024
    s_waitcnt lgkmcnt(6)
    v_mfma_f32_16x16x32_bf16 v[160:163], a[24:27], a[208:211], v[160:163]
    ds_read_b128 a[44:47], v7 offset:7168
    s_waitcnt lgkmcnt(6)
    v_mfma_f32_16x16x32_bf16 v[184:187], a[28:31], a[208:211], v[184:187]
    ds_read_b128 a[48:51], v7 offset:25600
    v_mfma_f32_16x16x32_bf16 v[20:23], a[0:3], a[212:215], v[20:23]
    ds_read_b128 a[52:55], v7 offset:44032
    v_mfma_f32_16x16x32_bf16 v[44:47], a[4:7], a[212:215], v[44:47]
    s_waitcnt vmcnt(9)
    ds_write_b128 v13, a[168:171] offset:2048
    v_mfma_f32_16x16x32_bf16 v[68:71], a[8:11], a[212:215], v[68:71]
    ds_read_b128 a[56:59], v9 offset:7168
    v_mfma_f32_16x16x32_bf16 v[92:95], a[12:15], a[212:215], v[92:95]
    ds_read_b128 a[60:63], v9 offset:25600
    v_mfma_f32_16x16x32_bf16 v[116:119], a[16:19], a[212:215], v[116:119]
    v_mfma_f32_16x16x32_bf16 v[140:143], a[20:23], a[212:215], v[140:143]
    s_waitcnt vmcnt(8)
    ds_write_b128 v14, a[172:175] offset:3072
    v_mfma_f32_16x16x32_bf16 v[164:167], a[24:27], a[212:215], v[164:167]
    ds_read_b64 v[208:209], v2 offset:0
    v_mfma_f32_16x16x32_bf16 v[188:191], a[28:31], a[212:215], v[188:191]
    ds_read_b64 v[210:211], v3 offset:0
    v_mfma_f32_16x16x32_bf16 v[24:27], a[0:3], a[216:219], v[24:27]
    ds_read_b64 v[212:213], v2 offset:2048
    v_mfma_f32_16x16x32_bf16 v[48:51], a[4:7], a[216:219], v[48:51]
    ds_read_b64 v[214:215], v3 offset:2048
    v_mfma_f32_16x16x32_bf16 v[72:75], a[8:11], a[216:219], v[72:75]
    ds_read_b64 v[232:233], v11 offset:0
    v_mfma_f32_16x16x32_bf16 v[96:99], a[12:15], a[216:219], v[96:99]
    ds_read_b64 v[234:235], v12 offset:0
    v_mfma_f32_16x16x32_bf16 v[120:123], a[16:19], a[216:219], v[120:123]
    ds_read_b64 v[236:237], v11 offset:2048
    v_mfma_f32_16x16x32_bf16 v[144:147], a[20:23], a[216:219], v[144:147]
    ds_read_b64 v[238:239], v12 offset:2048
    v_mfma_f32_16x16x32_bf16 v[168:171], a[24:27], a[216:219], v[168:171]
    s_waitcnt vmcnt(7)
    ds_write_b128 v13, a[176:179] offset:0
    v_mfma_f32_16x16x32_bf16 v[192:195], a[28:31], a[216:219], v[192:195]
    v_mfma_f32_16x16x32_bf16 v[28:31], a[0:3], a[220:223], v[28:31]
    v_mfma_f32_16x16x32_bf16 v[52:55], a[4:7], a[220:223], v[52:55]
    v_mfma_f32_16x16x32_bf16 v[76:79], a[8:11], a[220:223], v[76:79]
    s_waitcnt vmcnt(6)
    ds_write_b128 v14, a[180:183] offset:1024
    v_mfma_f32_16x16x32_bf16 v[100:103], a[12:15], a[220:223], v[100:103]
    v_mfma_f32_16x16x32_bf16 v[124:127], a[16:19], a[220:223], v[124:127]
    v_mfma_f32_16x16x32_bf16 v[148:151], a[20:23], a[220:223], v[148:151]
    v_mfma_f32_16x16x32_bf16 v[172:175], a[24:27], a[220:223], v[172:175]
    s_waitcnt vmcnt(5)
    ds_write_b128 v13, a[184:187] offset:2048
    v_mfma_f32_16x16x32_bf16 v[196:199], a[28:31], a[220:223], v[196:199]
    v_mfma_f32_16x16x32_bf16 v[32:35], a[0:3], a[224:227], v[32:35]
    v_mfma_f32_16x16x32_bf16 v[56:59], a[4:7], a[224:227], v[56:59]
    v_mfma_f32_16x16x32_bf16 v[80:83], a[8:11], a[224:227], v[80:83]
    s_waitcnt vmcnt(4)
    ds_write_b128 v14, a[188:191] offset:3072
    v_mfma_f32_16x16x32_bf16 v[104:107], a[12:15], a[224:227], v[104:107]
    ds_read_b64 v[216:217], v2 offset:0
    v_mfma_f32_16x16x32_bf16 v[128:131], a[16:19], a[224:227], v[128:131]
    ds_read_b64 v[218:219], v3 offset:0
    v_mfma_f32_16x16x32_bf16 v[152:155], a[20:23], a[224:227], v[152:155]
    ds_read_b64 v[220:221], v2 offset:2048
    v_mfma_f32_16x16x32_bf16 v[176:179], a[24:27], a[224:227], v[176:179]
    ds_read_b64 v[222:223], v3 offset:2048
    v_mfma_f32_16x16x32_bf16 v[200:203], a[28:31], a[224:227], v[200:203]
    ds_read_b64 v[240:241], v11 offset:0
    v_mfma_f32_16x16x32_bf16 v[36:39], a[0:3], a[228:231], v[36:39]
    ds_read_b64 v[242:243], v12 offset:0
    v_mfma_f32_16x16x32_bf16 v[60:63], a[4:7], a[228:231], v[60:63]
    ds_read_b64 v[244:245], v11 offset:2048
    v_mfma_f32_16x16x32_bf16 v[84:87], a[8:11], a[228:231], v[84:87]
    ds_read_b64 v[246:247], v12 offset:2048
    v_mfma_f32_16x16x32_bf16 v[108:111], a[12:15], a[228:231], v[108:111]
    s_waitcnt vmcnt(3)
    ds_write_b128 v13, a[192:195] offset:0
    v_mfma_f32_16x16x32_bf16 v[132:135], a[16:19], a[228:231], v[132:135]
    v_mfma_f32_16x16x32_bf16 v[156:159], a[20:23], a[228:231], v[156:159]
    v_mfma_f32_16x16x32_bf16 v[180:183], a[24:27], a[228:231], v[180:183]
    v_mfma_f32_16x16x32_bf16 v[204:207], a[28:31], a[228:231], v[204:207]
    s_waitcnt vmcnt(2)
    ds_write_b128 v14, a[196:199] offset:1024
    s_waitcnt lgkmcnt(15)
    v_mfma_f32_16x16x32_bf16 v[16:19], a[32:35], a[232:235], v[16:19]
    v_mfma_f32_16x16x32_bf16 v[40:43], a[36:39], a[232:235], v[40:43]
    ds_read_b128 a[0:3], v4 offset:8192
    v_mfma_f32_16x16x32_bf16 v[64:67], a[40:43], a[232:235], v[64:67]
    ds_read_b128 a[4:7], v4 offset:26624
    v_mfma_f32_16x16x32_bf16 v[88:91], a[44:47], a[232:235], v[88:91]
    s_waitcnt vmcnt(1)
    ds_write_b128 v13, a[200:203] offset:2048
    v_mfma_f32_16x16x32_bf16 v[112:115], a[48:51], a[232:235], v[112:115]
    ds_read_b128 a[8:11], v4 offset:45056
    v_mfma_f32_16x16x32_bf16 v[136:139], a[52:55], a[232:235], v[136:139]
    ds_read_b128 a[12:15], v6 offset:8192
    v_mfma_f32_16x16x32_bf16 v[160:163], a[56:59], a[232:235], v[160:163]
    ds_read_b128 a[16:19], v6 offset:26624
    v_mfma_f32_16x16x32_bf16 v[184:187], a[60:63], a[232:235], v[184:187]
    s_waitcnt vmcnt(0)
    ds_write_b128 v14, a[204:207] offset:3072
    v_mfma_f32_16x16x32_bf16 v[20:23], a[32:35], a[236:239], v[20:23]
    ds_read_b64 v[224:225], v2 offset:0
    v_mfma_f32_16x16x32_bf16 v[44:47], a[36:39], a[236:239], v[44:47]
    ds_read_b64 v[226:227], v3 offset:0
    v_mfma_f32_16x16x32_bf16 v[68:71], a[40:43], a[236:239], v[68:71]
    ds_read_b64 v[228:229], v2 offset:2048
    v_mfma_f32_16x16x32_bf16 v[92:95], a[44:47], a[236:239], v[92:95]
    ds_read_b64 v[230:231], v3 offset:2048
    v_mfma_f32_16x16x32_bf16 v[116:119], a[48:51], a[236:239], v[116:119]
    ds_read_b64 v[248:249], v11 offset:0
    v_mfma_f32_16x16x32_bf16 v[140:143], a[52:55], a[236:239], v[140:143]
    ds_read_b64 v[250:251], v12 offset:0
    v_mfma_f32_16x16x32_bf16 v[164:167], a[56:59], a[236:239], v[164:167]
    ds_read_b64 v[252:253], v11 offset:2048
    v_mfma_f32_16x16x32_bf16 v[188:191], a[60:63], a[236:239], v[188:191]
    ds_read_b64 v[254:255], v12 offset:2048
    v_mfma_f32_16x16x32_bf16 v[24:27], a[32:35], a[240:243], v[24:27]
    ds_read_b128 a[20:23], v6 offset:45056
    v_mfma_f32_16x16x32_bf16 v[48:51], a[36:39], a[240:243], v[48:51]
    ds_read_b128 a[24:27], v8 offset:8192
    v_mfma_f32_16x16x32_bf16 v[72:75], a[40:43], a[240:243], v[72:75]
    ds_read_b128 a[28:31], v8 offset:26624
    v_mfma_f32_16x16x32_bf16 v[96:99], a[44:47], a[240:243], v[96:99]
    v_mfma_f32_16x16x32_bf16 v[120:123], a[48:51], a[240:243], v[120:123]
    v_mfma_f32_16x16x32_bf16 v[144:147], a[52:55], a[240:243], v[144:147]
    v_mfma_f32_16x16x32_bf16 v[168:171], a[56:59], a[240:243], v[168:171]
    v_mfma_f32_16x16x32_bf16 v[192:195], a[60:63], a[240:243], v[192:195]
    v_mfma_f32_16x16x32_bf16 v[28:31], a[32:35], a[244:247], v[28:31]
    v_mfma_f32_16x16x32_bf16 v[52:55], a[36:39], a[244:247], v[52:55]
    v_mfma_f32_16x16x32_bf16 v[76:79], a[40:43], a[244:247], v[76:79]
    v_mfma_f32_16x16x32_bf16 v[100:103], a[44:47], a[244:247], v[100:103]
    v_mfma_f32_16x16x32_bf16 v[124:127], a[48:51], a[244:247], v[124:127]
    v_mfma_f32_16x16x32_bf16 v[148:151], a[52:55], a[244:247], v[148:151]
    v_mfma_f32_16x16x32_bf16 v[172:175], a[56:59], a[244:247], v[172:175]
    v_mfma_f32_16x16x32_bf16 v[196:199], a[60:63], a[244:247], v[196:199]
    v_mfma_f32_16x16x32_bf16 v[32:35], a[32:35], a[248:251], v[32:35]
    v_mfma_f32_16x16x32_bf16 v[56:59], a[36:39], a[248:251], v[56:59]
    v_mfma_f32_16x16x32_bf16 v[80:83], a[40:43], a[248:251], v[80:83]
    v_mfma_f32_16x16x32_bf16 v[104:107], a[44:47], a[248:251], v[104:107]
    v_mfma_f32_16x16x32_bf16 v[128:131], a[48:51], a[248:251], v[128:131]
    v_mfma_f32_16x16x32_bf16 v[152:155], a[52:55], a[248:251], v[152:155]
    v_mfma_f32_16x16x32_bf16 v[176:179], a[56:59], a[248:251], v[176:179]
    v_mfma_f32_16x16x32_bf16 v[200:203], a[60:63], a[248:251], v[200:203]
    v_mfma_f32_16x16x32_bf16 v[36:39], a[32:35], a[252:255], v[36:39]
    v_mfma_f32_16x16x32_bf16 v[60:63], a[36:39], a[252:255], v[60:63]
    v_mfma_f32_16x16x32_bf16 v[84:87], a[40:43], a[252:255], v[84:87]
    v_mfma_f32_16x16x32_bf16 v[108:111], a[44:47], a[252:255], v[108:111]
    v_mfma_f32_16x16x32_bf16 v[132:135], a[48:51], a[252:255], v[132:135]
    v_mfma_f32_16x16x32_bf16 v[156:159], a[52:55], a[252:255], v[156:159]
    v_mfma_f32_16x16x32_bf16 v[180:183], a[56:59], a[252:255], v[180:183]
    v_mfma_f32_16x16x32_bf16 v[204:207], a[60:63], a[252:255], v[204:207]
    s_waitcnt lgkmcnt(15)
    v_mfma_f32_16x16x32_bf16 v[16:19], a[0:3], v[208:211], v[16:19]
    v_mfma_f32_16x16x32_bf16 v[40:43], a[4:7], v[208:211], v[40:43]
    ds_read_b128 a[32:35], v5 offset:8192
    s_waitcnt lgkmcnt(15)
    v_mfma_f32_16x16x32_bf16 v[64:67], a[8:11], v[208:211], v[64:67]
    ds_read_b128 a[36:39], v5 offset:26624
    s_waitcnt lgkmcnt(15)
    v_mfma_f32_16x16x32_bf16 v[88:91], a[12:15], v[208:211], v[88:91]
    ds_read_b128 a[40:43], v5 offset:45056
    s_waitcnt lgkmcnt(15)
    v_mfma_f32_16x16x32_bf16 v[112:115], a[16:19], v[208:211], v[112:115]
    ds_read_b128 a[44:47], v7 offset:8192
    s_waitcnt lgkmcnt(6)
    v_mfma_f32_16x16x32_bf16 v[136:139], a[20:23], v[208:211], v[136:139]
    ds_read_b128 a[48:51], v7 offset:26624
    s_waitcnt lgkmcnt(6)
    v_mfma_f32_16x16x32_bf16 v[160:163], a[24:27], v[208:211], v[160:163]
    ds_read_b128 a[52:55], v7 offset:45056
    s_waitcnt lgkmcnt(6)
    v_mfma_f32_16x16x32_bf16 v[184:187], a[28:31], v[208:211], v[184:187]
    ds_read_b128 a[56:59], v9 offset:8192
    v_mfma_f32_16x16x32_bf16 v[20:23], a[0:3], v[212:215], v[20:23]
    ds_read_b128 a[60:63], v9 offset:26624
    v_mfma_f32_16x16x32_bf16 v[44:47], a[4:7], v[212:215], v[44:47]
    v_mfma_f32_16x16x32_bf16 v[68:71], a[8:11], v[212:215], v[68:71]
    v_mfma_f32_16x16x32_bf16 v[92:95], a[12:15], v[212:215], v[92:95]
    v_mfma_f32_16x16x32_bf16 v[116:119], a[16:19], v[212:215], v[116:119]
    v_mfma_f32_16x16x32_bf16 v[140:143], a[20:23], v[212:215], v[140:143]
    v_mfma_f32_16x16x32_bf16 v[164:167], a[24:27], v[212:215], v[164:167]
    v_mfma_f32_16x16x32_bf16 v[188:191], a[28:31], v[212:215], v[188:191]
    v_mfma_f32_16x16x32_bf16 v[24:27], a[0:3], v[216:219], v[24:27]
    v_mfma_f32_16x16x32_bf16 v[48:51], a[4:7], v[216:219], v[48:51]
    v_mfma_f32_16x16x32_bf16 v[72:75], a[8:11], v[216:219], v[72:75]
    v_mfma_f32_16x16x32_bf16 v[96:99], a[12:15], v[216:219], v[96:99]
    v_mfma_f32_16x16x32_bf16 v[120:123], a[16:19], v[216:219], v[120:123]
    v_mfma_f32_16x16x32_bf16 v[144:147], a[20:23], v[216:219], v[144:147]
    v_mfma_f32_16x16x32_bf16 v[168:171], a[24:27], v[216:219], v[168:171]
    v_mfma_f32_16x16x32_bf16 v[192:195], a[28:31], v[216:219], v[192:195]
    v_mfma_f32_16x16x32_bf16 v[28:31], a[0:3], v[220:223], v[28:31]
    v_mfma_f32_16x16x32_bf16 v[52:55], a[4:7], v[220:223], v[52:55]
    v_mfma_f32_16x16x32_bf16 v[76:79], a[8:11], v[220:223], v[76:79]
    v_mfma_f32_16x16x32_bf16 v[100:103], a[12:15], v[220:223], v[100:103]
    v_mfma_f32_16x16x32_bf16 v[124:127], a[16:19], v[220:223], v[124:127]
    v_mfma_f32_16x16x32_bf16 v[148:151], a[20:23], v[220:223], v[148:151]
    v_mfma_f32_16x16x32_bf16 v[172:175], a[24:27], v[220:223], v[172:175]
    v_mfma_f32_16x16x32_bf16 v[196:199], a[28:31], v[220:223], v[196:199]
    v_mfma_f32_16x16x32_bf16 v[32:35], a[0:3], v[224:227], v[32:35]
    v_mfma_f32_16x16x32_bf16 v[56:59], a[4:7], v[224:227], v[56:59]
    v_mfma_f32_16x16x32_bf16 v[80:83], a[8:11], v[224:227], v[80:83]
    v_mfma_f32_16x16x32_bf16 v[104:107], a[12:15], v[224:227], v[104:107]
    v_mfma_f32_16x16x32_bf16 v[128:131], a[16:19], v[224:227], v[128:131]
    v_mfma_f32_16x16x32_bf16 v[152:155], a[20:23], v[224:227], v[152:155]
    v_mfma_f32_16x16x32_bf16 v[176:179], a[24:27], v[224:227], v[176:179]
    v_mfma_f32_16x16x32_bf16 v[200:203], a[28:31], v[224:227], v[200:203]
    v_mfma_f32_16x16x32_bf16 v[36:39], a[0:3], v[228:231], v[36:39]
    v_mfma_f32_16x16x32_bf16 v[60:63], a[4:7], v[228:231], v[60:63]
    v_mfma_f32_16x16x32_bf16 v[84:87], a[8:11], v[228:231], v[84:87]
    v_mfma_f32_16x16x32_bf16 v[108:111], a[12:15], v[228:231], v[108:111]
    v_mfma_f32_16x16x32_bf16 v[132:135], a[16:19], v[228:231], v[132:135]
    v_mfma_f32_16x16x32_bf16 v[156:159], a[20:23], v[228:231], v[156:159]
    v_mfma_f32_16x16x32_bf16 v[180:183], a[24:27], v[228:231], v[180:183]
    v_mfma_f32_16x16x32_bf16 v[204:207], a[28:31], v[228:231], v[204:207]
    s_waitcnt lgkmcnt(7)
    v_mfma_f32_16x16x32_bf16 v[16:19], a[32:35], v[232:235], v[16:19]
    s_waitcnt lgkmcnt(6)
    v_mfma_f32_16x16x32_bf16 v[40:43], a[36:39], v[232:235], v[40:43]
    s_waitcnt lgkmcnt(5)
    v_mfma_f32_16x16x32_bf16 v[64:67], a[40:43], v[232:235], v[64:67]
    s_waitcnt lgkmcnt(4)
    v_mfma_f32_16x16x32_bf16 v[88:91], a[44:47], v[232:235], v[88:91]
    s_waitcnt lgkmcnt(3)
    v_mfma_f32_16x16x32_bf16 v[112:115], a[48:51], v[232:235], v[112:115]
    s_waitcnt lgkmcnt(2)
    v_mfma_f32_16x16x32_bf16 v[136:139], a[52:55], v[232:235], v[136:139]
    s_waitcnt lgkmcnt(1)
    v_mfma_f32_16x16x32_bf16 v[160:163], a[56:59], v[232:235], v[160:163]
    s_waitcnt lgkmcnt(0)
    v_mfma_f32_16x16x32_bf16 v[184:187], a[60:63], v[232:235], v[184:187]
    v_mfma_f32_16x16x32_bf16 v[20:23], a[32:35], v[236:239], v[20:23]
    v_mfma_f32_16x16x32_bf16 v[44:47], a[36:39], v[236:239], v[44:47]
    v_mfma_f32_16x16x32_bf16 v[68:71], a[40:43], v[236:239], v[68:71]
    v_mfma_f32_16x16x32_bf16 v[92:95], a[44:47], v[236:239], v[92:95]
    v_mfma_f32_16x16x32_bf16 v[116:119], a[48:51], v[236:239], v[116:119]
    v_mfma_f32_16x16x32_bf16 v[140:143], a[52:55], v[236:239], v[140:143]
    v_mfma_f32_16x16x32_bf16 v[164:167], a[56:59], v[236:239], v[164:167]
    v_mfma_f32_16x16x32_bf16 v[188:191], a[60:63], v[236:239], v[188:191]
    v_mfma_f32_16x16x32_bf16 v[24:27], a[32:35], v[240:243], v[24:27]
    v_mfma_f32_16x16x32_bf16 v[48:51], a[36:39], v[240:243], v[48:51]
    v_mfma_f32_16x16x32_bf16 v[72:75], a[40:43], v[240:243], v[72:75]
    v_mfma_f32_16x16x32_bf16 v[96:99], a[44:47], v[240:243], v[96:99]
    v_mfma_f32_16x16x32_bf16 v[120:123], a[48:51], v[240:243], v[120:123]
    v_mfma_f32_16x16x32_bf16 v[144:147], a[52:55], v[240:243], v[144:147]
    v_mfma_f32_16x16x32_bf16 v[168:171], a[56:59], v[240:243], v[168:171]
    v_mfma_f32_16x16x32_bf16 v[192:195], a[60:63], v[240:243], v[192:195]
    v_mfma_f32_16x16x32_bf16 v[28:31], a[32:35], v[244:247], v[28:31]
    v_mfma_f32_16x16x32_bf16 v[52:55], a[36:39], v[244:247], v[52:55]
    v_mfma_f32_16x16x32_bf16 v[76:79], a[40:43], v[244:247], v[76:79]
    v_mfma_f32_16x16x32_bf16 v[100:103], a[44:47], v[244:247], v[100:103]
    v_mfma_f32_16x16x32_bf16 v[124:127], a[48:51], v[244:247], v[124:127]
    v_mfma_f32_16x16x32_bf16 v[148:151], a[52:55], v[244:247], v[148:151]
    v_mfma_f32_16x16x32_bf16 v[172:175], a[56:59], v[244:247], v[172:175]
    v_mfma_f32_16x16x32_bf16 v[196:199], a[60:63], v[244:247], v[196:199]
    v_mfma_f32_16x16x32_bf16 v[32:35], a[32:35], v[248:251], v[32:35]
    v_mfma_f32_16x16x32_bf16 v[56:59], a[36:39], v[248:251], v[56:59]
    v_mfma_f32_16x16x32_bf16 v[80:83], a[40:43], v[248:251], v[80:83]
    v_mfma_f32_16x16x32_bf16 v[104:107], a[44:47], v[248:251], v[104:107]
    v_mfma_f32_16x16x32_bf16 v[128:131], a[48:51], v[248:251], v[128:131]
    v_mfma_f32_16x16x32_bf16 v[152:155], a[52:55], v[248:251], v[152:155]
    v_mfma_f32_16x16x32_bf16 v[176:179], a[56:59], v[248:251], v[176:179]
    v_mfma_f32_16x16x32_bf16 v[200:203], a[60:63], v[248:251], v[200:203]
    v_mfma_f32_16x16x32_bf16 v[36:39], a[32:35], v[252:255], v[36:39]
    v_mfma_f32_16x16x32_bf16 v[60:63], a[36:39], v[252:255], v[60:63]
    v_mfma_f32_16x16x32_bf16 v[84:87], a[40:43], v[252:255], v[84:87]
    v_mfma_f32_16x16x32_bf16 v[108:111], a[44:47], v[252:255], v[108:111]
    v_mfma_f32_16x16x32_bf16 v[132:135], a[48:51], v[252:255], v[132:135]
    v_mfma_f32_16x16x32_bf16 v[156:159], a[52:55], v[252:255], v[156:159]
    v_mfma_f32_16x16x32_bf16 v[180:183], a[56:59], v[252:255], v[180:183]
    v_mfma_f32_16x16x32_bf16 v[204:207], a[60:63], v[252:255], v[204:207]
    s_nop 15
    v_and_b32 v2, 15, v1
    v_lshrrev_b32 v3, 4, v1
    v_lshrrev_b32 v4, 1, v3
    v_and_b32 v5, 1, v3
    v_lshl_add_u32 v4, v5, 1, v4
    v_lshl_add_u32 v4, v4, 4, v2
    v_lshlrev_b32 v4, 4, v4
    s_mov_b32 s51, 0x20000
    s_add_u32 s48, s36, s60
    s_addc_u32 s49, s37, 0
    s_mov_b32 s50, 2359296
    s_lshr_b32 s10, s62, 4
    s_lshl_b32 s10, s10, 6
    s_lshl_b32 s11, s4, 2
    s_add_u32 s10, s10, s11
    s_lshl_b32 s10, s10, 10
    v_cvt_pk_bf16_f32 v208, v16, v17
    v_cvt_pk_bf16_f32 v209, v18, v19
    v_cvt_pk_bf16_f32 v210, v40, v41
    v_cvt_pk_bf16_f32 v211, v42, v43
    v_xor_b32 v208, s61, v208
    v_xor_b32 v209, s61, v209
    v_xor_b32 v210, s61, v210
    v_xor_b32 v211, s61, v211
    s_nop 1
    v_permlane16_swap_b32 v208, v210
    v_permlane16_swap_b32 v209, v211
    buffer_store_dwordx4 v[208:211], v4, s[48:51], s10 offen offset:0 sc1
    v_cvt_pk_bf16_f32 v212, v64, v65
    v_cvt_pk_bf16_f32 v213, v66, v67
    v_cvt_pk_bf16_f32 v214, v88, v89
    v_cvt_pk_bf16_f32 v215, v90, v91
    v_xor_b32 v212, s61, v212
    v_xor_b32 v213, s61, v213
    v_xor_b32 v214, s61, v214
    v_xor_b32 v215, s61, v215
    s_nop 1
    v_permlane16_swap_b32 v212, v214
    v_permlane16_swap_b32 v213, v215
    buffer_store_dwordx4 v[212:215], v4, s[48:51], s10 offen offset:1024 sc1
    v_cvt_pk_bf16_f32 v216, v112, v113
    v_cvt_pk_bf16_f32 v217, v114, v115
    v_cvt_pk_bf16_f32 v218, v136, v137
    v_cvt_pk_bf16_f32 v219, v138, v139
    v_xor_b32 v216, s61, v216
    v_xor_b32 v217, s61, v217
    v_xor_b32 v218, s61, v218
    v_xor_b32 v219, s61, v219
    s_nop 1
    v_permlane16_swap_b32 v216, v218
    v_permlane16_swap_b32 v217, v219
    buffer_store_dwordx4 v[216:219], v4, s[48:51], s10 offen offset:2048 sc1
    v_cvt_pk_bf16_f32 v220, v160, v161
    v_cvt_pk_bf16_f32 v221, v162, v163
    v_cvt_pk_bf16_f32 v222, v184, v185
    v_cvt_pk_bf16_f32 v223, v186, v187
    v_xor_b32 v220, s61, v220
    v_xor_b32 v221, s61, v221
    v_xor_b32 v222, s61, v222
    v_xor_b32 v223, s61, v223
    s_nop 1
    v_permlane16_swap_b32 v220, v222
    v_permlane16_swap_b32 v221, v223
    buffer_store_dwordx4 v[220:223], v4, s[48:51], s10 offen offset:3072 sc1
    s_add_u32 s10, s10, 65536
    v_cvt_pk_bf16_f32 v224, v20, v21
    v_cvt_pk_bf16_f32 v225, v22, v23
    v_cvt_pk_bf16_f32 v226, v44, v45
    v_cvt_pk_bf16_f32 v227, v46, v47
    v_xor_b32 v224, s61, v224
    v_xor_b32 v225, s61, v225
    v_xor_b32 v226, s61, v226
    v_xor_b32 v227, s61, v227
    s_nop 1
    v_permlane16_swap_b32 v224, v226
    v_permlane16_swap_b32 v225, v227
    buffer_store_dwordx4 v[224:227], v4, s[48:51], s10 offen offset:0 sc1
    v_cvt_pk_bf16_f32 v228, v68, v69
    v_cvt_pk_bf16_f32 v229, v70, v71
    v_cvt_pk_bf16_f32 v230, v92, v93
    v_cvt_pk_bf16_f32 v231, v94, v95
    v_xor_b32 v228, s61, v228
    v_xor_b32 v229, s61, v229
    v_xor_b32 v230, s61, v230
    v_xor_b32 v231, s61, v231
    s_nop 1
    v_permlane16_swap_b32 v228, v230
    v_permlane16_swap_b32 v229, v231
    buffer_store_dwordx4 v[228:231], v4, s[48:51], s10 offen offset:1024 sc1
    v_cvt_pk_bf16_f32 v232, v116, v117
    v_cvt_pk_bf16_f32 v233, v118, v119
    v_cvt_pk_bf16_f32 v234, v140, v141
    v_cvt_pk_bf16_f32 v235, v142, v143
    v_xor_b32 v232, s61, v232
    v_xor_b32 v233, s61, v233
    v_xor_b32 v234, s61, v234
    v_xor_b32 v235, s61, v235
    s_nop 1
    v_permlane16_swap_b32 v232, v234
    v_permlane16_swap_b32 v233, v235
    buffer_store_dwordx4 v[232:235], v4, s[48:51], s10 offen offset:2048 sc1
    v_cvt_pk_bf16_f32 v236, v164, v165
    v_cvt_pk_bf16_f32 v237, v166, v167
    v_cvt_pk_bf16_f32 v238, v188, v189
    v_cvt_pk_bf16_f32 v239, v190, v191
    v_xor_b32 v236, s61, v236
    v_xor_b32 v237, s61, v237
    v_xor_b32 v238, s61, v238
    v_xor_b32 v239, s61, v239
    s_nop 1
    v_permlane16_swap_b32 v236, v238
    v_permlane16_swap_b32 v237, v239
    buffer_store_dwordx4 v[236:239], v4, s[48:51], s10 offen offset:3072 sc1
    s_add_u32 s10, s10, 65536
    v_cvt_pk_bf16_f32 v240, v24, v25
    v_cvt_pk_bf16_f32 v241, v26, v27
    v_cvt_pk_bf16_f32 v242, v48, v49
    v_cvt_pk_bf16_f32 v243, v50, v51
    v_xor_b32 v240, s61, v240
    v_xor_b32 v241, s61, v241
    v_xor_b32 v242, s61, v242
    v_xor_b32 v243, s61, v243
    s_nop 1
    v_permlane16_swap_b32 v240, v242
    v_permlane16_swap_b32 v241, v243
    buffer_store_dwordx4 v[240:243], v4, s[48:51], s10 offen offset:0 sc1
    v_cvt_pk_bf16_f32 v244, v72, v73
    v_cvt_pk_bf16_f32 v245, v74, v75
    v_cvt_pk_bf16_f32 v246, v96, v97
    v_cvt_pk_bf16_f32 v247, v98, v99
    v_xor_b32 v244, s61, v244
    v_xor_b32 v245, s61, v245
    v_xor_b32 v246, s61, v246
    v_xor_b32 v247, s61, v247
    s_nop 1
    v_permlane16_swap_b32 v244, v246
    v_permlane16_swap_b32 v245, v247
    buffer_store_dwordx4 v[244:247], v4, s[48:51], s10 offen offset:1024 sc1
    v_cvt_pk_bf16_f32 v248, v120, v121
    v_cvt_pk_bf16_f32 v249, v122, v123
    v_cvt_pk_bf16_f32 v250, v144, v145
    v_cvt_pk_bf16_f32 v251, v146, v147
    v_xor_b32 v248, s61, v248
    v_xor_b32 v249, s61, v249
    v_xor_b32 v250, s61, v250
    v_xor_b32 v251, s61, v251
    s_nop 1
    v_permlane16_swap_b32 v248, v250
    v_permlane16_swap_b32 v249, v251
    buffer_store_dwordx4 v[248:251], v4, s[48:51], s10 offen offset:2048 sc1
    v_cvt_pk_bf16_f32 v252, v168, v169
    v_cvt_pk_bf16_f32 v253, v170, v171
    v_cvt_pk_bf16_f32 v254, v192, v193
    v_cvt_pk_bf16_f32 v255, v194, v195
    v_xor_b32 v252, s61, v252
    v_xor_b32 v253, s61, v253
    v_xor_b32 v254, s61, v254
    v_xor_b32 v255, s61, v255
    s_nop 1
    v_permlane16_swap_b32 v252, v254
    v_permlane16_swap_b32 v253, v255
    buffer_store_dwordx4 v[252:255], v4, s[48:51], s10 offen offset:3072 sc1
    s_add_u32 s10, s10, 65536
    v_cvt_pk_bf16_f32 v208, v28, v29
    v_cvt_pk_bf16_f32 v209, v30, v31
    v_cvt_pk_bf16_f32 v210, v52, v53
    v_cvt_pk_bf16_f32 v211, v54, v55
    v_xor_b32 v208, s61, v208
    v_xor_b32 v209, s61, v209
    v_xor_b32 v210, s61, v210
    v_xor_b32 v211, s61, v211
    s_nop 1
    v_permlane16_swap_b32 v208, v210
    v_permlane16_swap_b32 v209, v211
    buffer_store_dwordx4 v[208:211], v4, s[48:51], s10 offen offset:0 sc1
    v_cvt_pk_bf16_f32 v212, v76, v77
    v_cvt_pk_bf16_f32 v213, v78, v79
    v_cvt_pk_bf16_f32 v214, v100, v101
    v_cvt_pk_bf16_f32 v215, v102, v103
    v_xor_b32 v212, s61, v212
    v_xor_b32 v213, s61, v213
    v_xor_b32 v214, s61, v214
    v_xor_b32 v215, s61, v215
    s_nop 1
    v_permlane16_swap_b32 v212, v214
    v_permlane16_swap_b32 v213, v215
    buffer_store_dwordx4 v[212:215], v4, s[48:51], s10 offen offset:1024 sc1
    v_cvt_pk_bf16_f32 v216, v124, v125
    v_cvt_pk_bf16_f32 v217, v126, v127
    v_cvt_pk_bf16_f32 v218, v148, v149
    v_cvt_pk_bf16_f32 v219, v150, v151
    v_xor_b32 v216, s61, v216
    v_xor_b32 v217, s61, v217
    v_xor_b32 v218, s61, v218
    v_xor_b32 v219, s61, v219
    s_nop 1
    v_permlane16_swap_b32 v216, v218
    v_permlane16_swap_b32 v217, v219
    buffer_store_dwordx4 v[216:219], v4, s[48:51], s10 offen offset:2048 sc1
    v_cvt_pk_bf16_f32 v220, v172, v173
    v_cvt_pk_bf16_f32 v221, v174, v175
    v_cvt_pk_bf16_f32 v222, v196, v197
    v_cvt_pk_bf16_f32 v223, v198, v199
    v_xor_b32 v220, s61, v220
    v_xor_b32 v221, s61, v221
    v_xor_b32 v222, s61, v222
    v_xor_b32 v223, s61, v223
    s_nop 1
    v_permlane16_swap_b32 v220, v222
    v_permlane16_swap_b32 v221, v223
    buffer_store_dwordx4 v[220:223], v4, s[48:51], s10 offen offset:3072 sc1
    s_add_u32 s10, s10, 65536
    v_cvt_pk_bf16_f32 v224, v32, v33
    v_cvt_pk_bf16_f32 v225, v34, v35
    v_cvt_pk_bf16_f32 v226, v56, v57
    v_cvt_pk_bf16_f32 v227, v58, v59
    v_xor_b32 v224, s61, v224
    v_xor_b32 v225, s61, v225
    v_xor_b32 v226, s61, v226
    v_xor_b32 v227, s61, v227
    s_nop 1
    v_permlane16_swap_b32 v224, v226
    v_permlane16_swap_b32 v225, v227
    buffer_store_dwordx4 v[224:227], v4, s[48:51], s10 offen offset:0 sc1
    v_cvt_pk_bf16_f32 v228, v80, v81
    v_cvt_pk_bf16_f32 v229, v82, v83
    v_cvt_pk_bf16_f32 v230, v104, v105
    v_cvt_pk_bf16_f32 v231, v106, v107
    v_xor_b32 v228, s61, v228
    v_xor_b32 v229, s61, v229
    v_xor_b32 v230, s61, v230
    v_xor_b32 v231, s61, v231
    s_nop 1
    v_permlane16_swap_b32 v228, v230
    v_permlane16_swap_b32 v229, v231
    buffer_store_dwordx4 v[228:231], v4, s[48:51], s10 offen offset:1024 sc1
    v_cvt_pk_bf16_f32 v232, v128, v129
    v_cvt_pk_bf16_f32 v233, v130, v131
    v_cvt_pk_bf16_f32 v234, v152, v153
    v_cvt_pk_bf16_f32 v235, v154, v155
    v_xor_b32 v232, s61, v232
    v_xor_b32 v233, s61, v233
    v_xor_b32 v234, s61, v234
    v_xor_b32 v235, s61, v235
    s_nop 1
    v_permlane16_swap_b32 v232, v234
    v_permlane16_swap_b32 v233, v235
    buffer_store_dwordx4 v[232:235], v4, s[48:51], s10 offen offset:2048 sc1
    v_cvt_pk_bf16_f32 v236, v176, v177
    v_cvt_pk_bf16_f32 v237, v178, v179
    v_cvt_pk_bf16_f32 v238, v200, v201
    v_cvt_pk_bf16_f32 v239, v202, v203
    v_xor_b32 v236, s61, v236
    v_xor_b32 v237, s61, v237
    v_xor_b32 v238, s61, v238
    v_xor_b32 v239, s61, v239
    s_nop 1
    v_permlane16_swap_b32 v236, v238
    v_permlane16_swap_b32 v237, v239
    buffer_store_dwordx4 v[236:239], v4, s[48:51], s10 offen offset:3072 sc1
    s_add_u32 s10, s10, 65536
    v_cvt_pk_bf16_f32 v240, v36, v37
    v_cvt_pk_bf16_f32 v241, v38, v39
    v_cvt_pk_bf16_f32 v242, v60, v61
    v_cvt_pk_bf16_f32 v243, v62, v63
    v_xor_b32 v240, s61, v240
    v_xor_b32 v241, s61, v241
    v_xor_b32 v242, s61, v242
    v_xor_b32 v243, s61, v243
    s_nop 1
    v_permlane16_swap_b32 v240, v242
    v_permlane16_swap_b32 v241, v243
    buffer_store_dwordx4 v[240:243], v4, s[48:51], s10 offen offset:0 sc1
    v_cvt_pk_bf16_f32 v244, v84, v85
    v_cvt_pk_bf16_f32 v245, v86, v87
    v_cvt_pk_bf16_f32 v246, v108, v109
    v_cvt_pk_bf16_f32 v247, v110, v111
    v_xor_b32 v244, s61, v244
    v_xor_b32 v245, s61, v245
    v_xor_b32 v246, s61, v246
    v_xor_b32 v247, s61, v247
    s_nop 1
    v_permlane16_swap_b32 v244, v246
    v_permlane16_swap_b32 v245, v247
    buffer_store_dwordx4 v[244:247], v4, s[48:51], s10 offen offset:1024 sc1
    v_cvt_pk_bf16_f32 v248, v132, v133
    v_cvt_pk_bf16_f32 v249, v134, v135
    v_cvt_pk_bf16_f32 v250, v156, v157
    v_cvt_pk_bf16_f32 v251, v158, v159
    v_xor_b32 v248, s61, v248
    v_xor_b32 v249, s61, v249
    v_xor_b32 v250, s61, v250
    v_xor_b32 v251, s61, v251
    s_nop 1
    v_permlane16_swap_b32 v248, v250
    v_permlane16_swap_b32 v249, v251
    buffer_store_dwordx4 v[248:251], v4, s[48:51], s10 offen offset:2048 sc1
    v_cvt_pk_bf16_f32 v252, v180, v181
    v_cvt_pk_bf16_f32 v253, v182, v183
    v_cvt_pk_bf16_f32 v254, v204, v205
    v_cvt_pk_bf16_f32 v255, v206, v207
    v_xor_b32 v252, s61, v252
    v_xor_b32 v253, s61, v253
    v_xor_b32 v254, s61, v254
    v_xor_b32 v255, s61, v255
    s_nop 1
    v_permlane16_swap_b32 v252, v254
    v_permlane16_swap_b32 v253, v255
    buffer_store_dwordx4 v[252:255], v4, s[48:51], s10 offen offset:3072 sc1
    s_add_u32 s10, s10, 65536
    s_waitcnt vmcnt(0)
    s_branch K1_end
K1_help:
    s_add_u32 s52, s36, 25165824
    s_addc_u32 s53, s37, 0
    s_mov_b32 s54, 9437184
    s_mov_b32 s55, 0x20000
    s_bfe_u32 s38, s2, 0x20001
    s_and_b32 s56, s2, 1
    s_lshl_b32 s56, s56, 3
    s_lshr_b32 s59, s2, 5
    s_add_u32 s56, s56, s59
    s_lshl_b32 s56, s56, 2
    s_bfe_u32 s59, s2, 0x20003
    s_add_u32 s56, s56, s59
    s_lshl_b32 s63, s56, 14
    s_add_u32 s63, s63, 8388608
    s_lshl_b32 s59, s38, 10
    s_add_u32 s63, s63, s59
    s_lshl_b32 s56, s56, 17
    s_lshl_b32 s59, s3, 13
    s_add_u32 s56, s56, s59
    s_add_u32 s59, s3, s38
    s_and_b32 s59, s59, 3
    s_lshl_b32 s59, s59, 11
    s_add_u32 s56, s56, s59
    s_mov_b32 s76, s18
    s_mov_b32 s77, s19
    s_mov_b32 s78, 8388608
    s_mov_b32 s79, 0x20000
    s_mov_b32 s72, s20
    s_mov_b32 s73, s21
    s_mov_b32 s74, 8388608
    s_mov_b32 s75, 0x20000
    s_lshl_b32 s57, s9, 13
    s_lshl_b32 s58, s39, 11
    v_lshlrev_b32 v8, 4, v1
    v_mov_b32 v12, -1
    v_mov_b32 v13, -1
    v_mov_b32 v14, -1
    v_mov_b32 v15, -1
    v_lshlrev_b32 v9, 7, v1
    s_mov_b32 s28, s30
    s_mov_b32 s29, s31
    s_mov_b32 s30, 5308416
    s_mov_b32 s31, 0x20000
    s_add_u32 s48, s36, 37748736
    s_addc_u32 s49, s37, 0
    s_mov_b32 s50, 5308416
    s_mov_b32 s51, 0x20000
    s_mul_i32 s10, s3, 40960
    s_mov_b32 s11, s4
    s_sub_u32 s59, s9, 960
    s_lshl_b32 s59, s59, 13
    s_mul_i32 s12, s11, 331776
    s_mul_i32 s13, s3, 288
    s_add_u32 s12, s12, s13
    s_mul_i32 s13, s3, 1296
    s_mul_i32 s14, s11, 9
    s_add_u32 s13, s13, s14
    s_lshl_b32 s13, s13, 10
    v_add_u32 v16, 0, v1
    v_mul_u32_u24 v17, 3641, v16
    v_lshrrev_b32 v17, 16, v17
    v_mul_u32_u24 v18, 18, v17
    v_sub_u32 v18, v16, v18
    v_and_b32 v19, 0x13, v17
    v_and_b32 v16, 4, v17
    v_lshl_or_b32 v19, v16, 1, v19
    v_and_b32 v16, 8, v17
    v_lshrrev_b32 v16, 1, v16
    v_or_b32 v19, v19, v16
    v_mul_u32_u24 v19, 1152, v19
    v_lshl_add_u32 v20, v18, 4, v19
    v_add_u32 v16, 64, v1
    v_mul_u32_u24 v17, 3641, v16
    v_lshrrev_b32 v17, 16, v17
    v_mul_u32_u24 v18, 18, v17
    v_sub_u32 v18, v16, v18
    v_and_b32 v19, 0x13, v17
    v_and_b32 v16, 4, v17
    v_lshl_or_b32 v19, v16, 1, v19
    v_and_b32 v16, 8, v17
    v_lshrrev_b32 v16, 1, v16
    v_or_b32 v19, v19, v16
    v_mul_u32_u24 v19, 1152, v19
    v_lshl_add_u32 v21, v18, 4, v19
    v_add_u32 v16, 128, v1
    v_mul_u32_u24 v17, 3641, v16
    v_lshrrev_b32 v17, 16, v17
    v_mul_u32_u24 v18, 18, v17
    v_sub_u32 v18, v16, v18
    v_and_b32 v19, 0x13, v17
    v_and_b32 v16, 4, v17
    v_lshl_or_b32 v19, v16, 1, v19
    v_and_b32 v16, 8, v17
    v_lshrrev_b32 v16, 1, v16
    v_or_b32 v19, v19, v16
    v_mul_u32_u24 v19, 1152, v19
    v_lshl_add_u32 v22, v18, 4, v19
    v_add_u32 v16, 192, v1
    v_mul_u32_u24 v17, 3641, v16
    v_lshrrev_b32 v17, 16, v17
    v_mul_u32_u24 v18, 18, v17
    v_sub_u32 v18, v16, v18
    v_and_b32 v19, 0x13, v17
    v_and_b32 v16, 4, v17
    v_lshl_or_b32 v19, v16, 1, v19
    v_and_b32 v16, 8, v17
    v_lshrrev_b32 v16, 1, v16
    v_or_b32 v19, v19, v16
    v_mul_u32_u24 v19, 1152, v19
    v_lshl_add_u32 v23, v18, 4, v19
    v_add_u32 v16, 256, v1
    v_mul_u32_u24 v17, 3641, v16
    v_lshrrev_b32 v17, 16, v17
    v_mul_u32_u24 v18, 18, v17
    v_sub_u32 v18, v16, v18
    v_and_b32 v19, 0x13, v17
    v_and_b32 v16, 4, v17
    v_lshl_or_b32 v19, v16, 1, v19
    v_and_b32 v16, 8, v17
    v_lshrrev_b32 v16, 1, v16
    v_or_b32 v19, v19, v16
    v_mul_u32_u24 v19, 1152, v19
    v_lshl_add_u32 v24, v18, 4, v19
    v_add_u32 v16, 320, v1
    v_mul_u32_u24 v17, 3641, v16
    v_lshrrev_b32 v17, 16, v17
    v_mul_u32_u24 v18, 18, v17
    v_sub_u32 v18, v16, v18
    v_and_b32 v19, 0x13, v17
    v_and_b32 v16, 4, v17
    v_lshl_or_b32 v19, v16, 1, v19
    v_and_b32 v16, 8, v17
    v_lshrrev_b32 v16, 1, v16
    v_or_b32 v19, v19, v16
    v_mul_u32_u24 v19, 1152, v19
    v_lshl_add_u32 v25, v18, 4, v19
    v_add_u32 v16, 384, v1
    v_mul_u32_u24 v17, 3641, v16
    v_lshrrev_b32 v17, 16, v17
    v_mul_u32_u24 v18, 18, v17
    v_sub_u32 v18, v16, v18
    v_and_b32 v19, 0x13, v17
    v_and_b32 v16, 4, v17
    v_lshl_or_b32 v19, v16, 1, v19
    v_and_b32 v16, 8, v17
    v_lshrrev_b32 v16, 1, v16
    v_or_b32 v19, v19, v16
    v_mul_u32_u24 v19, 1152, v19
    v_lshl_add_u32 v26, v18, 4, v19
    v_add_u32 v16, 448, v1
    v_mul_u32_u24 v17, 3641, v16
    v_lshrrev_b32 v17, 16, v17
    v_mul_u32_u24 v18, 18, v17
    v_sub_u32 v18, v16, v18
    v_and_b32 v19, 0x13, v17
    v_and_b32 v16, 4, v17
    v_lshl_or_b32 v19, v16, 1, v19
    v_and_b32 v16, 8, v17
    v_lshrrev_b32 v16, 1, v16
    v_or_b32 v19, v19, v16
    v_mul_u32_u24 v19, 1152, v19
    v_lshl_add_u32 v27, v18, 4, v19
    v_add_u32 v16, 512, v1
    v_mul_u32_u24 v17, 3641, v16
    v_lshrrev_b32 v17, 16, v17
    v_mul_u32_u24 v18, 18, v17
    v_sub_u32 v18, v16, v18
    v_and_b32 v19, 0x13, v17
    v_and_b32 v16, 4, v17
    v_lshl_or_b32 v19, v16, 1, v19
    v_and_b32 v16, 8, v17
    v_lshrrev_b32 v16, 1, v16
    v_or_b32 v19, v19, v16
    v_mul_u32_u24 v19, 1152, v19
    v_lshl_add_u32 v28, v18, 4, v19
    v_lshrrev_b32 v16, 1, v3
    v_lshlrev_b32 v16, 4, v16
    v_and_b32 v17, 1, v3
    v_lshl_add_u32 v16, v17, 2, v16
    v_lshrrev_b32 v17, 2, v2
    v_add_u32 v16, v16, v17
    v_mul_u32_u24 v16, 288, v16
    v_and_b32 v17, 3, v1
    v_lshl_add_u32 v16, v17, 3, v16
    v_add_u32 v29, s10, v16
    s_add_u32 m0, s10, 0
    s_add_u32 s14, s12, 0
    buffer_load_dwordx4 v20, s[28:31], s14 offen lds
    s_add_u32 m0, s10, 1024
    s_add_u32 s14, s12, 0
    buffer_load_dwordx4 v21, s[28:31], s14 offen lds
    s_add_u32 m0, s10, 2048
    s_add_u32 s14, s12, 0
    buffer_load_dwordx4 v22, s[28:31], s14 offen lds
    s_add_u32 m0, s10, 3072
    s_add_u32 s14, s12, 0
    buffer_load_dwordx4 v23, s[28:31], s14 offen lds
    s_add_u32 m0, s10, 4096
    s_add_u32 s14, s12, 0
    buffer_load_dwordx4 v24, s[28:31], s14 offen lds
    s_add_u32 m0, s10, 5120
    s_add_u32 s14, s12, 0
    buffer_load_dwordx4 v25, s[28:31], s14 offen lds
    s_add_u32 m0, s10, 6144
    s_add_u32 s14, s12, 0
    buffer_load_dwordx4 v26, s[28:31], s14 offen lds
    s_add_u32 m0, s10, 7168
    s_add_u32 s14, s12, 0
    buffer_load_dwordx4 v27, s[28:31], s14 offen lds
    s_add_u32 m0, s10, 8192
    s_add_u32 s14, s12, 0
    buffer_load_dwordx4 v28, s[28:31], s14 offen lds
    s_add_u32 m0, s10, 9216
    s_add_u32 s14, s12, 36864
    buffer_load_dwordx4 v20, s[28:31], s14 offen lds
    s_add_u32 m0, s10, 10240
    s_add_u32 s14, s12, 36864
    buffer_load_dwordx4 v21, s[28:31], s14 offen lds
    s_add_u32 m0, s10, 11264
    s_add_u32 s14, s12, 36864
    buffer_load_dwordx4 v22, s[28:31], s14 offen lds
    s_add_u32 m0, s10, 12288
    s_add_u32 s14, s12, 36864
    buffer_load_dwordx4 v23, s[28:31], s14 offen lds
    s_add_u32 m0, s10, 13312
    s_add_u32 s14, s12, 36864
    buffer_load_dwordx4 v24, s[28:31], s14 offen lds
    s_add_u32 m0, s10, 14336
    s_add_u32 s14, s12, 36864
    buffer_load_dwordx4 v25, s[28:31], s14 offen lds
    s_add_u32 m0, s10, 15360
    s_add_u32 s14, s12, 36864
    buffer_load_dwordx4 v26, s[28:31], s14 offen lds
    s_add_u32 m0, s10, 16384
    s_add_u32 s14, s12, 36864
    buffer_load_dwordx4 v27, s[28:31], s14 offen lds
    s_add_u32 m0, s10, 17408
    s_add_u32 s14, s12, 36864
    buffer_load_dwordx4 v28, s[28:31], s14 offen lds
    s_add_u32 m0, s10, 18432
    s_add_u32 s14, s12, 73728
    buffer_load_dwordx4 v20, s[28:31], s14 offen lds
    s_add_u32 m0, s10, 19456
    s_add_u32 s14, s12, 73728
    buffer_load_dwordx4 v21, s[28:31], s14 offen lds
    s_add_u32 m0, s10, 20480
    s_add_u32 s14, s12, 73728
    buffer_load_dwordx4 v22, s[28:31], s14 offen lds
    s_add_u32 m0, s10, 21504
    s_add_u32 s14, s12, 73728
    buffer_load_dwordx4 v23, s[28:31], s14 offen lds
    s_add_u32 m0, s10, 22528
    s_add_u32 s14, s12, 73728
    buffer_load_dwordx4 v24, s[28:31], s14 offen lds
    s_add_u32 m0, s10, 23552
    s_add_u32 s14, s12, 73728
    buffer_load_dwordx4 v25, s[28:31], s14 offen lds
    s_add_u32 m0, s10, 24576
    s_add_u32 s14, s12, 73728
    buffer_load_dwordx4 v26, s[28:31], s14 offen lds
    s_add_u32 m0, s10, 25600
    s_add_u32 s14, s12, 73728
    buffer_load_dwordx4 v27, s[28:31], s14 offen lds
    s_add_u32 m0, s10, 26624
    s_add_u32 s14, s12, 73728
    buffer_load_dwordx4 v28, s[28:31], s14 offen lds
    s_waitcnt vmcnt(18)
    ds_read_b64_tr_b16 v[32:33], v29 offset:0
    ds_read_b64_tr_b16 v[34:35], v29 offset:2304
    ds_read_b64_tr_b16 v[36:37], v29 offset:32
    ds_read_b64_tr_b16 v[38:39], v29 offset:2336
    ds_read_b64_tr_b16 v[40:41], v29 offset:64
    ds_read_b64_tr_b16 v[42:43], v29 offset:2368
    ds_read_b64_tr_b16 v[44:45], v29 offset:96
    ds_read_b64_tr_b16 v[46:47], v29 offset:2400
    ds_read_b64_tr_b16 v[48:49], v29 offset:128
    ds_read_b64_tr_b16 v[50:51], v29 offset:2432
    ds_read_b64_tr_b16 v[52:53], v29 offset:160
    ds_read_b64_tr_b16 v[54:55], v29 offset:2464
    ds_read_b64_tr_b16 v[56:57], v29 offset:192
    ds_read_b64_tr_b16 v[58:59], v29 offset:2496
    ds_read_b64_tr_b16 v[60:61], v29 offset:224
    ds_read_b64_tr_b16 v[62:63], v29 offset:2528
    ds_read_b64_tr_b16 v[64:65], v29 offset:256
    ds_read_b64_tr_b16 v[66:67], v29 offset:2560
    s_waitcnt lgkmcnt(15)
    s_add_u32 s14, s13, 0
    buffer_store_dwordx4 v[32:35], v8, s[48:51], s14 offen sc1
    s_waitcnt lgkmcnt(14)
    s_add_u32 s14, s13, 147456
    buffer_store_dwordx4 v[36:39], v8, s[48:51], s14 offen sc1
    s_waitcnt lgkmcnt(12)
    s_add_u32 s14, s13, 294912
    buffer_store_dwordx4 v[40:43], v8, s[48:51], s14 offen sc1
    s_waitcnt lgkmcnt(10)
    s_add_u32 s14, s13, 442368
    buffer_store_dwordx4 v[44:47], v8, s[48:51], s14 offen sc1
    s_waitcnt lgkmcnt(8)
    s_add_u32 s14, s13, 589824
    buffer_store_dwordx4 v[48:51], v8, s[48:51], s14 offen sc1
    s_waitcnt lgkmcnt(6)
    s_add_u32 s14, s13, 737280
    buffer_store_dwordx4 v[52:55], v8, s[48:51], s14 offen sc1
    s_waitcnt lgkmcnt(4)
    s_add_u32 s14, s13, 884736
    buffer_store_dwordx4 v[56:59], v8, s[48:51], s14 offen sc1
    s_waitcnt lgkmcnt(2)
    s_add_u32 s14, s13, 1032192
    buffer_store_dwordx4 v[60:63], v8, s[48:51], s14 offen sc1
    s_waitcnt lgkmcnt(0)
    s_add_u32 s14, s13, 1179648
    buffer_store_dwordx4 v[64:67], v8, s[48:51], s14 offen sc1
    s_add_u32 m0, s10, 27648
    s_add_u32 s14, s12, 110592
    buffer_load_dwordx4 v20, s[28:31], s14 offen lds
    s_add_u32 m0, s10, 28672
    s_add_u32 s14, s12, 110592
    buffer_load_dwordx4 v21, s[28:31], s14 offen lds
    s_add_u32 m0, s10, 29696
    s_add_u32 s14, s12, 110592
    buffer_load_dwordx4 v22, s[28:31], s14 offen lds
    s_add_u32 m0, s10, 30720
    s_add_u32 s14, s12, 110592
    buffer_load_dwordx4 v23, s[28:31], s14 offen lds
    s_add_u32 m0, s10, 31744
    s_add_u32 s14, s12, 110592
    buffer_load_dwordx4 v24, s[28:31], s14 offen lds
    s_add_u32 m0, s10, 32768
    s_add_u32 s14, s12, 110592
    buffer_load_dwordx4 v25, s[28:31], s14 offen lds
    s_add_u32 m0, s10, 33792
    s_add_u32 s14, s12, 110592
    buffer_load_dwordx4 v26, s[28:31], s14 offen lds
    s_add_u32 m0, s10, 34816
    s_add_u32 s14, s12, 110592
    buffer_load_dwordx4 v27, s[28:31], s14 offen lds
    s_add_u32 m0, s10, 35840
    s_add_u32 s14, s12, 110592
    buffer_load_dwordx4 v28, s[28:31], s14 offen lds
    s_waitcnt vmcnt(27)
    ds_read_b64_tr_b16 v[68:69], v29 offset:9216
    ds_read_b64_tr_b16 v[70:71], v29 offset:11520
    ds_read_b64_tr_b16 v[72:73], v29 offset:9248
    ds_read_b64_tr_b16 v[74:75], v29 offset:11552
    ds_read_b64_tr_b16 v[76:77], v29 offset:9280
    ds_read_b64_tr_b16 v[78:79], v29 offset:11584
    ds_read_b64_tr_b16 v[80:81], v29 offset:9312
    ds_read_b64_tr_b16 v[82:83], v29 offset:11616
    ds_read_b64_tr_b16 v[84:85], v29 offset:9344
    ds_read_b64_tr_b16 v[86:87], v29 offset:11648
    ds_read_b64_tr_b16 v[88:89], v29 offset:9376
    ds_read_b64_tr_b16 v[90:91], v29 offset:11680
    ds_read_b64_tr_b16 v[92:93], v29 offset:9408
    ds_read_b64_tr_b16 v[94:95], v29 offset:11712
    ds_read_b64_tr_b16 v[96:97], v29 offset:9440
    ds_read_b64_tr_b16 v[98:99], v29 offset:11744
    ds_read_b64_tr_b16 v[100:101], v29 offset:9472
    ds_read_b64_tr_b16 v[102:103], v29 offset:11776
    s_waitcnt lgkmcnt(15)
    s_add_u32 s14, s13, 1024
    buffer_store_dwordx4 v[68:71], v8, s[48:51], s14 offen sc1
    s_waitcnt lgkmcnt(14)
    s_add_u32 s14, s13, 148480
    buffer_store_dwordx4 v[72:75], v8, s[48:51], s14 offen sc1
    s_waitcnt lgkmcnt(12)
    s_add_u32 s14, s13, 295936
    buffer_store_dwordx4 v[76:79], v8, s[48:51], s14 offen sc1
    s_waitcnt lgkmcnt(10)
    s_add_u32 s14, s13, 443392
    buffer_store_dwordx4 v[80:83], v8, s[48:51], s14 offen sc1
    s_waitcnt lgkmcnt(8)
    s_add_u32 s14, s13, 590848
    buffer_store_dwordx4 v[84:87], v8, s[48:51], s14 offen sc1
    s_waitcnt lgkmcnt(6)
    s_add_u32 s14, s13, 738304
    buffer_store_dwordx4 v[88:91], v8, s[48:51], s14 offen sc1
    s_waitcnt lgkmcnt(4)
    s_add_u32 s14, s13, 885760
    buffer_store_dwordx4 v[92:95], v8, s[48:51], s14 offen sc1
    s_waitcnt lgkmcnt(2)
    s_add_u32 s14, s13, 1033216
    buffer_store_dwordx4 v[96:99], v8, s[48:51], s14 offen sc1
    s_waitcnt lgkmcnt(0)
    s_add_u32 s14, s13, 1180672
    buffer_store_dwordx4 v[100:103], v8, s[48:51], s14 offen sc1
    s_add_u32 m0, s10, 0
    s_add_u32 s14, s12, 147456
    buffer_load_dwordx4 v20, s[28:31], s14 offen lds
    s_add_u32 m0, s10, 1024
    s_add_u32 s14, s12, 147456
    buffer_load_dwordx4 v21, s[28:31], s14 offen lds
    s_add_u32 m0, s10, 2048
    s_add_u32 s14, s12, 147456
    buffer_load_dwordx4 v22, s[28:31], s14 offen lds
    s_add_u32 m0, s10, 3072
    s_add_u32 s14, s12, 147456
    buffer_load_dwordx4 v23, s[28:31], s14 offen lds
    s_add_u32 m0, s10, 4096
    s_add_u32 s14, s12, 147456
    buffer_load_dwordx4 v24, s[28:31], s14 offen lds
    s_add_u32 m0, s10, 5120
    s_add_u32 s14, s12, 147456
    buffer_load_dwordx4 v25, s[28:31], s14 offen lds
    s_add_u32 m0, s10, 6144
    s_add_u32 s14, s12, 147456
    buffer_load_dwordx4 v26, s[28:31], s14 offen lds
    s_add_u32 m0, s10, 7168
    s_add_u32 s14, s12, 147456
    buffer_load_dwordx4 v27, s[28:31], s14 offen lds
    s_add_u32 m0, s10, 8192
    s_add_u32 s14, s12, 147456
    buffer_load_dwordx4 v28, s[28:31], s14 offen lds
    s_waitcnt vmcnt(36)
    ds_read_b64_tr_b16 v[32:33], v29 offset:18432
    ds_read_b64_tr_b16 v[34:35], v29 offset:20736
    ds_read_b64_tr_b16 v[36:37], v29 offset:18464
    ds_read_b64_tr_b16 v[38:39], v29 offset:20768
    ds_read_b64_tr_b16 v[40:41], v29 offset:18496
    ds_read_b64_tr_b16 v[42:43], v29 offset:20800
    ds_read_b64_tr_b16 v[44:45], v29 offset:18528
    ds_read_b64_tr_b16 v[46:47], v29 offset:20832
    ds_read_b64_tr_b16 v[48:49], v29 offset:18560
    ds_read_b64_tr_b16 v[50:51], v29 offset:20864
    ds_read_b64_tr_b16 v[52:53], v29 offset:18592
    ds_read_b64_tr_b16 v[54:55], v29 offset:20896
    ds_read_b64_tr_b16 v[56:57], v29 offset:18624
    ds_read_b64_tr_b16 v[58:59], v29 offset:20928
    ds_read_b64_tr_b16 v[60:61], v29 offset:18656
    ds_read_b64_tr_b16 v[62:63], v29 offset:20960
    ds_read_b64_tr_b16 v[64:65], v29 offset:18688
    ds_read_b64_tr_b16 v[66:67], v29 offset:20992
    s_waitcnt lgkmcnt(15)
    s_add_u32 s14, s13, 2048
    buffer_store_dwordx4 v[32:35], v8, s[48:51], s14 offen sc1
    s_waitcnt lgkmcnt(14)
    s_add_u32 s14, s13, 149504
    buffer_store_dwordx4 v[36:39], v8, s[48:51], s14 offen sc1
    s_waitcnt lgkmcnt(12)
    s_add_u32 s14, s13, 296960
    buffer_store_dwordx4 v[40:43], v8, s[48:51], s14 offen sc1
    s_waitcnt lgkmcnt(10)
    s_add_u32 s14, s13, 444416
    buffer_store_dwordx4 v[44:47], v8, s[48:51], s14 offen sc1
    s_waitcnt lgkmcnt(8)
    s_add_u32 s14, s13, 591872
    buffer_store_dwordx4 v[48:51], v8, s[48:51], s14 offen sc1
    s_waitcnt lgkmcnt(6)
    s_add_u32 s14, s13, 739328
    buffer_store_dwordx4 v[52:55], v8, s[48:51], s14 offen sc1
    s_waitcnt lgkmcnt(4)
    s_add_u32 s14, s13, 886784
    buffer_store_dwordx4 v[56:59], v8, s[48:51], s14 offen sc1
    s_waitcnt lgkmcnt(2)
    s_add_u32 s14, s13, 1034240
    buffer_store_dwordx4 v[60:63], v8, s[48:51], s14 offen sc1
    s_waitcnt lgkmcnt(0)
    s_add_u32 s14, s13, 1181696
    buffer_store_dwordx4 v[64:67], v8, s[48:51], s14 offen sc1
    s_add_u32 m0, s10, 9216
    s_add_u32 s14, s12, 184320
    buffer_load_dwordx4 v20, s[28:31], s14 offen lds
    s_add_u32 m0, s10, 10240
    s_add_u32 s14, s12, 184320
    buffer_load_dwordx4 v21, s[28:31], s14 offen lds
    s_add_u32 m0, s10, 11264
    s_add_u32 s14, s12, 184320
    buffer_load_dwordx4 v22, s[28:31], s14 offen lds
    s_add_u32 m0, s10, 12288
    s_add_u32 s14, s12, 184320
    buffer_load_dwordx4 v23, s[28:31], s14 offen lds
    s_add_u32 m0, s10, 13312
    s_add_u32 s14, s12, 184320
    buffer_load_dwordx4 v24, s[28:31], s14 offen lds
    s_add_u32 m0, s10, 14336
    s_add_u32 s14, s12, 184320
    buffer_load_dwordx4 v25, s[28:31], s14 offen lds
    s_add_u32 m0, s10, 15360
    s_add_u32 s14, s12, 184320
    buffer_load_dwordx4 v26, s[28:31], s14 offen lds
    s_add_u32 m0, s10, 16384
    s_add_u32 s14, s12, 184320
    buffer_load_dwordx4 v27, s[28:31], s14 offen lds
    s_add_u32 m0, s10, 17408
    s_add_u32 s14, s12, 184320
    buffer_load_dwordx4 v28, s[28:31], s14 offen lds
    s_waitcnt vmcnt(36)
    ds_read_b64_tr_b16 v[68:69], v29 offset:27648
    ds_read_b64_tr_b16 v[70:71], v29 offset:29952
    ds_read_b64_tr_b16 v[72:73], v29 offset:27680
    ds_read_b64_tr_b16 v[74:75], v29 offset:29984
    ds_read_b64_tr_b16 v[76:77], v29 offset:27712
    ds_read_b64_tr_b16 v[78:79], v29 offset:30016
    ds_read_b64_tr_b16 v[80:81], v29 offset:27744
    ds_read_b64_tr_b16 v[82:83], v29 offset:30048
    ds_read_b64_tr_b16 v[84:85], v29 offset:27776
    ds_read_b64_tr_b16 v[86:87], v29 offset:30080
    ds_read_b64_tr_b16 v[88:89], v29 offset:27808
    ds_read_b64_tr_b16 v[90:91], v29 offset:30112
    ds_read_b64_tr_b16 v[92:93], v29 offset:27840
    ds_read_b64_tr_b16 v[94:95], v29 offset:30144
    ds_read_b64_tr_b16 v[96:97], v29 offset:27872
    ds_read_b64_tr_b16 v[98:99], v29 offset:30176
    ds_read_b64_tr_b16 v[100:101], v29 offset:27904
    ds_read_b64_tr_b16 v[102:103], v29 offset:30208
    s_waitcnt lgkmcnt(15)
    s_add_u32 s14, s13, 3072
    buffer_store_dwordx4 v[68:71], v8, s[48:51], s14 offen sc1
    s_waitcnt lgkmcnt(14)
    s_add_u32 s14, s13, 150528
    buffer_store_dwordx4 v[72:75], v8, s[48:51], s14 offen sc1
    s_waitcnt lgkmcnt(12)
    s_add_u32 s14, s13, 297984
    buffer_store_dwordx4 v[76:79], v8, s[48:51], s14 offen sc1
    s_waitcnt lgkmcnt(10)
    s_add_u32 s14, s13, 445440
    buffer_store_dwordx4 v[80:83], v8, s[48:51], s14 offen sc1
    s_waitcnt lgkmcnt(8)
    s_add_u32 s14, s13, 592896
    buffer_store_dwordx4 v[84:87], v8, s[48:51], s14 offen sc1
    s_waitcnt lgkmcnt(6)
    s_add_u32 s14, s13, 740352
    buffer_store_dwordx4 v[88:91], v8, s[48:51], s14 offen sc1
    s_waitcnt lgkmcnt(4)
    s_add_u32 s14, s13, 887808
    buffer_store_dwordx4 v[92:95], v8, s[48:51], s14 offen sc1
    s_waitcnt lgkmcnt(2)
    s_add_u32 s14, s13, 1035264
    buffer_store_dwordx4 v[96:99], v8, s[48:51], s14 offen sc1
    s_waitcnt lgkmcnt(0)
    s_add_u32 s14, s13, 1182720
    buffer_store_dwordx4 v[100:103], v8, s[48:51], s14 offen sc1
    s_add_u32 m0, s10, 18432
    s_add_u32 s14, s12, 221184
    buffer_load_dwordx4 v20, s[28:31], s14 offen lds
    s_add_u32 m0, s10, 19456
    s_add_u32 s14, s12, 221184
    buffer_load_dwordx4 v21, s[28:31], s14 offen lds
    s_add_u32 m0, s10, 20480
    s_add_u32 s14, s12, 221184
    buffer_load_dwordx4 v22, s[28:31], s14 offen lds
    s_add_u32 m0, s10, 21504
    s_add_u32 s14, s12, 221184
    buffer_load_dwordx4 v23, s[28:31], s14 offen lds
    s_add_u32 m0, s10, 22528
    s_add_u32 s14, s12, 221184
    buffer_load_dwordx4 v24, s[28:31], s14 offen lds
    s_add_u32 m0, s10, 23552
    s_add_u32 s14, s12, 221184
    buffer_load_dwordx4 v25, s[28:31], s14 offen lds
    s_add_u32 m0, s10, 24576
    s_add_u32 s14, s12, 221184
    buffer_load_dwordx4 v26, s[28:31], s14 offen lds
    s_add_u32 m0, s10, 25600
    s_add_u32 s14, s12, 221184
    buffer_load_dwordx4 v27, s[28:31], s14 offen lds
    s_add_u32 m0, s10, 26624
    s_add_u32 s14, s12, 221184
    buffer_load_dwordx4 v28, s[28:31], s14 offen lds
    s_waitcnt vmcnt(36)
    ds_read_b64_tr_b16 v[32:33], v29 offset:0
    ds_read_b64_tr_b16 v[34:35], v29 offset:2304
    ds_read_b64_tr_b16 v[36:37], v29 offset:32
    ds_read_b64_tr_b16 v[38:39], v29 offset:2336
    ds_read_b64_tr_b16 v[40:41], v29 offset:64
    ds_read_b64_tr_b16 v[42:43], v29 offset:2368
    ds_read_b64_tr_b16 v[44:45], v29 offset:96
    ds_read_b64_tr_b16 v[46:47], v29 offset:2400
    ds_read_b64_tr_b16 v[48:49], v29 offset:128
    ds_read_b64_tr_b16 v[50:51], v29 offset:2432
    ds_read_b64_tr_b16 v[52:53], v29 offset:160
    ds_read_b64_tr_b16 v[54:55], v29 offset:2464
    ds_read_b64_tr_b16 v[56:57], v29 offset:192
    ds_read_b64_tr_b16 v[58:59], v29 offset:2496
    ds_read_b64_tr_b16 v[60:61], v29 offset:224
    ds_read_b64_tr_b16 v[62:63], v29 offset:2528
    ds_read_b64_tr_b16 v[64:65], v29 offset:256
    ds_read_b64_tr_b16 v[66:67], v29 offset:2560
    s_waitcnt lgkmcnt(15)
    s_add_u32 s14, s13, 4096
    buffer_store_dwordx4 v[32:35], v8, s[48:51], s14 offen sc1
    s_waitcnt lgkmcnt(14)
    s_add_u32 s14, s13, 151552
    buffer_store_dwordx4 v[36:39], v8, s[48:51], s14 offen sc1
    s_waitcnt lgkmcnt(12)
    s_add_u32 s14, s13, 299008
    buffer_store_dwordx4 v[40:43], v8, s[48:51], s14 offen sc1
    s_waitcnt lgkmcnt(10)
    s_add_u32 s14, s13, 446464
    buffer_store_dwordx4 v[44:47], v8, s[48:51], s14 offen sc1
    s_waitcnt lgkmcnt(8)
    s_add_u32 s14, s13, 593920
    buffer_store_dwordx4 v[48:51], v8, s[48:51], s14 offen sc1
    s_waitcnt lgkmcnt(6)
    s_add_u32 s14, s13, 741376
    buffer_store_dwordx4 v[52:55], v8, s[48:51], s14 offen sc1
    s_waitcnt lgkmcnt(4)
    s_add_u32 s14, s13, 888832
    buffer_store_dwordx4 v[56:59], v8, s[48:51], s14 offen sc1
    s_waitcnt lgkmcnt(2)
    s_add_u32 s14, s13, 1036288
    buffer_store_dwordx4 v[60:63], v8, s[48:51], s14 offen sc1
    s_waitcnt lgkmcnt(0)
    s_add_u32 s14, s13, 1183744
    buffer_store_dwordx4 v[64:67], v8, s[48:51], s14 offen sc1
    s_add_u32 m0, s10, 27648
    s_add_u32 s14, s12, 258048
    buffer_load_dwordx4 v20, s[28:31], s14 offen lds
    s_add_u32 m0, s10, 28672
    s_add_u32 s14, s12, 258048
    buffer_load_dwordx4 v21, s[28:31], s14 offen lds
    s_add_u32 m0, s10, 29696
    s_add_u32 s14, s12, 258048
    buffer_load_dwordx4 v22, s[28:31], s14 offen lds
    s_add_u32 m0, s10, 30720
    s_add_u32 s14, s12, 258048
    buffer_load_dwordx4 v23, s[28:31], s14 offen lds
    s_add_u32 m0, s10, 31744
    s_add_u32 s14, s12, 258048
    buffer_load_dwordx4 v24, s[28:31], s14 offen lds
    s_add_u32 m0, s10, 32768
    s_add_u32 s14, s12, 258048
    buffer_load_dwordx4 v25, s[28:31], s14 offen lds
    s_add_u32 m0, s10, 33792
    s_add_u32 s14, s12, 258048
    buffer_load_dwordx4 v26, s[28:31], s14 offen lds
    s_add_u32 m0, s10, 34816
    s_add_u32 s14, s12, 258048
    buffer_load_dwordx4 v27, s[28:31], s14 offen lds
    s_add_u32 m0, s10, 35840
    s_add_u32 s14, s12, 258048
    buffer_load_dwordx4 v28, s[28:31], s14 offen lds
    s_waitcnt vmcnt(36)
    ds_read_b64_tr_b16 v[68:69], v29 offset:9216
    ds_read_b64_tr_b16 v[70:71], v29 offset:11520
    ds_read_b64_tr_b16 v[72:73], v29 offset:9248
    ds_read_b64_tr_b16 v[74:75], v29 offset:11552
    ds_read_b64_tr_b16 v[76:77], v29 offset:9280
    ds_read_b64_tr_b16 v[78:79], v29 offset:11584
    ds_read_b64_tr_b16 v[80:81], v29 offset:9312
    ds_read_b64_tr_b16 v[82:83], v29 offset:11616
    ds_read_b64_tr_b16 v[84:85], v29 offset:9344
    ds_read_b64_tr_b16 v[86:87], v29 offset:11648
    ds_read_b64_tr_b16 v[88:89], v29 offset:9376
    ds_read_b64_tr_b16 v[90:91], v29 offset:11680
    ds_read_b64_tr_b16 v[92:93], v29 offset:9408
    ds_read_b64_tr_b16 v[94:95], v29 offset:11712
    ds_read_b64_tr_b16 v[96:97], v29 offset:9440
    ds_read_b64_tr_b16 v[98:99], v29 offset:11744
    ds_read_b64_tr_b16 v[100:101], v29 offset:9472
    ds_read_b64_tr_b16 v[102:103], v29 offset:11776
    s_waitcnt lgkmcnt(15)
    s_add_u32 s14, s13, 5120
    buffer_store_dwordx4 v[68:71], v8, s[48:51], s14 offen sc1
    s_waitcnt lgkmcnt(14)
    s_add_u32 s14, s13, 152576
    buffer_store_dwordx4 v[72:75], v8, s[48:51], s14 offen sc1
    s_waitcnt lgkmcnt(12)
    s_add_u32 s14, s13, 300032
    buffer_store_dwordx4 v[76:79], v8, s[48:51], s14 offen sc1
    s_waitcnt lgkmcnt(10)
    s_add_u32 s14, s13, 447488
    buffer_store_dwordx4 v[80:83], v8, s[48:51], s14 offen sc1
    s_waitcnt lgkmcnt(8)
    s_add_u32 s14, s13, 594944
    buffer_store_dwordx4 v[84:87], v8, s[48:51], s14 offen sc1
    s_waitcnt lgkmcnt(6)
    s_add_u32 s14, s13, 742400
    buffer_store_dwordx4 v[88:91], v8, s[48:51], s14 offen sc1
    s_waitcnt lgkmcnt(4)
    s_add_u32 s14, s13, 889856
    buffer_store_dwordx4 v[92:95], v8, s[48:51], s14 offen sc1
    s_waitcnt lgkmcnt(2)
    s_add_u32 s14, s13, 1037312
    buffer_store_dwordx4 v[96:99], v8, s[48:51], s14 offen sc1
    s_waitcnt lgkmcnt(0)
    s_add_u32 s14, s13, 1184768
    buffer_store_dwordx4 v[100:103], v8, s[48:51], s14 offen sc1
    s_add_u32 m0, s10, 0
    s_add_u32 s14, s12, 294912
    buffer_load_dwordx4 v20, s[28:31], s14 offen lds
    s_add_u32 m0, s10, 1024
    s_add_u32 s14, s12, 294912
    buffer_load_dwordx4 v21, s[28:31], s14 offen lds
    s_add_u32 m0, s10, 2048
    s_add_u32 s14, s12, 294912
    buffer_load_dwordx4 v22, s[28:31], s14 offen lds
    s_add_u32 m0, s10, 3072
    s_add_u32 s14, s12, 294912
    buffer_load_dwordx4 v23, s[28:31], s14 offen lds
    s_add_u32 m0, s10, 4096
    s_add_u32 s14, s12, 294912
    buffer_load_dwordx4 v24, s[28:31], s14 offen lds
    s_add_u32 m0, s10, 5120
    s_add_u32 s14, s12, 294912
    buffer_load_dwordx4 v25, s[28:31], s14 offen lds
    s_add_u32 m0, s10, 6144
    s_add_u32 s14, s12, 294912
    buffer_load_dwordx4 v26, s[28:31], s14 offen lds
    s_add_u32 m0, s10, 7168
    s_add_u32 s14, s12, 294912
    buffer_load_dwordx4 v27, s[28:31], s14 offen lds
    s_add_u32 m0, s10, 8192
    s_add_u32 s14, s12, 294912
    buffer_load_dwordx4 v28, s[28:31], s14 offen lds
    s_waitcnt vmcnt(36)
    ds_read_b64_tr_b16 v[32:33], v29 offset:18432
    ds_read_b64_tr_b16 v[34:35], v29 offset:20736
    ds_read_b64_tr_b16 v[36:37], v29 offset:18464
    ds_read_b64_tr_b16 v[38:39], v29 offset:20768
    ds_read_b64_tr_b16 v[40:41], v29 offset:18496
    ds_read_b64_tr_b16 v[42:43], v29 offset:20800
    ds_read_b64_tr_b16 v[44:45], v29 offset:18528
    ds_read_b64_tr_b16 v[46:47], v29 offset:20832
    ds_read_b64_tr_b16 v[48:49], v29 offset:18560
    ds_read_b64_tr_b16 v[50:51], v29 offset:20864
    ds_read_b64_tr_b16 v[52:53], v29 offset:18592
    ds_read_b64_tr_b16 v[54:55], v29 offset:20896
    ds_read_b64_tr_b16 v[56:57], v29 offset:18624
    ds_read_b64_tr_b16 v[58:59], v29 offset:20928
    ds_read_b64_tr_b16 v[60:61], v29 offset:18656
    ds_read_b64_tr_b16 v[62:63], v29 offset:20960
    ds_read_b64_tr_b16 v[64:65], v29 offset:18688
    ds_read_b64_tr_b16 v[66:67], v29 offset:20992
    s_waitcnt lgkmcnt(15)
    s_add_u32 s14, s13, 6144
    buffer_store_dwordx4 v[32:35], v8, s[48:51], s14 offen sc1
    s_waitcnt lgkmcnt(14)
    s_add_u32 s14, s13, 153600
    buffer_store_dwordx4 v[36:39], v8, s[48:51], s14 offen sc1
    s_waitcnt lgkmcnt(12)
    s_add_u32 s14, s13, 301056
    buffer_store_dwordx4 v[40:43], v8, s[48:51], s14 offen sc1
    s_waitcnt lgkmcnt(10)
    s_add_u32 s14, s13, 448512
    buffer_store_dwordx4 v[44:47], v8, s[48:51], s14 offen sc1
    s_waitcnt lgkmcnt(8)
    s_add_u32 s14, s13, 595968
    buffer_store_dwordx4 v[48:51], v8, s[48:51], s14 offen sc1
    s_waitcnt lgkmcnt(6)
    s_add_u32 s14, s13, 743424
    buffer_store_dwordx4 v[52:55], v8, s[48:51], s14 offen sc1
    s_waitcnt lgkmcnt(4)
    s_add_u32 s14, s13, 890880
    buffer_store_dwordx4 v[56:59], v8, s[48:51], s14 offen sc1
    s_waitcnt lgkmcnt(2)
    s_add_u32 s14, s13, 1038336
    buffer_store_dwordx4 v[60:63], v8, s[48:51], s14 offen sc1
    s_waitcnt lgkmcnt(0)
    s_add_u32 s14, s13, 1185792
    buffer_store_dwordx4 v[64:67], v8, s[48:51], s14 offen sc1
    s_waitcnt vmcnt(27)
    ds_read_b64_tr_b16 v[68:69], v29 offset:27648
    ds_read_b64_tr_b16 v[70:71], v29 offset:29952
    ds_read_b64_tr_b16 v[72:73], v29 offset:27680
    ds_read_b64_tr_b16 v[74:75], v29 offset:29984
    ds_read_b64_tr_b16 v[76:77], v29 offset:27712
    ds_read_b64_tr_b16 v[78:79], v29 offset:30016
    ds_read_b64_tr_b16 v[80:81], v29 offset:27744
    ds_read_b64_tr_b16 v[82:83], v29 offset:30048
    ds_read_b64_tr_b16 v[84:85], v29 offset:27776
    ds_read_b64_tr_b16 v[86:87], v29 offset:30080
    ds_read_b64_tr_b16 v[88:89], v29 offset:27808
    ds_read_b64_tr_b16 v[90:91], v29 offset:30112
    ds_read_b64_tr_b16 v[92:93], v29 offset:27840
    ds_read_b64_tr_b16 v[94:95], v29 offset:30144
    ds_read_b64_tr_b16 v[96:97], v29 offset:27872
    ds_read_b64_tr_b16 v[98:99], v29 offset:30176
    ds_read_b64_tr_b16 v[100:101], v29 offset:27904
    ds_read_b64_tr_b16 v[102:103], v29 offset:30208
    s_waitcnt lgkmcnt(15)
    s_add_u32 s14, s13, 7168
    buffer_store_dwordx4 v[68:71], v8, s[48:51], s14 offen sc1
    s_waitcnt lgkmcnt(14)
    s_add_u32 s14, s13, 154624
    buffer_store_dwordx4 v[72:75], v8, s[48:51], s14 offen sc1
    s_waitcnt lgkmcnt(12)
    s_add_u32 s14, s13, 302080
    buffer_store_dwordx4 v[76:79], v8, s[48:51], s14 offen sc1
    s_waitcnt lgkmcnt(10)
    s_add_u32 s14, s13, 449536
    buffer_store_dwordx4 v[80:83], v8, s[48:51], s14 offen sc1
    s_waitcnt lgkmcnt(8)
    s_add_u32 s14, s13, 596992
    buffer_store_dwordx4 v[84:87], v8, s[48:51], s14 offen sc1
    s_waitcnt lgkmcnt(6)
    s_add_u32 s14, s13, 744448
    buffer_store_dwordx4 v[88:91], v8, s[48:51], s14 offen sc1
    s_waitcnt lgkmcnt(4)
    s_add_u32 s14, s13, 891904
    buffer_store_dwordx4 v[92:95], v8, s[48:51], s14 offen sc1
    s_waitcnt lgkmcnt(2)
    s_add_u32 s14, s13, 1039360
    buffer_store_dwordx4 v[96:99], v8, s[48:51], s14 offen sc1
    s_waitcnt lgkmcnt(0)
    s_add_u32 s14, s13, 1186816
    buffer_store_dwordx4 v[100:103], v8, s[48:51], s14 offen sc1
    s_waitcnt vmcnt(18)
    ds_read_b64_tr_b16 v[32:33], v29 offset:0
    ds_read_b64_tr_b16 v[34:35], v29 offset:2304
    ds_read_b64_tr_b16 v[36:37], v29 offset:32
    ds_read_b64_tr_b16 v[38:39], v29 offset:2336
    ds_read_b64_tr_b16 v[40:41], v29 offset:64
    ds_read_b64_tr_b16 v[42:43], v29 offset:2368
    ds_read_b64_tr_b16 v[44:45], v29 offset:96
    ds_read_b64_tr_b16 v[46:47], v29 offset:2400
    ds_read_b64_tr_b16 v[48:49], v29 offset:128
    ds_read_b64_tr_b16 v[50:51], v29 offset:2432
    ds_read_b64_tr_b16 v[52:53], v29 offset:160
    ds_read_b64_tr_b16 v[54:55], v29 offset:2464
    ds_read_b64_tr_b16 v[56:57], v29 offset:192
    ds_read_b64_tr_b16 v[58:59], v29 offset:2496
    ds_read_b64_tr_b16 v[60:61], v29 offset:224
    ds_read_b64_tr_b16 v[62:63], v29 offset:2528
    ds_read_b64_tr_b16 v[64:65], v29 offset:256
    ds_read_b64_tr_b16 v[66:67], v29 offset:2560
    s_waitcnt lgkmcnt(15)
    s_add_u32 s14, s13, 8192
    buffer_store_dwordx4 v[32:35], v8, s[48:51], s14 offen sc1
    s_waitcnt lgkmcnt(14)
    s_add_u32 s14, s13, 155648
    buffer_store_dwordx4 v[36:39], v8, s[48:51], s14 offen sc1
    s_waitcnt lgkmcnt(12)
    s_add_u32 s14, s13, 303104
    buffer_store_dwordx4 v[40:43], v8, s[48:51], s14 offen sc1
    s_waitcnt lgkmcnt(10)
    s_add_u32 s14, s13, 450560
    buffer_store_dwordx4 v[44:47], v8, s[48:51], s14 offen sc1
    s_waitcnt lgkmcnt(8)
    s_add_u32 s14, s13, 598016
    buffer_store_dwordx4 v[48:51], v8, s[48:51], s14 offen sc1
    s_waitcnt lgkmcnt(6)
    s_add_u32 s14, s13, 745472
    buffer_store_dwordx4 v[52:55], v8, s[48:51], s14 offen sc1
    s_waitcnt lgkmcnt(4)
    s_add_u32 s14, s13, 892928
    buffer_store_dwordx4 v[56:59], v8, s[48:51], s14 offen sc1
    s_waitcnt lgkmcnt(2)
    s_add_u32 s14, s13, 1040384
    buffer_store_dwordx4 v[60:63], v8, s[48:51], s14 offen sc1
    s_waitcnt lgkmcnt(0)
    s_add_u32 s14, s13, 1187840
    buffer_store_dwordx4 v[64:67], v8, s[48:51], s14 offen sc1
    s_xor_b32 s10, s38, 1
    s_lshl_b32 s10, s10, 15
    s_add_u32 s10, s10, s56
    buffer_store_dwordx4 v[12:15], v8, s[52:55], s10 offen offset:0 sc1
    s_xor_b32 s10, s38, 1
    s_lshl_b32 s10, s10, 15
    s_add_u32 s10, s10, s56
    buffer_store_dwordx4 v[12:15], v8, s[52:55], s10 offen offset:1024 sc1
    s_xor_b32 s10, s38, 1
    s_lshl_b32 s10, s10, 12
    s_add_u32 s10, s10, s63
    buffer_store_dwordx4 v[12:15], v8, s[52:55], s10 offen sc1
    s_xor_b32 s10, s38, 2
    s_lshl_b32 s10, s10, 15
    s_add_u32 s10, s10, s56
    buffer_store_dwordx4 v[12:15], v8, s[52:55], s10 offen offset:0 sc1
    s_xor_b32 s10, s38, 2
    s_lshl_b32 s10, s10, 15
    s_add_u32 s10, s10, s56
    buffer_store_dwordx4 v[12:15], v8, s[52:55], s10 offen offset:1024 sc1
    s_xor_b32 s10, s38, 2
    s_lshl_b32 s10, s10, 12
    s_add_u32 s10, s10, s63
    buffer_store_dwordx4 v[12:15], v8, s[52:55], s10 offen sc1
    s_xor_b32 s10, s38, 3
    s_lshl_b32 s10, s10, 15
    s_add_u32 s10, s10, s56
    buffer_store_dwordx4 v[12:15], v8, s[52:55], s10 offen offset:0 sc1
    s_xor_b32 s10, s38, 3
    s_lshl_b32 s10, s10, 15
    s_add_u32 s10, s10, s56
    buffer_store_dwordx4 v[12:15], v8, s[52:55], s10 offen offset:1024 sc1
    s_xor_b32 s10, s38, 3
    s_lshl_b32 s10, s10, 12
    s_add_u32 s10, s10, s63
    buffer_store_dwordx4 v[12:15], v8, s[52:55], s10 offen sc1
    s_waitcnt vmcnt(0)
K1_end:
    s_endpgm
.globl k2_kernel
.p2align 8
.type k2_kernel,@function
k2_kernel:
    s_cmp_ge_u32 s2, 256
    s_cbranch_scc1 K2_end
    s_load_dwordx16 s[16:31], s[0:1], 0
    s_load_dwordx4 s[32:35], s[0:1], 64
    s_load_dwordx2 s[36:37], s[0:1], 80
    v_lshrrev_b32 v2, 6, v0
    v_and_b32 v1, 63, v0
    v_readfirstlane_b32 s3, v2
    s_mov_b32 s95, 0xffff0000
    s_and_b32 s4, s2, 7
    s_lshr_b32 s5, s2, 3
    s_lshr_b32 s6, s4, 1
    s_and_b32 s4, s4, 1
    s_lshl_b32 s4, s4, 3
    s_lshr_b32 s7, s5, 2
    s_add_u32 s4, s4, s7
    s_and_b32 s5, s5, 3
    s_lshl_b32 s9, s3, 1
    s_add_u32 s8, s3, s6
    s_lshl_b32 s8, s8, 1
    s_mul_i32 s10, s3, 40960
    v_lshlrev_b32 v20, 4, v1
    v_add_u32 v6, s10, v20
    s_add_u32 s12, s3, 1
    s_and_b32 s12, s12, 3
    s_mul_i32 s12, s12, 40960
    v_add_u32 v7, s12, v20
    s_add_u32 s12, s3, 2
    s_and_b32 s12, s12, 3
    s_mul_i32 s12, s12, 40960
    v_add_u32 v8, s12, v20
    s_add_u32 s12, s3, 3
    s_and_b32 s12, s12, 3
    s_mul_i32 s12, s12, 40960
    v_add_u32 v9, s12, v20
    s_cmp_lt_u32 s6, 2
    s_cbranch_scc0 K2_ffn
    v_and_b32 v16, 15, v1
    v_lshrrev_b32 v17, 4, v1
    v_and_b32 v18, 7, v1
    v_lshrrev_b32 v19, 3, v1
    s_and_b32 s11, s4, 7
    s_mov_b32 s11, 0
    v_xor_b32 v21, v18, v19
    v_lshlrev_b32 v21, 4, v21
    v_lshl_add_u32 v21, v19, 12, v21
    s_lshl_b32 s12, s3, 10
    s_lshl_b32 s13, s11, 7
    s_add_u32 s12, s12, s13
    v_add_u32 v2, s12, v21
    v_and_b32 v21, 7, v16
    v_lshrrev_b32 v22, 3, v16
    v_lshlrev_b32 v22, 10, v22
    v_lshl_add_u32 v22, v21, 7, v22
    v_xor_b32 v23, v17, v21
    v_lshl_add_u32 v22, v23, 4, v22
    v_add_u32 v3, s10, v22
    v_xor_b32 v4, 64, v3
    s_lshl_b32 s12, s3, 14
    s_lshl_b32 s13, s11, 11
    s_add_u32 s12, s12, s13
    v_add_u32 v5, s12, v20
    s_add_u32 s12, s11, 1
    s_cmp_eq_u32 s12, 8
    s_cselect_b32 s70, -7, 1
    s_add_u32 s12, s11, 2
    s_cmp_eq_u32 s12, 8
    s_cselect_b32 s71, -7, 1
    s_add_u32 s12, s11, 3
    s_cmp_eq_u32 s12, 8
    s_cselect_b32 s72, -7, 1
    s_add_u32 s12, s11, 4
    s_cmp_eq_u32 s12, 8
    s_cselect_b32 s73, -7, 1
    s_add_u32 s12, s11, 5
    s_cmp_eq_u32 s12, 8
    s_cselect_b32 s74, -7, 1
    s_add_u32 s12, s11, 6
    s_cmp_eq_u32 s12, 8
    s_cselect_b32 s75, -7, 1
    s_add_u32 s12, s11, 7
    s_cmp_eq_u32 s12, 8
    s_cselect_b32 s76, -7, 1
    s_add_u32 s12, s9, 0
    s_and_b32 s12, s12, 7
    s_mul_i32 s13, s5, 9
    s_add_u32 s12, s12, s13
    s_mul_i32 s44, s12, 65536
    s_add_u32 s12, s9, 1
    s_and_b32 s12, s12, 7
    s_mul_i32 s13, s5, 9
    s_add_u32 s12, s12, s13
    s_mul_i32 s45, s12, 65536
    s_add_u32 s12, s9, 2
    s_and_b32 s12, s12, 7
    s_mul_i32 s13, s5, 9
    s_add_u32 s12, s12, s13
    s_mul_i32 s46, s12, 65536
    s_add_u32 s12, s9, 3
    s_and_b32 s12, s12, 7
    s_mul_i32 s13, s5, 9
    s_add_u32 s12, s12, s13
    s_mul_i32 s47, s12, 65536
    s_add_u32 s12, s9, 4
    s_and_b32 s12, s12, 7
    s_mul_i32 s13, s5, 9
    s_add_u32 s12, s12, s13
    s_mul_i32 s48, s12, 65536
    s_add_u32 s12, s9, 5
    s_and_b32 s12, s12, 7
    s_mul_i32 s13, s5, 9
    s_add_u32 s12, s12, s13
    s_mul_i32 s49, s12, 65536
    s_add_u32 s12, s9, 6
    s_and_b32 s12, s12, 7
    s_mul_i32 s13, s5, 9
    s_add_u32 s12, s12, s13
    s_mul_i32 s50, s12, 65536
    s_add_u32 s12, s9, 7
    s_and_b32 s12, s12, 7
    s_mul_i32 s13, s5, 9
    s_add_u32 s12, s12, s13
    s_mul_i32 s51, s12, 65536
    s_mov_b32 s12, 8
    s_mul_i32 s13, s5, 9
    s_add_u32 s12, s12, s13
    s_mul_i32 s52, s12, 65536
    s_add_u32 s12, s8, 0
    s_and_b32 s12, s12, 7
    s_lshl_b32 s53, s12, 16
    s_add_u32 s54, s53, 32768
    s_add_u32 s12, s8, 1
    s_and_b32 s12, s12, 7
    s_lshl_b32 s55, s12, 16
    s_add_u32 s56, s55, 32768
    s_add_u32 s12, s8, 2
    s_and_b32 s12, s12, 7
    s_lshl_b32 s57, s12, 16
    s_add_u32 s58, s57, 32768
    s_add_u32 s12, s8, 3
    s_and_b32 s12, s12, 7
    s_lshl_b32 s59, s12, 16
    s_add_u32 s60, s59, 32768
    s_add_u32 s12, s8, 4
    s_and_b32 s12, s12, 7
    s_lshl_b32 s61, s12, 16
    s_add_u32 s62, s61, 32768
    s_add_u32 s12, s8, 5
    s_and_b32 s12, s12, 7
    s_lshl_b32 s63, s12, 16
    s_add_u32 s64, s63, 32768
    s_add_u32 s12, s8, 6
    s_and_b32 s12, s12, 7
    s_lshl_b32 s65, s12, 16
    s_add_u32 s66, s65, 32768
    s_add_u32 s12, s8, 7
    s_and_b32 s12, s12, 7
    s_lshl_b32 s67, s12, 16
    s_add_u32 s68, s67, 32768
    s_waitcnt lgkmcnt(0)
    s_cmp_eq_u32 s6, 0
    s_cselect_b32 s40, s18, s20
    s_cselect_b32 s41, s19, s21
    s_cselect_b32 s12, 0, 2359296
    s_lshl_b32 s13, s4, 19
    s_add_u32 s40, s40, s13
    s_addc_u32 s41, s41, 0
    s_mov_b32 s42, 524288
    s_mov_b32 s43, 0x20000
    s_add_u32 s20, s36, s12
    s_addc_u32 s21, s37, 0
    s_mov_b32 s22, 2359296
    s_mov_b32 s23, 0x20000
    s_add_u32 m0, s10, 0
    s_nop 0
    buffer_load_dwordx4 v2, s[40:43], s53 offen lds
    s_add_u32 m0, s10, 1024
    s_nop 0
    buffer_load_dwordx4 v2, s[40:43], s54 offen lds
    s_add_u32 m0, s10, 2048
    s_nop 0
    buffer_load_dwordx4 v2, s[40:43], s55 offen lds
    s_add_u32 m0, s10, 3072
    s_nop 0
    buffer_load_dwordx4 v2, s[40:43], s56 offen lds
    s_add_u32 m0, s10, 4096
    s_nop 0
    buffer_load_dwordx4 v2, s[40:43], s57 offen lds
    s_add_u32 m0, s10, 5120
    s_nop 0
    buffer_load_dwordx4 v2, s[40:43], s58 offen lds
    s_add_u32 m0, s10, 6144
    s_nop 0
    buffer_load_dwordx4 v2, s[40:43], s59 offen lds
    s_add_u32 m0, s10, 7168
    s_nop 0
    buffer_load_dwordx4 v2, s[40:43], s60 offen lds
    s_add_u32 m0, s10, 8192
    s_nop 0
    buffer_load_dwordx4 v2, s[40:43], s61 offen lds
    s_add_u32 m0, s10, 9216
    s_nop 0
    buffer_load_dwordx4 v2, s[40:43], s62 offen lds
    s_add_u32 m0, s10, 10240
    s_nop 0
    buffer_load_dwordx4 v2, s[40:43], s63 offen lds
    s_add_u32 m0, s10, 11264
    s_nop 0
    buffer_load_dwordx4 v2, s[40:43], s64 offen lds
    s_add_u32 m0, s10, 12288
    s_nop 0
    buffer_load_dwordx4 v2, s[40:43], s65 offen lds
    s_add_u32 m0, s10, 13312
    s_nop 0
    buffer_load_dwordx4 v2, s[40:43], s66 offen lds
    s_add_u32 m0, s10, 14336
    s_nop 0
    buffer_load_dwordx4 v2, s[40:43], s67 offen lds
    s_add_u32 m0, s10, 15360
    s_nop 0
    buffer_load_dwordx4 v2, s[40:43], s68 offen lds
    buffer_load_dwordx4 v[88:91], v5, s[20:23], s44 offen offset:0
    buffer_load_dwordx4 v[92:95], v5, s[20:23], s45 offen offset:0
    buffer_load_dwordx4 v[96:99], v5, s[20:23], s46 offen offset:0
    buffer_load_dwordx4 v[100:103], v5, s[20:23], s47 offen offset:0
    buffer_load_dwordx4 v[104:107], v5, s[20:23], s48 offen offset:0
    buffer_load_dwordx4 v[108:111], v5, s[20:23], s49 offen offset:0
    buffer_load_dwordx4 v[112:115], v5, s[20:23], s50 offen offset:0
    buffer_load_dwordx4 v[116:119], v5, s[20:23], s51 offen offset:0
    buffer_load_dwordx4 v[120:123], v5, s[20:23], s52 offen offset:0
    s_waitcnt vmcnt(23)
    ds_read_b128 a[216:219], v3 offset:0
    s_waitcnt vmcnt(21)
    ds_read_b128 a[220:223], v3 offset:2048
    s_waitcnt vmcnt(19)
    ds_read_b128 a[224:227], v3 offset:4096
    s_waitcnt vmcnt(17)
    ds_read_b128 a[228:231], v3 offset:6144
    s_waitcnt vmcnt(15)
    ds_read_b128 a[232:235], v3 offset:8192
    s_waitcnt vmcnt(13)
    ds_read_b128 a[236:239], v3 offset:10240
    s_waitcnt vmcnt(11)
    ds_read_b128 a[240:243], v3 offset:12288
    s_waitcnt vmcnt(9)
    ds_read_b128 a[244:247], v3 offset:14336
    s_waitcnt vmcnt(8) lgkmcnt(7)
    v_mfma_f32_16x16x32_bf16 v[16:19], v[88:91], a[216:219], 0
    s_waitcnt lgkmcnt(6)
    v_mfma_f32_16x16x32_bf16 v[24:27], v[88:91], a[220:223], 0
    s_waitcnt lgkmcnt(5)
    v_mfma_f32_16x16x32_bf16 v[32:35], v[88:91], a[224:227], 0
    s_waitcnt lgkmcnt(4)
    v_mfma_f32_16x16x32_bf16 v[40:43], v[88:91], a[228:231], 0
    buffer_load_dwordx4 v[124:127], v5, s[20:23], s44 offen offset:1024
    s_waitcnt lgkmcnt(3)
    v_mfma_f32_16x16x32_bf16 v[48:51], v[88:91], a[232:235], 0
    s_waitcnt lgkmcnt(2)
    v_mfma_f32_16x16x32_bf16 v[56:59], v[88:91], a[236:239], 0
    s_waitcnt lgkmcnt(1)
    v_mfma_f32_16x16x32_bf16 v[64:67], v[88:91], a[240:243], 0
    s_waitcnt lgkmcnt(0)
    v_mfma_f32_16x16x32_bf16 v[72:75], v[88:91], a[244:247], 0
    buffer_load_dwordx4 v[128:131], v5, s[20:23], s45 offen offset:1024
    s_waitcnt vmcnt(9)
    v_mfma_f32_16x16x32_bf16 v[20:23], v[92:95], a[216:219], 0
    v_mfma_f32_16x16x32_bf16 v[28:31], v[92:95], a[220:223], 0
    v_mfma_f32_16x16x32_bf16 v[36:39], v[92:95], a[224:227], 0
    v_mfma_f32_16x16x32_bf16 v[44:47], v[92:95], a[228:231], 0
    buffer_load_dwordx4 v[132:135], v5, s[20:23], s46 offen offset:1024
    v_mfma_f32_16x16x32_bf16 v[52:55], v[92:95], a[232:235], 0
    v_mfma_f32_16x16x32_bf16 v[60:63], v[92:95], a[236:239], 0
    v_mfma_f32_16x16x32_bf16 v[68:71], v[92:95], a[240:243], 0
    v_mfma_f32_16x16x32_bf16 v[76:79], v[92:95], a[244:247], 0
    buffer_load_dwordx4 v[136:139], v5, s[20:23], s47 offen offset:1024
    s_waitcnt vmcnt(10)
    v_mfma_f32_16x16x32_bf16 a[0:3], v[96:99], a[216:219], 0
    v_mfma_f32_16x16x32_bf16 a[24:27], v[96:99], a[220:223], 0
    v_mfma_f32_16x16x32_bf16 a[48:51], v[96:99], a[224:227], 0
    v_mfma_f32_16x16x32_bf16 a[72:75], v[96:99], a[228:231], 0
    buffer_load_dwordx4 v[140:143], v5, s[20:23], s48 offen offset:1024
    v_mfma_f32_16x16x32_bf16 a[96:99], v[96:99], a[232:235], 0
    v_mfma_f32_16x16x32_bf16 a[120:123], v[96:99], a[236:239], 0
    v_mfma_f32_16x16x32_bf16 a[144:147], v[96:99], a[240:243], 0
    v_mfma_f32_16x16x32_bf16 a[168:171], v[96:99], a[244:247], 0
    buffer_load_dwordx4 v[144:147], v5, s[20:23], s49 offen offset:1024
    s_waitcnt vmcnt(11)
    v_mfma_f32_16x16x32_bf16 a[4:7], v[100:103], a[216:219], 0
    v_mfma_f32_16x16x32_bf16 a[28:31], v[100:103], a[220:223], 0
    v_mfma_f32_16x16x32_bf16 a[52:55], v[100:103], a[224:227], 0
    v_mfma_f32_16x16x32_bf16 a[76:79], v[100:103], a[228:231], 0
    buffer_load_dwordx4 v[148:151], v5, s[20:23], s50 offen offset:1024
    v_mfma_f32_16x16x32_bf16 a[100:103], v[100:103], a[232:235], 0
    v_mfma_f32_16x16x32_bf16 a[124:127], v[100:103], a[236:239], 0
    v_mfma_f32_16x16x32_bf16 a[148:151], v[100:103], a[240:243], 0
    v_mfma_f32_16x16x32_bf16 a[172:175], v[100:103], a[244:247], 0
    buffer_load_dwordx4 v[152:155], v5, s[20:23], s51 offen offset:1024
    s_waitcnt vmcnt(12)
    v_mfma_f32_16x16x32_bf16 a[8:11], v[104:107], a[216:219], 0
    v_mfma_f32_16x16x32_bf16 a[32:35], v[104:107], a[220:223], 0
    v_mfma_f32_16x16x32_bf16 a[56:59], v[104:107], a[224:227], 0
    v_mfma_f32_16x16x32_bf16 a[80:83], v[104:107], a[228:231], 0
    buffer_load_dwordx4 v[156:159], v5, s[20:23], s52 offen offset:1024
    v_mfma_f32_16x16x32_bf16 a[104:107], v[104:107], a[232:235], 0
    v_mfma_f32_16x16x32_bf16 a[128:131], v[104:107], a[236:239], 0
    v_mfma_f32_16x16x32_bf16 a[152:155], v[104:107], a[240:243], 0
    v_mfma_f32_16x16x32_bf16 a[176:179], v[104:107], a[244:247], 0
    s_lshl_b32 s12, s70, 7
    v_add_u32 v2, s12, v2
    s_add_u32 m0, s10, 16384
    s_nop 0
    buffer_load_dwordx4 v2, s[40:43], s53 offen lds
    s_waitcnt vmcnt(13)
    v_mfma_f32_16x16x32_bf16 a[12:15], v[108:111], a[216:219], 0
    ds_read_b128 a[248:251], v4 offset:0
    v_mfma_f32_16x16x32_bf16 a[36:39], v[108:111], a[220:223], 0
    ds_read_b128 a[252:255], v4 offset:2048
    v_mfma_f32_16x16x32_bf16 a[60:63], v[108:111], a[224:227], 0
    ds_read_b128 v[232:235], v4 offset:4096
    v_mfma_f32_16x16x32_bf16 a[84:87], v[108:111], a[228:231], 0
    s_add_u32 m0, s10, 17408
    s_nop 0
    buffer_load_dwordx4 v2, s[40:43], s54 offen lds
    v_mfma_f32_16x16x32_bf16 a[108:111], v[108:111], a[232:235], 0
    ds_read_b128 v[236:239], v4 offset:6144
    v_mfma_f32_16x16x32_bf16 a[132:135], v[108:111], a[236:239], 0
    ds_read_b128 v[240:243], v4 offset:8192
    v_mfma_f32_16x16x32_bf16 a[156:159], v[108:111], a[240:243], 0
    ds_read_b128 v[244:247], v4 offset:10240
    v_mfma_f32_16x16x32_bf16 a[180:183], v[108:111], a[244:247], 0
    s_add_u32 m0, s10, 18432
    s_nop 0
    buffer_load_dwordx4 v2, s[40:43], s55 offen lds
    s_waitcnt vmcnt(14)
    v_mfma_f32_16x16x32_bf16 a[16:19], v[112:115], a[216:219], 0
    ds_read_b128 v[248:251], v4 offset:12288
    v_mfma_f32_16x16x32_bf16 a[40:43], v[112:115], a[220:223], 0
    ds_read_b128 v[252:255], v4 offset:14336
    v_mfma_f32_16x16x32_bf16 a[64:67], v[112:115], a[224:227], 0
    v_mfma_f32_16x16x32_bf16 a[88:91], v[112:115], a[228:231], 0
    s_add_u32 m0, s10, 19456
    s_nop 0
    buffer_load_dwordx4 v2, s[40:43], s56 offen lds
    v_mfma_f32_16x16x32_bf16 a[112:115], v[112:115], a[232:235], 0
    v_mfma_f32_16x16x32_bf16 a[136:139], v[112:115], a[236:239], 0
    v_mfma_f32_16x16x32_bf16 a[160:163], v[112:115], a[240:243], 0
    v_mfma_f32_16x16x32_bf16 a[184:187], v[112:115], a[244:247], 0
    s_add_u32 m0, s10, 20480
    s_nop 0
    buffer_load_dwordx4 v2, s[40:43], s57 offen lds
    s_waitcnt vmcnt(15)
    v_mfma_f32_16x16x32_bf16 a[20:23], v[116:119], a[216:219], 0
    v_mfma_f32_16x16x32_bf16 a[44:47], v[116:119], a[220:223], 0
    v_mfma_f32_16x16x32_bf16 a[68:71], v[116:119], a[224:227], 0
    v_mfma_f32_16x16x32_bf16 a[92:95], v[116:119], a[228:231], 0
    s_add_u32 m0, s10, 21504
    s_nop 0
    buffer_load_dwordx4 v2, s[40:43], s58 offen lds
    v_mfma_f32_16x16x32_bf16 a[116:119], v[116:119], a[232:235], 0
    v_mfma_f32_16x16x32_bf16 a[140:143], v[116:119], a[236:239], 0
    v_mfma_f32_16x16x32_bf16 a[164:167], v[116:119], a[240:243], 0
    v_mfma_f32_16x16x32_bf16 a[188:191], v[116:119], a[244:247], 0
    s_add_u32 m0, s10, 22528
    s_nop 0
    buffer_load_dwordx4 v2, s[40:43], s59 offen lds
    s_waitcnt vmcnt(16)
    v_mfma_f32_16x16x32_bf16 v[80:83], v[120:123], a[216:219], 0
    v_mfma_f32_16x16x32_bf16 v[84:87], v[120:123], a[220:223], 0
    v_mfma_f32_16x16x32_bf16 a[192:195], v[120:123], a[224:227], 0
    v_mfma_f32_16x16x32_bf16 a[196:199], v[120:123], a[228:231], 0
    s_add_u32 m0, s10, 23552
    s_nop 0
    buffer_load_dwordx4 v2, s[40:43], s60 offen lds
    v_mfma_f32_16x16x32_bf16 a[200:203], v[120:123], a[232:235], 0
    v_mfma_f32_16x16x32_bf16 a[204:207], v[120:123], a[236:239], 0
    v_mfma_f32_16x16x32_bf16 a[208:211], v[120:123], a[240:243], 0
    v_mfma_f32_16x16x32_bf16 a[212:215], v[120:123], a[244:247], 0
    s_add_u32 m0, s10, 24576
    s_nop 0
    buffer_load_dwordx4 v2, s[40:43], s61 offen lds
    s_waitcnt vmcnt(17) lgkmcnt(7)
    v_mfma_f32_16x16x32_bf16 v[16:19], v[124:127], a[248:251], v[16:19]
    s_waitcnt lgkmcnt(6)
    v_mfma_f32_16x16x32_bf16 v[24:27], v[124:127], a[252:255], v[24:27]
    s_waitcnt lgkmcnt(5)
    v_mfma_f32_16x16x32_bf16 v[32:35], v[124:127], v[232:235], v[32:35]
    s_waitcnt lgkmcnt(4)
    v_mfma_f32_16x16x32_bf16 v[40:43], v[124:127], v[236:239], v[40:43]
    s_add_u32 m0, s10, 25600
    s_nop 0
    buffer_load_dwordx4 v2, s[40:43], s62 offen lds
    s_waitcnt lgkmcnt(3)
    v_mfma_f32_16x16x32_bf16 v[48:51], v[124:127], v[240:243], v[48:51]
    s_waitcnt lgkmcnt(2)
    v_mfma_f32_16x16x32_bf16 v[56:59], v[124:127], v[244:247], v[56:59]
    s_waitcnt lgkmcnt(1)
    v_mfma_f32_16x16x32_bf16 v[64:67], v[124:127], v[248:251], v[64:67]
    s_waitcnt lgkmcnt(0)
    v_mfma_f32_16x16x32_bf16 v[72:75], v[124:127], v[252:255], v[72:75]
    s_add_u32 m0, s10, 26624
    s_nop 0
    buffer_load_dwordx4 v2, s[40:43], s63 offen lds
    s_waitcnt vmcnt(18)
    v_mfma_f32_16x16x32_bf16 v[20:23], v[128:131], a[248:251], v[20:23]
    v_mfma_f32_16x16x32_bf16 v[28:31], v[128:131], a[252:255], v[28:31]
    v_mfma_f32_16x16x32_bf16 v[36:39], v[128:131], v[232:235], v[36:39]
    v_mfma_f32_16x16x32_bf16 v[44:47], v[128:131], v[236:239], v[44:47]
    s_add_u32 m0, s10, 27648
    s_nop 0
    buffer_load_dwordx4 v2, s[40:43], s64 offen lds
    v_mfma_f32_16x16x32_bf16 v[52:55], v[128:131], v[240:243], v[52:55]
    v_mfma_f32_16x16x32_bf16 v[60:63], v[128:131], v[244:247], v[60:63]
    v_mfma_f32_16x16x32_bf16 v[68:71], v[128:131], v[248:251], v[68:71]
    v_mfma_f32_16x16x32_bf16 v[76:79], v[128:131], v[252:255], v[76:79]
    s_add_u32 m0, s10, 28672
    s_nop 0
    buffer_load_dwordx4 v2, s[40:43], s65 offen lds
    s_waitcnt vmcnt(19)
    v_mfma_f32_16x16x32_bf16 a[0:3], v[132:135], a[248:251], a[0:3]
    v_mfma_f32_16x16x32_bf16 a[24:27], v[132:135], a[252:255], a[24:27]
    v_mfma_f32_16x16x32_bf16 a[48:51], v[132:135], v[232:235], a[48:51]
    v_mfma_f32_16x16x32_bf16 a[72:75], v[132:135], v[236:239], a[72:75]
    s_add_u32 m0, s10, 29696
    s_nop 0
    buffer_load_dwordx4 v2, s[40:43], s66 offen lds
    v_mfma_f32_16x16x32_bf16 a[96:99], v[132:135], v[240:243], a[96:99]
    v_mfma_f32_16x16x32_bf16 a[120:123], v[132:135], v[244:247], a[120:123]
    v_mfma_f32_16x16x32_bf16 a[144:147], v[132:135], v[248:251], a[144:147]
    v_mfma_f32_16x16x32_bf16 a[168:171], v[132:135], v[252:255], a[168:171]
    s_add_u32 m0, s10, 30720
    s_nop 0
    buffer_load_dwordx4 v2, s[40:43], s67 offen lds
    s_waitcnt vmcnt(20)
    v_mfma_f32_16x16x32_bf16 a[4:7], v[136:139], a[248:251], a[4:7]
    v_mfma_f32_16x16x32_bf16 a[28:31], v[136:139], a[252:255], a[28:31]
    v_mfma_f32_16x16x32_bf16 a[52:55], v[136:139], v[232:235], a[52:55]
    v_mfma_f32_16x16x32_bf16 a[76:79], v[136:139], v[236:239], a[76:79]
    s_add_u32 m0, s10, 31744
    s_nop 0
    buffer_load_dwordx4 v2, s[40:43], s68 offen lds
    v_mfma_f32_16x16x32_bf16 a[100:103], v[136:139], v[240:243], a[100:103]
    v_mfma_f32_16x16x32_bf16 a[124:127], v[136:139], v[244:247], a[124:127]
    v_mfma_f32_16x16x32_bf16 a[148:151], v[136:139], v[248:251], a[148:151]
    v_mfma_f32_16x16x32_bf16 a[172:175], v[136:139], v[252:255], a[172:175]
    s_lshl_b32 s12, s70, 11
    v_add_u32 v5, s12, v5
    buffer_load_dwordx4 v[160:163], v5, s[20:23], s44 offen offset:0
    s_waitcnt vmcnt(21)
    v_mfma_f32_16x16x32_bf16 a[8:11], v[140:143], a[248:251], a[8:11]
    v_mfma_f32_16x16x32_bf16 a[32:35], v[140:143], a[252:255], a[32:35]
    v_mfma_f32_16x16x32_bf16 a[56:59], v[140:143], v[232:235], a[56:59]
    v_mfma_f32_16x16x32_bf16 a[80:83], v[140:143], v[236:239], a[80:83]
    buffer_load_dwordx4 v[164:167], v5, s[20:23], s45 offen offset:0
    v_mfma_f32_16x16x32_bf16 a[104:107], v[140:143], v[240:243], a[104:107]
    v_mfma_f32_16x16x32_bf16 a[128:131], v[140:143], v[244:247], a[128:131]
    v_mfma_f32_16x16x32_bf16 a[152:155], v[140:143], v[248:251], a[152:155]
    v_mfma_f32_16x16x32_bf16 a[176:179], v[140:143], v[252:255], a[176:179]
    buffer_load_dwordx4 v[168:171], v5, s[20:23], s46 offen offset:0
    s_waitcnt vmcnt(22)
    v_mfma_f32_16x16x32_bf16 a[12:15], v[144:147], a[248:251], a[12:15]
    s_waitcnt vmcnt(17)
    ds_read_b128 a[216:219], v3 offset:16384
    v_mfma_f32_16x16x32_bf16 a[36:39], v[144:147], a[252:255], a[36:39]
    s_waitcnt vmcnt(15)
    ds_read_b128 a[220:223], v3 offset:18432
    v_mfma_f32_16x16x32_bf16 a[60:63], v[144:147], v[232:235], a[60:63]
    s_waitcnt vmcnt(13)
    ds_read_b128 a[224:227], v3 offset:20480
    v_mfma_f32_16x16x32_bf16 a[84:87], v[144:147], v[236:239], a[84:87]
    buffer_load_dwordx4 v[172:175], v5, s[20:23], s47 offen offset:0
    v_mfma_f32_16x16x32_bf16 a[108:111], v[144:147], v[240:243], a[108:111]
    s_waitcnt vmcnt(12)
    ds_read_b128 a[228:231], v3 offset:22528
    v_mfma_f32_16x16x32_bf16 a[132:135], v[144:147], v[244:247], a[132:135]
    s_waitcnt vmcnt(10)
    ds_read_b128 a[232:235], v3 offset:24576
    v_mfma_f32_16x16x32_bf16 a[156:159], v[144:147], v[248:251], a[156:159]
    s_waitcnt vmcnt(8)
    ds_read_b128 a[236:239], v3 offset:26624
    v_mfma_f32_16x16x32_bf16 a[180:183], v[144:147], v[252:255], a[180:183]
    buffer_load_dwordx4 v[176:179], v5, s[20:23], s48 offen offset:0
    v_mfma_f32_16x16x32_bf16 a[16:19], v[148:151], a[248:251], a[16:19]
    s_waitcnt vmcnt(7)
    ds_read_b128 a[240:243], v3 offset:28672
    v_mfma_f32_16x16x32_bf16 a[40:43], v[148:151], a[252:255], a[40:43]
    s_waitcnt vmcnt(5)
    ds_read_b128 a[244:247], v3 offset:30720
    v_mfma_f32_16x16x32_bf16 a[64:67], v[148:151], v[232:235], a[64:67]
    v_mfma_f32_16x16x32_bf16 a[88:91], v[148:151], v[236:239], a[88:91]
    buffer_load_dwordx4 v[180:183], v5, s[20:23], s49 offen offset:0
    v_mfma_f32_16x16x32_bf16 a[112:115], v[148:151], v[240:243], a[112:115]
    v_mfma_f32_16x16x32_bf16 a[136:139], v[148:151], v[244:247], a[136:139]
    v_mfma_f32_16x16x32_bf16 a[160:163], v[148:151], v[248:251], a[160:163]
    v_mfma_f32_16x16x32_bf16 a[184:187], v[148:151], v[252:255], a[184:187]
    buffer_load_dwordx4 v[184:187], v5, s[20:23], s50 offen offset:0
    v_mfma_f32_16x16x32_bf16 a[20:23], v[152:155], a[248:251], a[20:23]
    v_mfma_f32_16x16x32_bf16 a[44:47], v[152:155], a[252:255], a[44:47]
    v_mfma_f32_16x16x32_bf16 a[68:71], v[152:155], v[232:235], a[68:71]
    v_mfma_f32_16x16x32_bf16 a[92:95], v[152:155], v[236:239], a[92:95]
    buffer_load_dwordx4 v[188:191], v5, s[20:23], s51 offen offset:0
    v_mfma_f32_16x16x32_bf16 a[116:119], v[152:155], v[240:243], a[116:119]
    v_mfma_f32_16x16x32_bf16 a[140:143], v[152:155], v[244:247], a[140:143]
    v_mfma_f32_16x16x32_bf16 a[164:167], v[152:155], v[248:251], a[164:167]
    v_mfma_f32_16x16x32_bf16 a[188:191], v[152:155], v[252:255], a[188:191]
    buffer_load_dwordx4 v[192:195], v5, s[20:23], s52 offen offset:0
    v_mfma_f32_16x16x32_bf16 v[80:83], v[156:159], a[248:251], v[80:83]
    v_mfma_f32_16x16x32_bf16 v[84:87], v[156:159], a[252:255], v[84:87]
    v_mfma_f32_16x16x32_bf16 a[192:195], v[156:159], v[232:235], a[192:195]
    v_mfma_f32_16x16x32_bf16 a[196:199], v[156:159], v[236:239], a[196:199]
    buffer_load_dwordx4 v[196:199], v5, s[20:23], s44 offen offset:1024
    v_mfma_f32_16x16x32_bf16 a[200:203], v[156:159], v[240:243], a[200:203]
    v_mfma_f32_16x16x32_bf16 a[204:207], v[156:159], v[244:247], a[204:207]
    v_mfma_f32_16x16x32_bf16 a[208:211], v[156:159], v[248:251], a[208:211]
    v_mfma_f32_16x16x32_bf16 a[212:215], v[156:159], v[252:255], a[212:215]
    buffer_load_dwordx4 v[200:203], v5, s[20:23], s45 offen offset:1024
    s_waitcnt vmcnt(10) lgkmcnt(7)
    v_mfma_f32_16x16x32_bf16 v[16:19], v[160:163], a[216:219], v[16:19]
    s_waitcnt lgkmcnt(6)
    v_mfma_f32_16x16x32_bf16 v[24:27], v[160:163], a[220:223], v[24:27]
    s_waitcnt lgkmcnt(5)
    v_mfma_f32_16x16x32_bf16 v[32:35], v[160:163], a[224:227], v[32:35]
    s_waitcnt lgkmcnt(4)
    v_mfma_f32_16x16x32_bf16 v[40:43], v[160:163], a[228:231], v[40:43]
    buffer_load_dwordx4 v[204:207], v5, s[20:23], s46 offen offset:1024
    s_waitcnt lgkmcnt(3)
    v_mfma_f32_16x16x32_bf16 v[48:51], v[160:163], a[232:235], v[48:51]
    s_waitcnt lgkmcnt(2)
    v_mfma_f32_16x16x32_bf16 v[56:59], v[160:163], a[236:239], v[56:59]
    s_waitcnt lgkmcnt(1)
    v_mfma_f32_16x16x32_bf16 v[64:67], v[160:163], a[240:243], v[64:67]
    s_waitcnt lgkmcnt(0)
    v_mfma_f32_16x16x32_bf16 v[72:75], v[160:163], a[244:247], v[72:75]
    buffer_load_dwordx4 v[208:211], v5, s[20:23], s47 offen offset:1024
    s_waitcnt vmcnt(11)
    v_mfma_f32_16x16x32_bf16 v[20:23], v[164:167], a[216:219], v[20:23]
    v_mfma_f32_16x16x32_bf16 v[28:31], v[164:167], a[220:223], v[28:31]
    v_mfma_f32_16x16x32_bf16 v[36:39], v[164:167], a[224:227], v[36:39]
    v_mfma_f32_16x16x32_bf16 v[44:47], v[164:167], a[228:231], v[44:47]
    buffer_load_dwordx4 v[212:215], v5, s[20:23], s48 offen offset:1024
    v_mfma_f32_16x16x32_bf16 v[52:55], v[164:167], a[232:235], v[52:55]
    v_mfma_f32_16x16x32_bf16 v[60:63], v[164:167], a[236:239], v[60:63]
    v_mfma_f32_16x16x32_bf16 v[68:71], v[164:167], a[240:243], v[68:71]
    v_mfma_f32_16x16x32_bf16 v[76:79], v[164:167], a[244:247], v[76:79]
    buffer_load_dwordx4 v[216:219], v5, s[20:23], s49 offen offset:1024
    s_waitcnt vmcnt(12)
    v_mfma_f32_16x16x32_bf16 a[0:3], v[168:171], a[216:219], a[0:3]
    v_mfma_f32_16x16x32_bf16 a[24:27], v[168:171], a[220:223], a[24:27]
    v_mfma_f32_16x16x32_bf16 a[48:51], v[168:171], a[224:227], a[48:51]
    v_mfma_f32_16x16x32_bf16 a[72:75], v[168:171], a[228:231], a[72:75]
    buffer_load_dwordx4 v[220:223], v5, s[20:23], s50 offen offset:1024
    v_mfma_f32_16x16x32_bf16 a[96:99], v[168:171], a[232:235], a[96:99]
    v_mfma_f32_16x16x32_bf16 a[120:123], v[168:171], a[236:239], a[120:123]
    v_mfma_f32_16x16x32_bf16 a[144:147], v[168:171], a[240:243], a[144:147]
    v_mfma_f32_16x16x32_bf16 a[168:171], v[168:171], a[244:247], a[168:171]
    buffer_load_dwordx4 v[224:227], v5, s[20:23], s51 offen offset:1024
    s_waitcnt vmcnt(13)
    v_mfma_f32_16x16x32_bf16 a[4:7], v[172:175], a[216:219], a[4:7]
    v_mfma_f32_16x16x32_bf16 a[28:31], v[172:175], a[220:223], a[28:31]
    v_mfma_f32_16x16x32_bf16 a[52:55], v[172:175], a[224:227], a[52:55]
    v_mfma_f32_16x16x32_bf16 a[76:79], v[172:175], a[228:231], a[76:79]
    buffer_load_dwordx4 v[228:231], v5, s[20:23], s52 offen offset:1024
    v_mfma_f32_16x16x32_bf16 a[100:103], v[172:175], a[232:235], a[100:103]
    v_mfma_f32_16x16x32_bf16 a[124:127], v[172:175], a[236:239], a[124:127]
    v_mfma_f32_16x16x32_bf16 a[148:151], v[172:175], a[240:243], a[148:151]
    v_mfma_f32_16x16x32_bf16 a[172:175], v[172:175], a[244:247], a[172:175]
    s_lshl_b32 s12, s71, 7
    v_add_u32 v2, s12, v2
    s_add_u32 m0, s10, 32768
    s_nop 0
    buffer_load_dwordx4 v2, s[40:43], s53 offen lds
    s_waitcnt vmcnt(14)
    v_mfma_f32_16x16x32_bf16 a[8:11], v[176:179], a[216:219], a[8:11]
    v_mfma_f32_16x16x32_bf16 a[32:35], v[176:179], a[220:223], a[32:35]
    v_mfma_f32_16x16x32_bf16 a[56:59], v[176:179], a[224:227], a[56:59]
    v_mfma_f32_16x16x32_bf16 a[80:83], v[176:179], a[228:231], a[80:83]
    s_add_u32 m0, s10, 33792
    s_nop 0
    buffer_load_dwordx4 v2, s[40:43], s54 offen lds
    v_mfma_f32_16x16x32_bf16 a[104:107], v[176:179], a[232:235], a[104:107]
    v_mfma_f32_16x16x32_bf16 a[128:131], v[176:179], a[236:239], a[128:131]
    v_mfma_f32_16x16x32_bf16 a[152:155], v[176:179], a[240:243], a[152:155]
    v_mfma_f32_16x16x32_bf16 a[176:179], v[176:179], a[244:247], a[176:179]
    s_add_u32 m0, s10, 34816
    s_nop 0
    buffer_load_dwordx4 v2, s[40:43], s55 offen lds
    s_waitcnt vmcnt(15)
    v_mfma_f32_16x16x32_bf16 a[12:15], v[180:183], a[216:219], a[12:15]
    ds_read_b128 a[248:251], v4 offset:16384
    v_mfma_f32_16x16x32_bf16 a[36:39], v[180:183], a[220:223], a[36:39]
    ds_read_b128 a[252:255], v4 offset:18432
    v_mfma_f32_16x16x32_bf16 a[60:63], v[180:183], a[224:227], a[60:63]
    ds_read_b128 v[232:235], v4 offset:20480
    v_mfma_f32_16x16x32_bf16 a[84:87], v[180:183], a[228:231], a[84:87]
    s_add_u32 m0, s10, 35840
    s_nop 0
    buffer_load_dwordx4 v2, s[40:43], s56 offen lds
    v_mfma_f32_16x16x32_bf16 a[108:111], v[180:183], a[232:235], a[108:111]
    ds_read_b128 v[236:239], v4 offset:22528
    v_mfma_f32_16x16x32_bf16 a[132:135], v[180:183], a[236:239], a[132:135]
    ds_read_b128 v[240:243], v4 offset:24576
    v_mfma_f32_16x16x32_bf16 a[156:159], v[180:183], a[240:243], a[156:159]
    ds_read_b128 v[244:247], v4 offset:26624
    v_mfma_f32_16x16x32_bf16 a[180:183], v[180:183], a[244:247], a[180:183]
    s_add_u32 m0, s10, 36864
    s_nop 0
    buffer_load_dwordx4 v2, s[40:43], s57 offen lds
    s_waitcnt vmcnt(16)
    v_mfma_f32_16x16x32_bf16 a[16:19], v[184:187], a[216:219], a[16:19]
    ds_read_b128 v[248:251], v4 offset:28672
    v_mfma_f32_16x16x32_bf16 a[40:43], v[184:187], a[220:223], a[40:43]
    ds_read_b128 v[252:255], v4 offset:30720
    v_mfma_f32_16x16x32_bf16 a[64:67], v[184:187], a[224:227], a[64:67]
    v_mfma_f32_16x16x32_bf16 a[88:91], v[184:187], a[228:231], a[88:91]
    s_add_u32 m0, s10, 37888
    s_nop 0
    buffer_load_dwordx4 v2, s[40:43], s58 offen lds
    v_mfma_f32_16x16x32_bf16 a[112:115], v[184:187], a[232:235], a[112:115]
    v_mfma_f32_16x16x32_bf16 a[136:139], v[184:187], a[236:239], a[136:139]
    v_mfma_f32_16x16x32_bf16 a[160:163], v[184:187], a[240:243], a[160:163]
    v_mfma_f32_16x16x32_bf16 a[184:187], v[184:187], a[244:247], a[184:187]
    s_add_u32 m0, s10, 38912
    s_nop 0
    buffer_load_dwordx4 v2, s[40:43], s59 offen lds
    s_waitcnt vmcnt(17)
    v_mfma_f32_16x16x32_bf16 a[20:23], v[188:191], a[216:219], a[20:23]
    v_mfma_f32_16x16x32_bf16 a[44:47], v[188:191], a[220:223], a[44:47]
    v_mfma_f32_16x16x32_bf16 a[68:71], v[188:191], a[224:227], a[68:71]
    v_mfma_f32_16x16x32_bf16 a[92:95], v[188:191], a[228:231], a[92:95]
    s_add_u32 m0, s10, 39936
    s_nop 0
    buffer_load_dwordx4 v2, s[40:43], s60 offen lds
    v_mfma_f32_16x16x32_bf16 a[116:119], v[188:191], a[232:235], a[116:119]
    v_mfma_f32_16x16x32_bf16 a[140:143], v[188:191], a[236:239], a[140:143]
    v_mfma_f32_16x16x32_bf16 a[164:167], v[188:191], a[240:243], a[164:167]
    v_mfma_f32_16x16x32_bf16 a[188:191], v[188:191], a[244:247], a[188:191]
    s_add_u32 m0, s10, 0
    s_nop 0
    buffer_load_dwordx4 v2, s[40:43], s61 offen lds
    s_waitcnt vmcnt(18)
    v_mfma_f32_16x16x32_bf16 v[80:83], v[192:195], a[216:219], v[80:83]
    v_mfma_f32_16x16x32_bf16 v[84:87], v[192:195], a[220:223], v[84:87]
    v_mfma_f32_16x16x32_bf16 a[192:195], v[192:195], a[224:227], a[192:195]
    v_mfma_f32_16x16x32_bf16 a[196:199], v[192:195], a[228:231], a[196:199]
    s_add_u32 m0, s10, 1024
    s_nop 0
    buffer_load_dwordx4 v2, s[40:43], s62 offen lds
    v_mfma_f32_16x16x32_bf16 a[200:203], v[192:195], a[232:235], a[200:203]
    v_mfma_f32_16x16x32_bf16 a[204:207], v[192:195], a[236:239], a[204:207]
    v_mfma_f32_16x16x32_bf16 a[208:211], v[192:195], a[240:243], a[208:211]
    v_mfma_f32_16x16x32_bf16 a[212:215], v[192:195], a[244:247], a[212:215]
    s_add_u32 m0, s10, 2048
    s_nop 0
    buffer_load_dwordx4 v2, s[40:43], s63 offen lds
    s_waitcnt vmcnt(19) lgkmcnt(7)
    v_mfma_f32_16x16x32_bf16 v[16:19], v[196:199], a[248:251], v[16:19]
    s_waitcnt lgkmcnt(6)
    v_mfma_f32_16x16x32_bf16 v[24:27], v[196:199], a[252:255], v[24:27]
    s_waitcnt lgkmcnt(5)
    v_mfma_f32_16x16x32_bf16 v[32:35], v[196:199], v[232:235], v[32:35]
    s_waitcnt lgkmcnt(4)
    v_mfma_f32_16x16x32_bf16 v[40:43], v[196:199], v[236:239], v[40:43]
    s_add_u32 m0, s10, 3072
    s_nop 0
    buffer_load_dwordx4 v2, s[40:43], s64 offen lds
    s_waitcnt lgkmcnt(3)
    v_mfma_f32_16x16x32_bf16 v[48:51], v[196:199], v[240:243], v[48:51]
    s_waitcnt lgkmcnt(2)
    v_mfma_f32_16x16x32_bf16 v[56:59], v[196:199], v[244:247], v[56:59]
    s_waitcnt lgkmcnt(1)
    v_mfma_f32_16x16x32_bf16 v[64:67], v[196:199], v[248:251], v[64:67]
    s_waitcnt lgkmcnt(0)
    v_mfma_f32_16x16x32_bf16 v[72:75], v[196:199], v[252:255], v[72:75]
    s_add_u32 m0, s10, 4096
    s_nop 0
    buffer_load_dwordx4 v2, s[40:43], s65 offen lds
    s_waitcnt vmcnt(20)
    v_mfma_f32_16x16x32_bf16 v[20:23], v[200:203], a[248:251], v[20:23]
    v_mfma_f32_16x16x32_bf16 v[28:31], v[200:203], a[252:255], v[28:31]
    v_mfma_f32_16x16x32_bf16 v[36:39], v[200:203], v[232:235], v[36:39]
    v_mfma_f32_16x16x32_bf16 v[44:47], v[200:203], v[236:239], v[44:47]
    s_add_u32 m0, s10, 5120
    s_nop 0
    buffer_load_dwordx4 v2, s[40:43], s66 offen lds
    v_mfma_f32_16x16x32_bf16 v[52:55], v[200:203], v[240:243], v[52:55]
    v_mfma_f32_16x16x32_bf16 v[60:63], v[200:203], v[244:247], v[60:63]
    v_mfma_f32_16x16x32_bf16 v[68:71], v[200:203], v[248:251], v[68:71]
    v_mfma_f32_16x16x32_bf16 v[76:79], v[200:203], v[252:255], v[76:79]
    s_add_u32 m0, s10, 6144
    s_nop 0
    buffer_load_dwordx4 v2, s[40:43], s67 offen lds
    s_waitcnt vmcnt(21)
    v_mfma_f32_16x16x32_bf16 a[0:3], v[204:207], a[248:251], a[0:3]
    v_mfma_f32_16x16x32_bf16 a[24:27], v[204:207], a[252:255], a[24:27]
    v_mfma_f32_16x16x32_bf16 a[48:51], v[204:207], v[232:235], a[48:51]
    v_mfma_f32_16x16x32_bf16 a[72:75], v[204:207], v[236:239], a[72:75]
    s_add_u32 m0, s10, 7168
    s_nop 0
    buffer_load_dwordx4 v2, s[40:43], s68 offen lds
    v_mfma_f32_16x16x32_bf16 a[96:99], v[204:207], v[240:243], a[96:99]
    v_mfma_f32_16x16x32_bf16 a[120:123], v[204:207], v[244:247], a[120:123]
    v_mfma_f32_16x16x32_bf16 a[144:147], v[204:207], v[248:251], a[144:147]
    v_mfma_f32_16x16x32_bf16 a[168:171], v[204:207], v[252:255], a[168:171]
    s_lshl_b32 s12, s71, 11
    v_add_u32 v5, s12, v5
    buffer_load_dwordx4 v[88:91], v5, s[20:23], s44 offen offset:0
    s_waitcnt vmcnt(22)
    v_mfma_f32_16x16x32_bf16 a[4:7], v[208:211], a[248:251], a[4:7]
    v_mfma_f32_16x16x32_bf16 a[28:31], v[208:211], a[252:255], a[28:31]
    v_mfma_f32_16x16x32_bf16 a[52:55], v[208:211], v[232:235], a[52:55]
    v_mfma_f32_16x16x32_bf16 a[76:79], v[208:211], v[236:239], a[76:79]
    buffer_load_dwordx4 v[92:95], v5, s[20:23], s45 offen offset:0
    v_mfma_f32_16x16x32_bf16 a[100:103], v[208:211], v[240:243], a[100:103]
    v_mfma_f32_16x16x32_bf16 a[124:127], v[208:211], v[244:247], a[124:127]
    v_mfma_f32_16x16x32_bf16 a[148:151], v[208:211], v[248:251], a[148:151]
    v_mfma_f32_16x16x32_bf16 a[172:175], v[208:211], v[252:255], a[172:175]
    buffer_load_dwordx4 v[96:99], v5, s[20:23], s46 offen offset:0
    s_waitcnt vmcnt(23)
    v_mfma_f32_16x16x32_bf16 a[8:11], v[212:215], a[248:251], a[8:11]
    v_mfma_f32_16x16x32_bf16 a[32:35], v[212:215], a[252:255], a[32:35]
    v_mfma_f32_16x16x32_bf16 a[56:59], v[212:215], v[232:235], a[56:59]
    v_mfma_f32_16x16x32_bf16 a[80:83], v[212:215], v[236:239], a[80:83]
    buffer_load_dwordx4 v[100:103], v5, s[20:23], s47 offen offset:0
    v_mfma_f32_16x16x32_bf16 a[104:107], v[212:215], v[240:243], a[104:107]
    v_mfma_f32_16x16x32_bf16 a[128:131], v[212:215], v[244:247], a[128:131]
    v_mfma_f32_16x16x32_bf16 a[152:155], v[212:215], v[248:251], a[152:155]
    v_mfma_f32_16x16x32_bf16 a[176:179], v[212:215], v[252:255], a[176:179]
    buffer_load_dwordx4 v[104:107], v5, s[20:23], s48 offen offset:0
    s_waitcnt vmcnt(24)
    v_mfma_f32_16x16x32_bf16 a[12:15], v[216:219], a[248:251], a[12:15]
    s_waitcnt vmcnt(19)
    ds_read_b128 a[216:219], v3 offset:32768
    v_mfma_f32_16x16x32_bf16 a[36:39], v[216:219], a[252:255], a[36:39]
    s_waitcnt vmcnt(17)
    ds_read_b128 a[220:223], v3 offset:34816
    v_mfma_f32_16x16x32_bf16 a[60:63], v[216:219], v[232:235], a[60:63]
    s_waitcnt vmcnt(15)
    ds_read_b128 a[224:227], v3 offset:36864
    v_mfma_f32_16x16x32_bf16 a[84:87], v[216:219], v[236:239], a[84:87]
    buffer_load_dwordx4 v[108:111], v5, s[20:23], s49 offen offset:0
    v_mfma_f32_16x16x32_bf16 a[108:111], v[216:219], v[240:243], a[108:111]
    s_waitcnt vmcnt(14)
    ds_read_b128 a[228:231], v3 offset:38912
    v_mfma_f32_16x16x32_bf16 a[132:135], v[216:219], v[244:247], a[132:135]
    s_waitcnt vmcnt(12)
    ds_read_b128 a[232:235], v3 offset:0
    v_mfma_f32_16x16x32_bf16 a[156:159], v[216:219], v[248:251], a[156:159]
    s_waitcnt vmcnt(10)
    ds_read_b128 a[236:239], v3 offset:2048
    v_mfma_f32_16x16x32_bf16 a[180:183], v[216:219], v[252:255], a[180:183]
    buffer_load_dwordx4 v[112:115], v5, s[20:23], s50 offen offset:0
    v_mfma_f32_16x16x32_bf16 a[16:19], v[220:223], a[248:251], a[16:19]
    s_waitcnt vmcnt(9)
    ds_read_b128 a[240:243], v3 offset:4096
    v_mfma_f32_16x16x32_bf16 a[40:43], v[220:223], a[252:255], a[40:43]
    s_waitcnt vmcnt(7)
    ds_read_b128 a[244:247], v3 offset:6144
    v_mfma_f32_16x16x32_bf16 a[64:67], v[220:223], v[232:235], a[64:67]
    v_mfma_f32_16x16x32_bf16 a[88:91], v[220:223], v[236:239], a[88:91]
    buffer_load_dwordx4 v[116:119], v5, s[20:23], s51 offen offset:0
    v_mfma_f32_16x16x32_bf16 a[112:115], v[220:223], v[240:243], a[112:115]
    v_mfma_f32_16x16x32_bf16 a[136:139], v[220:223], v[244:247], a[136:139]
    v_mfma_f32_16x16x32_bf16 a[160:163], v[220:223], v[248:251], a[160:163]
    v_mfma_f32_16x16x32_bf16 a[184:187], v[220:223], v[252:255], a[184:187]
    buffer_load_dwordx4 v[120:123], v5, s[20:23], s52 offen offset:0
    v_mfma_f32_16x16x32_bf16 a[20:23], v[224:227], a[248:251], a[20:23]
    v_mfma_f32_16x16x32_bf16 a[44:47], v[224:227], a[252:255], a[44:47]
    v_mfma_f32_16x16x32_bf16 a[68:71], v[224:227], v[232:235], a[68:71]
    v_mfma_f32_16x16x32_bf16 a[92:95], v[224:227], v[236:239], a[92:95]
    buffer_load_dwordx4 v[124:127], v5, s[20:23], s44 offen offset:1024
    v_mfma_f32_16x16x32_bf16 a[116:119], v[224:227], v[240:243], a[116:119]
    v_mfma_f32_16x16x32_bf16 a[140:143], v[224:227], v[244:247], a[140:143]
    v_mfma_f32_16x16x32_bf16 a[164:167], v[224:227], v[248:251], a[164:167]
    v_mfma_f32_16x16x32_bf16 a[188:191], v[224:227], v[252:255], a[188:191]
    buffer_load_dwordx4 v[128:131], v5, s[20:23], s45 offen offset:1024
    v_mfma_f32_16x16x32_bf16 v[80:83], v[228:231], a[248:251], v[80:83]
    v_mfma_f32_16x16x32_bf16 v[84:87], v[228:231], a[252:255], v[84:87]
    v_mfma_f32_16x16x32_bf16 a[192:195], v[228:231], v[232:235], a[192:195]
    v_mfma_f32_16x16x32_bf16 a[196:199], v[228:231], v[236:239], a[196:199]
    buffer_load_dwordx4 v[132:135], v5, s[20:23], s46 offen offset:1024
    v_mfma_f32_16x16x32_bf16 a[200:203], v[228:231], v[240:243], a[200:203]
    v_mfma_f32_16x16x32_bf16 a[204:207], v[228:231], v[244:247], a[204:207]
    v_mfma_f32_16x16x32_bf16 a[208:211], v[228:231], v[248:251], a[208:211]
    v_mfma_f32_16x16x32_bf16 a[212:215], v[228:231], v[252:255], a[212:215]
    buffer_load_dwordx4 v[136:139], v5, s[20:23], s47 offen offset:1024
    s_waitcnt vmcnt(12) lgkmcnt(7)
    v_mfma_f32_16x16x32_bf16 v[16:19], v[88:91], a[216:219], v[16:19]
    s_waitcnt lgkmcnt(6)
    v_mfma_f32_16x16x32_bf16 v[24:27], v[88:91], a[220:223], v[24:27]
    s_waitcnt lgkmcnt(5)
    v_mfma_f32_16x16x32_bf16 v[32:35], v[88:91], a[224:227], v[32:35]
    s_waitcnt lgkmcnt(4)
    v_mfma_f32_16x16x32_bf16 v[40:43], v[88:91], a[228:231], v[40:43]
    buffer_load_dwordx4 v[140:143], v5, s[20:23], s48 offen offset:1024
    s_waitcnt lgkmcnt(3)
    v_mfma_f32_16x16x32_bf16 v[48:51], v[88:91], a[232:235], v[48:51]
    s_waitcnt lgkmcnt(2)
    v_mfma_f32_16x16x32_bf16 v[56:59], v[88:91], a[236:239], v[56:59]
    s_waitcnt lgkmcnt(1)
    v_mfma_f32_16x16x32_bf16 v[64:67], v[88:91], a[240:243], v[64:67]
    s_waitcnt lgkmcnt(0)
    v_mfma_f32_16x16x32_bf16 v[72:75], v[88:91], a[244:247], v[72:75]
    buffer_load_dwordx4 v[144:147], v5, s[20:23], s49 offen offset:1024
    s_waitcnt vmcnt(13)
    v_mfma_f32_16x16x32_bf16 v[20:23], v[92:95], a[216:219], v[20:23]
    v_mfma_f32_16x16x32_bf16 v[28:31], v[92:95], a[220:223], v[28:31]
    v_mfma_f32_16x16x32_bf16 v[36:39], v[92:95], a[224:227], v[36:39]
    v_mfma_f32_16x16x32_bf16 v[44:47], v[92:95], a[228:231], v[44:47]
    buffer_load_dwordx4 v[148:151], v5, s[20:23], s50 offen offset:1024
    v_mfma_f32_16x16x32_bf16 v[52:55], v[92:95], a[232:235], v[52:55]
    v_mfma_f32_16x16x32_bf16 v[60:63], v[92:95], a[236:239], v[60:63]
    v_mfma_f32_16x16x32_bf16 v[68:71], v[92:95], a[240:243], v[68:71]
    v_mfma_f32_16x16x32_bf16 v[76:79], v[92:95], a[244:247], v[76:79]
    buffer_load_dwordx4 v[152:155], v5, s[20:23], s51 offen offset:1024
    s_waitcnt vmcnt(14)
    v_mfma_f32_16x16x32_bf16 a[0:3], v[96:99], a[216:219], a[0:3]
    v_mfma_f32_16x16x32_bf16 a[24:27], v[96:99], a[220:223], a[24:27]
    v_mfma_f32_16x16x32_bf16 a[48:51], v[96:99], a[224:227], a[48:51]
    v_mfma_f32_16x16x32_bf16 a[72:75], v[96:99], a[228:231], a[72:75]
    buffer_load_dwordx4 v[156:159], v5, s[20:23], s52 offen offset:1024
    v_mfma_f32_16x16x32_bf16 a[96:99], v[96:99], a[232:235], a[96:99]
    v_mfma_f32_16x16x32_bf16 a[120:123], v[96:99], a[236:239], a[120:123]
    v_mfma_f32_16x16x32_bf16 a[144:147], v[96:99], a[240:243], a[144:147]
    v_mfma_f32_16x16x32_bf16 a[168:171], v[96:99], a[244:247], a[168:171]
    s_lshl_b32 s12, s72, 7
    v_add_u32 v2, s12, v2
    s_add_u32 m0, s10, 8192
    s_nop 0
    buffer_load_dwordx4 v2, s[40:43], s53 offen lds
    s_waitcnt vmcnt(15)
    v_mfma_f32_16x16x32_bf16 a[4:7], v[100:103], a[216:219], a[4:7]
    v_mfma_f32_16x16x32_bf16 a[28:31], v[100:103], a[220:223], a[28:31]
    v_mfma_f32_16x16x32_bf16 a[52:55], v[100:103], a[224:227], a[52:55]
    v_mfma_f32_16x16x32_bf16 a[76:79], v[100:103], a[228:231], a[76:79]
    s_add_u32 m0, s10, 9216
    s_nop 0
    buffer_load_dwordx4 v2, s[40:43], s54 offen lds
    v_mfma_f32_16x16x32_bf16 a[100:103], v[100:103], a[232:235], a[100:103]
    v_mfma_f32_16x16x32_bf16 a[124:127], v[100:103], a[236:239], a[124:127]
    v_mfma_f32_16x16x32_bf16 a[148:151], v[100:103], a[240:243], a[148:151]
    v_mfma_f32_16x16x32_bf16 a[172:175], v[100:103], a[244:247], a[172:175]
    s_add_u32 m0, s10, 10240
    s_nop 0
    buffer_load_dwordx4 v2, s[40:43], s55 offen lds
    s_waitcnt vmcnt(16)
    v_mfma_f32_16x16x32_bf16 a[8:11], v[104:107], a[216:219], a[8:11]
    v_mfma_f32_16x16x32_bf16 a[32:35], v[104:107], a[220:223], a[32:35]
    v_mfma_f32_16x16x32_bf16 a[56:59], v[104:107], a[224:227], a[56:59]
    v_mfma_f32_16x16x32_bf16 a[80:83], v[104:107], a[228:231], a[80:83]
    s_add_u32 m0, s10, 11264
    s_nop 0
    buffer_load_dwordx4 v2, s[40:43], s56 offen lds
    v_mfma_f32_16x16x32_bf16 a[104:107], v[104:107], a[232:235], a[104:107]
    v_mfma_f32_16x16x32_bf16 a[128:131], v[104:107], a[236:239], a[128:131]
    v_mfma_f32_16x16x32_bf16 a[152:155], v[104:107], a[240:243], a[152:155]
    v_mfma_f32_16x16x32_bf16 a[176:179], v[104:107], a[244:247], a[176:179]
    s_add_u32 m0, s10, 12288
    s_nop 0
    buffer_load_dwordx4 v2, s[40:43], s57 offen lds
    s_waitcnt vmcnt(17)
    v_mfma_f32_16x16x32_bf16 a[12:15], v[108:111], a[216:219], a[12:15]
    ds_read_b128 a[248:251], v4 offset:32768
    v_mfma_f32_16x16x32_bf16 a[36:39], v[108:111], a[220:223], a[36:39]
    ds_read_b128 a[252:255], v4 offset:34816
    v_mfma_f32_16x16x32_bf16 a[60:63], v[108:111], a[224:227], a[60:63]
    ds_read_b128 v[232:235], v4 offset:36864
    v_mfma_f32_16x16x32_bf16 a[84:87], v[108:111], a[228:231], a[84:87]
    s_add_u32 m0, s10, 13312
    s_nop 0
    buffer_load_dwordx4 v2, s[40:43], s58 offen lds
    v_mfma_f32_16x16x32_bf16 a[108:111], v[108:111], a[232:235], a[108:111]
    ds_read_b128 v[236:239], v4 offset:38912
    v_mfma_f32_16x16x32_bf16 a[132:135], v[108:111], a[236:239], a[132:135]
    ds_read_b128 v[240:243], v4 offset:0
    v_mfma_f32_16x16x32_bf16 a[156:159], v[108:111], a[240:243], a[156:159]
    ds_read_b128 v[244:247], v4 offset:2048
    v_mfma_f32_16x16x32_bf16 a[180:183], v[108:111], a[244:247], a[180:183]
    s_add_u32 m0, s10, 14336
    s_nop 0
    buffer_load_dwordx4 v2, s[40:43], s59 offen lds
    s_waitcnt vmcnt(18)
    v_mfma_f32_16x16x32_bf16 a[16:19], v[112:115], a[216:219], a[16:19]
    ds_read_b128 v[248:251], v4 offset:4096
    v_mfma_f32_16x16x32_bf16 a[40:43], v[112:115], a[220:223], a[40:43]
    ds_read_b128 v[252:255], v4 offset:6144
    v_mfma_f32_16x16x32_bf16 a[64:67], v[112:115], a[224:227], a[64:67]
    v_mfma_f32_16x16x32_bf16 a[88:91], v[112:115], a[228:231], a[88:91]
    s_add_u32 m0, s10, 15360
    s_nop 0
    buffer_load_dwordx4 v2, s[40:43], s60 offen lds
    v_mfma_f32_16x16x32_bf16 a[112:115], v[112:115], a[232:235], a[112:115]
    v_mfma_f32_16x16x32_bf16 a[136:139], v[112:115], a[236:239], a[136:139]
    v_mfma_f32_16x16x32_bf16 a[160:163], v[112:115], a[240:243], a[160:163]
    v_mfma_f32_16x16x32_bf16 a[184:187], v[112:115], a[244:247], a[184:187]
    s_add_u32 m0, s10, 16384
    s_nop 0
    buffer_load_dwordx4 v2, s[40:43], s61 offen lds
    s_waitcnt vmcnt(19)
    v_mfma_f32_16x16x32_bf16 a[20:23], v[116:119], a[216:219], a[20:23]
    v_mfma_f32_16x16x32_bf16 a[44:47], v[116:119], a[220:223], a[44:47]
    v_mfma_f32_16x16x32_bf16 a[68:71], v[116:119], a[224:227], a[68:71]
    v_mfma_f32_16x16x32_bf16 a[92:95], v[116:119], a[228:231], a[92:95]
    s_add_u32 m0, s10, 17408
    s_nop 0
    buffer_load_dwordx4 v2, s[40:43], s62 offen lds
    v_mfma_f32_16x16x32_bf16 a[116:119], v[116:119], a[232:235], a[116:119]
    v_mfma_f32_16x16x32_bf16 a[140:143], v[116:119], a[236:239], a[140:143]
    v_mfma_f32_16x16x32_bf16 a[164:167], v[116:119], a[240:243], a[164:167]
    v_mfma_f32_16x16x32_bf16 a[188:191], v[116:119], a[244:247], a[188:191]
    s_add_u32 m0, s10, 18432
    s_nop 0
    buffer_load_dwordx4 v2, s[40:43], s63 offen lds
    s_waitcnt vmcnt(20)
    v_mfma_f32_16x16x32_bf16 v[80:83], v[120:123], a[216:219], v[80:83]
    v_mfma_f32_16x16x32_bf16 v[84:87], v[120:123], a[220:223], v[84:87]
    v_mfma_f32_16x16x32_bf16 a[192:195], v[120:123], a[224:227], a[192:195]
    v_mfma_f32_16x16x32_bf16 a[196:199], v[120:123], a[228:231], a[196:199]
    s_add_u32 m0, s10, 19456
    s_nop 0
    buffer_load_dwordx4 v2, s[40:43], s64 offen lds
    v_mfma_f32_16x16x32_bf16 a[200:203], v[120:123], a[232:235], a[200:203]
    v_mfma_f32_16x16x32_bf16 a[204:207], v[120:123], a[236:239], a[204:207]
    v_mfma_f32_16x16x32_bf16 a[208:211], v[120:123], a[240:243], a[208:211]
    v_mfma_f32_16x16x32_bf16 a[212:215], v[120:123], a[244:247], a[212:215]
    s_add_u32 m0, s10, 20480
    s_nop 0
    buffer_load_dwordx4 v2, s[40:43], s65 offen lds
    s_waitcnt vmcnt(21) lgkmcnt(7)
    v_mfma_f32_16x16x32_bf16 v[16:19], v[124:127], a[248:251], v[16:19]
    s_waitcnt lgkmcnt(6)
    v_mfma_f32_16x16x32_bf16 v[24:27], v[124:127], a[252:255], v[24:27]
    s_waitcnt lgkmcnt(5)
    v_mfma_f32_16x16x32_bf16 v[32:35], v[124:127], v[232:235], v[32:35]
    s_waitcnt lgkmcnt(4)
    v_mfma_f32_16x16x32_bf16 v[40:43], v[124:127], v[236:239], v[40:43]
    s_add_u32 m0, s10, 21504
    s_nop 0
    buffer_load_dwordx4 v2, s[40:43], s66 offen lds
    s_waitcnt lgkmcnt(3)
    v_mfma_f32_16x16x32_bf16 v[48:51], v[124:127], v[240:243], v[48:51]
    s_waitcnt lgkmcnt(2)
    v_mfma_f32_16x16x32_bf16 v[56:59], v[124:127], v[244:247], v[56:59]
    s_waitcnt lgkmcnt(1)
    v_mfma_f32_16x16x32_bf16 v[64:67], v[124:127], v[248:251], v[64:67]
    s_waitcnt lgkmcnt(0)
    v_mfma_f32_16x16x32_bf16 v[72:75], v[124:127], v[252:255], v[72:75]
    s_add_u32 m0, s10, 22528
    s_nop 0
    buffer_load_dwordx4 v2, s[40:43], s67 offen lds
    s_waitcnt vmcnt(22)
    v_mfma_f32_16x16x32_bf16 v[20:23], v[128:131], a[248:251], v[20:23]
    v_mfma_f32_16x16x32_bf16 v[28:31], v[128:131], a[252:255], v[28:31]
    v_mfma_f32_16x16x32_bf16 v[36:39], v[128:131], v[232:235], v[36:39]
    v_mfma_f32_16x16x32_bf16 v[44:47], v[128:131], v[236:239], v[44:47]
    s_add_u32 m0, s10, 23552
    s_nop 0
    buffer_load_dwordx4 v2, s[40:43], s68 offen lds
    v_mfma_f32_16x16x32_bf16 v[52:55], v[128:131], v[240:243], v[52:55]
    v_mfma_f32_16x16x32_bf16 v[60:63], v[128:131], v[244:247], v[60:63]
    v_mfma_f32_16x16x32_bf16 v[68:71], v[128:131], v[248:251], v[68:71]
    v_mfma_f32_16x16x32_bf16 v[76:79], v[128:131], v[252:255], v[76:79]
    s_lshl_b32 s12, s72, 11
    v_add_u32 v5, s12, v5
    buffer_load_dwordx4 v[160:163], v5, s[20:23], s44 offen offset:0
    s_waitcnt vmcnt(23)
    v_mfma_f32_16x16x32_bf16 a[0:3], v[132:135], a[248:251], a[0:3]
    v_mfma_f32_16x16x32_bf16 a[24:27], v[132:135], a[252:255], a[24:27]
    v_mfma_f32_16x16x32_bf16 a[48:51], v[132:135], v[232:235], a[48:51]
    v_mfma_f32_16x16x32_bf16 a[72:75], v[132:135], v[236:239], a[72:75]
    buffer_load_dwordx4 v[164:167], v5, s[20:23], s45 offen offset:0
    v_mfma_f32_16x16x32_bf16 a[96:99], v[132:135], v[240:243], a[96:99]
    v_mfma_f32_16x16x32_bf16 a[120:123], v[132:135], v[244:247], a[120:123]
    v_mfma_f32_16x16x32_bf16 a[144:147], v[132:135], v[248:251], a[144:147]
    v_mfma_f32_16x16x32_bf16 a[168:171], v[132:135], v[252:255], a[168:171]
    buffer_load_dwordx4 v[168:171], v5, s[20:23], s46 offen offset:0
    s_waitcnt vmcnt(24)
    v_mfma_f32_16x16x32_bf16 a[4:7], v[136:139], a[248:251], a[4:7]
    v_mfma_f32_16x16x32_bf16 a[28:31], v[136:139], a[252:255], a[28:31]
    v_mfma_f32_16x16x32_bf16 a[52:55], v[136:139], v[232:235], a[52:55]
    v_mfma_f32_16x16x32_bf16 a[76:79], v[136:139], v[236:239], a[76:79]
    buffer_load_dwordx4 v[172:175], v5, s[20:23], s47 offen offset:0
    v_mfma_f32_16x16x32_bf16 a[100:103], v[136:139], v[240:243], a[100:103]
    v_mfma_f32_16x16x32_bf16 a[124:127], v[136:139], v[244:247], a[124:127]
    v_mfma_f32_16x16x32_bf16 a[148:151], v[136:139], v[248:251], a[148:151]
    v_mfma_f32_16x16x32_bf16 a[172:175], v[136:139], v[252:255], a[172:175]
    buffer_load_dwordx4 v[176:179], v5, s[20:23], s48 offen offset:0
    s_waitcnt vmcnt(25)
    v_mfma_f32_16x16x32_bf16 a[8:11], v[140:143], a[248:251], a[8:11]
    v_mfma_f32_16x16x32_bf16 a[32:35], v[140:143], a[252:255], a[32:35]
    v_mfma_f32_16x16x32_bf16 a[56:59], v[140:143], v[232:235], a[56:59]
    v_mfma_f32_16x16x32_bf16 a[80:83], v[140:143], v[236:239], a[80:83]
    buffer_load_dwordx4 v[180:183], v5, s[20:23], s49 offen offset:0
    v_mfma_f32_16x16x32_bf16 a[104:107], v[140:143], v[240:243], a[104:107]
    v_mfma_f32_16x16x32_bf16 a[128:131], v[140:143], v[244:247], a[128:131]
    v_mfma_f32_16x16x32_bf16 a[152:155], v[140:143], v[248:251], a[152:155]
    v_mfma_f32_16x16x32_bf16 a[176:179], v[140:143], v[252:255], a[176:179]
    buffer_load_dwordx4 v[184:187], v5, s[20:23], s50 offen offset:0
    s_waitcnt vmcnt(26)
    v_mfma_f32_16x16x32_bf16 a[12:15], v[144:147], a[248:251], a[12:15]
    s_waitcnt vmcnt(21)
    ds_read_b128 a[216:219], v3 offset:8192
    v_mfma_f32_16x16x32_bf16 a[36:39], v[144:147], a[252:255], a[36:39]
    s_waitcnt vmcnt(19)
    ds_read_b128 a[220:223], v3 offset:10240
    v_mfma_f32_16x16x32_bf16 a[60:63], v[144:147], v[232:235], a[60:63]
    s_waitcnt vmcnt(17)
    ds_read_b128 a[224:227], v3 offset:12288
    v_mfma_f32_16x16x32_bf16 a[84:87], v[144:147], v[236:239], a[84:87]
    buffer_load_dwordx4 v[188:191], v5, s[20:23], s51 offen offset:0
    v_mfma_f32_16x16x32_bf16 a[108:111], v[144:147], v[240:243], a[108:111]
    s_waitcnt vmcnt(16)
    ds_read_b128 a[228:231], v3 offset:14336
    v_mfma_f32_16x16x32_bf16 a[132:135], v[144:147], v[244:247], a[132:135]
    s_waitcnt vmcnt(14)
    ds_read_b128 a[232:235], v3 offset:16384
    v_mfma_f32_16x16x32_bf16 a[156:159], v[144:147], v[248:251], a[156:159]
    s_waitcnt vmcnt(12)
    ds_read_b128 a[236:239], v3 offset:18432
    v_mfma_f32_16x16x32_bf16 a[180:183], v[144:147], v[252:255], a[180:183]
    buffer_load_dwordx4 v[192:195], v5, s[20:23], s52 offen offset:0
    v_mfma_f32_16x16x32_bf16 a[16:19], v[148:151], a[248:251], a[16:19]
    s_waitcnt vmcnt(11)
    ds_read_b128 a[240:243], v3 offset:20480
    v_mfma_f32_16x16x32_bf16 a[40:43], v[148:151], a[252:255], a[40:43]
    s_waitcnt vmcnt(9)
    ds_read_b128 a[244:247], v3 offset:22528
    v_mfma_f32_16x16x32_bf16 a[64:67], v[148:151], v[232:235], a[64:67]
    v_mfma_f32_16x16x32_bf16 a[88:91], v[148:151], v[236:239], a[88:91]
    buffer_load_dwordx4 v[196:199], v5, s[20:23], s44 offen offset:1024
    v_mfma_f32_16x16x32_bf16 a[112:115], v[148:151], v[240:243], a[112:115]
    v_mfma_f32_16x16x32_bf16 a[136:139], v[148:151], v[244:247], a[136:139]
    v_mfma_f32_16x16x32_bf16 a[160:163], v[148:151], v[248:251], a[160:163]
    v_mfma_f32_16x16x32_bf16 a[184:187], v[148:151], v[252:255], a[184:187]
    buffer_load_dwordx4 v[200:203], v5, s[20:23], s45 offen offset:1024
    v_mfma_f32_16x16x32_bf16 a[20:23], v[152:155], a[248:251], a[20:23]
    v_mfma_f32_16x16x32_bf16 a[44:47], v[152:155], a[252:255], a[44:47]
    v_mfma_f32_16x16x32_bf16 a[68:71], v[152:155], v[232:235], a[68:71]
    v_mfma_f32_16x16x32_bf16 a[92:95], v[152:155], v[236:239], a[92:95]
    buffer_load_dwordx4 v[204:207], v5, s[20:23], s46 offen offset:1024
    v_mfma_f32_16x16x32_bf16 a[116:119], v[152:155], v[240:243], a[116:119]
    v_mfma_f32_16x16x32_bf16 a[140:143], v[152:155], v[244:247], a[140:143]
    v_mfma_f32_16x16x32_bf16 a[164:167], v[152:155], v[248:251], a[164:167]
    v_mfma_f32_16x16x32_bf16 a[188:191], v[152:155], v[252:255], a[188:191]
    buffer_load_dwordx4 v[208:211], v5, s[20:23], s47 offen offset:1024
    v_mfma_f32_16x16x32_bf16 v[80:83], v[156:159], a[248:251], v[80:83]
    v_mfma_f32_16x16x32_bf16 v[84:87], v[156:159], a[252:255], v[84:87]
    v_mfma_f32_16x16x32_bf16 a[192:195], v[156:159], v[232:235], a[192:195]
    v_mfma_f32_16x16x32_bf16 a[196:199], v[156:159], v[236:239], a[196:199]
    buffer_load_dwordx4 v[212:215], v5, s[20:23], s48 offen offset:1024
    v_mfma_f32_16x16x32_bf16 a[200:203], v[156:159], v[240:243], a[200:203]
    v_mfma_f32_16x16x32_bf16 a[204:207], v[156:159], v[244:247], a[204:207]
    v_mfma_f32_16x16x32_bf16 a[208:211], v[156:159], v[248:251], a[208:211]
    v_mfma_f32_16x16x32_bf16 a[212:215], v[156:159], v[252:255], a[212:215]
    buffer_load_dwordx4 v[216:219], v5, s[20:23], s49 offen offset:1024
    s_waitcnt vmcnt(14) lgkmcnt(7)
    v_mfma_f32_16x16x32_bf16 v[16:19], v[160:163], a[216:219], v[16:19]
    s_waitcnt lgkmcnt(6)
    v_mfma_f32_16x16x32_bf16 v[24:27], v[160:163], a[220:223], v[24:27]
    s_waitcnt lgkmcnt(5)
    v_mfma_f32_16x16x32_bf16 v[32:35], v[160:163], a[224:227], v[32:35]
    s_waitcnt lgkmcnt(4)
    v_mfma_f32_16x16x32_bf16 v[40:43], v[160:163], a[228:231], v[40:43]
    buffer_load_dwordx4 v[220:223], v5, s[20:23], s50 offen offset:1024
    s_waitcnt lgkmcnt(3)
    v_mfma_f32_16x16x32_bf16 v[48:51], v[160:163], a[232:235], v[48:51]
    s_waitcnt lgkmcnt(2)
    v_mfma_f32_16x16x32_bf16 v[56:59], v[160:163], a[236:239], v[56:59]
    s_waitcnt lgkmcnt(1)
    v_mfma_f32_16x16x32_bf16 v[64:67], v[160:163], a[240:243], v[64:67]
    s_waitcnt lgkmcnt(0)
    v_mfma_f32_16x16x32_bf16 v[72:75], v[160:163], a[244:247], v[72:75]
    buffer_load_dwordx4 v[224:227], v5, s[20:23], s51 offen offset:1024
    s_waitcnt vmcnt(15)
    v_mfma_f32_16x16x32_bf16 v[20:23], v[164:167], a[216:219], v[20:23]
    v_mfma_f32_16x16x32_bf16 v[28:31], v[164:167], a[220:223], v[28:31]
    v_mfma_f32_16x16x32_bf16 v[36:39], v[164:167], a[224:227], v[36:39]
    v_mfma_f32_16x16x32_bf16 v[44:47], v[164:167], a[228:231], v[44:47]
    buffer_load_dwordx4 v[228:231], v5, s[20:23], s52 offen offset:1024
    v_mfma_f32_16x16x32_bf16 v[52:55], v[164:167], a[232:235], v[52:55]
    v_mfma_f32_16x16x32_bf16 v[60:63], v[164:167], a[236:239], v[60:63]
    v_mfma_f32_16x16x32_bf16 v[68:71], v[164:167], a[240:243], v[68:71]
    v_mfma_f32_16x16x32_bf16 v[76:79], v[164:167], a[244:247], v[76:79]
    s_lshl_b32 s12, s73, 7
    v_add_u32 v2, s12, v2
    s_add_u32 m0, s10, 24576
    s_nop 0
    buffer_load_dwordx4 v2, s[40:43], s53 offen lds
    s_waitcnt vmcnt(16)
    v_mfma_f32_16x16x32_bf16 a[0:3], v[168:171], a[216:219], a[0:3]
    v_mfma_f32_16x16x32_bf16 a[24:27], v[168:171], a[220:223], a[24:27]
    v_mfma_f32_16x16x32_bf16 a[48:51], v[168:171], a[224:227], a[48:51]
    v_mfma_f32_16x16x32_bf16 a[72:75], v[168:171], a[228:231], a[72:75]
    s_add_u32 m0, s10, 25600
    s_nop 0
    buffer_load_dwordx4 v2, s[40:43], s54 offen lds
    v_mfma_f32_16x16x32_bf16 a[96:99], v[168:171], a[232:235], a[96:99]
    v_mfma_f32_16x16x32_bf16 a[120:123], v[168:171], a[236:239], a[120:123]
    v_mfma_f32_16x16x32_bf16 a[144:147], v[168:171], a[240:243], a[144:147]
    v_mfma_f32_16x16x32_bf16 a[168:171], v[168:171], a[244:247], a[168:171]
    s_add_u32 m0, s10, 26624
    s_nop 0
    buffer_load_dwordx4 v2, s[40:43], s55 offen lds
    s_waitcnt vmcnt(17)
    v_mfma_f32_16x16x32_bf16 a[4:7], v[172:175], a[216:219], a[4:7]
    v_mfma_f32_16x16x32_bf16 a[28:31], v[172:175], a[220:223], a[28:31]
    v_mfma_f32_16x16x32_bf16 a[52:55], v[172:175], a[224:227], a[52:55]
    v_mfma_f32_16x16x32_bf16 a[76:79], v[172:175], a[228:231], a[76:79]
    s_add_u32 m0, s10, 27648
    s_nop 0
    buffer_load_dwordx4 v2, s[40:43], s56 offen lds
    v_mfma_f32_16x16x32_bf16 a[100:103], v[172:175], a[232:235], a[100:103]
    v_mfma_f32_16x16x32_bf16 a[124:127], v[172:175], a[236:239], a[124:127]
    v_mfma_f32_16x16x32_bf16 a[148:151], v[172:175], a[240:243], a[148:151]
    v_mfma_f32_16x16x32_bf16 a[172:175], v[172:175], a[244:247], a[172:175]
    s_add_u32 m0, s10, 28672
    s_nop 0
    buffer_load_dwordx4 v2, s[40:43], s57 offen lds
    s_waitcnt vmcnt(18)
    v_mfma_f32_16x16x32_bf16 a[8:11], v[176:179], a[216:219], a[8:11]
    v_mfma_f32_16x16x32_bf16 a[32:35], v[176:179], a[220:223], a[32:35]
    v_mfma_f32_16x16x32_bf16 a[56:59], v[176:179], a[224:227], a[56:59]
    v_mfma_f32_16x16x32_bf16 a[80:83], v[176:179], a[228:231], a[80:83]
    s_add_u32 m0, s10, 29696
    s_nop 0
    buffer_load_dwordx4 v2, s[40:43], s58 offen lds
    v_mfma_f32_16x16x32_bf16 a[104:107], v[176:179], a[232:235], a[104:107]
    v_mfma_f32_16x16x32_bf16 a[128:131], v[176:179], a[236:239], a[128:131]
    v_mfma_f32_16x16x32_bf16 a[152:155], v[176:179], a[240:243], a[152:155]
    v_mfma_f32_16x16x32_bf16 a[176:179], v[176:179], a[244:247], a[176:179]
    s_add_u32 m0, s10, 30720
    s_nop 0
    buffer_load_dwordx4 v2, s[40:43], s59 offen lds
    s_waitcnt vmcnt(19)
    v_mfma_f32_16x16x32_bf16 a[12:15], v[180:183], a[216:219], a[12:15]
    ds_read_b128 a[248:251], v4 offset:8192
    v_mfma_f32_16x16x32_bf16 a[36:39], v[180:183], a[220:223], a[36:39]
    ds_read_b128 a[252:255], v4 offset:10240
    v_mfma_f32_16x16x32_bf16 a[60:63], v[180:183], a[224:227], a[60:63]
    ds_read_b128 v[232:235], v4 offset:12288
    v_mfma_f32_16x16x32_bf16 a[84:87], v[180:183], a[228:231], a[84:87]
    s_add_u32 m0, s10, 31744
    s_nop 0
    buffer_load_dwordx4 v2, s[40:43], s60 offen lds
    v_mfma_f32_16x16x32_bf16 a[108:111], v[180:183], a[232:235], a[108:111]
    ds_read_b128 v[236:239], v4 offset:14336
    v_mfma_f32_16x16x32_bf16 a[132:135], v[180:183], a[236:239], a[132:135]
    ds_read_b128 v[240:243], v4 offset:16384
    v_mfma_f32_16x16x32_bf16 a[156:159], v[180:183], a[240:243], a[156:159]
    ds_read_b128 v[244:247], v4 offset:18432
    v_mfma_f32_16x16x32_bf16 a[180:183], v[180:183], a[244:247], a[180:183]
    s_add_u32 m0, s10, 32768
    s_nop 0
    buffer_load_dwordx4 v2, s[40:43], s61 offen lds
    s_waitcnt vmcnt(20)
    v_mfma_f32_16x16x32_bf16 a[16:19], v[184:187], a[216:219], a[16:19]
    ds_read_b128 v[248:251], v4 offset:20480
    v_mfma_f32_16x16x32_bf16 a[40:43], v[184:187], a[220:223], a[40:43]
    ds_read_b128 v[252:255], v4 offset:22528
    v_mfma_f32_16x16x32_bf16 a[64:67], v[184:187], a[224:227], a[64:67]
    v_mfma_f32_16x16x32_bf16 a[88:91], v[184:187], a[228:231], a[88:91]
    s_add_u32 m0, s10, 33792
    s_nop 0
    buffer_load_dwordx4 v2, s[40:43], s62 offen lds
    v_mfma_f32_16x16x32_bf16 a[112:115], v[184:187], a[232:235], a[112:115]
    v_mfma_f32_16x16x32_bf16 a[136:139], v[184:187], a[236:239], a[136:139]
    v_mfma_f32_16x16x32_bf16 a[160:163], v[184:187], a[240:243], a[160:163]
    v_mfma_f32_16x16x32_bf16 a[184:187], v[184:187], a[244:247], a[184:187]
    s_add_u32 m0, s10, 34816
    s_nop 0
    buffer_load_dwordx4 v2, s[40:43], s63 offen lds
    s_waitcnt vmcnt(21)
    v_mfma_f32_16x16x32_bf16 a[20:23], v[188:191], a[216:219], a[20:23]
    v_mfma_f32_16x16x32_bf16 a[44:47], v[188:191], a[220:223], a[44:47]
    v_mfma_f32_16x16x32_bf16 a[68:71], v[188:191], a[224:227], a[68:71]
    v_mfma_f32_16x16x32_bf16 a[92:95], v[188:191], a[228:231], a[92:95]
    s_add_u32 m0, s10, 35840
    s_nop 0
    buffer_load_dwordx4 v2, s[40:43], s64 offen lds
    v_mfma_f32_16x16x32_bf16 a[116:119], v[188:191], a[232:235], a[116:119]
    v_mfma_f32_16x16x32_bf16 a[140:143], v[188:191], a[236:239], a[140:143]
    v_mfma_f32_16x16x32_bf16 a[164:167], v[188:191], a[240:243], a[164:167]
    v_mfma_f32_16x16x32_bf16 a[188:191], v[188:191], a[244:247], a[188:191]
    s_add_u32 m0, s10, 36864
    s_nop 0
    buffer_load_dwordx4 v2, s[40:43], s65 offen lds
    s_waitcnt vmcnt(22)
    v_mfma_f32_16x16x32_bf16 v[80:83], v[192:195], a[216:219], v[80:83]
    v_mfma_f32_16x16x32_bf16 v[84:87], v[192:195], a[220:223], v[84:87]
    v_mfma_f32_16x16x32_bf16 a[192:195], v[192:195], a[224:227], a[192:195]
    v_mfma_f32_16x16x32_bf16 a[196:199], v[192:195], a[228:231], a[196:199]
    s_add_u32 m0, s10, 37888
    s_nop 0
    buffer_load_dwordx4 v2, s[40:43], s66 offen lds
    v_mfma_f32_16x16x32_bf16 a[200:203], v[192:195], a[232:235], a[200:203]
    v_mfma_f32_16x16x32_bf16 a[204:207], v[192:195], a[236:239], a[204:207]
    v_mfma_f32_16x16x32_bf16 a[208:211], v[192:195], a[240:243], a[208:211]
    v_mfma_f32_16x16x32_bf16 a[212:215], v[192:195], a[244:247], a[212:215]
    s_add_u32 m0, s10, 38912
    s_nop 0
    buffer_load_dwordx4 v2, s[40:43], s67 offen lds
    s_waitcnt vmcnt(23) lgkmcnt(7)
    v_mfma_f32_16x16x32_bf16 v[16:19], v[196:199], a[248:251], v[16:19]
    s_waitcnt lgkmcnt(6)
    v_mfma_f32_16x16x32_bf16 v[24:27], v[196:199], a[252:255], v[24:27]
    s_waitcnt lgkmcnt(5)
    v_mfma_f32_16x16x32_bf16 v[32:35], v[196:199], v[232:235], v[32:35]
    s_waitcnt lgkmcnt(4)
    v_mfma_f32_16x16x32_bf16 v[40:43], v[196:199], v[236:239], v[40:43]
    s_add_u32 m0, s10, 39936
    s_nop 0
    buffer_load_dwordx4 v2, s[40:43], s68 offen lds
    s_waitcnt lgkmcnt(3)
    v_mfma_f32_16x16x32_bf16 v[48:51], v[196:199], v[240:243], v[48:51]
    s_waitcnt lgkmcnt(2)
    v_mfma_f32_16x16x32_bf16 v[56:59], v[196:199], v[244:247], v[56:59]
    s_waitcnt lgkmcnt(1)
    v_mfma_f32_16x16x32_bf16 v[64:67], v[196:199], v[248:251], v[64:67]
    s_waitcnt lgkmcnt(0)
    v_mfma_f32_16x16x32_bf16 v[72:75], v[196:199], v[252:255], v[72:75]
    s_lshl_b32 s12, s73, 11
    v_add_u32 v5, s12, v5
    buffer_load_dwordx4 v[88:91], v5, s[20:23], s44 offen offset:0
    s_waitcnt vmcnt(24)
    v_mfma_f32_16x16x32_bf16 v[20:23], v[200:203], a[248:251], v[20:23]
    v_mfma_f32_16x16x32_bf16 v[28:31], v[200:203], a[252:255], v[28:31]
    v_mfma_f32_16x16x32_bf16 v[36:39], v[200:203], v[232:235], v[36:39]
    v_mfma_f32_16x16x32_bf16 v[44:47], v[200:203], v[236:239], v[44:47]
    buffer_load_dwordx4 v[92:95], v5, s[20:23], s45 offen offset:0
    v_mfma_f32_16x16x32_bf16 v[52:55], v[200:203], v[240:243], v[52:55]
    v_mfma_f32_16x16x32_bf16 v[60:63], v[200:203], v[244:247], v[60:63]
    v_mfma_f32_16x16x32_bf16 v[68:71], v[200:203], v[248:251], v[68:71]
    v_mfma_f32_16x16x32_bf16 v[76:79], v[200:203], v[252:255], v[76:79]
    buffer_load_dwordx4 v[96:99], v5, s[20:23], s46 offen offset:0
    s_waitcnt vmcnt(25)
    v_mfma_f32_16x16x32_bf16 a[0:3], v[204:207], a[248:251], a[0:3]
    v_mfma_f32_16x16x32_bf16 a[24:27], v[204:207], a[252:255], a[24:27]
    v_mfma_f32_16x16x32_bf16 a[48:51], v[204:207], v[232:235], a[48:51]
    v_mfma_f32_16x16x32_bf16 a[72:75], v[204:207], v[236:239], a[72:75]
    buffer_load_dwordx4 v[100:103], v5, s[20:23], s47 offen offset:0
    v_mfma_f32_16x16x32_bf16 a[96:99], v[204:207], v[240:243], a[96:99]
    v_mfma_f32_16x16x32_bf16 a[120:123], v[204:207], v[244:247], a[120:123]
    v_mfma_f32_16x16x32_bf16 a[144:147], v[204:207], v[248:251], a[144:147]
    v_mfma_f32_16x16x32_bf16 a[168:171], v[204:207], v[252:255], a[168:171]
    buffer_load_dwordx4 v[104:107], v5, s[20:23], s48 offen offset:0
    s_waitcnt vmcnt(26)
    v_mfma_f32_16x16x32_bf16 a[4:7], v[208:211], a[248:251], a[4:7]
    v_mfma_f32_16x16x32_bf16 a[28:31], v[208:211], a[252:255], a[28:31]
    v_mfma_f32_16x16x32_bf16 a[52:55], v[208:211], v[232:235], a[52:55]
    v_mfma_f32_16x16x32_bf16 a[76:79], v[208:211], v[236:239], a[76:79]
    buffer_load_dwordx4 v[108:111], v5, s[20:23], s49 offen offset:0
    v_mfma_f32_16x16x32_bf16 a[100:103], v[208:211], v[240:243], a[100:103]
    v_mfma_f32_16x16x32_bf16 a[124:127], v[208:211], v[244:247], a[124:127]
    v_mfma_f32_16x16x32_bf16 a[148:151], v[208:211], v[248:251], a[148:151]
    v_mfma_f32_16x16x32_bf16 a[172:175], v[208:211], v[252:255], a[172:175]
    buffer_load_dwordx4 v[112:115], v5, s[20:23], s50 offen offset:0
    s_waitcnt vmcnt(27)
    v_mfma_f32_16x16x32_bf16 a[8:11], v[212:215], a[248:251], a[8:11]
    v_mfma_f32_16x16x32_bf16 a[32:35], v[212:215], a[252:255], a[32:35]
    v_mfma_f32_16x16x32_bf16 a[56:59], v[212:215], v[232:235], a[56:59]
    v_mfma_f32_16x16x32_bf16 a[80:83], v[212:215], v[236:239], a[80:83]
    buffer_load_dwordx4 v[116:119], v5, s[20:23], s51 offen offset:0
    v_mfma_f32_16x16x32_bf16 a[104:107], v[212:215], v[240:243], a[104:107]
    v_mfma_f32_16x16x32_bf16 a[128:131], v[212:215], v[244:247], a[128:131]
    v_mfma_f32_16x16x32_bf16 a[152:155], v[212:215], v[248:251], a[152:155]
    v_mfma_f32_16x16x32_bf16 a[176:179], v[212:215], v[252:255], a[176:179]
    buffer_load_dwordx4 v[120:123], v5, s[20:23], s52 offen offset:0
    s_waitcnt vmcnt(28)
    v_mfma_f32_16x16x32_bf16 a[12:15], v[216:219], a[248:251], a[12:15]
    s_waitcnt vmcnt(23)
    ds_read_b128 a[216:219], v3 offset:24576
    v_mfma_f32_16x16x32_bf16 a[36:39], v[216:219], a[252:255], a[36:39]
    s_waitcnt vmcnt(21)
    ds_read_b128 a[220:223], v3 offset:26624
    v_mfma_f32_16x16x32_bf16 a[60:63], v[216:219], v[232:235], a[60:63]
    s_waitcnt vmcnt(19)
    ds_read_b128 a[224:227], v3 offset:28672
    v_mfma_f32_16x16x32_bf16 a[84:87], v[216:219], v[236:239], a[84:87]
    buffer_load_dwordx4 v[124:127], v5, s[20:23], s44 offen offset:1024
    v_mfma_f32_16x16x32_bf16 a[108:111], v[216:219], v[240:243], a[108:111]
    s_waitcnt vmcnt(18)
    ds_read_b128 a[228:231], v3 offset:30720
    v_mfma_f32_16x16x32_bf16 a[132:135], v[216:219], v[244:247], a[132:135]
    s_waitcnt vmcnt(16)
    ds_read_b128 a[232:235], v3 offset:32768
    v_mfma_f32_16x16x32_bf16 a[156:159], v[216:219], v[248:251], a[156:159]
    s_waitcnt vmcnt(14)
    ds_read_b128 a[236:239], v3 offset:34816
    v_mfma_f32_16x16x32_bf16 a[180:183], v[216:219], v[252:255], a[180:183]
    buffer_load_dwordx4 v[128:131], v5, s[20:23], s45 offen offset:1024
    v_mfma_f32_16x16x32_bf16 a[16:19], v[220:223], a[248:251], a[16:19]
    s_waitcnt vmcnt(13)
    ds_read_b128 a[240:243], v3 offset:36864
    v_mfma_f32_16x16x32_bf16 a[40:43], v[220:223], a[252:255], a[40:43]
    s_waitcnt vmcnt(11)
    ds_read_b128 a[244:247], v3 offset:38912
    v_mfma_f32_16x16x32_bf16 a[64:67], v[220:223], v[232:235], a[64:67]
    v_mfma_f32_16x16x32_bf16 a[88:91], v[220:223], v[236:239], a[88:91]
    buffer_load_dwordx4 v[132:135], v5, s[20:23], s46 offen offset:1024
    v_mfma_f32_16x16x32_bf16 a[112:115], v[220:223], v[240:243], a[112:115]
    v_mfma_f32_16x16x32_bf16 a[136:139], v[220:223], v[244:247], a[136:139]
    v_mfma_f32_16x16x32_bf16 a[160:163], v[220:223], v[248:251], a[160:163]
    v_mfma_f32_16x16x32_bf16 a[184:187], v[220:223], v[252:255], a[184:187]
    buffer_load_dwordx4 v[136:139], v5, s[20:23], s47 offen offset:1024
    v_mfma_f32_16x16x32_bf16 a[20:23], v[224:227], a[248:251], a[20:23]
    v_mfma_f32_16x16x32_bf16 a[44:47], v[224:227], a[252:255], a[44:47]
    v_mfma_f32_16x16x32_bf16 a[68:71], v[224:227], v[232:235], a[68:71]
    v_mfma_f32_16x16x32_bf16 a[92:95], v[224:227], v[236:239], a[92:95]
    buffer_load_dwordx4 v[140:143], v5, s[20:23], s48 offen offset:1024
    v_mfma_f32_16x16x32_bf16 a[116:119], v[224:227], v[240:243], a[116:119]
    v_mfma_f32_16x16x32_bf16 a[140:143], v[224:227], v[244:247], a[140:143]
    v_mfma_f32_16x16x32_bf16 a[164:167], v[224:227], v[248:251], a[164:167]
    v_mfma_f32_16x16x32_bf16 a[188:191], v[224:227], v[252:255], a[188:191]
    buffer_load_dwordx4 v[144:147], v5, s[20:23], s49 offen offset:1024
    v_mfma_f32_16x16x32_bf16 v[80:83], v[228:231], a[248:251], v[80:83]
    v_mfma_f32_16x16x32_bf16 v[84:87], v[228:231], a[252:255], v[84:87]
    v_mfma_f32_16x16x32_bf16 a[192:195], v[228:231], v[232:235], a[192:195]
    v_mfma_f32_16x16x32_bf16 a[196:199], v[228:231], v[236:239], a[196:199]
    buffer_load_dwordx4 v[148:151], v5, s[20:23], s50 offen offset:1024
    v_mfma_f32_16x16x32_bf16 a[200:203], v[228:231], v[240:243], a[200:203]
    v_mfma_f32_16x16x32_bf16 a[204:207], v[228:231], v[244:247], a[204:207]
    v_mfma_f32_16x16x32_bf16 a[208:211], v[228:231], v[248:251], a[208:211]
    v_mfma_f32_16x16x32_bf16 a[212:215], v[228:231], v[252:255], a[212:215]
    buffer_load_dwordx4 v[152:155], v5, s[20:23], s51 offen offset:1024
    s_waitcnt vmcnt(16) lgkmcnt(7)
    v_mfma_f32_16x16x32_bf16 v[16:19], v[88:91], a[216:219], v[16:19]
    s_waitcnt lgkmcnt(6)
    v_mfma_f32_16x16x32_bf16 v[24:27], v[88:91], a[220:223], v[24:27]
    s_waitcnt lgkmcnt(5)
    v_mfma_f32_16x16x32_bf16 v[32:35], v[88:91], a[224:227], v[32:35]
    s_waitcnt lgkmcnt(4)
    v_mfma_f32_16x16x32_bf16 v[40:43], v[88:91], a[228:231], v[40:43]
    buffer_load_dwordx4 v[156:159], v5, s[20:23], s52 offen offset:1024
    s_waitcnt lgkmcnt(3)
    v_mfma_f32_16x16x32_bf16 v[48:51], v[88:91], a[232:235], v[48:51]
    s_waitcnt lgkmcnt(2)
    v_mfma_f32_16x16x32_bf16 v[56:59], v[88:91], a[236:239], v[56:59]
    s_waitcnt lgkmcnt(1)
    v_mfma_f32_16x16x32_bf16 v[64:67], v[88:91], a[240:243], v[64:67]
    s_waitcnt lgkmcnt(0)
    v_mfma_f32_16x16x32_bf16 v[72:75], v[88:91], a[244:247], v[72:75]
    s_lshl_b32 s12, s74, 7
    v_add_u32 v2, s12, v2
    s_add_u32 m0, s10, 0
    s_nop 0
    buffer_load_dwordx4 v2, s[40:43], s53 offen lds
    s_waitcnt vmcnt(17)
    v_mfma_f32_16x16x32_bf16 v[20:23], v[92:95], a[216:219], v[20:23]
    v_mfma_f32_16x16x32_bf16 v[28:31], v[92:95], a[220:223], v[28:31]
    v_mfma_f32_16x16x32_bf16 v[36:39], v[92:95], a[224:227], v[36:39]
    v_mfma_f32_16x16x32_bf16 v[44:47], v[92:95], a[228:231], v[44:47]
    s_add_u32 m0, s10, 1024
    s_nop 0
    buffer_load_dwordx4 v2, s[40:43], s54 offen lds
    v_mfma_f32_16x16x32_bf16 v[52:55], v[92:95], a[232:235], v[52:55]
    v_mfma_f32_16x16x32_bf16 v[60:63], v[92:95], a[236:239], v[60:63]
    v_mfma_f32_16x16x32_bf16 v[68:71], v[92:95], a[240:243], v[68:71]
    v_mfma_f32_16x16x32_bf16 v[76:79], v[92:95], a[244:247], v[76:79]
    s_add_u32 m0, s10, 2048
    s_nop 0
    buffer_load_dwordx4 v2, s[40:43], s55 offen lds
    s_waitcnt vmcnt(18)
    v_mfma_f32_16x16x32_bf16 a[0:3], v[96:99], a[216:219], a[0:3]
    v_mfma_f32_16x16x32_bf16 a[24:27], v[96:99], a[220:223], a[24:27]
    v_mfma_f32_16x16x32_bf16 a[48:51], v[96:99], a[224:227], a[48:51]
    v_mfma_f32_16x16x32_bf16 a[72:75], v[96:99], a[228:231], a[72:75]
    s_add_u32 m0, s10, 3072
    s_nop 0
    buffer_load_dwordx4 v2, s[40:43], s56 offen lds
    v_mfma_f32_16x16x32_bf16 a[96:99], v[96:99], a[232:235], a[96:99]
    v_mfma_f32_16x16x32_bf16 a[120:123], v[96:99], a[236:239], a[120:123]
    v_mfma_f32_16x16x32_bf16 a[144:147], v[96:99], a[240:243], a[144:147]
    v_mfma_f32_16x16x32_bf16 a[168:171], v[96:99], a[244:247], a[168:171]
    s_add_u32 m0, s10, 4096
    s_nop 0
    buffer_load_dwordx4 v2, s[40:43], s57 offen lds
    s_waitcnt vmcnt(19)
    v_mfma_f32_16x16x32_bf16 a[4:7], v[100:103], a[216:219], a[4:7]
    v_mfma_f32_16x16x32_bf16 a[28:31], v[100:103], a[220:223], a[28:31]
    v_mfma_f32_16x16x32_bf16 a[52:55], v[100:103], a[224:227], a[52:55]
    v_mfma_f32_16x16x32_bf16 a[76:79], v[100:103], a[228:231], a[76:79]
    s_add_u32 m0, s10, 5120
    s_nop 0
    buffer_load_dwordx4 v2, s[40:43], s58 offen lds
    v_mfma_f32_16x16x32_bf16 a[100:103], v[100:103], a[232:235], a[100:103]
    v_mfma_f32_16x16x32_bf16 a[124:127], v[100:103], a[236:239], a[124:127]
    v_mfma_f32_16x16x32_bf16 a[148:151], v[100:103], a[240:243], a[148:151]
    v_mfma_f32_16x16x32_bf16 a[172:175], v[100:103], a[244:247], a[172:175]
    s_add_u32 m0, s10, 6144
    s_nop 0
    buffer_load_dwordx4 v2, s[40:43], s59 offen lds
    s_waitcnt vmcnt(20)
    v_mfma_f32_16x16x32_bf16 a[8:11], v[104:107], a[216:219], a[8:11]
    v_mfma_f32_16x16x32_bf16 a[32:35], v[104:107], a[220:223], a[32:35]
    v_mfma_f32_16x16x32_bf16 a[56:59], v[104:107], a[224:227], a[56:59]
    v_mfma_f32_16x16x32_bf16 a[80:83], v[104:107], a[228:231], a[80:83]
    s_add_u32 m0, s10, 7168
    s_nop 0
    buffer_load_dwordx4 v2, s[40:43], s60 offen lds
    v_mfma_f32_16x16x32_bf16 a[104:107], v[104:107], a[232:235], a[104:107]
    v_mfma_f32_16x16x32_bf16 a[128:131], v[104:107], a[236:239], a[128:131]
    v_mfma_f32_16x16x32_bf16 a[152:155], v[104:107], a[240:243], a[152:155]
    v_mfma_f32_16x16x32_bf16 a[176:179], v[104:107], a[244:247], a[176:179]
    s_add_u32 m0, s10, 8192
    s_nop 0
    buffer_load_dwordx4 v2, s[40:43], s61 offen lds
    s_waitcnt vmcnt(21)
    v_mfma_f32_16x16x32_bf16 a[12:15], v[108:111], a[216:219], a[12:15]
    ds_read_b128 a[248:251], v4 offset:24576
    v_mfma_f32_16x16x32_bf16 a[36:39], v[108:111], a[220:223], a[36:39]
    ds_read_b128 a[252:255], v4 offset:26624
    v_mfma_f32_16x16x32_bf16 a[60:63], v[108:111], a[224:227], a[60:63]
    ds_read_b128 v[232:235], v4 offset:28672
    v_mfma_f32_16x16x32_bf16 a[84:87], v[108:111], a[228:231], a[84:87]
    s_add_u32 m0, s10, 9216
    s_nop 0
    buffer_load_dwordx4 v2, s[40:43], s62 offen lds
    v_mfma_f32_16x16x32_bf16 a[108:111], v[108:111], a[232:235], a[108:111]
    ds_read_b128 v[236:239], v4 offset:30720
    v_mfma_f32_16x16x32_bf16 a[132:135], v[108:111], a[236:239], a[132:135]
    ds_read_b128 v[240:243], v4 offset:32768
    v_mfma_f32_16x16x32_bf16 a[156:159], v[108:111], a[240:243], a[156:159]
    ds_read_b128 v[244:247], v4 offset:34816
    v_mfma_f32_16x16x32_bf16 a[180:183], v[108:111], a[244:247], a[180:183]
    s_add_u32 m0, s10, 10240
    s_nop 0
    buffer_load_dwordx4 v2, s[40:43], s63 offen lds
    s_waitcnt vmcnt(22)
    v_mfma_f32_16x16x32_bf16 a[16:19], v[112:115], a[216:219], a[16:19]
    ds_read_b128 v[248:251], v4 offset:36864
    v_mfma_f32_16x16x32_bf16 a[40:43], v[112:115], a[220:223], a[40:43]
    ds_read_b128 v[252:255], v4 offset:38912
    v_mfma_f32_16x16x32_bf16 a[64:67], v[112:115], a[224:227], a[64:67]
    v_mfma_f32_16x16x32_bf16 a[88:91], v[112:115], a[228:231], a[88:91]
    s_add_u32 m0, s10, 11264
    s_nop 0
    buffer_load_dwordx4 v2, s[40:43], s64 offen lds
    v_mfma_f32_16x16x32_bf16 a[112:115], v[112:115], a[232:235], a[112:115]
    v_mfma_f32_16x16x32_bf16 a[136:139], v[112:115], a[236:239], a[136:139]
    v_mfma_f32_16x16x32_bf16 a[160:163], v[112:115], a[240:243], a[160:163]
    v_mfma_f32_16x16x32_bf16 a[184:187], v[112:115], a[244:247], a[184:187]
    s_add_u32 m0, s10, 12288
    s_nop 0
    buffer_load_dwordx4 v2, s[40:43], s65 offen lds
    s_waitcnt vmcnt(23)
    v_mfma_f32_16x16x32_bf16 a[20:23], v[116:119], a[216:219], a[20:23]
    v_mfma_f32_16x16x32_bf16 a[44:47], v[116:119], a[220:223], a[44:47]
    v_mfma_f32_16x16x32_bf16 a[68:71], v[116:119], a[224:227], a[68:71]
    v_mfma_f32_16x16x32_bf16 a[92:95], v[116:119], a[228:231], a[92:95]
    s_add_u32 m0, s10, 13312
    s_nop 0
    buffer_load_dwordx4 v2, s[40:43], s66 offen lds
    v_mfma_f32_16x16x32_bf16 a[116:119], v[116:119], a[232:235], a[116:119]
    v_mfma_f32_16x16x32_bf16 a[140:143], v[116:119], a[236:239], a[140:143]
    v_mfma_f32_16x16x32_bf16 a[164:167], v[116:119], a[240:243], a[164:167]
    v_mfma_f32_16x16x32_bf16 a[188:191], v[116:119], a[244:247], a[188:191]
    s_add_u32 m0, s10, 14336
    s_nop 0
    buffer_load_dwordx4 v2, s[40:43], s67 offen lds
    s_waitcnt vmcnt(24)
    v_mfma_f32_16x16x32_bf16 v[80:83], v[120:123], a[216:219], v[80:83]
    v_mfma_f32_16x16x32_bf16 v[84:87], v[120:123], a[220:223], v[84:87]
    v_mfma_f32_16x16x32_bf16 a[192:195], v[120:123], a[224:227], a[192:195]
    v_mfma_f32_16x16x32_bf16 a[196:199], v[120:123], a[228:231], a[196:199]
    s_add_u32 m0, s10, 15360
    s_nop 0
    buffer_load_dwordx4 v2, s[40:43], s68 offen lds
    v_mfma_f32_16x16x32_bf16 a[200:203], v[120:123], a[232:235], a[200:203]
    v_mfma_f32_16x16x32_bf16 a[204:207], v[120:123], a[236:239], a[204:207]
    v_mfma_f32_16x16x32_bf16 a[208:211], v[120:123], a[240:243], a[208:211]
    v_mfma_f32_16x16x32_bf16 a[212:215], v[120:123], a[244:247], a[212:215]
    s_lshl_b32 s12, s74, 11
    v_add_u32 v5, s12, v5
    buffer_load_dwordx4 v[160:163], v5, s[20:23], s44 offen offset:0
    s_waitcnt vmcnt(25) lgkmcnt(7)
    v_mfma_f32_16x16x32_bf16 v[16:19], v[124:127], a[248:251], v[16:19]
    s_waitcnt lgkmcnt(6)
    v_mfma_f32_16x16x32_bf16 v[24:27], v[124:127], a[252:255], v[24:27]
    s_waitcnt lgkmcnt(5)
    v_mfma_f32_16x16x32_bf16 v[32:35], v[124:127], v[232:235], v[32:35]
    s_waitcnt lgkmcnt(4)
    v_mfma_f32_16x16x32_bf16 v[40:43], v[124:127], v[236:239], v[40:43]
    buffer_load_dwordx4 v[164:167], v5, s[20:23], s45 offen offset:0
    s_waitcnt lgkmcnt(3)
    v_mfma_f32_16x16x32_bf16 v[48:51], v[124:127], v[240:243], v[48:51]
    s_waitcnt lgkmcnt(2)
    v_mfma_f32_16x16x32_bf16 v[56:59], v[124:127], v[244:247], v[56:59]
    s_waitcnt lgkmcnt(1)
    v_mfma_f32_16x16x32_bf16 v[64:67], v[124:127], v[248:251], v[64:67]
    s_waitcnt lgkmcnt(0)
    v_mfma_f32_16x16x32_bf16 v[72:75], v[124:127], v[252:255], v[72:75]
    buffer_load_dwordx4 v[168:171], v5, s[20:23], s46 offen offset:0
    s_waitcnt vmcnt(26)
    v_mfma_f32_16x16x32_bf16 v[20:23], v[128:131], a[248:251], v[20:23]
    v_mfma_f32_16x16x32_bf16 v[28:31], v[128:131], a[252:255], v[28:31]
    v_mfma_f32_16x16x32_bf16 v[36:39], v[128:131], v[232:235], v[36:39]
    v_mfma_f32_16x16x32_bf16 v[44:47], v[128:131], v[236:239], v[44:47]
    buffer_load_dwordx4 v[172:175], v5, s[20:23], s47 offen offset:0
    v_mfma_f32_16x16x32_bf16 v[52:55], v[128:131], v[240:243], v[52:55]
    v_mfma_f32_16x16x32_bf16 v[60:63], v[128:131], v[244:247], v[60:63]
    v_mfma_f32_16x16x32_bf16 v[68:71], v[128:131], v[248:251], v[68:71]
    v_mfma_f32_16x16x32_bf16 v[76:79], v[128:131], v[252:255], v[76:79]
    buffer_load_dwordx4 v[176:179], v5, s[20:23], s48 offen offset:0
    s_waitcnt vmcnt(27)
    v_mfma_f32_16x16x32_bf16 a[0:3], v[132:135], a[248:251], a[0:3]
    v_mfma_f32_16x16x32_bf16 a[24:27], v[132:135], a[252:255], a[24:27]
    v_mfma_f32_16x16x32_bf16 a[48:51], v[132:135], v[232:235], a[48:51]
    v_mfma_f32_16x16x32_bf16 a[72:75], v[132:135], v[236:239], a[72:75]
    buffer_load_dwordx4 v[180:183], v5, s[20:23], s49 offen offset:0
    v_mfma_f32_16x16x32_bf16 a[96:99], v[132:135], v[240:243], a[96:99]
    v_mfma_f32_16x16x32_bf16 a[120:123], v[132:135], v[244:247], a[120:123]
    v_mfma_f32_16x16x32_bf16 a[144:147], v[132:135], v[248:251], a[144:147]
    v_mfma_f32_16x16x32_bf16 a[168:171], v[132:135], v[252:255], a[168:171]
    buffer_load_dwordx4 v[184:187], v5, s[20:23], s50 offen offset:0
    s_waitcnt vmcnt(28)
    v_mfma_f32_16x16x32_bf16 a[4:7], v[136:139], a[248:251], a[4:7]
    v_mfma_f32_16x16x32_bf16 a[28:31], v[136:139], a[252:255], a[28:31]
    v_mfma_f32_16x16x32_bf16 a[52:55], v[136:139], v[232:235], a[52:55]
    v_mfma_f32_16x16x32_bf16 a[76:79], v[136:139], v[236:239], a[76:79]
    buffer_load_dwordx4 v[188:191], v5, s[20:23], s51 offen offset:0
    v_mfma_f32_16x16x32_bf16 a[100:103], v[136:139], v[240:243], a[100:103]
    v_mfma_f32_16x16x32_bf16 a[124:127], v[136:139], v[244:247], a[124:127]
    v_mfma_f32_16x16x32_bf16 a[148:151], v[136:139], v[248:251], a[148:151]
    v_mfma_f32_16x16x32_bf16 a[172:175], v[136:139], v[252:255], a[172:175]
    buffer_load_dwordx4 v[192:195], v5, s[20:23], s52 offen offset:0
    s_waitcnt vmcnt(29)
    v_mfma_f32_16x16x32_bf16 a[8:11], v[140:143], a[248:251], a[8:11]
    v_mfma_f32_16x16x32_bf16 a[32:35], v[140:143], a[252:255], a[32:35]
    v_mfma_f32_16x16x32_bf16 a[56:59], v[140:143], v[232:235], a[56:59]
    v_mfma_f32_16x16x32_bf16 a[80:83], v[140:143], v[236:239], a[80:83]
    buffer_load_dwordx4 v[196:199], v5, s[20:23], s44 offen offset:1024
    v_mfma_f32_16x16x32_bf16 a[104:107], v[140:143], v[240:243], a[104:107]
    v_mfma_f32_16x16x32_bf16 a[128:131], v[140:143], v[244:247], a[128:131]
    v_mfma_f32_16x16x32_bf16 a[152:155], v[140:143], v[248:251], a[152:155]
    v_mfma_f32_16x16x32_bf16 a[176:179], v[140:143], v[252:255], a[176:179]
    buffer_load_dwordx4 v[200:203], v5, s[20:23], s45 offen offset:1024
    s_waitcnt vmcnt(30)
    v_mfma_f32_16x16x32_bf16 a[12:15], v[144:147], a[248:251], a[12:15]
    s_waitcnt vmcnt(25)
    ds_read_b128 a[216:219], v3 offset:0
    v_mfma_f32_16x16x32_bf16 a[36:39], v[144:147], a[252:255], a[36:39]
    s_waitcnt vmcnt(23)
    ds_read_b128 a[220:223], v3 offset:2048
    v_mfma_f32_16x16x32_bf16 a[60:63], v[144:147], v[232:235], a[60:63]
    s_waitcnt vmcnt(21)
    ds_read_b128 a[224:227], v3 offset:4096
    v_mfma_f32_16x16x32_bf16 a[84:87], v[144:147], v[236:239], a[84:87]
    buffer_load_dwordx4 v[204:207], v5, s[20:23], s46 offen offset:1024
    v_mfma_f32_16x16x32_bf16 a[108:111], v[144:147], v[240:243], a[108:111]
    s_waitcnt vmcnt(20)
    ds_read_b128 a[228:231], v3 offset:6144
    v_mfma_f32_16x16x32_bf16 a[132:135], v[144:147], v[244:247], a[132:135]
    s_waitcnt vmcnt(18)
    ds_read_b128 a[232:235], v3 offset:8192
    v_mfma_f32_16x16x32_bf16 a[156:159], v[144:147], v[248:251], a[156:159]
    s_waitcnt vmcnt(16)
    ds_read_b128 a[236:239], v3 offset:10240
    v_mfma_f32_16x16x32_bf16 a[180:183], v[144:147], v[252:255], a[180:183]
    buffer_load_dwordx4 v[208:211], v5, s[20:23], s47 offen offset:1024
    v_mfma_f32_16x16x32_bf16 a[16:19], v[148:151], a[248:251], a[16:19]
    s_waitcnt vmcnt(15)
    ds_read_b128 a[240:243], v3 offset:12288
    v_mfma_f32_16x16x32_bf16 a[40:43], v[148:151], a[252:255], a[40:43]
    s_waitcnt vmcnt(13)
    ds_read_b128 a[244:247], v3 offset:14336
    v_mfma_f32_16x16x32_bf16 a[64:67], v[148:151], v[232:235], a[64:67]
    v_mfma_f32_16x16x32_bf16 a[88:91], v[148:151], v[236:239], a[88:91]
    buffer_load_dwordx4 v[212:215], v5, s[20:23], s48 offen offset:1024
    v_mfma_f32_16x16x32_bf16 a[112:115], v[148:151], v[240:243], a[112:115]
    v_mfma_f32_16x16x32_bf16 a[136:139], v[148:151], v[244:247], a[136:139]
    v_mfma_f32_16x16x32_bf16 a[160:163], v[148:151], v[248:251], a[160:163]
    v_mfma_f32_16x16x32_bf16 a[184:187], v[148:151], v[252:255], a[184:187]
    buffer_load_dwordx4 v[216:219], v5, s[20:23], s49 offen offset:1024
    v_mfma_f32_16x16x32_bf16 a[20:23], v[152:155], a[248:251], a[20:23]
    v_mfma_f32_16x16x32_bf16 a[44:47], v[152:155], a[252:255], a[44:47]
    v_mfma_f32_16x16x32_bf16 a[68:71], v[152:155], v[232:235], a[68:71]
    v_mfma_f32_16x16x32_bf16 a[92:95], v[152:155], v[236:239], a[92:95]
    buffer_load_dwordx4 v[220:223], v5, s[20:23], s50 offen offset:1024
    v_mfma_f32_16x16x32_bf16 a[116:119], v[152:155], v[240:243], a[116:119]
    v_mfma_f32_16x16x32_bf16 a[140:143], v[152:155], v[244:247], a[140:143]
    v_mfma_f32_16x16x32_bf16 a[164:167], v[152:155], v[248:251], a[164:167]
    v_mfma_f32_16x16x32_bf16 a[188:191], v[152:155], v[252:255], a[188:191]
    buffer_load_dwordx4 v[224:227], v5, s[20:23], s51 offen offset:1024
    v_mfma_f32_16x16x32_bf16 v[80:83], v[156:159], a[248:251], v[80:83]
    v_mfma_f32_16x16x32_bf16 v[84:87], v[156:159], a[252:255], v[84:87]
    v_mfma_f32_16x16x32_bf16 a[192:195], v[156:159], v[232:235], a[192:195]
    v_mfma_f32_16x16x32_bf16 a[196:199], v[156:159], v[236:239], a[196:199]
    buffer_load_dwordx4 v[228:231], v5, s[20:23], s52 offen offset:1024
    v_mfma_f32_16x16x32_bf16 a[200:203], v[156:159], v[240:243], a[200:203]
    v_mfma_f32_16x16x32_bf16 a[204:207], v[156:159], v[244:247], a[204:207]
    v_mfma_f32_16x16x32_bf16 a[208:211], v[156:159], v[248:251], a[208:211]
    v_mfma_f32_16x16x32_bf16 a[212:215], v[156:159], v[252:255], a[212:215]
    s_lshl_b32 s12, s75, 7
    v_add_u32 v2, s12, v2
    s_add_u32 m0, s10, 16384
    s_nop 0
    buffer_load_dwordx4 v2, s[40:43], s53 offen lds
    s_waitcnt vmcnt(18) lgkmcnt(7)
    v_mfma_f32_16x16x32_bf16 v[16:19], v[160:163], a[216:219], v[16:19]
    s_waitcnt lgkmcnt(6)
    v_mfma_f32_16x16x32_bf16 v[24:27], v[160:163], a[220:223], v[24:27]
    s_waitcnt lgkmcnt(5)
    v_mfma_f32_16x16x32_bf16 v[32:35], v[160:163], a[224:227], v[32:35]
    s_waitcnt lgkmcnt(4)
    v_mfma_f32_16x16x32_bf16 v[40:43], v[160:163], a[228:231], v[40:43]
    s_add_u32 m0, s10, 17408
    s_nop 0
    buffer_load_dwordx4 v2, s[40:43], s54 offen lds
    s_waitcnt lgkmcnt(3)
    v_mfma_f32_16x16x32_bf16 v[48:51], v[160:163], a[232:235], v[48:51]
    s_waitcnt lgkmcnt(2)
    v_mfma_f32_16x16x32_bf16 v[56:59], v[160:163], a[236:239], v[56:59]
    s_waitcnt lgkmcnt(1)
    v_mfma_f32_16x16x32_bf16 v[64:67], v[160:163], a[240:243], v[64:67]
    s_waitcnt lgkmcnt(0)
    v_mfma_f32_16x16x32_bf16 v[72:75], v[160:163], a[244:247], v[72:75]
    s_add_u32 m0, s10, 18432
    s_nop 0
    buffer_load_dwordx4 v2, s[40:43], s55 offen lds
    s_waitcnt vmcnt(19)
    v_mfma_f32_16x16x32_bf16 v[20:23], v[164:167], a[216:219], v[20:23]
    v_mfma_f32_16x16x32_bf16 v[28:31], v[164:167], a[220:223], v[28:31]
    v_mfma_f32_16x16x32_bf16 v[36:39], v[164:167], a[224:227], v[36:39]
    v_mfma_f32_16x16x32_bf16 v[44:47], v[164:167], a[228:231], v[44:47]
    s_add_u32 m0, s10, 19456
    s_nop 0
    buffer_load_dwordx4 v2, s[40:43], s56 offen lds
    v_mfma_f32_16x16x32_bf16 v[52:55], v[164:167], a[232:235], v[52:55]
    v_mfma_f32_16x16x32_bf16 v[60:63], v[164:167], a[236:239], v[60:63]
    v_mfma_f32_16x16x32_bf16 v[68:71], v[164:167], a[240:243], v[68:71]
    v_mfma_f32_16x16x32_bf16 v[76:79], v[164:167], a[244:247], v[76:79]
    s_add_u32 m0, s10, 20480
    s_nop 0
    buffer_load_dwordx4 v2, s[40:43], s57 offen lds
    s_waitcnt vmcnt(20)
    v_mfma_f32_16x16x32_bf16 a[0:3], v[168:171], a[216:219], a[0:3]
    v_mfma_f32_16x16x32_bf16 a[24:27], v[168:171], a[220:223], a[24:27]
    v_mfma_f32_16x16x32_bf16 a[48:51], v[168:171], a[224:227], a[48:51]
    v_mfma_f32_16x16x32_bf16 a[72:75], v[168:171], a[228:231], a[72:75]
    s_add_u32 m0, s10, 21504
    s_nop 0
    buffer_load_dwordx4 v2, s[40:43], s58 offen lds
    v_mfma_f32_16x16x32_bf16 a[96:99], v[168:171], a[232:235], a[96:99]
    v_mfma_f32_16x16x32_bf16 a[120:123], v[168:171], a[236:239], a[120:123]
    v_mfma_f32_16x16x32_bf16 a[144:147], v[168:171], a[240:243], a[144:147]
    v_mfma_f32_16x16x32_bf16 a[168:171], v[168:171], a[244:247], a[168:171]
    s_add_u32 m0, s10, 22528
    s_nop 0
    buffer_load_dwordx4 v2, s[40:43], s59 offen lds
    s_waitcnt vmcnt(21)
    v_mfma_f32_16x16x32_bf16 a[4:7], v[172:175], a[216:219], a[4:7]
    v_mfma_f32_16x16x32_bf16 a[28:31], v[172:175], a[220:223], a[28:31]
    v_mfma_f32_16x16x32_bf16 a[52:55], v[172:175], a[224:227], a[52:55]
    v_mfma_f32_16x16x32_bf16 a[76:79], v[172:175], a[228:231], a[76:79]
    s_add_u32 m0, s10, 23552
    s_nop 0
    buffer_load_dwordx4 v2, s[40:43], s60 offen lds
    v_mfma_f32_16x16x32_bf16 a[100:103], v[172:175], a[232:235], a[100:103]
    v_mfma_f32_16x16x32_bf16 a[124:127], v[172:175], a[236:239], a[124:127]
    v_mfma_f32_16x16x32_bf16 a[148:151], v[172:175], a[240:243], a[148:151]
    v_mfma_f32_16x16x32_bf16 a[172:175], v[172:175], a[244:247], a[172:175]
    s_add_u32 m0, s10, 24576
    s_nop 0
    buffer_load_dwordx4 v2, s[40:43], s61 offen lds
    s_waitcnt vmcnt(22)
    v_mfma_f32_16x16x32_bf16 a[8:11], v[176:179], a[216:219], a[8:11]
    v_mfma_f32_16x16x32_bf16 a[32:35], v[176:179], a[220:223], a[32:35]
    v_mfma_f32_16x16x32_bf16 a[56:59], v[176:179], a[224:227], a[56:59]
    v_mfma_f32_16x16x32_bf16 a[80:83], v[176:179], a[228:231], a[80:83]
    s_add_u32 m0, s10, 25600
    s_nop 0
    buffer_load_dwordx4 v2, s[40:43], s62 offen lds
    v_mfma_f32_16x16x32_bf16 a[104:107], v[176:179], a[232:235], a[104:107]
    v_mfma_f32_16x16x32_bf16 a[128:131], v[176:179], a[236:239], a[128:131]
    v_mfma_f32_16x16x32_bf16 a[152:155], v[176:179], a[240:243], a[152:155]
    v_mfma_f32_16x16x32_bf16 a[176:179], v[176:179], a[244:247], a[176:179]
    s_add_u32 m0, s10, 26624
    s_nop 0
    buffer_load_dwordx4 v2, s[40:43], s63 offen lds
    s_waitcnt vmcnt(23)
    v_mfma_f32_16x16x32_bf16 a[12:15], v[180:183], a[216:219], a[12:15]
    ds_read_b128 a[248:251], v4 offset:0
    v_mfma_f32_16x16x32_bf16 a[36:39], v[180:183], a[220:223], a[36:39]
    ds_read_b128 a[252:255], v4 offset:2048
    v_mfma_f32_16x16x32_bf16 a[60:63], v[180:183], a[224:227], a[60:63]
    ds_read_b128 v[232:235], v4 offset:4096
    v_mfma_f32_16x16x32_bf16 a[84:87], v[180:183], a[228:231], a[84:87]
    s_add_u32 m0, s10, 27648
    s_nop 0
    buffer_load_dwordx4 v2, s[40:43], s64 offen lds
    v_mfma_f32_16x16x32_bf16 a[108:111], v[180:183], a[232:235], a[108:111]
    ds_read_b128 v[236:239], v4 offset:6144
    v_mfma_f32_16x16x32_bf16 a[132:135], v[180:183], a[236:239], a[132:135]
    ds_read_b128 v[240:243], v4 offset:8192
    v_mfma_f32_16x16x32_bf16 a[156:159], v[180:183], a[240:243], a[156:159]
    ds_read_b128 v[244:247], v4 offset:10240
    v_mfma_f32_16x16x32_bf16 a[180:183], v[180:183], a[244:247], a[180:183]
    s_add_u32 m0, s10, 28672
    s_nop 0
    buffer_load_dwordx4 v2, s[40:43], s65 offen lds
    s_waitcnt vmcnt(24)
    v_mfma_f32_16x16x32_bf16 a[16:19], v[184:187], a[216:219], a[16:19]
    ds_read_b128 v[248:251], v4 offset:12288
    v_mfma_f32_16x16x32_bf16 a[40:43], v[184:187], a[220:223], a[40:43]
    ds_read_b128 v[252:255], v4 offset:14336
    v_mfma_f32_16x16x32_bf16 a[64:67], v[184:187], a[224:227], a[64:67]
    v_mfma_f32_16x16x32_bf16 a[88:91], v[184:187], a[228:231], a[88:91]
    s_add_u32 m0, s10, 29696
    s_nop 0
    buffer_load_dwordx4 v2, s[40:43], s66 offen lds
    v_mfma_f32_16x16x32_bf16 a[112:115], v[184:187], a[232:235], a[112:115]
    v_mfma_f32_16x16x32_bf16 a[136:139], v[184:187], a[236:239], a[136:139]
    v_mfma_f32_16x16x32_bf16 a[160:163], v[184:187], a[240:243], a[160:163]
    v_mfma_f32_16x16x32_bf16 a[184:187], v[184:187], a[244:247], a[184:187]
    s_add_u32 m0, s10, 30720
    s_nop 0
    buffer_load_dwordx4 v2, s[40:43], s67 offen lds
    s_waitcnt vmcnt(25)
    v_mfma_f32_16x16x32_bf16 a[20:23], v[188:191], a[216:219], a[20:23]
    v_mfma_f32_16x16x32_bf16 a[44:47], v[188:191], a[220:223], a[44:47]
    v_mfma_f32_16x16x32_bf16 a[68:71], v[188:191], a[224:227], a[68:71]
    v_mfma_f32_16x16x32_bf16 a[92:95], v[188:191], a[228:231], a[92:95]
    s_add_u32 m0, s10, 31744
    s_nop 0
    buffer_load_dwordx4 v2, s[40:43], s68 offen lds
    v_mfma_f32_16x16x32_bf16 a[116:119], v[188:191], a[232:235], a[116:119]
    v_mfma_f32_16x16x32_bf16 a[140:143], v[188:191], a[236:239], a[140:143]
    v_mfma_f32_16x16x32_bf16 a[164:167], v[188:191], a[240:243], a[164:167]
    v_mfma_f32_16x16x32_bf16 a[188:191], v[188:191], a[244:247], a[188:191]
    s_lshl_b32 s12, s75, 11
    v_add_u32 v5, s12, v5
    buffer_load_dwordx4 v[88:91], v5, s[20:23], s44 offen offset:0
    s_waitcnt vmcnt(26)
    v_mfma_f32_16x16x32_bf16 v[80:83], v[192:195], a[216:219], v[80:83]
    v_mfma_f32_16x16x32_bf16 v[84:87], v[192:195], a[220:223], v[84:87]
    v_mfma_f32_16x16x32_bf16 a[192:195], v[192:195], a[224:227], a[192:195]
    v_mfma_f32_16x16x32_bf16 a[196:199], v[192:195], a[228:231], a[196:199]
    buffer_load_dwordx4 v[92:95], v5, s[20:23], s45 offen offset:0
    v_mfma_f32_16x16x32_bf16 a[200:203], v[192:195], a[232:235], a[200:203]
    v_mfma_f32_16x16x32_bf16 a[204:207], v[192:195], a[236:239], a[204:207]
    v_mfma_f32_16x16x32_bf16 a[208:211], v[192:195], a[240:243], a[208:211]
    v_mfma_f32_16x16x32_bf16 a[212:215], v[192:195], a[244:247], a[212:215]
    buffer_load_dwordx4 v[96:99], v5, s[20:23], s46 offen offset:0
    s_waitcnt vmcnt(27) lgkmcnt(7)
    v_mfma_f32_16x16x32_bf16 v[16:19], v[196:199], a[248:251], v[16:19]
    s_waitcnt lgkmcnt(6)
    v_mfma_f32_16x16x32_bf16 v[24:27], v[196:199], a[252:255], v[24:27]
    s_waitcnt lgkmcnt(5)
    v_mfma_f32_16x16x32_bf16 v[32:35], v[196:199], v[232:235], v[32:35]
    s_waitcnt lgkmcnt(4)
    v_mfma_f32_16x16x32_bf16 v[40:43], v[196:199], v[236:239], v[40:43]
    buffer_load_dwordx4 v[100:103], v5, s[20:23], s47 offen offset:0
    s_waitcnt lgkmcnt(3)
    v_mfma_f32_16x16x32_bf16 v[48:51], v[196:199], v[240:243], v[48:51]
    s_waitcnt lgkmcnt(2)
    v_mfma_f32_16x16x32_bf16 v[56:59], v[196:199], v[244:247], v[56:59]
    s_waitcnt lgkmcnt(1)
    v_mfma_f32_16x16x32_bf16 v[64:67], v[196:199], v[248:251], v[64:67]
    s_waitcnt lgkmcnt(0)
    v_mfma_f32_16x16x32_bf16 v[72:75], v[196:199], v[252:255], v[72:75]
    buffer_load_dwordx4 v[104:107], v5, s[20:23], s48 offen offset:0
    s_waitcnt vmcnt(28)
    v_mfma_f32_16x16x32_bf16 v[20:23], v[200:203], a[248:251], v[20:23]
    v_mfma_f32_16x16x32_bf16 v[28:31], v[200:203], a[252:255], v[28:31]
    v_mfma_f32_16x16x32_bf16 v[36:39], v[200:203], v[232:235], v[36:39]
    v_mfma_f32_16x16x32_bf16 v[44:47], v[200:203], v[236:239], v[44:47]
    buffer_load_dwordx4 v[108:111], v5, s[20:23], s49 offen offset:0
    v_mfma_f32_16x16x32_bf16 v[52:55], v[200:203], v[240:243], v[52:55]
    v_mfma_f32_16x16x32_bf16 v[60:63], v[200:203], v[244:247], v[60:63]
    v_mfma_f32_16x16x32_bf16 v[68:71], v[200:203], v[248:251], v[68:71]
    v_mfma_f32_16x16x32_bf16 v[76:79], v[200:203], v[252:255], v[76:79]
    buffer_load_dwordx4 v[112:115], v5, s[20:23], s50 offen offset:0
    s_waitcnt vmcnt(29)
    v_mfma_f32_16x16x32_bf16 a[0:3], v[204:207], a[248:251], a[0:3]
    v_mfma_f32_16x16x32_bf16 a[24:27], v[204:207], a[252:255], a[24:27]
    v_mfma_f32_16x16x32_bf16 a[48:51], v[204:207], v[232:235], a[48:51]
    v_mfma_f32_16x16x32_bf16 a[72:75], v[204:207], v[236:239], a[72:75]
    buffer_load_dwordx4 v[116:119], v5, s[20:23], s51 offen offset:0
    v_mfma_f32_16x16x32_bf16 a[96:99], v[204:207], v[240:243], a[96:99]
    v_mfma_f32_16x16x32_bf16 a[120:123], v[204:207], v[244:247], a[120:123]
    v_mfma_f32_16x16x32_bf16 a[144:147], v[204:207], v[248:251], a[144:147]
    v_mfma_f32_16x16x32_bf16 a[168:171], v[204:207], v[252:255], a[168:171]
    buffer_load_dwordx4 v[120:123], v5, s[20:23], s52 offen offset:0
    s_waitcnt vmcnt(30)
    v_mfma_f32_16x16x32_bf16 a[4:7], v[208:211], a[248:251], a[4:7]
    v_mfma_f32_16x16x32_bf16 a[28:31], v[208:211], a[252:255], a[28:31]
    v_mfma_f32_16x16x32_bf16 a[52:55], v[208:211], v[232:235], a[52:55]
    v_mfma_f32_16x16x32_bf16 a[76:79], v[208:211], v[236:239], a[76:79]
    buffer_load_dwordx4 v[124:127], v5, s[20:23], s44 offen offset:1024
    v_mfma_f32_16x16x32_bf16 a[100:103], v[208:211], v[240:243], a[100:103]
    v_mfma_f32_16x16x32_bf16 a[124:127], v[208:211], v[244:247], a[124:127]
    v_mfma_f32_16x16x32_bf16 a[148:151], v[208:211], v[248:251], a[148:151]
    v_mfma_f32_16x16x32_bf16 a[172:175], v[208:211], v[252:255], a[172:175]
    buffer_load_dwordx4 v[128:131], v5, s[20:23], s45 offen offset:1024
    s_waitcnt vmcnt(31)
    v_mfma_f32_16x16x32_bf16 a[8:11], v[212:215], a[248:251], a[8:11]
    v_mfma_f32_16x16x32_bf16 a[32:35], v[212:215], a[252:255], a[32:35]
    v_mfma_f32_16x16x32_bf16 a[56:59], v[212:215], v[232:235], a[56:59]
    v_mfma_f32_16x16x32_bf16 a[80:83], v[212:215], v[236:239], a[80:83]
    buffer_load_dwordx4 v[132:135], v5, s[20:23], s46 offen offset:1024
    v_mfma_f32_16x16x32_bf16 a[104:107], v[212:215], v[240:243], a[104:107]
    v_mfma_f32_16x16x32_bf16 a[128:131], v[212:215], v[244:247], a[128:131]
    v_mfma_f32_16x16x32_bf16 a[152:155], v[212:215], v[248:251], a[152:155]
    v_mfma_f32_16x16x32_bf16 a[176:179], v[212:215], v[252:255], a[176:179]
    buffer_load_dwordx4 v[136:139], v5, s[20:23], s47 offen offset:1024
    s_waitcnt vmcnt(32)
    v_mfma_f32_16x16x32_bf16 a[12:15], v[216:219], a[248:251], a[12:15]
    s_waitcnt vmcnt(27)
    ds_read_b128 a[216:219], v3 offset:16384
    v_mfma_f32_16x16x32_bf16 a[36:39], v[216:219], a[252:255], a[36:39]
    s_waitcnt vmcnt(25)
    ds_read_b128 a[220:223], v3 offset:18432
    v_mfma_f32_16x16x32_bf16 a[60:63], v[216:219], v[232:235], a[60:63]
    s_waitcnt vmcnt(23)
    ds_read_b128 a[224:227], v3 offset:20480
    v_mfma_f32_16x16x32_bf16 a[84:87], v[216:219], v[236:239], a[84:87]
    buffer_load_dwordx4 v[140:143], v5, s[20:23], s48 offen offset:1024
    v_mfma_f32_16x16x32_bf16 a[108:111], v[216:219], v[240:243], a[108:111]
    s_waitcnt vmcnt(22)
    ds_read_b128 a[228:231], v3 offset:22528
    v_mfma_f32_16x16x32_bf16 a[132:135], v[216:219], v[244:247], a[132:135]
    s_waitcnt vmcnt(20)
    ds_read_b128 a[232:235], v3 offset:24576
    v_mfma_f32_16x16x32_bf16 a[156:159], v[216:219], v[248:251], a[156:159]
    s_waitcnt vmcnt(18)
    ds_read_b128 a[236:239], v3 offset:26624
    v_mfma_f32_16x16x32_bf16 a[180:183], v[216:219], v[252:255], a[180:183]
    buffer_load_dwordx4 v[144:147], v5, s[20:23], s49 offen offset:1024
    v_mfma_f32_16x16x32_bf16 a[16:19], v[220:223], a[248:251], a[16:19]
    s_waitcnt vmcnt(17)
    ds_read_b128 a[240:243], v3 offset:28672
    v_mfma_f32_16x16x32_bf16 a[40:43], v[220:223], a[252:255], a[40:43]
    s_waitcnt vmcnt(15)
    ds_read_b128 a[244:247], v3 offset:30720
    v_mfma_f32_16x16x32_bf16 a[64:67], v[220:223], v[232:235], a[64:67]
    v_mfma_f32_16x16x32_bf16 a[88:91], v[220:223], v[236:239], a[88:91]
    buffer_load_dwordx4 v[148:151], v5, s[20:23], s50 offen offset:1024
    v_mfma_f32_16x16x32_bf16 a[112:115], v[220:223], v[240:243], a[112:115]
    v_mfma_f32_16x16x32_bf16 a[136:139], v[220:223], v[244:247], a[136:139]
    v_mfma_f32_16x16x32_bf16 a[160:163], v[220:223], v[248:251], a[160:163]
    v_mfma_f32_16x16x32_bf16 a[184:187], v[220:223], v[252:255], a[184:187]
    buffer_load_dwordx4 v[152:155], v5, s[20:23], s51 offen offset:1024
    v_mfma_f32_16x16x32_bf16 a[20:23], v[224:227], a[248:251], a[20:23]
    v_mfma_f32_16x16x32_bf16 a[44:47], v[224:227], a[252:255], a[44:47]
    v_mfma_f32_16x16x32_bf16 a[68:71], v[224:227], v[232:235], a[68:71]
    v_mfma_f32_16x16x32_bf16 a[92:95], v[224:227], v[236:239], a[92:95]
    buffer_load_dwordx4 v[156:159], v5, s[20:23], s52 offen offset:1024
    v_mfma_f32_16x16x32_bf16 a[116:119], v[224:227], v[240:243], a[116:119]
    v_mfma_f32_16x16x32_bf16 a[140:143], v[224:227], v[244:247], a[140:143]
    v_mfma_f32_16x16x32_bf16 a[164:167], v[224:227], v[248:251], a[164:167]
    v_mfma_f32_16x16x32_bf16 a[188:191], v[224:227], v[252:255], a[188:191]
    s_lshl_b32 s12, s76, 7
    v_add_u32 v2, s12, v2
    s_add_u32 m0, s10, 32768
    s_nop 0
    buffer_load_dwordx4 v2, s[40:43], s53 offen lds
    v_mfma_f32_16x16x32_bf16 v[80:83], v[228:231], a[248:251], v[80:83]
    v_mfma_f32_16x16x32_bf16 v[84:87], v[228:231], a[252:255], v[84:87]
    v_mfma_f32_16x16x32_bf16 a[192:195], v[228:231], v[232:235], a[192:195]
    v_mfma_f32_16x16x32_bf16 a[196:199], v[228:231], v[236:239], a[196:199]
    s_add_u32 m0, s10, 33792
    s_nop 0
    buffer_load_dwordx4 v2, s[40:43], s54 offen lds
    v_mfma_f32_16x16x32_bf16 a[200:203], v[228:231], v[240:243], a[200:203]
    v_mfma_f32_16x16x32_bf16 a[204:207], v[228:231], v[244:247], a[204:207]
    v_mfma_f32_16x16x32_bf16 a[208:211], v[228:231], v[248:251], a[208:211]
    v_mfma_f32_16x16x32_bf16 a[212:215], v[228:231], v[252:255], a[212:215]
    s_add_u32 m0, s10, 34816
    s_nop 0
    buffer_load_dwordx4 v2, s[40:43], s55 offen lds
    s_waitcnt vmcnt(20) lgkmcnt(7)
    v_mfma_f32_16x16x32_bf16 v[16:19], v[88:91], a[216:219], v[16:19]
    s_waitcnt lgkmcnt(6)
    v_mfma_f32_16x16x32_bf16 v[24:27], v[88:91], a[220:223], v[24:27]
    s_waitcnt lgkmcnt(5)
    v_mfma_f32_16x16x32_bf16 v[32:35], v[88:91], a[224:227], v[32:35]
    s_waitcnt lgkmcnt(4)
    v_mfma_f32_16x16x32_bf16 v[40:43], v[88:91], a[228:231], v[40:43]
    s_add_u32 m0, s10, 35840
    s_nop 0
    buffer_load_dwordx4 v2, s[40:43], s56 offen lds
    s_waitcnt lgkmcnt(3)
    v_mfma_f32_16x16x32_bf16 v[48:51], v[88:91], a[232:235], v[48:51]
    s_waitcnt lgkmcnt(2)
    v_mfma_f32_16x16x32_bf16 v[56:59], v[88:91], a[236:239], v[56:59]
    s_waitcnt lgkmcnt(1)
    v_mfma_f32_16x16x32_bf16 v[64:67], v[88:91], a[240:243], v[64:67]
    s_waitcnt lgkmcnt(0)
    v_mfma_f32_16x16x32_bf16 v[72:75], v[88:91], a[244:247], v[72:75]
    s_add_u32 m0, s10, 36864
    s_nop 0
    buffer_load_dwordx4 v2, s[40:43], s57 offen lds
    s_waitcnt vmcnt(21)
    v_mfma_f32_16x16x32_bf16 v[20:23], v[92:95], a[216:219], v[20:23]
    v_mfma_f32_16x16x32_bf16 v[28:31], v[92:95], a[220:223], v[28:31]
    v_mfma_f32_16x16x32_bf16 v[36:39], v[92:95], a[224:227], v[36:39]
    v_mfma_f32_16x16x32_bf16 v[44:47], v[92:95], a[228:231], v[44:47]
    s_add_u32 m0, s10, 37888
    s_nop 0
    buffer_load_dwordx4 v2, s[40:43], s58 offen lds
    v_mfma_f32_16x16x32_bf16 v[52:55], v[92:95], a[232:235], v[52:55]
    v_mfma_f32_16x16x32_bf16 v[60:63], v[92:95], a[236:239], v[60:63]
    v_mfma_f32_16x16x32_bf16 v[68:71], v[92:95], a[240:243], v[68:71]
    v_mfma_f32_16x16x32_bf16 v[76:79], v[92:95], a[244:247], v[76:79]
    s_add_u32 m0, s10, 38912
    s_nop 0
    buffer_load_dwordx4 v2, s[40:43], s59 offen lds
    s_waitcnt vmcnt(22)
    v_mfma_f32_16x16x32_bf16 a[0:3], v[96:99], a[216:219], a[0:3]
    v_mfma_f32_16x16x32_bf16 a[24:27], v[96:99], a[220:223], a[24:27]
    v_mfma_f32_16x16x32_bf16 a[48:51], v[96:99], a[224:227], a[48:51]
    v_mfma_f32_16x16x32_bf16 a[72:75], v[96:99], a[228:231], a[72:75]
    s_add_u32 m0, s10, 39936
    s_nop 0
    buffer_load_dwordx4 v2, s[40:43], s60 offen lds
    v_mfma_f32_16x16x32_bf16 a[96:99], v[96:99], a[232:235], a[96:99]
    v_mfma_f32_16x16x32_bf16 a[120:123], v[96:99], a[236:239], a[120:123]
    v_mfma_f32_16x16x32_bf16 a[144:147], v[96:99], a[240:243], a[144:147]
    v_mfma_f32_16x16x32_bf16 a[168:171], v[96:99], a[244:247], a[168:171]
    s_add_u32 m0, s10, 0
    s_nop 0
    buffer_load_dwordx4 v2, s[40:43], s61 offen lds
    s_waitcnt vmcnt(23)
    v_mfma_f32_16x16x32_bf16 a[4:7], v[100:103], a[216:219], a[4:7]
    v_mfma_f32_16x16x32_bf16 a[28:31], v[100:103], a[220:223], a[28:31]
    v_mfma_f32_16x16x32_bf16 a[52:55], v[100:103], a[224:227], a[52:55]
    v_mfma_f32_16x16x32_bf16 a[76:79], v[100:103], a[228:231], a[76:79]
    s_add_u32 m0, s10, 1024
    s_nop 0
    buffer_load_dwordx4 v2, s[40:43], s62 offen lds
    v_mfma_f32_16x16x32_bf16 a[100:103], v[100:103], a[232:235], a[100:103]
    v_mfma_f32_16x16x32_bf16 a[124:127], v[100:103], a[236:239], a[124:127]
    v_mfma_f32_16x16x32_bf16 a[148:151], v[100:103], a[240:243], a[148:151]
    v_mfma_f32_16x16x32_bf16 a[172:175], v[100:103], a[244:247], a[172:175]
    s_add_u32 m0, s10, 2048
    s_nop 0
    buffer_load_dwordx4 v2, s[40:43], s63 offen lds
    s_waitcnt vmcnt(24)
    v_mfma_f32_16x16x32_bf16 a[8:11], v[104:107], a[216:219], a[8:11]
    v_mfma_f32_16x16x32_bf16 a[32:35], v[104:107], a[220:223], a[32:35]
    v_mfma_f32_16x16x32_bf16 a[56:59], v[104:107], a[224:227], a[56:59]
    v_mfma_f32_16x16x32_bf16 a[80:83], v[104:107], a[228:231], a[80:83]
    s_add_u32 m0, s10, 3072
    s_nop 0
    buffer_load_dwordx4 v2, s[40:43], s64 offen lds
    v_mfma_f32_16x16x32_bf16 a[104:107], v[104:107], a[232:235], a[104:107]
    v_mfma_f32_16x16x32_bf16 a[128:131], v[104:107], a[236:239], a[128:131]
    v_mfma_f32_16x16x32_bf16 a[152:155], v[104:107], a[240:243], a[152:155]
    v_mfma_f32_16x16x32_bf16 a[176:179], v[104:107], a[244:247], a[176:179]
    s_add_u32 m0, s10, 4096
    s_nop 0
    buffer_load_dwordx4 v2, s[40:43], s65 offen lds
    s_waitcnt vmcnt(25)
    v_mfma_f32_16x16x32_bf16 a[12:15], v[108:111], a[216:219], a[12:15]
    ds_read_b128 a[248:251], v4 offset:16384
    v_mfma_f32_16x16x32_bf16 a[36:39], v[108:111], a[220:223], a[36:39]
    ds_read_b128 a[252:255], v4 offset:18432
    v_mfma_f32_16x16x32_bf16 a[60:63], v[108:111], a[224:227], a[60:63]
    ds_read_b128 v[232:235], v4 offset:20480
    v_mfma_f32_16x16x32_bf16 a[84:87], v[108:111], a[228:231], a[84:87]
    s_add_u32 m0, s10, 5120
    s_nop 0
    buffer_load_dwordx4 v2, s[40:43], s66 offen lds
    v_mfma_f32_16x16x32_bf16 a[108:111], v[108:111], a[232:235], a[108:111]
    ds_read_b128 v[236:239], v4 offset:22528
    v_mfma_f32_16x16x32_bf16 a[132:135], v[108:111], a[236:239], a[132:135]
    ds_read_b128 v[240:243], v4 offset:24576
    v_mfma_f32_16x16x32_bf16 a[156:159], v[108:111], a[240:243], a[156:159]
    ds_read_b128 v[244:247], v4 offset:26624
    v_mfma_f32_16x16x32_bf16 a[180:183], v[108:111], a[244:247], a[180:183]
    s_add_u32 m0, s10, 6144
    s_nop 0
    buffer_load_dwordx4 v2, s[40:43], s67 offen lds
    s_waitcnt vmcnt(26)
    v_mfma_f32_16x16x32_bf16 a[16:19], v[112:115], a[216:219], a[16:19]
    ds_read_b128 v[248:251], v4 offset:28672
    v_mfma_f32_16x16x32_bf16 a[40:43], v[112:115], a[220:223], a[40:43]
    ds_read_b128 v[252:255], v4 offset:30720
    v_mfma_f32_16x16x32_bf16 a[64:67], v[112:115], a[224:227], a[64:67]
    v_mfma_f32_16x16x32_bf16 a[88:91], v[112:115], a[228:231], a[88:91]
    s_add_u32 m0, s10, 7168
    s_nop 0
    buffer_load_dwordx4 v2, s[40:43], s68 offen lds
    v_mfma_f32_16x16x32_bf16 a[112:115], v[112:115], a[232:235], a[112:115]
    v_mfma_f32_16x16x32_bf16 a[136:139], v[112:115], a[236:239], a[136:139]
    v_mfma_f32_16x16x32_bf16 a[160:163], v[112:115], a[240:243], a[160:163]
    v_mfma_f32_16x16x32_bf16 a[184:187], v[112:115], a[244:247], a[184:187]
    s_lshl_b32 s12, s76, 11
    v_add_u32 v5, s12, v5
    buffer_load_dwordx4 v[160:163], v5, s[20:23], s44 offen offset:0
    s_waitcnt vmcnt(27)
    v_mfma_f32_16x16x32_bf16 a[20:23], v[116:119], a[216:219], a[20:23]
    v_mfma_f32_16x16x32_bf16 a[44:47], v[116:119], a[220:223], a[44:47]
    v_mfma_f32_16x16x32_bf16 a[68:71], v[116:119], a[224:227], a[68:71]
    v_mfma_f32_16x16x32_bf16 a[92:95], v[116:119], a[228:231], a[92:95]
    buffer_load_dwordx4 v[164:167], v5, s[20:23], s45 offen offset:0
    v_mfma_f32_16x16x32_bf16 a[116:119], v[116:119], a[232:235], a[116:119]
    v_mfma_f32_16x16x32_bf16 a[140:143], v[116:119], a[236:239], a[140:143]
    v_mfma_f32_16x16x32_bf16 a[164:167], v[116:119], a[240:243], a[164:167]
    v_mfma_f32_16x16x32_bf16 a[188:191], v[116:119], a[244:247], a[188:191]
    buffer_load_dwordx4 v[168:171], v5, s[20:23], s46 offen offset:0
    s_waitcnt vmcnt(28)
    v_mfma_f32_16x16x32_bf16 v[80:83], v[120:123], a[216:219], v[80:83]
    v_mfma_f32_16x16x32_bf16 v[84:87], v[120:123], a[220:223], v[84:87]
    v_mfma_f32_16x16x32_bf16 a[192:195], v[120:123], a[224:227], a[192:195]
    v_mfma_f32_16x16x32_bf16 a[196:199], v[120:123], a[228:231], a[196:199]
    buffer_load_dwordx4 v[172:175], v5, s[20:23], s47 offen offset:0
    v_mfma_f32_16x16x32_bf16 a[200:203], v[120:123], a[232:235], a[200:203]
    v_mfma_f32_16x16x32_bf16 a[204:207], v[120:123], a[236:239], a[204:207]
    v_mfma_f32_16x16x32_bf16 a[208:211], v[120:123], a[240:243], a[208:211]
    v_mfma_f32_16x16x32_bf16 a[212:215], v[120:123], a[244:247], a[212:215]
    buffer_load_dwordx4 v[176:179], v5, s[20:23], s48 offen offset:0
    s_waitcnt vmcnt(29) lgkmcnt(7)
    v_mfma_f32_16x16x32_bf16 v[16:19], v[124:127], a[248:251], v[16:19]
    s_waitcnt lgkmcnt(6)
    v_mfma_f32_16x16x32_bf16 v[24:27], v[124:127], a[252:255], v[24:27]
    s_waitcnt lgkmcnt(5)
    v_mfma_f32_16x16x32_bf16 v[32:35], v[124:127], v[232:235], v[32:35]
    s_waitcnt lgkmcnt(4)
    v_mfma_f32_16x16x32_bf16 v[40:43], v[124:127], v[236:239], v[40:43]
    buffer_load_dwordx4 v[180:183], v5, s[20:23], s49 offen offset:0
    s_waitcnt lgkmcnt(3)
    v_mfma_f32_16x16x32_bf16 v[48:51], v[124:127], v[240:243], v[48:51]
    s_waitcnt lgkmcnt(2)
    v_mfma_f32_16x16x32_bf16 v[56:59], v[124:127], v[244:247], v[56:59]
    s_waitcnt lgkmcnt(1)
    v_mfma_f32_16x16x32_bf16 v[64:67], v[124:127], v[248:251], v[64:67]
    s_waitcnt lgkmcnt(0)
    v_mfma_f32_16x16x32_bf16 v[72:75], v[124:127], v[252:255], v[72:75]
    buffer_load_dwordx4 v[184:187], v5, s[20:23], s50 offen offset:0
    s_waitcnt vmcnt(30)
    v_mfma_f32_16x16x32_bf16 v[20:23], v[128:131], a[248:251], v[20:23]
    v_mfma_f32_16x16x32_bf16 v[28:31], v[128:131], a[252:255], v[28:31]
    v_mfma_f32_16x16x32_bf16 v[36:39], v[128:131], v[232:235], v[36:39]
    v_mfma_f32_16x16x32_bf16 v[44:47], v[128:131], v[236:239], v[44:47]
    buffer_load_dwordx4 v[188:191], v5, s[20:23], s51 offen offset:0
    v_mfma_f32_16x16x32_bf16 v[52:55], v[128:131], v[240:243], v[52:55]
    v_mfma_f32_16x16x32_bf16 v[60:63], v[128:131], v[244:247], v[60:63]
    v_mfma_f32_16x16x32_bf16 v[68:71], v[128:131], v[248:251], v[68:71]
    v_mfma_f32_16x16x32_bf16 v[76:79], v[128:131], v[252:255], v[76:79]
    buffer_load_dwordx4 v[192:195], v5, s[20:23], s52 offen offset:0
    s_waitcnt vmcnt(31)
    v_mfma_f32_16x16x32_bf16 a[0:3], v[132:135], a[248:251], a[0:3]
    v_mfma_f32_16x16x32_bf16 a[24:27], v[132:135], a[252:255], a[24:27]
    v_mfma_f32_16x16x32_bf16 a[48:51], v[132:135], v[232:235], a[48:51]
    v_mfma_f32_16x16x32_bf16 a[72:75], v[132:135], v[236:239], a[72:75]
    buffer_load_dwordx4 v[196:199], v5, s[20:23], s44 offen offset:1024
    v_mfma_f32_16x16x32_bf16 a[96:99], v[132:135], v[240:243], a[96:99]
    v_mfma_f32_16x16x32_bf16 a[120:123], v[132:135], v[244:247], a[120:123]
    v_mfma_f32_16x16x32_bf16 a[144:147], v[132:135], v[248:251], a[144:147]
    v_mfma_f32_16x16x32_bf16 a[168:171], v[132:135], v[252:255], a[168:171]
    buffer_load_dwordx4 v[200:203], v5, s[20:23], s45 offen offset:1024
    s_waitcnt vmcnt(32)
    v_mfma_f32_16x16x32_bf16 a[4:7], v[136:139], a[248:251], a[4:7]
    v_mfma_f32_16x16x32_bf16 a[28:31], v[136:139], a[252:255], a[28:31]
    v_mfma_f32_16x16x32_bf16 a[52:55], v[136:139], v[232:235], a[52:55]
    v_mfma_f32_16x16x32_bf16 a[76:79], v[136:139], v[236:239], a[76:79]
    buffer_load_dwordx4 v[204:207], v5, s[20:23], s46 offen offset:1024
    v_mfma_f32_16x16x32_bf16 a[100:103], v[136:139], v[240:243], a[100:103]
    v_mfma_f32_16x16x32_bf16 a[124:127], v[136:139], v[244:247], a[124:127]
    v_mfma_f32_16x16x32_bf16 a[148:151], v[136:139], v[248:251], a[148:151]
    v_mfma_f32_16x16x32_bf16 a[172:175], v[136:139], v[252:255], a[172:175]
    buffer_load_dwordx4 v[208:211], v5, s[20:23], s47 offen offset:1024
    s_waitcnt vmcnt(33)
    v_mfma_f32_16x16x32_bf16 a[8:11], v[140:143], a[248:251], a[8:11]
    v_mfma_f32_16x16x32_bf16 a[32:35], v[140:143], a[252:255], a[32:35]
    v_mfma_f32_16x16x32_bf16 a[56:59], v[140:143], v[232:235], a[56:59]
    v_mfma_f32_16x16x32_bf16 a[80:83], v[140:143], v[236:239], a[80:83]
    buffer_load_dwordx4 v[212:215], v5, s[20:23], s48 offen offset:1024
    v_mfma_f32_16x16x32_bf16 a[104:107], v[140:143], v[240:243], a[104:107]
    v_mfma_f32_16x16x32_bf16 a[128:131], v[140:143], v[244:247], a[128:131]
    v_mfma_f32_16x16x32_bf16 a[152:155], v[140:143], v[248:251], a[152:155]
    v_mfma_f32_16x16x32_bf16 a[176:179], v[140:143], v[252:255], a[176:179]
    buffer_load_dwordx4 v[216:219], v5, s[20:23], s49 offen offset:1024
    s_waitcnt vmcnt(34)
    v_mfma_f32_16x16x32_bf16 a[12:15], v[144:147], a[248:251], a[12:15]
    s_waitcnt vmcnt(29)
    ds_read_b128 a[216:219], v3 offset:32768
    v_mfma_f32_16x16x32_bf16 a[36:39], v[144:147], a[252:255], a[36:39]
    s_waitcnt vmcnt(27)
    ds_read_b128 a[220:223], v3 offset:34816
    v_mfma_f32_16x16x32_bf16 a[60:63], v[144:147], v[232:235], a[60:63]
    s_waitcnt vmcnt(25)
    ds_read_b128 a[224:227], v3 offset:36864
    v_mfma_f32_16x16x32_bf16 a[84:87], v[144:147], v[236:239], a[84:87]
    buffer_load_dwordx4 v[220:223], v5, s[20:23], s50 offen offset:1024
    v_mfma_f32_16x16x32_bf16 a[108:111], v[144:147], v[240:243], a[108:111]
    s_waitcnt vmcnt(24)
    ds_read_b128 a[228:231], v3 offset:38912
    v_mfma_f32_16x16x32_bf16 a[132:135], v[144:147], v[244:247], a[132:135]
    s_waitcnt vmcnt(22)
    ds_read_b128 a[232:235], v3 offset:0
    v_mfma_f32_16x16x32_bf16 a[156:159], v[144:147], v[248:251], a[156:159]
    s_waitcnt vmcnt(20)
    ds_read_b128 a[236:239], v3 offset:2048
    v_mfma_f32_16x16x32_bf16 a[180:183], v[144:147], v[252:255], a[180:183]
    buffer_load_dwordx4 v[224:227], v5, s[20:23], s51 offen offset:1024
    v_mfma_f32_16x16x32_bf16 a[16:19], v[148:151], a[248:251], a[16:19]
    s_waitcnt vmcnt(19)
    ds_read_b128 a[240:243], v3 offset:4096
    v_mfma_f32_16x16x32_bf16 a[40:43], v[148:151], a[252:255], a[40:43]
    s_waitcnt vmcnt(17)
    ds_read_b128 a[244:247], v3 offset:6144
    v_mfma_f32_16x16x32_bf16 a[64:67], v[148:151], v[232:235], a[64:67]
    v_mfma_f32_16x16x32_bf16 a[88:91], v[148:151], v[236:239], a[88:91]
    buffer_load_dwordx4 v[228:231], v5, s[20:23], s52 offen offset:1024
    v_mfma_f32_16x16x32_bf16 a[112:115], v[148:151], v[240:243], a[112:115]
    v_mfma_f32_16x16x32_bf16 a[136:139], v[148:151], v[244:247], a[136:139]
    v_mfma_f32_16x16x32_bf16 a[160:163], v[148:151], v[248:251], a[160:163]
    v_mfma_f32_16x16x32_bf16 a[184:187], v[148:151], v[252:255], a[184:187]
    v_mfma_f32_16x16x32_bf16 a[20:23], v[152:155], a[248:251], a[20:23]
    v_mfma_f32_16x16x32_bf16 a[44:47], v[152:155], a[252:255], a[44:47]
    v_mfma_f32_16x16x32_bf16 a[68:71], v[152:155], v[232:235], a[68:71]
    v_mfma_f32_16x16x32_bf16 a[92:95], v[152:155], v[236:239], a[92:95]
    v_mfma_f32_16x16x32_bf16 a[116:119], v[152:155], v[240:243], a[116:119]
    v_mfma_f32_16x16x32_bf16 a[140:143], v[152:155], v[244:247], a[140:143]
    v_mfma_f32_16x16x32_bf16 a[164:167], v[152:155], v[248:251], a[164:167]
    v_mfma_f32_16x16x32_bf16 a[188:191], v[152:155], v[252:255], a[188:191]
    v_mfma_f32_16x16x32_bf16 v[80:83], v[156:159], a[248:251], v[80:83]
    v_mfma_f32_16x16x32_bf16 v[84:87], v[156:159], a[252:255], v[84:87]
    v_mfma_f32_16x16x32_bf16 a[192:195], v[156:159], v[232:235], a[192:195]
    v_mfma_f32_16x16x32_bf16 a[196:199], v[156:159], v[236:239], a[196:199]
    v_mfma_f32_16x16x32_bf16 a[200:203], v[156:159], v[240:243], a[200:203]
    v_mfma_f32_16x16x32_bf16 a[204:207], v[156:159], v[244:247], a[204:207]
    v_mfma_f32_16x16x32_bf16 a[208:211], v[156:159], v[248:251], a[208:211]
    v_mfma_f32_16x16x32_bf16 a[212:215], v[156:159], v[252:255], a[212:215]
    s_waitcnt vmcnt(17) lgkmcnt(7)
    v_mfma_f32_16x16x32_bf16 v[16:19], v[160:163], a[216:219], v[16:19]
    s_waitcnt lgkmcnt(6)
    v_mfma_f32_16x16x32_bf16 v[24:27], v[160:163], a[220:223], v[24:27]
    s_waitcnt lgkmcnt(5)
    v_mfma_f32_16x16x32_bf16 v[32:35], v[160:163], a[224:227], v[32:35]
    s_waitcnt lgkmcnt(4)
    v_mfma_f32_16x16x32_bf16 v[40:43], v[160:163], a[228:231], v[40:43]
    s_waitcnt lgkmcnt(3)
    v_mfma_f32_16x16x32_bf16 v[48:51], v[160:163], a[232:235], v[48:51]
    s_waitcnt lgkmcnt(2)
    v_mfma_f32_16x16x32_bf16 v[56:59], v[160:163], a[236:239], v[56:59]
    s_waitcnt lgkmcnt(1)
    v_mfma_f32_16x16x32_bf16 v[64:67], v[160:163], a[240:243], v[64:67]
    s_waitcnt lgkmcnt(0)
    v_mfma_f32_16x16x32_bf16 v[72:75], v[160:163], a[244:247], v[72:75]
    s_waitcnt vmcnt(16)
    v_mfma_f32_16x16x32_bf16 v[20:23], v[164:167], a[216:219], v[20:23]
    v_mfma_f32_16x16x32_bf16 v[28:31], v[164:167], a[220:223], v[28:31]
    v_mfma_f32_16x16x32_bf16 v[36:39], v[164:167], a[224:227], v[36:39]
    v_mfma_f32_16x16x32_bf16 v[44:47], v[164:167], a[228:231], v[44:47]
    v_mfma_f32_16x16x32_bf16 v[52:55], v[164:167], a[232:235], v[52:55]
    v_mfma_f32_16x16x32_bf16 v[60:63], v[164:167], a[236:239], v[60:63]
    v_mfma_f32_16x16x32_bf16 v[68:71], v[164:167], a[240:243], v[68:71]
    v_mfma_f32_16x16x32_bf16 v[76:79], v[164:167], a[244:247], v[76:79]
    s_waitcnt vmcnt(15)
    v_mfma_f32_16x16x32_bf16 a[0:3], v[168:171], a[216:219], a[0:3]
    v_mfma_f32_16x16x32_bf16 a[24:27], v[168:171], a[220:223], a[24:27]
    v_mfma_f32_16x16x32_bf16 a[48:51], v[168:171], a[224:227], a[48:51]
    v_mfma_f32_16x16x32_bf16 a[72:75], v[168:171], a[228:231], a[72:75]
    v_mfma_f32_16x16x32_bf16 a[96:99], v[168:171], a[232:235], a[96:99]
    v_mfma_f32_16x16x32_bf16 a[120:123], v[168:171], a[236:239], a[120:123]
    v_mfma_f32_16x16x32_bf16 a[144:147], v[168:171], a[240:243], a[144:147]
    v_mfma_f32_16x16x32_bf16 a[168:171], v[168:171], a[244:247], a[168:171]
    s_waitcnt vmcnt(14)
    v_mfma_f32_16x16x32_bf16 a[4:7], v[172:175], a[216:219], a[4:7]
    v_mfma_f32_16x16x32_bf16 a[28:31], v[172:175], a[220:223], a[28:31]
    v_mfma_f32_16x16x32_bf16 a[52:55], v[172:175], a[224:227], a[52:55]
    v_mfma_f32_16x16x32_bf16 a[76:79], v[172:175], a[228:231], a[76:79]
    v_mfma_f32_16x16x32_bf16 a[100:103], v[172:175], a[232:235], a[100:103]
    v_mfma_f32_16x16x32_bf16 a[124:127], v[172:175], a[236:239], a[124:127]
    v_mfma_f32_16x16x32_bf16 a[148:151], v[172:175], a[240:243], a[148:151]
    v_mfma_f32_16x16x32_bf16 a[172:175], v[172:175], a[244:247], a[172:175]
    s_waitcnt vmcnt(13)
    v_mfma_f32_16x16x32_bf16 a[8:11], v[176:179], a[216:219], a[8:11]
    v_mfma_f32_16x16x32_bf16 a[32:35], v[176:179], a[220:223], a[32:35]
    v_mfma_f32_16x16x32_bf16 a[56:59], v[176:179], a[224:227], a[56:59]
    v_mfma_f32_16x16x32_bf16 a[80:83], v[176:179], a[228:231], a[80:83]
    v_mfma_f32_16x16x32_bf16 a[104:107], v[176:179], a[232:235], a[104:107]
    v_mfma_f32_16x16x32_bf16 a[128:131], v[176:179], a[236:239], a[128:131]
    v_mfma_f32_16x16x32_bf16 a[152:155], v[176:179], a[240:243], a[152:155]
    v_mfma_f32_16x16x32_bf16 a[176:179], v[176:179], a[244:247], a[176:179]
    s_waitcnt vmcnt(12)
    v_mfma_f32_16x16x32_bf16 a[12:15], v[180:183], a[216:219], a[12:15]
    ds_read_b128 a[248:251], v4 offset:32768
    v_mfma_f32_16x16x32_bf16 a[36:39], v[180:183], a[220:223], a[36:39]
    ds_read_b128 a[252:255], v4 offset:34816
    v_mfma_f32_16x16x32_bf16 a[60:63], v[180:183], a[224:227], a[60:63]
    ds_read_b128 v[232:235], v4 offset:36864
    v_mfma_f32_16x16x32_bf16 a[84:87], v[180:183], a[228:231], a[84:87]
    ds_read_b128 v[236:239], v4 offset:38912
    v_mfma_f32_16x16x32_bf16 a[108:111], v[180:183], a[232:235], a[108:111]
    ds_read_b128 v[240:243], v4 offset:0
    v_mfma_f32_16x16x32_bf16 a[132:135], v[180:183], a[236:239], a[132:135]
    ds_read_b128 v[244:247], v4 offset:2048
    v_mfma_f32_16x16x32_bf16 a[156:159], v[180:183], a[240:243], a[156:159]
    ds_read_b128 v[248:251], v4 offset:4096
    v_mfma_f32_16x16x32_bf16 a[180:183], v[180:183], a[244:247], a[180:183]
    ds_read_b128 v[252:255], v4 offset:6144
    s_waitcnt vmcnt(11)
    v_mfma_f32_16x16x32_bf16 a[16:19], v[184:187], a[216:219], a[16:19]
    v_mfma_f32_16x16x32_bf16 a[40:43], v[184:187], a[220:223], a[40:43]
    v_mfma_f32_16x16x32_bf16 a[64:67], v[184:187], a[224:227], a[64:67]
    v_mfma_f32_16x16x32_bf16 a[88:91], v[184:187], a[228:231], a[88:91]
    v_mfma_f32_16x16x32_bf16 a[112:115], v[184:187], a[232:235], a[112:115]
    v_mfma_f32_16x16x32_bf16 a[136:139], v[184:187], a[236:239], a[136:139]
    v_mfma_f32_16x16x32_bf16 a[160:163], v[184:187], a[240:243], a[160:163]
    v_mfma_f32_16x16x32_bf16 a[184:187], v[184:187], a[244:247], a[184:187]
    s_waitcnt vmcnt(10)
    v_mfma_f32_16x16x32_bf16 a[20:23], v[188:191], a[216:219], a[20:23]
    v_mfma_f32_16x16x32_bf16 a[44:47], v[188:191], a[220:223], a[44:47]
    v_mfma_f32_16x16x32_bf16 a[68:71], v[188:191], a[224:227], a[68:71]
    v_mfma_f32_16x16x32_bf16 a[92:95], v[188:191], a[228:231], a[92:95]
    v_mfma_f32_16x16x32_bf16 a[116:119], v[188:191], a[232:235], a[116:119]
    v_mfma_f32_16x16x32_bf16 a[140:143], v[188:191], a[236:239], a[140:143]
    v_mfma_f32_16x16x32_bf16 a[164:167], v[188:191], a[240:243], a[164:167]
    v_mfma_f32_16x16x32_bf16 a[188:191], v[188:191], a[244:247], a[188:191]
    s_waitcnt vmcnt(9)
    v_mfma_f32_16x16x32_bf16 v[80:83], v[192:195], a[216:219], v[80:83]
    v_mfma_f32_16x16x32_bf16 v[84:87], v[192:195], a[220:223], v[84:87]
    v_mfma_f32_16x16x32_bf16 a[192:195], v[192:195], a[224:227], a[192:195]
    v_mfma_f32_16x16x32_bf16 a[196:199], v[192:195], a[228:231], a[196:199]
    v_mfma_f32_16x16x32_bf16 a[200:203], v[192:195], a[232:235], a[200:203]
    v_mfma_f32_16x16x32_bf16 a[204:207], v[192:195], a[236:239], a[204:207]
    v_mfma_f32_16x16x32_bf16 a[208:211], v[192:195], a[240:243], a[208:211]
    v_mfma_f32_16x16x32_bf16 a[212:215], v[192:195], a[244:247], a[212:215]
    s_waitcnt vmcnt(8) lgkmcnt(7)
    v_mfma_f32_16x16x32_bf16 v[16:19], v[196:199], a[248:251], v[16:19]
    s_waitcnt vmcnt(7)
    v_mfma_f32_16x16x32_bf16 v[20:23], v[200:203], a[248:251], v[20:23]
    s_waitcnt vmcnt(6)
    v_mfma_f32_16x16x32_bf16 a[0:3], v[204:207], a[248:251], a[0:3]
    s_waitcnt vmcnt(5)
    v_mfma_f32_16x16x32_bf16 a[4:7], v[208:211], a[248:251], a[4:7]
    s_waitcnt vmcnt(4)
    v_mfma_f32_16x16x32_bf16 a[8:11], v[212:215], a[248:251], a[8:11]
    s_waitcnt vmcnt(3)
    v_mfma_f32_16x16x32_bf16 a[12:15], v[216:219], a[248:251], a[12:15]
    s_waitcnt vmcnt(2)
    v_mfma_f32_16x16x32_bf16 a[16:19], v[220:223], a[248:251], a[16:19]
    s_waitcnt vmcnt(1)
    v_mfma_f32_16x16x32_bf16 a[20:23], v[224:227], a[248:251], a[20:23]
    s_waitcnt vmcnt(0)
    v_mfma_f32_16x16x32_bf16 v[80:83], v[228:231], a[248:251], v[80:83]
    s_waitcnt lgkmcnt(6)
    v_mfma_f32_16x16x32_bf16 v[24:27], v[196:199], a[252:255], v[24:27]
    v_mfma_f32_16x16x32_bf16 v[28:31], v[200:203], a[252:255], v[28:31]
    v_mfma_f32_16x16x32_bf16 a[24:27], v[204:207], a[252:255], a[24:27]
    v_mfma_f32_16x16x32_bf16 a[28:31], v[208:211], a[252:255], a[28:31]
    v_mfma_f32_16x16x32_bf16 a[32:35], v[212:215], a[252:255], a[32:35]
    v_mfma_f32_16x16x32_bf16 a[36:39], v[216:219], a[252:255], a[36:39]
    v_mfma_f32_16x16x32_bf16 a[40:43], v[220:223], a[252:255], a[40:43]
    v_mfma_f32_16x16x32_bf16 a[44:47], v[224:227], a[252:255], a[44:47]
    v_mfma_f32_16x16x32_bf16 v[84:87], v[228:231], a[252:255], v[84:87]
    s_waitcnt lgkmcnt(5)
    v_mfma_f32_16x16x32_bf16 v[32:35], v[196:199], v[232:235], v[32:35]
    v_mfma_f32_16x16x32_bf16 v[36:39], v[200:203], v[232:235], v[36:39]
    v_mfma_f32_16x16x32_bf16 a[48:51], v[204:207], v[232:235], a[48:51]
    v_mfma_f32_16x16x32_bf16 a[52:55], v[208:211], v[232:235], a[52:55]
    v_mfma_f32_16x16x32_bf16 a[56:59], v[212:215], v[232:235], a[56:59]
    v_mfma_f32_16x16x32_bf16 a[60:63], v[216:219], v[232:235], a[60:63]
    v_mfma_f32_16x16x32_bf16 a[64:67], v[220:223], v[232:235], a[64:67]
    v_mfma_f32_16x16x32_bf16 a[68:71], v[224:227], v[232:235], a[68:71]
    v_mfma_f32_16x16x32_bf16 a[192:195], v[228:231], v[232:235], a[192:195]
    s_waitcnt lgkmcnt(4)
    v_mfma_f32_16x16x32_bf16 v[40:43], v[196:199], v[236:239], v[40:43]
    v_mfma_f32_16x16x32_bf16 v[44:47], v[200:203], v[236:239], v[44:47]
    ds_write_b128 v6, a[0:3] offset:0
    v_mfma_f32_16x16x32_bf16 a[72:75], v[204:207], v[236:239], a[72:75]
    v_mfma_f32_16x16x32_bf16 a[76:79], v[208:211], v[236:239], a[76:79]
    ds_write_b128 v6, a[4:7] offset:1024
    v_mfma_f32_16x16x32_bf16 a[80:83], v[212:215], v[236:239], a[80:83]
    v_mfma_f32_16x16x32_bf16 a[84:87], v[216:219], v[236:239], a[84:87]
    ds_write_b128 v6, a[8:11] offset:2048
    v_mfma_f32_16x16x32_bf16 a[88:91], v[220:223], v[236:239], a[88:91]
    v_mfma_f32_16x16x32_bf16 a[92:95], v[224:227], v[236:239], a[92:95]
    ds_write_b128 v6, a[12:15] offset:3072
    v_mfma_f32_16x16x32_bf16 a[196:199], v[228:231], v[236:239], a[196:199]
    s_waitcnt lgkmcnt(7)
    v_mfma_f32_16x16x32_bf16 v[48:51], v[196:199], v[240:243], v[48:51]
    ds_write_b128 v6, a[16:19] offset:4096
    v_mfma_f32_16x16x32_bf16 v[52:55], v[200:203], v[240:243], v[52:55]
    v_mfma_f32_16x16x32_bf16 a[96:99], v[204:207], v[240:243], a[96:99]
    ds_write_b128 v6, a[20:23] offset:5120
    v_mfma_f32_16x16x32_bf16 a[100:103], v[208:211], v[240:243], a[100:103]
    v_mfma_f32_16x16x32_bf16 a[104:107], v[212:215], v[240:243], a[104:107]
    ds_write_b128 v6, a[24:27] offset:6144
    v_mfma_f32_16x16x32_bf16 a[108:111], v[216:219], v[240:243], a[108:111]
    v_mfma_f32_16x16x32_bf16 a[112:115], v[220:223], v[240:243], a[112:115]
    ds_write_b128 v6, a[28:31] offset:7168
    v_mfma_f32_16x16x32_bf16 a[116:119], v[224:227], v[240:243], a[116:119]
    v_mfma_f32_16x16x32_bf16 a[200:203], v[228:231], v[240:243], a[200:203]
    ds_write_b128 v6, a[32:35] offset:8192
    s_waitcnt lgkmcnt(11)
    v_mfma_f32_16x16x32_bf16 v[56:59], v[196:199], v[244:247], v[56:59]
    v_mfma_f32_16x16x32_bf16 v[60:63], v[200:203], v[244:247], v[60:63]
    ds_write_b128 v6, a[36:39] offset:9216
    v_mfma_f32_16x16x32_bf16 a[120:123], v[204:207], v[244:247], a[120:123]
    v_mfma_f32_16x16x32_bf16 a[124:127], v[208:211], v[244:247], a[124:127]
    ds_write_b128 v6, a[40:43] offset:10240
    v_mfma_f32_16x16x32_bf16 a[128:131], v[212:215], v[244:247], a[128:131]
    v_mfma_f32_16x16x32_bf16 a[132:135], v[216:219], v[244:247], a[132:135]
    ds_write_b128 v6, a[44:47] offset:11264
    v_mfma_f32_16x16x32_bf16 a[136:139], v[220:223], v[244:247], a[136:139]
    v_mfma_f32_16x16x32_bf16 a[140:143], v[224:227], v[244:247], a[140:143]
    ds_write_b128 v6, a[48:51] offset:12288
    v_mfma_f32_16x16x32_bf16 a[204:207], v[228:231], v[244:247], a[204:207]
    s_waitcnt lgkmcnt(14)
    v_mfma_f32_16x16x32_bf16 v[64:67], v[196:199], v[248:251], v[64:67]
    ds_write_b128 v6, a[52:55] offset:13312
    v_mfma_f32_16x16x32_bf16 v[68:71], v[200:203], v[248:251], v[68:71]
    v_mfma_f32_16x16x32_bf16 a[144:147], v[204:207], v[248:251], a[144:147]
    ds_write_b128 v6, a[56:59] offset:14336
    v_mfma_f32_16x16x32_bf16 a[148:151], v[208:211], v[248:251], a[148:151]
    v_mfma_f32_16x16x32_bf16 a[152:155], v[212:215], v[248:251], a[152:155]
    ds_write_b128 v6, a[60:63] offset:15360
    v_mfma_f32_16x16x32_bf16 a[156:159], v[216:219], v[248:251], a[156:159]
    v_mfma_f32_16x16x32_bf16 a[160:163], v[220:223], v[248:251], a[160:163]
    ds_write_b128 v6, a[64:67] offset:16384
    v_mfma_f32_16x16x32_bf16 a[164:167], v[224:227], v[248:251], a[164:167]
    v_mfma_f32_16x16x32_bf16 a[208:211], v[228:231], v[248:251], a[208:211]
    ds_write_b128 v6, a[68:71] offset:17408
    s_waitcnt lgkmcnt(15)
    v_mfma_f32_16x16x32_bf16 v[72:75], v[196:199], v[252:255], v[72:75]
    v_mfma_f32_16x16x32_bf16 v[76:79], v[200:203], v[252:255], v[76:79]
    ds_write_b128 v6, a[192:195] offset:18432
    v_mfma_f32_16x16x32_bf16 a[168:171], v[204:207], v[252:255], a[168:171]
    v_mfma_f32_16x16x32_bf16 a[172:175], v[208:211], v[252:255], a[172:175]
    ds_write_b128 v6, a[72:75] offset:19456
    v_mfma_f32_16x16x32_bf16 a[176:179], v[212:215], v[252:255], a[176:179]
    v_mfma_f32_16x16x32_bf16 a[180:183], v[216:219], v[252:255], a[180:183]
    ds_write_b128 v6, a[76:79] offset:20480
    v_mfma_f32_16x16x32_bf16 a[184:187], v[220:223], v[252:255], a[184:187]
    v_mfma_f32_16x16x32_bf16 a[188:191], v[224:227], v[252:255], a[188:191]
    ds_write_b128 v6, a[80:83] offset:21504
    v_mfma_f32_16x16x32_bf16 a[212:215], v[228:231], v[252:255], a[212:215]
    ds_write_b128 v6, a[84:87] offset:22528
    ds_write_b128 v6, a[88:91] offset:23552
    ds_write_b128 v6, a[92:95] offset:24576
    ds_write_b128 v6, a[196:199] offset:25600
    ds_write_b128 v6, a[96:99] offset:26624
    ds_write_b128 v6, a[100:103] offset:27648
    ds_write_b128 v6, a[104:107] offset:28672
    ds_write_b128 v6, a[108:111] offset:29696
    ds_write_b128 v6, a[112:115] offset:30720
    ds_write_b128 v6, a[116:119] offset:31744
    ds_write_b128 v6, a[200:203] offset:32768
    ds_write_b128 v6, a[120:123] offset:33792
    ds_write_b128 v6, a[124:127] offset:34816
    ds_write_b128 v6, a[128:131] offset:35840
    ds_write_b128 v6, a[132:135] offset:36864
    ds_write_b128 v6, a[136:139] offset:37888
    ds_write_b128 v6, a[140:143] offset:38912
    ds_write_b128 v6, a[204:207] offset:39936
    v_lshlrev_b32 v2, 4, v1
    v_and_b32 v3, 15, v1
    v_lshrrev_b32 v4, 4, v1
    v_lshrrev_b32 v5, 1, v4
    v_and_b32 v10, 1, v4
    v_lshl_add_u32 v5, v10, 1, v5
    v_mul_u32_u24 v10, 1152, v3
    v_lshl_add_u32 v11, v5, 4, v10
    v_lshl_add_u32 v12, v4, 3, v10
    v_mov_b32 v13, 0
    s_and_b32 s12, s8, 7
    s_lshl_b32 s13, s4, 3
    s_add_u32 s13, s13, s12
    s_mul_i32 s13, s13, 18432
    s_mul_i32 s14, s5, 288
    s_add_u32 s13, s13, s14
    s_lshl_b32 s14, s9, 5
    s_add_u32 s78, s13, s14
    s_add_u32 s79, s13, 256
    s_mov_b32 s40, s16
    s_mov_b32 s41, s17
    s_mov_b32 s42, 2359296
    s_mov_b32 s43, 0x20000
    s_mov_b32 s44, s32
    s_mov_b32 s45, s33
    s_mov_b32 s46, 2359296
    s_mov_b32 s47, 0x20000
    s_add_u32 s12, s78, 0
    buffer_load_dwordx4 v[88:91], v11, s[40:43], s12 offen
    s_add_u32 s12, s78, 18432
    buffer_load_dwordx4 v[92:95], v11, s[40:43], s12 offen
    s_add_u32 s12, s79, 0
    buffer_load_dwordx2 v[96:97], v12, s[40:43], s12 offen
    s_add_u32 s12, s79, 18432
    buffer_load_dwordx2 v[98:99], v12, s[40:43], s12 offen
    s_waitcnt lgkmcnt(0)
    s_barrier
    ds_read_b128 v[108:111], v7 offset:4096
    ds_read_b128 v[112:115], v7 offset:5120
    ds_read_b128 v[116:119], v7 offset:10240
    ds_read_b128 v[120:123], v7 offset:11264
    ds_read_b128 v[124:127], v8 offset:2048
    ds_read_b128 v[128:131], v8 offset:3072
    ds_read_b128 v[132:135], v8 offset:8192
    ds_read_b128 v[136:139], v8 offset:9216
    ds_read_b128 v[140:143], v9 offset:0
    ds_read_b128 v[144:147], v9 offset:1024
    ds_read_b128 v[148:151], v9 offset:6144
    ds_read_b128 v[152:155], v9 offset:7168
    ds_read_b128 v[156:159], v7 offset:16384
    ds_read_b128 v[160:163], v7 offset:17408
    ds_read_b128 v[164:167], v7 offset:23552
    ds_read_b128 v[168:171], v7 offset:24576
    ds_read_b128 v[172:175], v8 offset:14336
    ds_read_b128 v[176:179], v8 offset:15360
    ds_read_b128 v[180:183], v8 offset:21504
    ds_read_b128 v[184:187], v8 offset:22528
    ds_read_b128 v[188:191], v9 offset:12288
    ds_read_b128 v[192:195], v9 offset:13312
    ds_read_b128 v[196:199], v9 offset:19456
    ds_read_b128 v[200:203], v9 offset:20480
    ds_read_b128 v[204:207], v9 offset:18432
    ds_read_b128 v[208:211], v9 offset:25600
    s_waitcnt lgkmcnt(15)
    v_add_f32 v32, v32, v108
    v_add_f32 v33, v33, v109
    v_add_f32 v34, v34, v110
    v_add_f32 v35, v35, v111
    v_add_f32 v36, v36, v112
    v_add_f32 v37, v37, v113
    v_add_f32 v38, v38, v114
    v_add_f32 v39, v39, v115
    v_add_f32 v40, v40, v116
    v_add_f32 v41, v41, v117
    v_add_f32 v42, v42, v118
    v_add_f32 v43, v43, v119
    v_add_f32 v44, v44, v120
    v_add_f32 v45, v45, v121
    v_add_f32 v46, v46, v122
    v_add_f32 v47, v47, v123
    v_add_f32 v48, v48, v124
    v_add_f32 v49, v49, v125
    v_add_f32 v50, v50, v126
    v_add_f32 v51, v51, v127
    v_add_f32 v52, v52, v128
    v_add_f32 v53, v53, v129
    v_add_f32 v54, v54, v130
    v_add_f32 v55, v55, v131
    v_add_f32 v56, v56, v132
    v_add_f32 v57, v57, v133
    v_add_f32 v58, v58, v134
    v_add_f32 v59, v59, v135
    v_add_f32 v60, v60, v136
    v_add_f32 v61, v61, v137
    v_add_f32 v62, v62, v138
    v_add_f32 v63, v63, v139
    v_add_f32 v64, v64, v140
    v_add_f32 v65, v65, v141
    v_add_f32 v66, v66, v142
    v_add_f32 v67, v67, v143
    v_add_f32 v68, v68, v144
    v_add_f32 v69, v69, v145
    v_add_f32 v70, v70, v146
    v_add_f32 v71, v71, v147
    v_add_f32 v72, v72, v148
    v_add_f32 v73, v73, v149
    v_add_f32 v74, v74, v150
    v_add_f32 v75, v75, v151
    s_waitcnt lgkmcnt(14)
    v_add_f32 v76, v76, v152
    v_add_f32 v77, v77, v153
    v_add_f32 v78, v78, v154
    v_add_f32 v79, v79, v155
    s_waitcnt lgkmcnt(13)
    v_add_f32 v48, v48, v156
    v_add_f32 v49, v49, v157
    v_add_f32 v50, v50, v158
    v_add_f32 v51, v51, v159
    s_waitcnt lgkmcnt(12)
    v_add_f32 v52, v52, v160
    v_add_f32 v53, v53, v161
    v_add_f32 v54, v54, v162
    v_add_f32 v55, v55, v163
    s_waitcnt lgkmcnt(11)
    v_add_f32 v56, v56, v164
    v_add_f32 v57, v57, v165
    v_add_f32 v58, v58, v166
    v_add_f32 v59, v59, v167
    s_waitcnt lgkmcnt(10)
    v_add_f32 v60, v60, v168
    v_add_f32 v61, v61, v169
    v_add_f32 v62, v62, v170
    v_add_f32 v63, v63, v171
    s_waitcnt lgkmcnt(9)
    v_add_f32 v64, v64, v172
    v_add_f32 v65, v65, v173
    v_add_f32 v66, v66, v174
    v_add_f32 v67, v67, v175
    s_waitcnt lgkmcnt(8)
    v_add_f32 v68, v68, v176
    v_add_f32 v69, v69, v177
    v_add_f32 v70, v70, v178
    v_add_f32 v71, v71, v179
    s_waitcnt lgkmcnt(7)
    v_add_f32 v72, v72, v180
    v_add_f32 v73, v73, v181
    v_add_f32 v74, v74, v182
    v_add_f32 v75, v75, v183
    s_waitcnt lgkmcnt(6)
    v_add_f32 v76, v76, v184
    v_add_f32 v77, v77, v185
    v_add_f32 v78, v78, v186
    v_add_f32 v79, v79, v187
    s_waitcnt lgkmcnt(5)
    v_add_f32 v16, v16, v188
    v_add_f32 v17, v17, v189
    v_add_f32 v18, v18, v190
    v_add_f32 v19, v19, v191
    s_waitcnt lgkmcnt(4)
    v_add_f32 v20, v20, v192
    v_add_f32 v21, v21, v193
    v_add_f32 v22, v22, v194
    v_add_f32 v23, v23, v195
    s_waitcnt lgkmcnt(3)
    v_add_f32 v24, v24, v196
    v_add_f32 v25, v25, v197
    v_add_f32 v26, v26, v198
    v_add_f32 v27, v27, v199
    s_waitcnt lgkmcnt(2)
    v_add_f32 v28, v28, v200
    v_add_f32 v29, v29, v201
    v_add_f32 v30, v30, v202
    v_add_f32 v31, v31, v203
    s_waitcnt lgkmcnt(1)
    v_add_f32 v80, v80, v204
    v_add_f32 v81, v81, v205
    v_add_f32 v82, v82, v206
    v_add_f32 v83, v83, v207
    s_waitcnt lgkmcnt(0)
    v_add_f32 v84, v84, v208
    v_add_f32 v85, v85, v209
    v_add_f32 v86, v86, v210
    v_add_f32 v87, v87, v211
    s_barrier
    ds_read_b128 v[108:111], v7 offset:30720
    ds_read_b128 v[112:115], v7 offset:31744
    ds_read_b128 v[116:119], v7 offset:37888
    ds_read_b128 v[120:123], v7 offset:38912
    ds_read_b128 v[124:127], v8 offset:28672
    ds_read_b128 v[128:131], v8 offset:29696
    ds_read_b128 v[132:135], v8 offset:35840
    ds_read_b128 v[136:139], v8 offset:36864
    ds_read_b128 v[140:143], v8 offset:32768
    ds_read_b128 v[144:147], v8 offset:39936
    ds_read_b128 v[148:151], v9 offset:26624
    ds_read_b128 v[152:155], v9 offset:27648
    ds_read_b128 v[156:159], v9 offset:33792
    ds_read_b128 v[160:163], v9 offset:34816
    ds_write_b128 v6, a[144:147] offset:0
    s_waitcnt lgkmcnt(14)
    v_add_f32 v64, v64, v108
    v_add_f32 v65, v65, v109
    v_add_f32 v66, v66, v110
    v_add_f32 v67, v67, v111
    ds_write_b128 v6, a[148:151] offset:1024
    s_waitcnt lgkmcnt(14)
    v_add_f32 v68, v68, v112
    v_add_f32 v69, v69, v113
    v_add_f32 v70, v70, v114
    v_add_f32 v71, v71, v115
    ds_write_b128 v6, a[152:155] offset:2048
    s_waitcnt lgkmcnt(14)
    v_add_f32 v72, v72, v116
    v_add_f32 v73, v73, v117
    v_add_f32 v74, v74, v118
    v_add_f32 v75, v75, v119
    ds_write_b128 v6, a[156:159] offset:3072
    s_waitcnt lgkmcnt(14)
    v_add_f32 v76, v76, v120
    v_add_f32 v77, v77, v121
    v_add_f32 v78, v78, v122
    v_add_f32 v79, v79, v123
    ds_write_b128 v6, a[160:163] offset:4096
    s_waitcnt lgkmcnt(14)
    v_add_f32 v16, v16, v124
    v_add_f32 v17, v17, v125
    v_add_f32 v18, v18, v126
    v_add_f32 v19, v19, v127
    ds_write_b128 v6, a[164:167] offset:5120
    s_waitcnt lgkmcnt(14)
    v_add_f32 v20, v20, v128
    v_add_f32 v21, v21, v129
    v_add_f32 v22, v22, v130
    v_add_f32 v23, v23, v131
    ds_write_b128 v6, a[208:211] offset:6144
    s_waitcnt lgkmcnt(14)
    v_add_f32 v24, v24, v132
    v_add_f32 v25, v25, v133
    v_add_f32 v26, v26, v134
    v_add_f32 v27, v27, v135
    ds_write_b128 v6, a[168:171] offset:7168
    s_waitcnt lgkmcnt(14)
    v_add_f32 v28, v28, v136
    v_add_f32 v29, v29, v137
    v_add_f32 v30, v30, v138
    v_add_f32 v31, v31, v139
    ds_write_b128 v6, a[172:175] offset:8192
    s_waitcnt lgkmcnt(14)
    v_add_f32 v80, v80, v140
    v_add_f32 v81, v81, v141
    v_add_f32 v82, v82, v142
    v_add_f32 v83, v83, v143
    ds_write_b128 v6, a[176:179] offset:9216
    s_waitcnt lgkmcnt(14)
    v_add_f32 v84, v84, v144
    v_add_f32 v85, v85, v145
    v_add_f32 v86, v86, v146
    v_add_f32 v87, v87, v147
    ds_write_b128 v6, a[180:183] offset:10240
    s_waitcnt lgkmcnt(14)
    v_add_f32 v32, v32, v148
    v_add_f32 v33, v33, v149
    v_add_f32 v34, v34, v150
    v_add_f32 v35, v35, v151
    ds_write_b128 v6, a[184:187] offset:11264
    s_waitcnt lgkmcnt(14)
    v_add_f32 v36, v36, v152
    v_add_f32 v37, v37, v153
    v_add_f32 v38, v38, v154
    v_add_f32 v39, v39, v155
    ds_write_b128 v6, a[188:191] offset:12288
    s_waitcnt lgkmcnt(14)
    v_add_f32 v40, v40, v156
    v_add_f32 v41, v41, v157
    v_add_f32 v42, v42, v158
    v_add_f32 v43, v43, v159
    ds_write_b128 v6, a[212:215] offset:13312
    s_waitcnt lgkmcnt(14)
    v_add_f32 v44, v44, v160
    v_add_f32 v45, v45, v161
    v_add_f32 v46, v46, v162
    v_add_f32 v47, v47, v163
    s_waitcnt lgkmcnt(0)
    s_barrier
    ds_read_b128 v[108:111], v7 offset:4096
    ds_read_b128 v[112:115], v7 offset:5120
    ds_read_b128 v[116:119], v7 offset:11264
    ds_read_b128 v[120:123], v7 offset:12288
    ds_read_b128 v[124:127], v7 offset:6144
    ds_read_b128 v[128:131], v7 offset:13312
    ds_read_b128 v[132:135], v8 offset:2048
    ds_read_b128 v[136:139], v8 offset:3072
    ds_read_b128 v[140:143], v8 offset:9216
    ds_read_b128 v[144:147], v8 offset:10240
    ds_read_b128 v[148:151], v9 offset:0
    ds_read_b128 v[152:155], v9 offset:1024
    ds_read_b128 v[156:159], v9 offset:7168
    ds_read_b128 v[160:163], v9 offset:8192
    s_waitcnt lgkmcnt(13)
    v_add_f32 v16, v16, v108
    v_add_f32 v17, v17, v109
    v_add_f32 v18, v18, v110
    v_add_f32 v19, v19, v111
    s_waitcnt lgkmcnt(12)
    v_add_f32 v20, v20, v112
    v_add_f32 v21, v21, v113
    v_add_f32 v22, v22, v114
    v_add_f32 v23, v23, v115
    s_waitcnt lgkmcnt(11)
    v_add_f32 v24, v24, v116
    v_add_f32 v25, v25, v117
    v_add_f32 v26, v26, v118
    v_add_f32 v27, v27, v119
    s_waitcnt lgkmcnt(10)
    v_add_f32 v28, v28, v120
    v_add_f32 v29, v29, v121
    v_add_f32 v30, v30, v122
    v_add_f32 v31, v31, v123
    s_waitcnt lgkmcnt(9)
    v_add_f32 v80, v80, v124
    v_add_f32 v81, v81, v125
    v_add_f32 v82, v82, v126
    v_add_f32 v83, v83, v127
    s_waitcnt lgkmcnt(8)
    v_add_f32 v84, v84, v128
    v_add_f32 v85, v85, v129
    v_add_f32 v86, v86, v130
    v_add_f32 v87, v87, v131
    s_waitcnt lgkmcnt(7)
    v_add_f32 v32, v32, v132
    v_add_f32 v33, v33, v133
    v_add_f32 v34, v34, v134
    v_add_f32 v35, v35, v135
    s_waitcnt lgkmcnt(6)
    v_add_f32 v36, v36, v136
    v_add_f32 v37, v37, v137
    v_add_f32 v38, v38, v138
    v_add_f32 v39, v39, v139
    s_waitcnt lgkmcnt(5)
    v_add_f32 v40, v40, v140
    v_add_f32 v41, v41, v141
    v_add_f32 v42, v42, v142
    v_add_f32 v43, v43, v143
    s_waitcnt lgkmcnt(4)
    v_add_f32 v44, v44, v144
    v_add_f32 v45, v45, v145
    v_add_f32 v46, v46, v146
    v_add_f32 v47, v47, v147
    s_waitcnt lgkmcnt(3)
    v_add_f32 v48, v48, v148
    v_add_f32 v49, v49, v149
    v_add_f32 v50, v50, v150
    v_add_f32 v51, v51, v151
    s_waitcnt lgkmcnt(2)
    v_add_f32 v52, v52, v152
    v_add_f32 v53, v53, v153
    v_add_f32 v54, v54, v154
    v_add_f32 v55, v55, v155
    s_waitcnt lgkmcnt(1)
    v_add_f32 v56, v56, v156
    v_add_f32 v57, v57, v157
    v_add_f32 v58, v58, v158
    v_add_f32 v59, v59, v159
    s_waitcnt lgkmcnt(0)
    v_add_f32 v60, v60, v160
    v_add_f32 v61, v61, v161
    v_add_f32 v62, v62, v162
    v_add_f32 v63, v63, v163
    s_add_u32 s48, s36, 25165824
    s_addc_u32 s49, s37, 0
    s_mov_b32 s50, 9437184
    s_mov_b32 s51, 0x20000
    s_lshl_b32 s12, s4, 2
    s_add_u32 s12, s12, s5
    s_lshl_b32 s13, s12, 17
    s_lshl_b32 s14, s3, 13
    s_add_u32 s13, s13, s14
    s_lshl_b32 s14, s12, 14
    s_add_u32 s14, s14, 8388608
    s_lshl_b32 s15, s6, 15
    s_add_u32 s15, s15, s13
    v_cvt_pk_bf16_f32 v116, v32, v33
    v_cvt_pk_bf16_f32 v117, v34, v35
    v_cvt_pk_bf16_f32 v118, v36, v37
    v_cvt_pk_bf16_f32 v119, v38, v39
    v_min_u32 v116, -2, v116
    v_min_u32 v117, -2, v117
    v_min_u32 v118, -2, v118
    v_min_u32 v119, -2, v119
    s_add_u32 s12, s8, 2
    s_and_b32 s12, s12, 7
    s_lshl_b32 s12, s12, 10
    s_add_u32 s12, s12, s15
    buffer_store_dwordx4 v[116:119], v2, s[48:51], s12 offen sc1
    v_cvt_pk_bf16_f32 v120, v40, v41
    v_cvt_pk_bf16_f32 v121, v42, v43
    v_cvt_pk_bf16_f32 v122, v44, v45
    v_cvt_pk_bf16_f32 v123, v46, v47
    v_min_u32 v120, -2, v120
    v_min_u32 v121, -2, v121
    v_min_u32 v122, -2, v122
    v_min_u32 v123, -2, v123
    s_add_u32 s12, s8, 3
    s_and_b32 s12, s12, 7
    s_lshl_b32 s12, s12, 10
    s_add_u32 s12, s12, s15
    buffer_store_dwordx4 v[120:123], v2, s[48:51], s12 offen sc1
    v_cvt_pk_bf16_f32 v124, v48, v49
    v_cvt_pk_bf16_f32 v125, v50, v51
    v_cvt_pk_bf16_f32 v126, v52, v53
    v_cvt_pk_bf16_f32 v127, v54, v55
    v_min_u32 v124, -2, v124
    v_min_u32 v125, -2, v125
    v_min_u32 v126, -2, v126
    v_min_u32 v127, -2, v127
    s_add_u32 s12, s8, 4
    s_and_b32 s12, s12, 7
    s_lshl_b32 s12, s12, 10
    s_add_u32 s12, s12, s15
    buffer_store_dwordx4 v[124:127], v2, s[48:51], s12 offen sc1
    v_cvt_pk_bf16_f32 v128, v56, v57
    v_cvt_pk_bf16_f32 v129, v58, v59
    v_cvt_pk_bf16_f32 v130, v60, v61
    v_cvt_pk_bf16_f32 v131, v62, v63
    v_min_u32 v128, -2, v128
    v_min_u32 v129, -2, v129
    v_min_u32 v130, -2, v130
    v_min_u32 v131, -2, v131
    s_add_u32 s12, s8, 5
    s_and_b32 s12, s12, 7
    s_lshl_b32 s12, s12, 10
    s_add_u32 s12, s12, s15
    buffer_store_dwordx4 v[128:131], v2, s[48:51], s12 offen sc1
    v_cvt_pk_bf16_f32 v132, v64, v65
    v_cvt_pk_bf16_f32 v133, v66, v67
    v_cvt_pk_bf16_f32 v134, v68, v69
    v_cvt_pk_bf16_f32 v135, v70, v71
    v_min_u32 v132, -2, v132
    v_min_u32 v133, -2, v133
    v_min_u32 v134, -2, v134
    v_min_u32 v135, -2, v135
    s_add_u32 s12, s8, 6
    s_and_b32 s12, s12, 7
    s_lshl_b32 s12, s12, 10
    s_add_u32 s12, s12, s15
    buffer_store_dwordx4 v[132:135], v2, s[48:51], s12 offen sc1
    v_cvt_pk_bf16_f32 v136, v72, v73
    v_cvt_pk_bf16_f32 v137, v74, v75
    v_cvt_pk_bf16_f32 v138, v76, v77
    v_cvt_pk_bf16_f32 v139, v78, v79
    v_min_u32 v136, -2, v136
    v_min_u32 v137, -2, v137
    v_min_u32 v138, -2, v138
    v_min_u32 v139, -2, v139
    s_add_u32 s12, s8, 7
    s_and_b32 s12, s12, 7
    s_lshl_b32 s12, s12, 10
    s_add_u32 s12, s12, s15
    buffer_store_dwordx4 v[136:139], v2, s[48:51], s12 offen sc1
    v_cvt_pk_bf16_f32 v140, v80, v81
    v_cvt_pk_bf16_f32 v141, v82, v83
    v_cvt_pk_bf16_f32 v142, v84, v85
    v_cvt_pk_bf16_f32 v143, v86, v87
    v_min_u32 v140, -2, v140
    v_min_u32 v141, -2, v141
    v_min_u32 v142, -2, v142
    v_min_u32 v143, -2, v143
    s_cmp_eq_u32 s3, 0
    s_cbranch_scc1 K2_nospD
    s_lshr_b32 s12, s8, 1
    s_and_b32 s12, s12, 3
    s_lshl_b32 s15, s6, 2
    s_add_u32 s12, s12, s15
    s_lshl_b32 s12, s12, 10
    s_add_u32 s12, s12, s14
    buffer_store_dwordx4 v[140:143], v2, s[48:51], s12 offen sc1
K2_nospD:
    v_cvt_pk_bf16_f32 v108, v16, v17
    v_cvt_pk_bf16_f32 v109, v18, v19
    v_cvt_pk_bf16_f32 v110, v20, v21
    v_cvt_pk_bf16_f32 v111, v22, v23
    v_min_u32 v108, -2, v108
    v_min_u32 v109, -2, v109
    v_min_u32 v110, -2, v110
    v_min_u32 v111, -2, v111
    v_cvt_pk_bf16_f32 v112, v24, v25
    v_cvt_pk_bf16_f32 v113, v26, v27
    v_cvt_pk_bf16_f32 v114, v28, v29
    v_cvt_pk_bf16_f32 v115, v30, v31
    v_min_u32 v112, -2, v112
    v_min_u32 v113, -2, v113
    v_min_u32 v114, -2, v114
    v_min_u32 v115, -2, v115
    s_and_b32 s12, s8, 7
    s_lshl_b32 s12, s12, 10
    s_add_u32 s13, s13, s12
    s_xor_b32 s12, s6, 1
    s_lshl_b32 s15, s12, 15
    s_add_u32 s61, s13, s15
    s_lshl_b32 s15, s12, 12
    s_add_u32 s15, s15, s14
    s_lshl_b32 s12, s6, 10
    s_add_u32 s65, s15, s12
    s_xor_b32 s12, s6, 2
    s_lshl_b32 s15, s12, 15
    s_add_u32 s62, s13, s15
    s_lshl_b32 s15, s12, 12
    s_add_u32 s15, s15, s14
    s_lshl_b32 s12, s6, 10
    s_add_u32 s66, s15, s12
    s_xor_b32 s12, s6, 3
    s_lshl_b32 s15, s12, 15
    s_add_u32 s63, s13, s15
    s_lshl_b32 s15, s12, 12
    s_add_u32 s15, s15, s14
    s_lshl_b32 s12, s6, 10
    s_add_u32 s67, s15, s12
    s_cmp_eq_u32 s3, 0
    s_cselect_b32 s65, s65, s61
    s_cselect_b32 s66, s66, s62
    s_cselect_b32 s67, s67, s63
    s_mov_b32 s74, 0
K2_lpD:
    s_sleep 4
    buffer_load_dword v149, v13, s[48:51], s61 offen offset:2044 sc1
    buffer_load_dword v152, v13, s[48:51], s65 offen offset:1020 sc1
    buffer_load_dword v150, v13, s[48:51], s62 offen offset:2044 sc1
    buffer_load_dword v153, v13, s[48:51], s66 offen offset:1020 sc1
    buffer_load_dword v151, v13, s[48:51], s63 offen offset:2044 sc1
    buffer_load_dword v154, v13, s[48:51], s67 offen offset:1020 sc1
    s_waitcnt vmcnt(0)
    v_max3_u32 v14, v149, v150, v151
    v_max3_u32 v14, v14, v152, v153
    v_max_u32 v14, v14, v154
    v_cmp_eq_u32 vcc, -1, v14
    s_add_u32 s74, s74, 1
    s_cmp_gt_u32 s74, 200000
    s_cbranch_scc1 K2_goD
    s_cbranch_vccnz K2_lpD
    buffer_load_dwordx4 v[148:151], v2, s[48:51], s61 offen offset:0 sc1
    buffer_load_dwordx4 v[152:155], v2, s[48:51], s61 offen offset:1024 sc1
    buffer_load_dwordx4 v[156:159], v2, s[48:51], s65 offen sc1
    buffer_load_dwordx4 v[160:163], v2, s[48:51], s62 offen offset:0 sc1
    buffer_load_dwordx4 v[164:167], v2, s[48:51], s62 offen offset:1024 sc1
    buffer_load_dwordx4 v[168:171], v2, s[48:51], s66 offen sc1
    buffer_load_dwordx4 v[172:175], v2, s[48:51], s63 offen offset:0 sc1
    buffer_load_dwordx4 v[176:179], v2, s[48:51], s63 offen offset:1024 sc1
    buffer_load_dwordx4 v[180:183], v2, s[48:51], s67 offen sc1
    s_waitcnt vmcnt(0)
    v_max_u32 v14, v148, v149
    v_max3_u32 v14, v14, v150, v151
    v_max3_u32 v14, v14, v152, v153
    v_max3_u32 v14, v14, v154, v155
    v_max3_u32 v14, v14, v156, v157
    v_max3_u32 v14, v14, v158, v159
    v_max3_u32 v14, v14, v160, v161
    v_max3_u32 v14, v14, v162, v163
    v_max3_u32 v14, v14, v164, v165
    v_max3_u32 v14, v14, v166, v167
    v_max3_u32 v14, v14, v168, v169
    v_max3_u32 v14, v14, v170, v171
    v_max3_u32 v14, v14, v172, v173
    v_max3_u32 v14, v14, v174, v175
    v_max3_u32 v14, v14, v176, v177
    v_max3_u32 v14, v14, v178, v179
    v_max3_u32 v14, v14, v180, v181
    v_max3_u32 v14, v14, v182, v183
    v_cmp_eq_u32 vcc, -1, v14
    s_cbranch_vccnz K2_lpD
K2_goD:
    v_lshlrev_b32 v16, 16, v108
    v_and_b32 v17, s95, v108
    v_lshlrev_b32 v18, 16, v109
    v_and_b32 v19, s95, v109
    v_lshlrev_b32 v64, 16, v148
    v_and_b32 v65, s95, v148
    v_lshlrev_b32 v66, 16, v149
    v_and_b32 v67, s95, v149
    v_add_f32 v16, v16, v64
    v_add_f32 v17, v17, v65
    v_add_f32 v18, v18, v66
    v_add_f32 v19, v19, v67
    v_cvt_pk_bf16_f32 v14, v16, v17
    v_cvt_pk_bf16_f32 v15, v18, v19
    v_lshlrev_b32 v16, 16, v14
    v_and_b32 v17, s95, v14
    v_lshlrev_b32 v18, 16, v15
    v_and_b32 v19, s95, v15
    v_lshlrev_b32 v40, 16, v160
    v_and_b32 v41, s95, v160
    v_lshlrev_b32 v42, 16, v161
    v_and_b32 v43, s95, v161
    v_lshlrev_b32 v64, 16, v172
    v_and_b32 v65, s95, v172
    v_lshlrev_b32 v66, 16, v173
    v_and_b32 v67, s95, v173
    v_add_f32 v40, v40, v64
    v_add_f32 v41, v41, v65
    v_add_f32 v42, v42, v66
    v_add_f32 v43, v43, v67
    v_cvt_pk_bf16_f32 v14, v40, v41
    v_cvt_pk_bf16_f32 v15, v42, v43
    v_lshlrev_b32 v40, 16, v14
    v_and_b32 v41, s95, v14
    v_lshlrev_b32 v42, 16, v15
    v_and_b32 v43, s95, v15
    v_lshlrev_b32 v20, 16, v110
    v_and_b32 v21, s95, v110
    v_lshlrev_b32 v22, 16, v111
    v_and_b32 v23, s95, v111
    v_lshlrev_b32 v64, 16, v150
    v_and_b32 v65, s95, v150
    v_lshlrev_b32 v66, 16, v151
    v_and_b32 v67, s95, v151
    v_add_f32 v20, v20, v64
    v_add_f32 v21, v21, v65
    v_add_f32 v22, v22, v66
    v_add_f32 v23, v23, v67
    v_cvt_pk_bf16_f32 v14, v20, v21
    v_cvt_pk_bf16_f32 v15, v22, v23
    v_lshlrev_b32 v20, 16, v14
    v_and_b32 v21, s95, v14
    v_lshlrev_b32 v22, 16, v15
    v_and_b32 v23, s95, v15
    v_lshlrev_b32 v44, 16, v162
    v_and_b32 v45, s95, v162
    v_lshlrev_b32 v46, 16, v163
    v_and_b32 v47, s95, v163
    v_lshlrev_b32 v64, 16, v174
    v_and_b32 v65, s95, v174
    v_lshlrev_b32 v66, 16, v175
    v_and_b32 v67, s95, v175
    v_add_f32 v44, v44, v64
    v_add_f32 v45, v45, v65
    v_add_f32 v46, v46, v66
    v_add_f32 v47, v47, v67
    v_cvt_pk_bf16_f32 v14, v44, v45
    v_cvt_pk_bf16_f32 v15, v46, v47
    v_lshlrev_b32 v44, 16, v14
    v_and_b32 v45, s95, v14
    v_lshlrev_b32 v46, 16, v15
    v_and_b32 v47, s95, v15
    s_nop 1
    v_permlane16_swap_b32 v16, v20
    v_permlane16_swap_b32 v17, v21
    v_permlane16_swap_b32 v18, v22
    v_permlane16_swap_b32 v19, v23
    v_permlane16_swap_b32 v40, v44
    v_permlane16_swap_b32 v41, v45
    v_permlane16_swap_b32 v42, v46
    v_permlane16_swap_b32 v43, v47
    v_lshlrev_b32 v64, 16, v88
    v_and_b32 v65, s95, v88
    v_lshlrev_b32 v66, 16, v89
    v_and_b32 v67, s95, v89
    v_add_f32 v16, v16, v64
    v_add_f32 v17, v17, v65
    v_add_f32 v18, v18, v66
    v_add_f32 v19, v19, v67
    v_cvt_pk_bf16_f32 v14, v16, v17
    v_cvt_pk_bf16_f32 v15, v18, v19
    v_lshlrev_b32 v16, 16, v14
    v_and_b32 v17, s95, v14
    v_lshlrev_b32 v18, 16, v15
    v_and_b32 v19, s95, v15
    v_add_f32 v16, v16, v40
    v_add_f32 v17, v17, v41
    v_add_f32 v18, v18, v42
    v_add_f32 v19, v19, v43
    v_cvt_pk_bf16_f32 v72, v16, v17
    v_cvt_pk_bf16_f32 v73, v18, v19
    v_lshlrev_b32 v64, 16, v90
    v_and_b32 v65, s95, v90
    v_lshlrev_b32 v66, 16, v91
    v_and_b32 v67, s95, v91
    v_add_f32 v20, v20, v64
    v_add_f32 v21, v21, v65
    v_add_f32 v22, v22, v66
    v_add_f32 v23, v23, v67
    v_cvt_pk_bf16_f32 v14, v20, v21
    v_cvt_pk_bf16_f32 v15, v22, v23
    v_lshlrev_b32 v20, 16, v14
    v_and_b32 v21, s95, v14
    v_lshlrev_b32 v22, 16, v15
    v_and_b32 v23, s95, v15
    v_add_f32 v20, v20, v44
    v_add_f32 v21, v21, v45
    v_add_f32 v22, v22, v46
    v_add_f32 v23, v23, v47
    v_cvt_pk_bf16_f32 v74, v20, v21
    v_cvt_pk_bf16_f32 v75, v22, v23
    s_add_u32 s12, s78, 0
    buffer_store_dwordx4 v[72:75], v11, s[44:47], s12 offen
    v_lshlrev_b32 v24, 16, v112
    v_and_b32 v25, s95, v112
    v_lshlrev_b32 v26, 16, v113
    v_and_b32 v27, s95, v113
    v_lshlrev_b32 v64, 16, v152
    v_and_b32 v65, s95, v152
    v_lshlrev_b32 v66, 16, v153
    v_and_b32 v67, s95, v153
    v_add_f32 v24, v24, v64
    v_add_f32 v25, v25, v65
    v_add_f32 v26, v26, v66
    v_add_f32 v27, v27, v67
    v_cvt_pk_bf16_f32 v14, v24, v25
    v_cvt_pk_bf16_f32 v15, v26, v27
    v_lshlrev_b32 v24, 16, v14
    v_and_b32 v25, s95, v14
    v_lshlrev_b32 v26, 16, v15
    v_and_b32 v27, s95, v15
    v_lshlrev_b32 v48, 16, v164
    v_and_b32 v49, s95, v164
    v_lshlrev_b32 v50, 16, v165
    v_and_b32 v51, s95, v165
    v_lshlrev_b32 v64, 16, v176
    v_and_b32 v65, s95, v176
    v_lshlrev_b32 v66, 16, v177
    v_and_b32 v67, s95, v177
    v_add_f32 v48, v48, v64
    v_add_f32 v49, v49, v65
    v_add_f32 v50, v50, v66
    v_add_f32 v51, v51, v67
    v_cvt_pk_bf16_f32 v14, v48, v49
    v_cvt_pk_bf16_f32 v15, v50, v51
    v_lshlrev_b32 v48, 16, v14
    v_and_b32 v49, s95, v14
    v_lshlrev_b32 v50, 16, v15
    v_and_b32 v51, s95, v15
    v_lshlrev_b32 v28, 16, v114
    v_and_b32 v29, s95, v114
    v_lshlrev_b32 v30, 16, v115
    v_and_b32 v31, s95, v115
    v_lshlrev_b32 v64, 16, v154
    v_and_b32 v65, s95, v154
    v_lshlrev_b32 v66, 16, v155
    v_and_b32 v67, s95, v155
    v_add_f32 v28, v28, v64
    v_add_f32 v29, v29, v65
    v_add_f32 v30, v30, v66
    v_add_f32 v31, v31, v67
    v_cvt_pk_bf16_f32 v14, v28, v29
    v_cvt_pk_bf16_f32 v15, v30, v31
    v_lshlrev_b32 v28, 16, v14
    v_and_b32 v29, s95, v14
    v_lshlrev_b32 v30, 16, v15
    v_and_b32 v31, s95, v15
    v_lshlrev_b32 v52, 16, v166
    v_and_b32 v53, s95, v166
    v_lshlrev_b32 v54, 16, v167
    v_and_b32 v55, s95, v167
    v_lshlrev_b32 v64, 16, v178
    v_and_b32 v65, s95, v178
    v_lshlrev_b32 v66, 16, v179
    v_and_b32 v67, s95, v179
    v_add_f32 v52, v52, v64
    v_add_f32 v53, v53, v65
    v_add_f32 v54, v54, v66
    v_add_f32 v55, v55, v67
    v_cvt_pk_bf16_f32 v14, v52, v53
    v_cvt_pk_bf16_f32 v15, v54, v55
    v_lshlrev_b32 v52, 16, v14
    v_and_b32 v53, s95, v14
    v_lshlrev_b32 v54, 16, v15
    v_and_b32 v55, s95, v15
    s_nop 1
    v_permlane16_swap_b32 v24, v28
    v_permlane16_swap_b32 v25, v29
    v_permlane16_swap_b32 v26, v30
    v_permlane16_swap_b32 v27, v31
    v_permlane16_swap_b32 v48, v52
    v_permlane16_swap_b32 v49, v53
    v_permlane16_swap_b32 v50, v54
    v_permlane16_swap_b32 v51, v55
    v_lshlrev_b32 v64, 16, v92
    v_and_b32 v65, s95, v92
    v_lshlrev_b32 v66, 16, v93
    v_and_b32 v67, s95, v93
    v_add_f32 v24, v24, v64
    v_add_f32 v25, v25, v65
    v_add_f32 v26, v26, v66
    v_add_f32 v27, v27, v67
    v_cvt_pk_bf16_f32 v14, v24, v25
    v_cvt_pk_bf16_f32 v15, v26, v27
    v_lshlrev_b32 v24, 16, v14
    v_and_b32 v25, s95, v14
    v_lshlrev_b32 v26, 16, v15
    v_and_b32 v27, s95, v15
    v_add_f32 v24, v24, v48
    v_add_f32 v25, v25, v49
    v_add_f32 v26, v26, v50
    v_add_f32 v27, v27, v51
    v_cvt_pk_bf16_f32 v76, v24, v25
    v_cvt_pk_bf16_f32 v77, v26, v27
    v_lshlrev_b32 v64, 16, v94
    v_and_b32 v65, s95, v94
    v_lshlrev_b32 v66, 16, v95
    v_and_b32 v67, s95, v95
    v_add_f32 v28, v28, v64
    v_add_f32 v29, v29, v65
    v_add_f32 v30, v30, v66
    v_add_f32 v31, v31, v67
    v_cvt_pk_bf16_f32 v14, v28, v29
    v_cvt_pk_bf16_f32 v15, v30, v31
    v_lshlrev_b32 v28, 16, v14
    v_and_b32 v29, s95, v14
    v_lshlrev_b32 v30, 16, v15
    v_and_b32 v31, s95, v15
    v_add_f32 v28, v28, v52
    v_add_f32 v29, v29, v53
    v_add_f32 v30, v30, v54
    v_add_f32 v31, v31, v55
    v_cvt_pk_bf16_f32 v78, v28, v29
    v_cvt_pk_bf16_f32 v79, v30, v31
    s_add_u32 s12, s78, 18432
    buffer_store_dwordx4 v[76:79], v11, s[44:47], s12 offen
    s_cmp_eq_u32 s3, 0
    s_cbranch_scc0 K2_finD
    v_lshlrev_b32 v32, 16, v140
    v_and_b32 v33, s95, v140
    v_lshlrev_b32 v34, 16, v141
    v_and_b32 v35, s95, v141
    v_lshlrev_b32 v64, 16, v156
    v_and_b32 v65, s95, v156
    v_lshlrev_b32 v66, 16, v157
    v_and_b32 v67, s95, v157
    v_add_f32 v32, v32, v64
    v_add_f32 v33, v33, v65
    v_add_f32 v34, v34, v66
    v_add_f32 v35, v35, v67
    v_cvt_pk_bf16_f32 v14, v32, v33
    v_cvt_pk_bf16_f32 v15, v34, v35
    v_lshlrev_b32 v32, 16, v14
    v_and_b32 v33, s95, v14
    v_lshlrev_b32 v34, 16, v15
    v_and_b32 v35, s95, v15
    v_lshlrev_b32 v56, 16, v168
    v_and_b32 v57, s95, v168
    v_lshlrev_b32 v58, 16, v169
    v_and_b32 v59, s95, v169
    v_lshlrev_b32 v64, 16, v180
    v_and_b32 v65, s95, v180
    v_lshlrev_b32 v66, 16, v181
    v_and_b32 v67, s95, v181
    v_add_f32 v56, v56, v64
    v_add_f32 v57, v57, v65
    v_add_f32 v58, v58, v66
    v_add_f32 v59, v59, v67
    v_cvt_pk_bf16_f32 v14, v56, v57
    v_cvt_pk_bf16_f32 v15, v58, v59
    v_lshlrev_b32 v56, 16, v14
    v_and_b32 v57, s95, v14
    v_lshlrev_b32 v58, 16, v15
    v_and_b32 v59, s95, v15
    v_lshlrev_b32 v64, 16, v96
    v_and_b32 v65, s95, v96
    v_lshlrev_b32 v66, 16, v97
    v_and_b32 v67, s95, v97
    v_add_f32 v32, v32, v64
    v_add_f32 v33, v33, v65
    v_add_f32 v34, v34, v66
    v_add_f32 v35, v35, v67
    v_cvt_pk_bf16_f32 v14, v32, v33
    v_cvt_pk_bf16_f32 v15, v34, v35
    v_lshlrev_b32 v32, 16, v14
    v_and_b32 v33, s95, v14
    v_lshlrev_b32 v34, 16, v15
    v_and_b32 v35, s95, v15
    v_add_f32 v32, v32, v56
    v_add_f32 v33, v33, v57
    v_add_f32 v34, v34, v58
    v_add_f32 v35, v35, v59
    v_cvt_pk_bf16_f32 v80, v32, v33
    v_cvt_pk_bf16_f32 v81, v34, v35
    s_add_u32 s12, s79, 0
    buffer_store_dwordx2 v[80:81], v12, s[44:47], s12 offen
    v_lshlrev_b32 v36, 16, v142
    v_and_b32 v37, s95, v142
    v_lshlrev_b32 v38, 16, v143
    v_and_b32 v39, s95, v143
    v_lshlrev_b32 v64, 16, v158
    v_and_b32 v65, s95, v158
    v_lshlrev_b32 v66, 16, v159
    v_and_b32 v67, s95, v159
    v_add_f32 v36, v36, v64
    v_add_f32 v37, v37, v65
    v_add_f32 v38, v38, v66
    v_add_f32 v39, v39, v67
    v_cvt_pk_bf16_f32 v14, v36, v37
    v_cvt_pk_bf16_f32 v15, v38, v39
    v_lshlrev_b32 v36, 16, v14
    v_and_b32 v37, s95, v14
    v_lshlrev_b32 v38, 16, v15
    v_and_b32 v39, s95, v15
    v_lshlrev_b32 v60, 16, v170
    v_and_b32 v61, s95, v170
    v_lshlrev_b32 v62, 16, v171
    v_and_b32 v63, s95, v171
    v_lshlrev_b32 v64, 16, v182
    v_and_b32 v65, s95, v182
    v_lshlrev_b32 v66, 16, v183
    v_and_b32 v67, s95, v183
    v_add_f32 v60, v60, v64
    v_add_f32 v61, v61, v65
    v_add_f32 v62, v62, v66
    v_add_f32 v63, v63, v67
    v_cvt_pk_bf16_f32 v14, v60, v61
    v_cvt_pk_bf16_f32 v15, v62, v63
    v_lshlrev_b32 v60, 16, v14
    v_and_b32 v61, s95, v14
    v_lshlrev_b32 v62, 16, v15
    v_and_b32 v63, s95, v15
    v_lshlrev_b32 v64, 16, v98
    v_and_b32 v65, s95, v98
    v_lshlrev_b32 v66, 16, v99
    v_and_b32 v67, s95, v99
    v_add_f32 v36, v36, v64
    v_add_f32 v37, v37, v65
    v_add_f32 v38, v38, v66
    v_add_f32 v39, v39, v67
    v_cvt_pk_bf16_f32 v14, v36, v37
    v_cvt_pk_bf16_f32 v15, v38, v39
    v_lshlrev_b32 v36, 16, v14
    v_and_b32 v37, s95, v14
    v_lshlrev_b32 v38, 16, v15
    v_and_b32 v39, s95, v15
    v_add_f32 v36, v36, v60
    v_add_f32 v37, v37, v61
    v_add_f32 v38, v38, v62
    v_add_f32 v39, v39, v63
    v_cvt_pk_bf16_f32 v82, v36, v37
    v_cvt_pk_bf16_f32 v83, v38, v39
    s_add_u32 s12, s79, 18432
    buffer_store_dwordx2 v[82:83], v12, s[44:47], s12 offen
K2_finD:
    s_waitcnt vmcnt(0)
    s_branch K2_end
K2_ffn:
    s_sub_u32 s11, s6, 2
    s_mul_i32 s11, s11, 72
    s_mul_i32 s12, s3, 18
    s_add_u32 s11, s11, s12
    s_lshl_b32 s11, s11, 10
    v_add_u32 v2, s11, v20
    v_mov_b32 v3, v2
    s_add_u32 s12, s9, 0
    s_and_b32 s12, s12, 7
    s_mul_i32 s13, s5, 9
    s_add_u32 s12, s12, s13
    s_mul_i32 s44, s12, 147456
    s_add_u32 s12, s9, 1
    s_and_b32 s12, s12, 7
    s_mul_i32 s13, s5, 9
    s_add_u32 s12, s12, s13
    s_mul_i32 s45, s12, 147456
    s_add_u32 s12, s9, 2
    s_and_b32 s12, s12, 7
    s_mul_i32 s13, s5, 9
    s_add_u32 s12, s12, s13
    s_mul_i32 s46, s12, 147456
    s_add_u32 s12, s9, 3
    s_and_b32 s12, s12, 7
    s_mul_i32 s13, s5, 9
    s_add_u32 s12, s12, s13
    s_mul_i32 s47, s12, 147456
    s_add_u32 s12, s9, 4
    s_and_b32 s12, s12, 7
    s_mul_i32 s13, s5, 9
    s_add_u32 s12, s12, s13
    s_mul_i32 s48, s12, 147456
    s_add_u32 s12, s9, 5
    s_and_b32 s12, s12, 7
    s_mul_i32 s13, s5, 9
    s_add_u32 s12, s12, s13
    s_mul_i32 s49, s12, 147456
    s_add_u32 s12, s9, 6
    s_and_b32 s12, s12, 7
    s_mul_i32 s13, s5, 9
    s_add_u32 s12, s12, s13
    s_mul_i32 s50, s12, 147456
    s_add_u32 s12, s9, 7
    s_and_b32 s12, s12, 7
    s_mul_i32 s13, s5, 9
    s_add_u32 s12, s12, s13
    s_mul_i32 s51, s12, 147456
    s_mov_b32 s12, 8
    s_mul_i32 s13, s5, 9
    s_add_u32 s12, s12, s13
    s_mul_i32 s52, s12, 147456
    s_add_u32 s12, s8, 0
    s_and_b32 s12, s12, 7
    s_lshl_b32 s13, s4, 3
    s_add_u32 s12, s12, s13
    s_mul_i32 s53, s12, 147456
    s_add_u32 s12, s8, 1
    s_and_b32 s12, s12, 7
    s_lshl_b32 s13, s4, 3
    s_add_u32 s12, s12, s13
    s_mul_i32 s54, s12, 147456
    s_add_u32 s12, s8, 2
    s_and_b32 s12, s12, 7
    s_lshl_b32 s13, s4, 3
    s_add_u32 s12, s12, s13
    s_mul_i32 s55, s12, 147456
    s_add_u32 s12, s8, 3
    s_and_b32 s12, s12, 7
    s_lshl_b32 s13, s4, 3
    s_add_u32 s12, s12, s13
    s_mul_i32 s56, s12, 147456
    s_add_u32 s12, s8, 4
    s_and_b32 s12, s12, 7
    s_lshl_b32 s13, s4, 3
    s_add_u32 s12, s12, s13
    s_mul_i32 s57, s12, 147456
    s_add_u32 s12, s8, 5
    s_and_b32 s12, s12, 7
    s_lshl_b32 s13, s4, 3
    s_add_u32 s12, s12, s13
    s_mul_i32 s58, s12, 147456
    s_add_u32 s12, s8, 6
    s_and_b32 s12, s12, 7
    s_lshl_b32 s13, s4, 3
    s_add_u32 s12, s12, s13
    s_mul_i32 s59, s12, 147456
    s_add_u32 s12, s8, 7
    s_and_b32 s12, s12, 7
    s_lshl_b32 s13, s4, 3
    s_add_u32 s12, s12, s13
    s_mul_i32 s60, s12, 147456
    s_waitcnt lgkmcnt(0)
    s_add_u32 s24, s36, 5242880
    s_addc_u32 s25, s37, 0
    s_mov_b32 s26, 18874368
    s_mov_b32 s27, 0x20000
    s_add_u32 s28, s36, 37748736
    s_addc_u32 s29, s37, 0
    s_mov_b32 s30, 5308416
    s_mov_b32 s31, 0x20000
    buffer_load_dwordx4 v[88:91], v2, s[24:27], s53 offen offset:0
    buffer_load_dwordx4 v[92:95], v2, s[24:27], s54 offen offset:0
    buffer_load_dwordx4 v[96:99], v2, s[24:27], s55 offen offset:0
    buffer_load_dwordx4 v[100:103], v2, s[24:27], s56 offen offset:0
    buffer_load_dwordx4 v[104:107], v2, s[24:27], s57 offen offset:0
    buffer_load_dwordx4 v[108:111], v2, s[24:27], s58 offen offset:0
    buffer_load_dwordx4 v[112:115], v2, s[24:27], s59 offen offset:0
    buffer_load_dwordx4 v[116:119], v2, s[24:27], s60 offen offset:0
    buffer_load_dwordx4 v[120:123], v3, s[28:31], s44 offen offset:0
    buffer_load_dwordx4 v[124:127], v3, s[28:31], s45 offen offset:0
    buffer_load_dwordx4 v[128:131], v3, s[28:31], s46 offen offset:0
    buffer_load_dwordx4 v[132:135], v3, s[28:31], s47 offen offset:0
    buffer_load_dwordx4 v[136:139], v3, s[28:31], s48 offen offset:0
    buffer_load_dwordx4 v[140:143], v3, s[28:31], s49 offen offset:0
    buffer_load_dwordx4 v[144:147], v3, s[28:31], s50 offen offset:0
    buffer_load_dwordx4 v[148:151], v3, s[28:31], s51 offen offset:0
    buffer_load_dwordx4 v[152:155], v3, s[28:31], s52 offen offset:0
    s_waitcnt vmcnt(8)
    v_mfma_f32_16x16x32_bf16 v[16:19], v[120:123], v[88:91], 0
    v_mfma_f32_16x16x32_bf16 v[24:27], v[120:123], v[92:95], 0
    v_mfma_f32_16x16x32_bf16 v[32:35], v[120:123], v[96:99], 0
    v_mfma_f32_16x16x32_bf16 v[40:43], v[120:123], v[100:103], 0
    buffer_load_dwordx4 v[156:159], v2, s[24:27], s53 offen offset:1024
    v_mfma_f32_16x16x32_bf16 v[48:51], v[120:123], v[104:107], 0
    v_mfma_f32_16x16x32_bf16 v[56:59], v[120:123], v[108:111], 0
    v_mfma_f32_16x16x32_bf16 v[64:67], v[120:123], v[112:115], 0
    v_mfma_f32_16x16x32_bf16 v[72:75], v[120:123], v[116:119], 0
    buffer_load_dwordx4 v[160:163], v2, s[24:27], s54 offen offset:1024
    s_waitcnt vmcnt(9)
    v_mfma_f32_16x16x32_bf16 v[20:23], v[124:127], v[88:91], 0
    v_mfma_f32_16x16x32_bf16 v[28:31], v[124:127], v[92:95], 0
    v_mfma_f32_16x16x32_bf16 v[36:39], v[124:127], v[96:99], 0
    v_mfma_f32_16x16x32_bf16 v[44:47], v[124:127], v[100:103], 0
    buffer_load_dwordx4 v[164:167], v2, s[24:27], s55 offen offset:1024
    v_mfma_f32_16x16x32_bf16 v[52:55], v[124:127], v[104:107], 0
    v_mfma_f32_16x16x32_bf16 v[60:63], v[124:127], v[108:111], 0
    v_mfma_f32_16x16x32_bf16 v[68:71], v[124:127], v[112:115], 0
    v_mfma_f32_16x16x32_bf16 v[76:79], v[124:127], v[116:119], 0
    buffer_load_dwordx4 v[168:171], v2, s[24:27], s56 offen offset:1024
    s_waitcnt vmcnt(10)
    v_mfma_f32_16x16x32_bf16 a[0:3], v[128:131], v[88:91], 0
    v_mfma_f32_16x16x32_bf16 a[24:27], v[128:131], v[92:95], 0
    v_mfma_f32_16x16x32_bf16 a[48:51], v[128:131], v[96:99], 0
    v_mfma_f32_16x16x32_bf16 a[72:75], v[128:131], v[100:103], 0
    buffer_load_dwordx4 v[172:175], v2, s[24:27], s57 offen offset:1024
    v_mfma_f32_16x16x32_bf16 a[96:99], v[128:131], v[104:107], 0
    v_mfma_f32_16x16x32_bf16 a[120:123], v[128:131], v[108:111], 0
    v_mfma_f32_16x16x32_bf16 a[144:147], v[128:131], v[112:115], 0
    v_mfma_f32_16x16x32_bf16 a[168:171], v[128:131], v[116:119], 0
    buffer_load_dwordx4 v[176:179], v2, s[24:27], s58 offen offset:1024
    s_waitcnt vmcnt(11)
    v_mfma_f32_16x16x32_bf16 a[4:7], v[132:135], v[88:91], 0
    v_mfma_f32_16x16x32_bf16 a[28:31], v[132:135], v[92:95], 0
    v_mfma_f32_16x16x32_bf16 a[52:55], v[132:135], v[96:99], 0
    v_mfma_f32_16x16x32_bf16 a[76:79], v[132:135], v[100:103], 0
    buffer_load_dwordx4 v[180:183], v2, s[24:27], s59 offen offset:1024
    v_mfma_f32_16x16x32_bf16 a[100:103], v[132:135], v[104:107], 0
    v_mfma_f32_16x16x32_bf16 a[124:127], v[132:135], v[108:111], 0
    v_mfma_f32_16x16x32_bf16 a[148:151], v[132:135], v[112:115], 0
    v_mfma_f32_16x16x32_bf16 a[172:175], v[132:135], v[116:119], 0
    buffer_load_dwordx4 v[184:187], v2, s[24:27], s60 offen offset:1024
    s_waitcnt vmcnt(12)
    v_mfma_f32_16x16x32_bf16 a[8:11], v[136:139], v[88:91], 0
    v_mfma_f32_16x16x32_bf16 a[32:35], v[136:139], v[92:95], 0
    v_mfma_f32_16x16x32_bf16 a[56:59], v[136:139], v[96:99], 0
    v_mfma_f32_16x16x32_bf16 a[80:83], v[136:139], v[100:103], 0
    buffer_load_dwordx4 v[188:191], v3, s[28:31], s44 offen offset:1024
    v_mfma_f32_16x16x32_bf16 a[104:107], v[136:139], v[104:107], 0
    v_mfma_f32_16x16x32_bf16 a[128:131], v[136:139], v[108:111], 0
    v_mfma_f32_16x16x32_bf16 a[152:155], v[136:139], v[112:115], 0
    v_mfma_f32_16x16x32_bf16 a[176:179], v[136:139], v[116:119], 0
    buffer_load_dwordx4 v[192:195], v3, s[28:31], s45 offen offset:1024
    s_waitcnt vmcnt(13)
    v_mfma_f32_16x16x32_bf16 a[12:15], v[140:143], v[88:91], 0
    v_mfma_f32_16x16x32_bf16 a[36:39], v[140:143], v[92:95], 0
    v_mfma_f32_16x16x32_bf16 a[60:63], v[140:143], v[96:99], 0
    v_mfma_f32_16x16x32_bf16 a[84:87], v[140:143], v[100:103], 0
    buffer_load_dwordx4 v[196:199], v3, s[28:31], s46 offen offset:1024
    v_mfma_f32_16x16x32_bf16 a[108:111], v[140:143], v[104:107], 0
    v_mfma_f32_16x16x32_bf16 a[132:135], v[140:143], v[108:111], 0
    v_mfma_f32_16x16x32_bf16 a[156:159], v[140:143], v[112:115], 0
    v_mfma_f32_16x16x32_bf16 a[180:183], v[140:143], v[116:119], 0
    buffer_load_dwordx4 v[200:203], v3, s[28:31], s47 offen offset:1024
    s_waitcnt vmcnt(14)
    v_mfma_f32_16x16x32_bf16 a[16:19], v[144:147], v[88:91], 0
    v_mfma_f32_16x16x32_bf16 a[40:43], v[144:147], v[92:95], 0
    v_mfma_f32_16x16x32_bf16 a[64:67], v[144:147], v[96:99], 0
    v_mfma_f32_16x16x32_bf16 a[88:91], v[144:147], v[100:103], 0
    buffer_load_dwordx4 v[204:207], v3, s[28:31], s48 offen offset:1024
    v_mfma_f32_16x16x32_bf16 a[112:115], v[144:147], v[104:107], 0
    v_mfma_f32_16x16x32_bf16 a[136:139], v[144:147], v[108:111], 0
    v_mfma_f32_16x16x32_bf16 a[160:163], v[144:147], v[112:115], 0
    v_mfma_f32_16x16x32_bf16 a[184:187], v[144:147], v[116:119], 0
    buffer_load_dwordx4 v[208:211], v3, s[28:31], s49 offen offset:1024
    s_waitcnt vmcnt(15)
    v_mfma_f32_16x16x32_bf16 a[20:23], v[148:151], v[88:91], 0
    v_mfma_f32_16x16x32_bf16 a[44:47], v[148:151], v[92:95], 0
    v_mfma_f32_16x16x32_bf16 a[68:71], v[148:151], v[96:99], 0
    v_mfma_f32_16x16x32_bf16 a[92:95], v[148:151], v[100:103], 0
    buffer_load_dwordx4 v[212:215], v3, s[28:31], s50 offen offset:1024
    v_mfma_f32_16x16x32_bf16 a[116:119], v[148:151], v[104:107], 0
    v_mfma_f32_16x16x32_bf16 a[140:143], v[148:151], v[108:111], 0
    v_mfma_f32_16x16x32_bf16 a[164:167], v[148:151], v[112:115], 0
    v_mfma_f32_16x16x32_bf16 a[188:191], v[148:151], v[116:119], 0
    buffer_load_dwordx4 v[216:219], v3, s[28:31], s51 offen offset:1024
    s_waitcnt vmcnt(16)
    v_mfma_f32_16x16x32_bf16 v[80:83], v[152:155], v[88:91], 0
    v_mfma_f32_16x16x32_bf16 v[84:87], v[152:155], v[92:95], 0
    v_mfma_f32_16x16x32_bf16 a[192:195], v[152:155], v[96:99], 0
    v_mfma_f32_16x16x32_bf16 a[196:199], v[152:155], v[100:103], 0
    buffer_load_dwordx4 v[220:223], v3, s[28:31], s52 offen offset:1024
    v_mfma_f32_16x16x32_bf16 a[200:203], v[152:155], v[104:107], 0
    v_mfma_f32_16x16x32_bf16 a[204:207], v[152:155], v[108:111], 0
    v_mfma_f32_16x16x32_bf16 a[208:211], v[152:155], v[112:115], 0
    v_mfma_f32_16x16x32_bf16 a[212:215], v[152:155], v[116:119], 0
    buffer_load_dwordx4 v[224:227], v2, s[24:27], s53 offen offset:2048
    s_waitcnt vmcnt(9)
    v_mfma_f32_16x16x32_bf16 v[16:19], v[188:191], v[156:159], v[16:19]
    v_mfma_f32_16x16x32_bf16 v[24:27], v[188:191], v[160:163], v[24:27]
    v_mfma_f32_16x16x32_bf16 v[32:35], v[188:191], v[164:167], v[32:35]
    v_mfma_f32_16x16x32_bf16 v[40:43], v[188:191], v[168:171], v[40:43]
    buffer_load_dwordx4 v[228:231], v2, s[24:27], s54 offen offset:2048
    v_mfma_f32_16x16x32_bf16 v[48:51], v[188:191], v[172:175], v[48:51]
    v_mfma_f32_16x16x32_bf16 v[56:59], v[188:191], v[176:179], v[56:59]
    v_mfma_f32_16x16x32_bf16 v[64:67], v[188:191], v[180:183], v[64:67]
    v_mfma_f32_16x16x32_bf16 v[72:75], v[188:191], v[184:187], v[72:75]
    buffer_load_dwordx4 v[232:235], v2, s[24:27], s55 offen offset:2048
    s_waitcnt vmcnt(10)
    v_mfma_f32_16x16x32_bf16 v[20:23], v[192:195], v[156:159], v[20:23]
    v_mfma_f32_16x16x32_bf16 v[28:31], v[192:195], v[160:163], v[28:31]
    v_mfma_f32_16x16x32_bf16 v[36:39], v[192:195], v[164:167], v[36:39]
    v_mfma_f32_16x16x32_bf16 v[44:47], v[192:195], v[168:171], v[44:47]
    buffer_load_dwordx4 v[236:239], v2, s[24:27], s56 offen offset:2048
    v_mfma_f32_16x16x32_bf16 v[52:55], v[192:195], v[172:175], v[52:55]
    v_mfma_f32_16x16x32_bf16 v[60:63], v[192:195], v[176:179], v[60:63]
    v_mfma_f32_16x16x32_bf16 v[68:71], v[192:195], v[180:183], v[68:71]
    v_mfma_f32_16x16x32_bf16 v[76:79], v[192:195], v[184:187], v[76:79]
    buffer_load_dwordx4 v[240:243], v2, s[24:27], s57 offen offset:2048
    s_waitcnt vmcnt(11)
    v_mfma_f32_16x16x32_bf16 a[0:3], v[196:199], v[156:159], a[0:3]
    v_mfma_f32_16x16x32_bf16 a[24:27], v[196:199], v[160:163], a[24:27]
    v_mfma_f32_16x16x32_bf16 a[48:51], v[196:199], v[164:167], a[48:51]
    v_mfma_f32_16x16x32_bf16 a[72:75], v[196:199], v[168:171], a[72:75]
    buffer_load_dwordx4 v[244:247], v2, s[24:27], s58 offen offset:2048
    v_mfma_f32_16x16x32_bf16 a[96:99], v[196:199], v[172:175], a[96:99]
    v_mfma_f32_16x16x32_bf16 a[120:123], v[196:199], v[176:179], a[120:123]
    v_mfma_f32_16x16x32_bf16 a[144:147], v[196:199], v[180:183], a[144:147]
    v_mfma_f32_16x16x32_bf16 a[168:171], v[196:199], v[184:187], a[168:171]
    buffer_load_dwordx4 v[248:251], v2, s[24:27], s59 offen offset:2048
    s_waitcnt vmcnt(12)
    v_mfma_f32_16x16x32_bf16 a[4:7], v[200:203], v[156:159], a[4:7]
    v_mfma_f32_16x16x32_bf16 a[28:31], v[200:203], v[160:163], a[28:31]
    v_mfma_f32_16x16x32_bf16 a[52:55], v[200:203], v[164:167], a[52:55]
    v_mfma_f32_16x16x32_bf16 a[76:79], v[200:203], v[168:171], a[76:79]
    buffer_load_dwordx4 v[252:255], v2, s[24:27], s60 offen offset:2048
    v_mfma_f32_16x16x32_bf16 a[100:103], v[200:203], v[172:175], a[100:103]
    v_mfma_f32_16x16x32_bf16 a[124:127], v[200:203], v[176:179], a[124:127]
    v_mfma_f32_16x16x32_bf16 a[148:151], v[200:203], v[180:183], a[148:151]
    v_mfma_f32_16x16x32_bf16 a[172:175], v[200:203], v[184:187], a[172:175]
    buffer_load_dwordx4 a[216:219], v3, s[28:31], s44 offen offset:2048
    s_waitcnt vmcnt(13)
    v_mfma_f32_16x16x32_bf16 a[8:11], v[204:207], v[156:159], a[8:11]
    v_mfma_f32_16x16x32_bf16 a[32:35], v[204:207], v[160:163], a[32:35]
    v_mfma_f32_16x16x32_bf16 a[56:59], v[204:207], v[164:167], a[56:59]
    v_mfma_f32_16x16x32_bf16 a[80:83], v[204:207], v[168:171], a[80:83]
    buffer_load_dwordx4 a[220:223], v3, s[28:31], s45 offen offset:2048
    v_mfma_f32_16x16x32_bf16 a[104:107], v[204:207], v[172:175], a[104:107]
    v_mfma_f32_16x16x32_bf16 a[128:131], v[204:207], v[176:179], a[128:131]
    v_mfma_f32_16x16x32_bf16 a[152:155], v[204:207], v[180:183], a[152:155]
    v_mfma_f32_16x16x32_bf16 a[176:179], v[204:207], v[184:187], a[176:179]
    buffer_load_dwordx4 a[224:227], v3, s[28:31], s46 offen offset:2048
    s_waitcnt vmcnt(14)
    v_mfma_f32_16x16x32_bf16 a[12:15], v[208:211], v[156:159], a[12:15]
    v_mfma_f32_16x16x32_bf16 a[36:39], v[208:211], v[160:163], a[36:39]
    v_mfma_f32_16x16x32_bf16 a[60:63], v[208:211], v[164:167], a[60:63]
    v_mfma_f32_16x16x32_bf16 a[84:87], v[208:211], v[168:171], a[84:87]
    buffer_load_dwordx4 a[228:231], v3, s[28:31], s47 offen offset:2048
    v_mfma_f32_16x16x32_bf16 a[108:111], v[208:211], v[172:175], a[108:111]
    v_mfma_f32_16x16x32_bf16 a[132:135], v[208:211], v[176:179], a[132:135]
    v_mfma_f32_16x16x32_bf16 a[156:159], v[208:211], v[180:183], a[156:159]
    v_mfma_f32_16x16x32_bf16 a[180:183], v[208:211], v[184:187], a[180:183]
    buffer_load_dwordx4 a[232:235], v3, s[28:31], s48 offen offset:2048
    s_waitcnt vmcnt(15)
    v_mfma_f32_16x16x32_bf16 a[16:19], v[212:215], v[156:159], a[16:19]
    v_mfma_f32_16x16x32_bf16 a[40:43], v[212:215], v[160:163], a[40:43]
    v_mfma_f32_16x16x32_bf16 a[64:67], v[212:215], v[164:167], a[64:67]
    v_mfma_f32_16x16x32_bf16 a[88:91], v[212:215], v[168:171], a[88:91]
    buffer_load_dwordx4 a[236:239], v3, s[28:31], s49 offen offset:2048
    v_mfma_f32_16x16x32_bf16 a[112:115], v[212:215], v[172:175], a[112:115]
    v_mfma_f32_16x16x32_bf16 a[136:139], v[212:215], v[176:179], a[136:139]
    v_mfma_f32_16x16x32_bf16 a[160:163], v[212:215], v[180:183], a[160:163]
    v_mfma_f32_16x16x32_bf16 a[184:187], v[212:215], v[184:187], a[184:187]
    buffer_load_dwordx4 a[240:243], v3, s[28:31], s50 offen offset:2048
    s_waitcnt vmcnt(16)
    v_mfma_f32_16x16x32_bf16 a[20:23], v[216:219], v[156:159], a[20:23]
    v_mfma_f32_16x16x32_bf16 a[44:47], v[216:219], v[160:163], a[44:47]
    v_mfma_f32_16x16x32_bf16 a[68:71], v[216:219], v[164:167], a[68:71]
    v_mfma_f32_16x16x32_bf16 a[92:95], v[216:219], v[168:171], a[92:95]
    buffer_load_dwordx4 a[244:247], v3, s[28:31], s51 offen offset:2048
    v_mfma_f32_16x16x32_bf16 a[116:119], v[216:219], v[172:175], a[116:119]
    v_mfma_f32_16x16x32_bf16 a[140:143], v[216:219], v[176:179], a[140:143]
    v_mfma_f32_16x16x32_bf16 a[164:167], v[216:219], v[180:183], a[164:167]
    v_mfma_f32_16x16x32_bf16 a[188:191], v[216:219], v[184:187], a[188:191]
    buffer_load_dwordx4 a[248:251], v3, s[28:31], s52 offen offset:2048
    s_waitcnt vmcnt(17)
    v_mfma_f32_16x16x32_bf16 v[80:83], v[220:223], v[156:159], v[80:83]
    v_mfma_f32_16x16x32_bf16 v[84:87], v[220:223], v[160:163], v[84:87]
    v_mfma_f32_16x16x32_bf16 a[192:195], v[220:223], v[164:167], a[192:195]
    v_mfma_f32_16x16x32_bf16 a[196:199], v[220:223], v[168:171], a[196:199]
    buffer_load_dwordx4 v[88:91], v2, s[24:27], s53 offen offset:3072
    v_mfma_f32_16x16x32_bf16 a[200:203], v[220:223], v[172:175], a[200:203]
    v_mfma_f32_16x16x32_bf16 a[204:207], v[220:223], v[176:179], a[204:207]
    v_mfma_f32_16x16x32_bf16 a[208:211], v[220:223], v[180:183], a[208:211]
    v_mfma_f32_16x16x32_bf16 a[212:215], v[220:223], v[184:187], a[212:215]
    buffer_load_dwordx4 v[92:95], v2, s[24:27], s54 offen offset:3072
    s_waitcnt vmcnt(10)
    v_mfma_f32_16x16x32_bf16 v[16:19], a[216:219], v[224:227], v[16:19]
    v_mfma_f32_16x16x32_bf16 v[24:27], a[216:219], v[228:231], v[24:27]
    v_mfma_f32_16x16x32_bf16 v[32:35], a[216:219], v[232:235], v[32:35]
    v_mfma_f32_16x16x32_bf16 v[40:43], a[216:219], v[236:239], v[40:43]
    buffer_load_dwordx4 v[96:99], v2, s[24:27], s55 offen offset:3072
    v_mfma_f32_16x16x32_bf16 v[48:51], a[216:219], v[240:243], v[48:51]
    v_mfma_f32_16x16x32_bf16 v[56:59], a[216:219], v[244:247], v[56:59]
    v_mfma_f32_16x16x32_bf16 v[64:67], a[216:219], v[248:251], v[64:67]
    v_mfma_f32_16x16x32_bf16 v[72:75], a[216:219], v[252:255], v[72:75]
    buffer_load_dwordx4 v[100:103], v2, s[24:27], s56 offen offset:3072
    s_waitcnt vmcnt(11)
    v_mfma_f32_16x16x32_bf16 v[20:23], a[220:223], v[224:227], v[20:23]
    v_mfma_f32_16x16x32_bf16 v[28:31], a[220:223], v[228:231], v[28:31]
    v_mfma_f32_16x16x32_bf16 v[36:39], a[220:223], v[232:235], v[36:39]
    v_mfma_f32_16x16x32_bf16 v[44:47], a[220:223], v[236:239], v[44:47]
    buffer_load_dwordx4 v[104:107], v2, s[24:27], s57 offen offset:3072
    v_mfma_f32_16x16x32_bf16 v[52:55], a[220:223], v[240:243], v[52:55]
    v_mfma_f32_16x16x32_bf16 v[60:63], a[220:223], v[244:247], v[60:63]
    v_mfma_f32_16x16x32_bf16 v[68:71], a[220:223], v[248:251], v[68:71]
    v_mfma_f32_16x16x32_bf16 v[76:79], a[220:223], v[252:255], v[76:79]
    buffer_load_dwordx4 v[108:111], v2, s[24:27], s58 offen offset:3072
    s_waitcnt vmcnt(12)
    v_mfma_f32_16x16x32_bf16 a[0:3], a[224:227], v[224:227], a[0:3]
    v_mfma_f32_16x16x32_bf16 a[24:27], a[224:227], v[228:231], a[24:27]
    v_mfma_f32_16x16x32_bf16 a[48:51], a[224:227], v[232:235], a[48:51]
    v_mfma_f32_16x16x32_bf16 a[72:75], a[224:227], v[236:239], a[72:75]
    buffer_load_dwordx4 v[112:115], v2, s[24:27], s59 offen offset:3072
    v_mfma_f32_16x16x32_bf16 a[96:99], a[224:227], v[240:243], a[96:99]
    v_mfma_f32_16x16x32_bf16 a[120:123], a[224:227], v[244:247], a[120:123]
    v_mfma_f32_16x16x32_bf16 a[144:147], a[224:227], v[248:251], a[144:147]
    v_mfma_f32_16x16x32_bf16 a[168:171], a[224:227], v[252:255], a[168:171]
    buffer_load_dwordx4 v[116:119], v2, s[24:27], s60 offen offset:3072
    s_waitcnt vmcnt(13)
    v_mfma_f32_16x16x32_bf16 a[4:7], a[228:231], v[224:227], a[4:7]
    v_mfma_f32_16x16x32_bf16 a[28:31], a[228:231], v[228:231], a[28:31]
    v_mfma_f32_16x16x32_bf16 a[52:55], a[228:231], v[232:235], a[52:55]
    v_mfma_f32_16x16x32_bf16 a[76:79], a[228:231], v[236:239], a[76:79]
    buffer_load_dwordx4 v[120:123], v3, s[28:31], s44 offen offset:3072
    v_mfma_f32_16x16x32_bf16 a[100:103], a[228:231], v[240:243], a[100:103]
    v_mfma_f32_16x16x32_bf16 a[124:127], a[228:231], v[244:247], a[124:127]
    v_mfma_f32_16x16x32_bf16 a[148:151], a[228:231], v[248:251], a[148:151]
    v_mfma_f32_16x16x32_bf16 a[172:175], a[228:231], v[252:255], a[172:175]
    buffer_load_dwordx4 v[124:127], v3, s[28:31], s45 offen offset:3072
    s_waitcnt vmcnt(14)
    v_mfma_f32_16x16x32_bf16 a[8:11], a[232:235], v[224:227], a[8:11]
    v_mfma_f32_16x16x32_bf16 a[32:35], a[232:235], v[228:231], a[32:35]
    v_mfma_f32_16x16x32_bf16 a[56:59], a[232:235], v[232:235], a[56:59]
    v_mfma_f32_16x16x32_bf16 a[80:83], a[232:235], v[236:239], a[80:83]
    buffer_load_dwordx4 v[128:131], v3, s[28:31], s46 offen offset:3072
    v_mfma_f32_16x16x32_bf16 a[104:107], a[232:235], v[240:243], a[104:107]
    v_mfma_f32_16x16x32_bf16 a[128:131], a[232:235], v[244:247], a[128:131]
    v_mfma_f32_16x16x32_bf16 a[152:155], a[232:235], v[248:251], a[152:155]
    v_mfma_f32_16x16x32_bf16 a[176:179], a[232:235], v[252:255], a[176:179]
    buffer_load_dwordx4 v[132:135], v3, s[28:31], s47 offen offset:3072
    s_waitcnt vmcnt(15)
    v_mfma_f32_16x16x32_bf16 a[12:15], a[236:239], v[224:227], a[12:15]
    v_mfma_f32_16x16x32_bf16 a[36:39], a[236:239], v[228:231], a[36:39]
    v_mfma_f32_16x16x32_bf16 a[60:63], a[236:239], v[232:235], a[60:63]
    v_mfma_f32_16x16x32_bf16 a[84:87], a[236:239], v[236:239], a[84:87]
    buffer_load_dwordx4 v[136:139], v3, s[28:31], s48 offen offset:3072
    v_mfma_f32_16x16x32_bf16 a[108:111], a[236:239], v[240:243], a[108:111]
    v_mfma_f32_16x16x32_bf16 a[132:135], a[236:239], v[244:247], a[132:135]
    v_mfma_f32_16x16x32_bf16 a[156:159], a[236:239], v[248:251], a[156:159]
    v_mfma_f32_16x16x32_bf16 a[180:183], a[236:239], v[252:255], a[180:183]
    buffer_load_dwordx4 v[140:143], v3, s[28:31], s49 offen offset:3072
    s_waitcnt vmcnt(16)
    v_mfma_f32_16x16x32_bf16 a[16:19], a[240:243], v[224:227], a[16:19]
    v_mfma_f32_16x16x32_bf16 a[40:43], a[240:243], v[228:231], a[40:43]
    v_mfma_f32_16x16x32_bf16 a[64:67], a[240:243], v[232:235], a[64:67]
    v_mfma_f32_16x16x32_bf16 a[88:91], a[240:243], v[236:239], a[88:91]
    buffer_load_dwordx4 v[144:147], v3, s[28:31], s50 offen offset:3072
    v_mfma_f32_16x16x32_bf16 a[112:115], a[240:243], v[240:243], a[112:115]
    v_mfma_f32_16x16x32_bf16 a[136:139], a[240:243], v[244:247], a[136:139]
    v_mfma_f32_16x16x32_bf16 a[160:163], a[240:243], v[248:251], a[160:163]
    v_mfma_f32_16x16x32_bf16 a[184:187], a[240:243], v[252:255], a[184:187]
    buffer_load_dwordx4 v[148:151], v3, s[28:31], s51 offen offset:3072
    s_waitcnt vmcnt(17)
    v_mfma_f32_16x16x32_bf16 a[20:23], a[244:247], v[224:227], a[20:23]
    v_mfma_f32_16x16x32_bf16 a[44:47], a[244:247], v[228:231], a[44:47]
    v_mfma_f32_16x16x32_bf16 a[68:71], a[244:247], v[232:235], a[68:71]
    v_mfma_f32_16x16x32_bf16 a[92:95], a[244:247], v[236:239], a[92:95]
    buffer_load_dwordx4 v[152:155], v3, s[28:31], s52 offen offset:3072
    v_mfma_f32_16x16x32_bf16 a[116:119], a[244:247], v[240:243], a[116:119]
    v_mfma_f32_16x16x32_bf16 a[140:143], a[244:247], v[244:247], a[140:143]
    v_mfma_f32_16x16x32_bf16 a[164:167], a[244:247], v[248:251], a[164:167]
    v_mfma_f32_16x16x32_bf16 a[188:191], a[244:247], v[252:255], a[188:191]
    v_add_u32 v2, 4096, v2
    buffer_load_dwordx4 v[156:159], v2, s[24:27], s53 offen offset:0
    s_waitcnt vmcnt(18)
    v_mfma_f32_16x16x32_bf16 v[80:83], a[248:251], v[224:227], v[80:83]
    v_mfma_f32_16x16x32_bf16 v[84:87], a[248:251], v[228:231], v[84:87]
    v_mfma_f32_16x16x32_bf16 a[192:195], a[248:251], v[232:235], a[192:195]
    v_mfma_f32_16x16x32_bf16 a[196:199], a[248:251], v[236:239], a[196:199]
    buffer_load_dwordx4 v[160:163], v2, s[24:27], s54 offen offset:0
    v_mfma_f32_16x16x32_bf16 a[200:203], a[248:251], v[240:243], a[200:203]
    v_mfma_f32_16x16x32_bf16 a[204:207], a[248:251], v[244:247], a[204:207]
    v_mfma_f32_16x16x32_bf16 a[208:211], a[248:251], v[248:251], a[208:211]
    v_mfma_f32_16x16x32_bf16 a[212:215], a[248:251], v[252:255], a[212:215]
    buffer_load_dwordx4 v[164:167], v2, s[24:27], s55 offen offset:0
    s_waitcnt vmcnt(11)
    v_mfma_f32_16x16x32_bf16 v[16:19], v[120:123], v[88:91], v[16:19]
    v_mfma_f32_16x16x32_bf16 v[24:27], v[120:123], v[92:95], v[24:27]
    v_mfma_f32_16x16x32_bf16 v[32:35], v[120:123], v[96:99], v[32:35]
    v_mfma_f32_16x16x32_bf16 v[40:43], v[120:123], v[100:103], v[40:43]
    buffer_load_dwordx4 v[168:171], v2, s[24:27], s56 offen offset:0
    v_mfma_f32_16x16x32_bf16 v[48:51], v[120:123], v[104:107], v[48:51]
    v_mfma_f32_16x16x32_bf16 v[56:59], v[120:123], v[108:111], v[56:59]
    v_mfma_f32_16x16x32_bf16 v[64:67], v[120:123], v[112:115], v[64:67]
    v_mfma_f32_16x16x32_bf16 v[72:75], v[120:123], v[116:119], v[72:75]
    buffer_load_dwordx4 v[172:175], v2, s[24:27], s57 offen offset:0
    s_waitcnt vmcnt(12)
    v_mfma_f32_16x16x32_bf16 v[20:23], v[124:127], v[88:91], v[20:23]
    v_mfma_f32_16x16x32_bf16 v[28:31], v[124:127], v[92:95], v[28:31]
    v_mfma_f32_16x16x32_bf16 v[36:39], v[124:127], v[96:99], v[36:39]
    v_mfma_f32_16x16x32_bf16 v[44:47], v[124:127], v[100:103], v[44:47]
    buffer_load_dwordx4 v[176:179], v2, s[24:27], s58 offen offset:0
    v_mfma_f32_16x16x32_bf16 v[52:55], v[124:127], v[104:107], v[52:55]
    v_mfma_f32_16x16x32_bf16 v[60:63], v[124:127], v[108:111], v[60:63]
    v_mfma_f32_16x16x32_bf16 v[68:71], v[124:127], v[112:115], v[68:71]
    v_mfma_f32_16x16x32_bf16 v[76:79], v[124:127], v[116:119], v[76:79]
    buffer_load_dwordx4 v[180:183], v2, s[24:27], s59 offen offset:0
    s_waitcnt vmcnt(13)
    v_mfma_f32_16x16x32_bf16 a[0:3], v[128:131], v[88:91], a[0:3]
    v_mfma_f32_16x16x32_bf16 a[24:27], v[128:131], v[92:95], a[24:27]
    v_mfma_f32_16x16x32_bf16 a[48:51], v[128:131], v[96:99], a[48:51]
    v_mfma_f32_16x16x32_bf16 a[72:75], v[128:131], v[100:103], a[72:75]
    buffer_load_dwordx4 v[184:187], v2, s[24:27], s60 offen offset:0
    v_mfma_f32_16x16x32_bf16 a[96:99], v[128:131], v[104:107], a[96:99]
    v_mfma_f32_16x16x32_bf16 a[120:123], v[128:131], v[108:111], a[120:123]
    v_mfma_f32_16x16x32_bf16 a[144:147], v[128:131], v[112:115], a[144:147]
    v_mfma_f32_16x16x32_bf16 a[168:171], v[128:131], v[116:119], a[168:171]
    v_add_u32 v3, 4096, v3
    buffer_load_dwordx4 v[188:191], v3, s[28:31], s44 offen offset:0
    s_waitcnt vmcnt(14)
    v_mfma_f32_16x16x32_bf16 a[4:7], v[132:135], v[88:91], a[4:7]
    v_mfma_f32_16x16x32_bf16 a[28:31], v[132:135], v[92:95], a[28:31]
    v_mfma_f32_16x16x32_bf16 a[52:55], v[132:135], v[96:99], a[52:55]
    v_mfma_f32_16x16x32_bf16 a[76:79], v[132:135], v[100:103], a[76:79]
    buffer_load_dwordx4 v[192:195], v3, s[28:31], s45 offen offset:0
    v_mfma_f32_16x16x32_bf16 a[100:103], v[132:135], v[104:107], a[100:103]
    v_mfma_f32_16x16x32_bf16 a[124:127], v[132:135], v[108:111], a[124:127]
    v_mfma_f32_16x16x32_bf16 a[148:151], v[132:135], v[112:115], a[148:151]
    v_mfma_f32_16x16x32_bf16 a[172:175], v[132:135], v[116:119], a[172:175]
    buffer_load_dwordx4 v[196:199], v3, s[28:31], s46 offen offset:0
    s_waitcnt vmcnt(15)
    v_mfma_f32_16x16x32_bf16 a[8:11], v[136:139], v[88:91], a[8:11]
    v_mfma_f32_16x16x32_bf16 a[32:35], v[136:139], v[92:95], a[32:35]
    v_mfma_f32_16x16x32_bf16 a[56:59], v[136:139], v[96:99], a[56:59]
    v_mfma_f32_16x16x32_bf16 a[80:83], v[136:139], v[100:103], a[80:83]
    buffer_load_dwordx4 v[200:203], v3, s[28:31], s47 offen offset:0
    v_mfma_f32_16x16x32_bf16 a[104:107], v[136:139], v[104:107], a[104:107]
    v_mfma_f32_16x16x32_bf16 a[128:131], v[136:139], v[108:111], a[128:131]
    v_mfma_f32_16x16x32_bf16 a[152:155], v[136:139], v[112:115], a[152:155]
    v_mfma_f32_16x16x32_bf16 a[176:179], v[136:139], v[116:119], a[176:179]
    buffer_load_dwordx4 v[204:207], v3, s[28:31], s48 offen offset:0
    s_waitcnt vmcnt(16)
    v_mfma_f32_16x16x32_bf16 a[12:15], v[140:143], v[88:91], a[12:15]
    v_mfma_f32_16x16x32_bf16 a[36:39], v[140:143], v[92:95], a[36:39]
    v_mfma_f32_16x16x32_bf16 a[60:63], v[140:143], v[96:99], a[60:63]
    v_mfma_f32_16x16x32_bf16 a[84:87], v[140:143], v[100:103], a[84:87]
    buffer_load_dwordx4 v[208:211], v3, s[28:31], s49 offen offset:0
    v_mfma_f32_16x16x32_bf16 a[108:111], v[140:143], v[104:107], a[108:111]
    v_mfma_f32_16x16x32_bf16 a[132:135], v[140:143], v[108:111], a[132:135]
    v_mfma_f32_16x16x32_bf16 a[156:159], v[140:143], v[112:115], a[156:159]
    v_mfma_f32_16x16x32_bf16 a[180:183], v[140:143], v[116:119], a[180:183]
    buffer_load_dwordx4 v[212:215], v3, s[28:31], s50 offen offset:0
    s_waitcnt vmcnt(17)
    v_mfma_f32_16x16x32_bf16 a[16:19], v[144:147], v[88:91], a[16:19]
    v_mfma_f32_16x16x32_bf16 a[40:43], v[144:147], v[92:95], a[40:43]
    v_mfma_f32_16x16x32_bf16 a[64:67], v[144:147], v[96:99], a[64:67]
    v_mfma_f32_16x16x32_bf16 a[88:91], v[144:147], v[100:103], a[88:91]
    buffer_load_dwordx4 v[216:219], v3, s[28:31], s51 offen offset:0
    v_mfma_f32_16x16x32_bf16 a[112:115], v[144:147], v[104:107], a[112:115]
    v_mfma_f32_16x16x32_bf16 a[136:139], v[144:147], v[108:111], a[136:139]
    v_mfma_f32_16x16x32_bf16 a[160:163], v[144:147], v[112:115], a[160:163]
    v_mfma_f32_16x16x32_bf16 a[184:187], v[144:147], v[116:119], a[184:187]
    buffer_load_dwordx4 v[220:223], v3, s[28:31], s52 offen offset:0
    s_waitcnt vmcnt(18)
    v_mfma_f32_16x16x32_bf16 a[20:23], v[148:151], v[88:91], a[20:23]
    v_mfma_f32_16x16x32_bf16 a[44:47], v[148:151], v[92:95], a[44:47]
    v_mfma_f32_16x16x32_bf16 a[68:71], v[148:151], v[96:99], a[68:71]
    v_mfma_f32_16x16x32_bf16 a[92:95], v[148:151], v[100:103], a[92:95]
    buffer_load_dwordx4 v[224:227], v2, s[24:27], s53 offen offset:1024
    v_mfma_f32_16x16x32_bf16 a[116:119], v[148:151], v[104:107], a[116:119]
    v_mfma_f32_16x16x32_bf16 a[140:143], v[148:151], v[108:111], a[140:143]
    v_mfma_f32_16x16x32_bf16 a[164:167], v[148:151], v[112:115], a[164:167]
    v_mfma_f32_16x16x32_bf16 a[188:191], v[148:151], v[116:119], a[188:191]
    buffer_load_dwordx4 v[228:231], v2, s[24:27], s54 offen offset:1024
    s_waitcnt vmcnt(19)
    v_mfma_f32_16x16x32_bf16 v[80:83], v[152:155], v[88:91], v[80:83]
    v_mfma_f32_16x16x32_bf16 v[84:87], v[152:155], v[92:95], v[84:87]
    v_mfma_f32_16x16x32_bf16 a[192:195], v[152:155], v[96:99], a[192:195]
    v_mfma_f32_16x16x32_bf16 a[196:199], v[152:155], v[100:103], a[196:199]
    buffer_load_dwordx4 v[232:235], v2, s[24:27], s55 offen offset:1024
    v_mfma_f32_16x16x32_bf16 a[200:203], v[152:155], v[104:107], a[200:203]
    v_mfma_f32_16x16x32_bf16 a[204:207], v[152:155], v[108:111], a[204:207]
    v_mfma_f32_16x16x32_bf16 a[208:211], v[152:155], v[112:115], a[208:211]
    v_mfma_f32_16x16x32_bf16 a[212:215], v[152:155], v[116:119], a[212:215]
    buffer_load_dwordx4 v[236:239], v2, s[24:27], s56 offen offset:1024
    s_waitcnt vmcnt(12)
    v_mfma_f32_16x16x32_bf16 v[16:19], v[188:191], v[156:159], v[16:19]
    v_mfma_f32_16x16x32_bf16 v[24:27], v[188:191], v[160:163], v[24:27]
    v_mfma_f32_16x16x32_bf16 v[32:35], v[188:191], v[164:167], v[32:35]
    v_mfma_f32_16x16x32_bf16 v[40:43], v[188:191], v[168:171], v[40:43]
    buffer_load_dwordx4 v[240:243], v2, s[24:27], s57 offen offset:1024
    v_mfma_f32_16x16x32_bf16 v[48:51], v[188:191], v[172:175], v[48:51]
    v_mfma_f32_16x16x32_bf16 v[56:59], v[188:191], v[176:179], v[56:59]
    v_mfma_f32_16x16x32_bf16 v[64:67], v[188:191], v[180:183], v[64:67]
    v_mfma_f32_16x16x32_bf16 v[72:75], v[188:191], v[184:187], v[72:75]
    buffer_load_dwordx4 v[244:247], v2, s[24:27], s58 offen offset:1024
    s_waitcnt vmcnt(13)
    v_mfma_f32_16x16x32_bf16 v[20:23], v[192:195], v[156:159], v[20:23]
    v_mfma_f32_16x16x32_bf16 v[28:31], v[192:195], v[160:163], v[28:31]
    v_mfma_f32_16x16x32_bf16 v[36:39], v[192:195], v[164:167], v[36:39]
    v_mfma_f32_16x16x32_bf16 v[44:47], v[192:195], v[168:171], v[44:47]
    buffer_load_dwordx4 v[248:251], v2, s[24:27], s59 offen offset:1024
    v_mfma_f32_16x16x32_bf16 v[52:55], v[192:195], v[172:175], v[52:55]
    v_mfma_f32_16x16x32_bf16 v[60:63], v[192:195], v[176:179], v[60:63]
    v_mfma_f32_16x16x32_bf16 v[68:71], v[192:195], v[180:183], v[68:71]
    v_mfma_f32_16x16x32_bf16 v[76:79], v[192:195], v[184:187], v[76:79]
    buffer_load_dwordx4 v[252:255], v2, s[24:27], s60 offen offset:1024
    s_waitcnt vmcnt(14)
    v_mfma_f32_16x16x32_bf16 a[0:3], v[196:199], v[156:159], a[0:3]
    v_mfma_f32_16x16x32_bf16 a[24:27], v[196:199], v[160:163], a[24:27]
    v_mfma_f32_16x16x32_bf16 a[48:51], v[196:199], v[164:167], a[48:51]
    v_mfma_f32_16x16x32_bf16 a[72:75], v[196:199], v[168:171], a[72:75]
    buffer_load_dwordx4 a[216:219], v3, s[28:31], s44 offen offset:1024
    v_mfma_f32_16x16x32_bf16 a[96:99], v[196:199], v[172:175], a[96:99]
    v_mfma_f32_16x16x32_bf16 a[120:123], v[196:199], v[176:179], a[120:123]
    v_mfma_f32_16x16x32_bf16 a[144:147], v[196:199], v[180:183], a[144:147]
    v_mfma_f32_16x16x32_bf16 a[168:171], v[196:199], v[184:187], a[168:171]
    buffer_load_dwordx4 a[220:223], v3, s[28:31], s45 offen offset:1024
    s_waitcnt vmcnt(15)
    v_mfma_f32_16x16x32_bf16 a[4:7], v[200:203], v[156:159], a[4:7]
    v_mfma_f32_16x16x32_bf16 a[28:31], v[200:203], v[160:163], a[28:31]
    v_mfma_f32_16x16x32_bf16 a[52:55], v[200:203], v[164:167], a[52:55]
    v_mfma_f32_16x16x32_bf16 a[76:79], v[200:203], v[168:171], a[76:79]
    buffer_load_dwordx4 a[224:227], v3, s[28:31], s46 offen offset:1024
    v_mfma_f32_16x16x32_bf16 a[100:103], v[200:203], v[172:175], a[100:103]
    v_mfma_f32_16x16x32_bf16 a[124:127], v[200:203], v[176:179], a[124:127]
    v_mfma_f32_16x16x32_bf16 a[148:151], v[200:203], v[180:183], a[148:151]
    v_mfma_f32_16x16x32_bf16 a[172:175], v[200:203], v[184:187], a[172:175]
    buffer_load_dwordx4 a[228:231], v3, s[28:31], s47 offen offset:1024
    s_waitcnt vmcnt(16)
    v_mfma_f32_16x16x32_bf16 a[8:11], v[204:207], v[156:159], a[8:11]
    v_mfma_f32_16x16x32_bf16 a[32:35], v[204:207], v[160:163], a[32:35]
    v_mfma_f32_16x16x32_bf16 a[56:59], v[204:207], v[164:167], a[56:59]
    v_mfma_f32_16x16x32_bf16 a[80:83], v[204:207], v[168:171], a[80:83]
    buffer_load_dwordx4 a[232:235], v3, s[28:31], s48 offen offset:1024
    v_mfma_f32_16x16x32_bf16 a[104:107], v[204:207], v[172:175], a[104:107]
    v_mfma_f32_16x16x32_bf16 a[128:131], v[204:207], v[176:179], a[128:131]
    v_mfma_f32_16x16x32_bf16 a[152:155], v[204:207], v[180:183], a[152:155]
    v_mfma_f32_16x16x32_bf16 a[176:179], v[204:207], v[184:187], a[176:179]
    buffer_load_dwordx4 a[236:239], v3, s[28:31], s49 offen offset:1024
    s_waitcnt vmcnt(17)
    v_mfma_f32_16x16x32_bf16 a[12:15], v[208:211], v[156:159], a[12:15]
    v_mfma_f32_16x16x32_bf16 a[36:39], v[208:211], v[160:163], a[36:39]
    v_mfma_f32_16x16x32_bf16 a[60:63], v[208:211], v[164:167], a[60:63]
    v_mfma_f32_16x16x32_bf16 a[84:87], v[208:211], v[168:171], a[84:87]
    buffer_load_dwordx4 a[240:243], v3, s[28:31], s50 offen offset:1024
    v_mfma_f32_16x16x32_bf16 a[108:111], v[208:211], v[172:175], a[108:111]
    v_mfma_f32_16x16x32_bf16 a[132:135], v[208:211], v[176:179], a[132:135]
    v_mfma_f32_16x16x32_bf16 a[156:159], v[208:211], v[180:183], a[156:159]
    v_mfma_f32_16x16x32_bf16 a[180:183], v[208:211], v[184:187], a[180:183]
    buffer_load_dwordx4 a[244:247], v3, s[28:31], s51 offen offset:1024
    s_waitcnt vmcnt(18)
    v_mfma_f32_16x16x32_bf16 a[16:19], v[212:215], v[156:159], a[16:19]
    v_mfma_f32_16x16x32_bf16 a[40:43], v[212:215], v[160:163], a[40:43]
    v_mfma_f32_16x16x32_bf16 a[64:67], v[212:215], v[164:167], a[64:67]
    v_mfma_f32_16x16x32_bf16 a[88:91], v[212:215], v[168:171], a[88:91]
    buffer_load_dwordx4 a[248:251], v3, s[28:31], s52 offen offset:1024
    v_mfma_f32_16x16x32_bf16 a[112:115], v[212:215], v[172:175], a[112:115]
    v_mfma_f32_16x16x32_bf16 a[136:139], v[212:215], v[176:179], a[136:139]
    v_mfma_f32_16x16x32_bf16 a[160:163], v[212:215], v[180:183], a[160:163]
    v_mfma_f32_16x16x32_bf16 a[184:187], v[212:215], v[184:187], a[184:187]
    buffer_load_dwordx4 v[88:91], v2, s[24:27], s53 offen offset:2048
    s_waitcnt vmcnt(19)
    v_mfma_f32_16x16x32_bf16 a[20:23], v[216:219], v[156:159], a[20:23]
    v_mfma_f32_16x16x32_bf16 a[44:47], v[216:219], v[160:163], a[44:47]
    v_mfma_f32_16x16x32_bf16 a[68:71], v[216:219], v[164:167], a[68:71]
    v_mfma_f32_16x16x32_bf16 a[92:95], v[216:219], v[168:171], a[92:95]
    buffer_load_dwordx4 v[92:95], v2, s[24:27], s54 offen offset:2048
    v_mfma_f32_16x16x32_bf16 a[116:119], v[216:219], v[172:175], a[116:119]
    v_mfma_f32_16x16x32_bf16 a[140:143], v[216:219], v[176:179], a[140:143]
    v_mfma_f32_16x16x32_bf16 a[164:167], v[216:219], v[180:183], a[164:167]
    v_mfma_f32_16x16x32_bf16 a[188:191], v[216:219], v[184:187], a[188:191]
    buffer_load_dwordx4 v[96:99], v2, s[24:27], s55 offen offset:2048
    s_waitcnt vmcnt(20)
    v_mfma_f32_16x16x32_bf16 v[80:83], v[220:223], v[156:159], v[80:83]
    v_mfma_f32_16x16x32_bf16 v[84:87], v[220:223], v[160:163], v[84:87]
    v_mfma_f32_16x16x32_bf16 a[192:195], v[220:223], v[164:167], a[192:195]
    v_mfma_f32_16x16x32_bf16 a[196:199], v[220:223], v[168:171], a[196:199]
    buffer_load_dwordx4 v[100:103], v2, s[24:27], s56 offen offset:2048
    v_mfma_f32_16x16x32_bf16 a[200:203], v[220:223], v[172:175], a[200:203]
    v_mfma_f32_16x16x32_bf16 a[204:207], v[220:223], v[176:179], a[204:207]
    v_mfma_f32_16x16x32_bf16 a[208:211], v[220:223], v[180:183], a[208:211]
    v_mfma_f32_16x16x32_bf16 a[212:215], v[220:223], v[184:187], a[212:215]
    buffer_load_dwordx4 v[104:107], v2, s[24:27], s57 offen offset:2048
    s_waitcnt vmcnt(13)
    v_mfma_f32_16x16x32_bf16 v[16:19], a[216:219], v[224:227], v[16:19]
    v_mfma_f32_16x16x32_bf16 v[24:27], a[216:219], v[228:231], v[24:27]
    v_mfma_f32_16x16x32_bf16 v[32:35], a[216:219], v[232:235], v[32:35]
    v_mfma_f32_16x16x32_bf16 v[40:43], a[216:219], v[236:239], v[40:43]
    buffer_load_dwordx4 v[108:111], v2, s[24:27], s58 offen offset:2048
    v_mfma_f32_16x16x32_bf16 v[48:51], a[216:219], v[240:243], v[48:51]
    v_mfma_f32_16x16x32_bf16 v[56:59], a[216:219], v[244:247], v[56:59]
    v_mfma_f32_16x16x32_bf16 v[64:67], a[216:219], v[248:251], v[64:67]
    v_mfma_f32_16x16x32_bf16 v[72:75], a[216:219], v[252:255], v[72:75]
    buffer_load_dwordx4 v[112:115], v2, s[24:27], s59 offen offset:2048
    s_waitcnt vmcnt(14)
    v_mfma_f32_16x16x32_bf16 v[20:23], a[220:223], v[224:227], v[20:23]
    v_mfma_f32_16x16x32_bf16 v[28:31], a[220:223], v[228:231], v[28:31]
    v_mfma_f32_16x16x32_bf16 v[36:39], a[220:223], v[232:235], v[36:39]
    v_mfma_f32_16x16x32_bf16 v[44:47], a[220:223], v[236:239], v[44:47]
    buffer_load_dwordx4 v[116:119], v2, s[24:27], s60 offen offset:2048
    v_mfma_f32_16x16x32_bf16 v[52:55], a[220:223], v[240:243], v[52:55]
    v_mfma_f32_16x16x32_bf16 v[60:63], a[220:223], v[244:247], v[60:63]
    v_mfma_f32_16x16x32_bf16 v[68:71], a[220:223], v[248:251], v[68:71]
    v_mfma_f32_16x16x32_bf16 v[76:79], a[220:223], v[252:255], v[76:79]
    buffer_load_dwordx4 v[120:123], v3, s[28:31], s44 offen offset:2048
    s_waitcnt vmcnt(15)
    v_mfma_f32_16x16x32_bf16 a[0:3], a[224:227], v[224:227], a[0:3]
    v_mfma_f32_16x16x32_bf16 a[24:27], a[224:227], v[228:231], a[24:27]
    v_mfma_f32_16x16x32_bf16 a[48:51], a[224:227], v[232:235], a[48:51]
    v_mfma_f32_16x16x32_bf16 a[72:75], a[224:227], v[236:239], a[72:75]
    buffer_load_dwordx4 v[124:127], v3, s[28:31], s45 offen offset:2048
    v_mfma_f32_16x16x32_bf16 a[96:99], a[224:227], v[240:243], a[96:99]
    v_mfma_f32_16x16x32_bf16 a[120:123], a[224:227], v[244:247], a[120:123]
    v_mfma_f32_16x16x32_bf16 a[144:147], a[224:227], v[248:251], a[144:147]
    v_mfma_f32_16x16x32_bf16 a[168:171], a[224:227], v[252:255], a[168:171]
    buffer_load_dwordx4 v[128:131], v3, s[28:31], s46 offen offset:2048
    s_waitcnt vmcnt(16)
    v_mfma_f32_16x16x32_bf16 a[4:7], a[228:231], v[224:227], a[4:7]
    v_mfma_f32_16x16x32_bf16 a[28:31], a[228:231], v[228:231], a[28:31]
    v_mfma_f32_16x16x32_bf16 a[52:55], a[228:231], v[232:235], a[52:55]
    v_mfma_f32_16x16x32_bf16 a[76:79], a[228:231], v[236:239], a[76:79]
    buffer_load_dwordx4 v[132:135], v3, s[28:31], s47 offen offset:2048
    v_mfma_f32_16x16x32_bf16 a[100:103], a[228:231], v[240:243], a[100:103]
    v_mfma_f32_16x16x32_bf16 a[124:127], a[228:231], v[244:247], a[124:127]
    v_mfma_f32_16x16x32_bf16 a[148:151], a[228:231], v[248:251], a[148:151]
    v_mfma_f32_16x16x32_bf16 a[172:175], a[228:231], v[252:255], a[172:175]
    buffer_load_dwordx4 v[136:139], v3, s[28:31], s48 offen offset:2048
    s_waitcnt vmcnt(17)
    v_mfma_f32_16x16x32_bf16 a[8:11], a[232:235], v[224:227], a[8:11]
    v_mfma_f32_16x16x32_bf16 a[32:35], a[232:235], v[228:231], a[32:35]
    v_mfma_f32_16x16x32_bf16 a[56:59], a[232:235], v[232:235], a[56:59]
    v_mfma_f32_16x16x32_bf16 a[80:83], a[232:235], v[236:239], a[80:83]
    buffer_load_dwordx4 v[140:143], v3, s[28:31], s49 offen offset:2048
    v_mfma_f32_16x16x32_bf16 a[104:107], a[232:235], v[240:243], a[104:107]
    v_mfma_f32_16x16x32_bf16 a[128:131], a[232:235], v[244:247], a[128:131]
    v_mfma_f32_16x16x32_bf16 a[152:155], a[232:235], v[248:251], a[152:155]
    v_mfma_f32_16x16x32_bf16 a[176:179], a[232:235], v[252:255], a[176:179]
    buffer_load_dwordx4 v[144:147], v3, s[28:31], s50 offen offset:2048
    s_waitcnt vmcnt(18)
    v_mfma_f32_16x16x32_bf16 a[12:15], a[236:239], v[224:227], a[12:15]
    v_mfma_f32_16x16x32_bf16 a[36:39], a[236:239], v[228:231], a[36:39]
    v_mfma_f32_16x16x32_bf16 a[60:63], a[236:239], v[232:235], a[60:63]
    v_mfma_f32_16x16x32_bf16 a[84:87], a[236:239], v[236:239], a[84:87]
    buffer_load_dwordx4 v[148:151], v3, s[28:31], s51 offen offset:2048
    v_mfma_f32_16x16x32_bf16 a[108:111], a[236:239], v[240:243], a[108:111]
    v_mfma_f32_16x16x32_bf16 a[132:135], a[236:239], v[244:247], a[132:135]
    v_mfma_f32_16x16x32_bf16 a[156:159], a[236:239], v[248:251], a[156:159]
    v_mfma_f32_16x16x32_bf16 a[180:183], a[236:239], v[252:255], a[180:183]
    buffer_load_dwordx4 v[152:155], v3, s[28:31], s52 offen offset:2048
    s_waitcnt vmcnt(19)
    v_mfma_f32_16x16x32_bf16 a[16:19], a[240:243], v[224:227], a[16:19]
    v_mfma_f32_16x16x32_bf16 a[40:43], a[240:243], v[228:231], a[40:43]
    v_mfma_f32_16x16x32_bf16 a[64:67], a[240:243], v[232:235], a[64:67]
    v_mfma_f32_16x16x32_bf16 a[88:91], a[240:243], v[236:239], a[88:91]
    buffer_load_dwordx4 v[156:159], v2, s[24:27], s53 offen offset:3072
    v_mfma_f32_16x16x32_bf16 a[112:115], a[240:243], v[240:243], a[112:115]
    v_mfma_f32_16x16x32_bf16 a[136:139], a[240:243], v[244:247], a[136:139]
    v_mfma_f32_16x16x32_bf16 a[160:163], a[240:243], v[248:251], a[160:163]
    v_mfma_f32_16x16x32_bf16 a[184:187], a[240:243], v[252:255], a[184:187]
    buffer_load_dwordx4 v[160:163], v2, s[24:27], s54 offen offset:3072
    s_waitcnt vmcnt(20)
    v_mfma_f32_16x16x32_bf16 a[20:23], a[244:247], v[224:227], a[20:23]
    v_mfma_f32_16x16x32_bf16 a[44:47], a[244:247], v[228:231], a[44:47]
    v_mfma_f32_16x16x32_bf16 a[68:71], a[244:247], v[232:235], a[68:71]
    v_mfma_f32_16x16x32_bf16 a[92:95], a[244:247], v[236:239], a[92:95]
    buffer_load_dwordx4 v[164:167], v2, s[24:27], s55 offen offset:3072
    v_mfma_f32_16x16x32_bf16 a[116:119], a[244:247], v[240:243], a[116:119]
    v_mfma_f32_16x16x32_bf16 a[140:143], a[244:247], v[244:247], a[140:143]
    v_mfma_f32_16x16x32_bf16 a[164:167], a[244:247], v[248:251], a[164:167]
    v_mfma_f32_16x16x32_bf16 a[188:191], a[244:247], v[252:255], a[188:191]
    buffer_load_dwordx4 v[168:171], v2, s[24:27], s56 offen offset:3072
    s_waitcnt vmcnt(21)
    v_mfma_f32_16x16x32_bf16 v[80:83], a[248:251], v[224:227], v[80:83]
    v_mfma_f32_16x16x32_bf16 v[84:87], a[248:251], v[228:231], v[84:87]
    v_mfma_f32_16x16x32_bf16 a[192:195], a[248:251], v[232:235], a[192:195]
    v_mfma_f32_16x16x32_bf16 a[196:199], a[248:251], v[236:239], a[196:199]
    buffer_load_dwordx4 v[172:175], v2, s[24:27], s57 offen offset:3072
    v_mfma_f32_16x16x32_bf16 a[200:203], a[248:251], v[240:243], a[200:203]
    v_mfma_f32_16x16x32_bf16 a[204:207], a[248:251], v[244:247], a[204:207]
    v_mfma_f32_16x16x32_bf16 a[208:211], a[248:251], v[248:251], a[208:211]
    v_mfma_f32_16x16x32_bf16 a[212:215], a[248:251], v[252:255], a[212:215]
    buffer_load_dwordx4 v[176:179], v2, s[24:27], s58 offen offset:3072
    s_waitcnt vmcnt(14)
    v_mfma_f32_16x16x32_bf16 v[16:19], v[120:123], v[88:91], v[16:19]
    v_mfma_f32_16x16x32_bf16 v[24:27], v[120:123], v[92:95], v[24:27]
    v_mfma_f32_16x16x32_bf16 v[32:35], v[120:123], v[96:99], v[32:35]
    v_mfma_f32_16x16x32_bf16 v[40:43], v[120:123], v[100:103], v[40:43]
    buffer_load_dwordx4 v[180:183], v2, s[24:27], s59 offen offset:3072
    v_mfma_f32_16x16x32_bf16 v[48:51], v[120:123], v[104:107], v[48:51]
    v_mfma_f32_16x16x32_bf16 v[56:59], v[120:123], v[108:111], v[56:59]
    v_mfma_f32_16x16x32_bf16 v[64:67], v[120:123], v[112:115], v[64:67]
    v_mfma_f32_16x16x32_bf16 v[72:75], v[120:123], v[116:119], v[72:75]
    buffer_load_dwordx4 v[184:187], v2, s[24:27], s60 offen offset:3072
    s_waitcnt vmcnt(15)
    v_mfma_f32_16x16x32_bf16 v[20:23], v[124:127], v[88:91], v[20:23]
    v_mfma_f32_16x16x32_bf16 v[28:31], v[124:127], v[92:95], v[28:31]
    v_mfma_f32_16x16x32_bf16 v[36:39], v[124:127], v[96:99], v[36:39]
    v_mfma_f32_16x16x32_bf16 v[44:47], v[124:127], v[100:103], v[44:47]
    buffer_load_dwordx4 v[188:191], v3, s[28:31], s44 offen offset:3072
    v_mfma_f32_16x16x32_bf16 v[52:55], v[124:127], v[104:107], v[52:55]
    v_mfma_f32_16x16x32_bf16 v[60:63], v[124:127], v[108:111], v[60:63]
    v_mfma_f32_16x16x32_bf16 v[68:71], v[124:127], v[112:115], v[68:71]
    v_mfma_f32_16x16x32_bf16 v[76:79], v[124:127], v[116:119], v[76:79]
    buffer_load_dwordx4 v[192:195], v3, s[28:31], s45 offen offset:3072
    s_waitcnt vmcnt(16)
    v_mfma_f32_16x16x32_bf16 a[0:3], v[128:131], v[88:91], a[0:3]
    v_mfma_f32_16x16x32_bf16 a[24:27], v[128:131], v[92:95], a[24:27]
    v_mfma_f32_16x16x32_bf16 a[48:51], v[128:131], v[96:99], a[48:51]
    v_mfma_f32_16x16x32_bf16 a[72:75], v[128:131], v[100:103], a[72:75]
    buffer_load_dwordx4 v[196:199], v3, s[28:31], s46 offen offset:3072
    v_mfma_f32_16x16x32_bf16 a[96:99], v[128:131], v[104:107], a[96:99]
    v_mfma_f32_16x16x32_bf16 a[120:123], v[128:131], v[108:111], a[120:123]
    v_mfma_f32_16x16x32_bf16 a[144:147], v[128:131], v[112:115], a[144:147]
    v_mfma_f32_16x16x32_bf16 a[168:171], v[128:131], v[116:119], a[168:171]
    buffer_load_dwordx4 v[200:203], v3, s[28:31], s47 offen offset:3072
    s_waitcnt vmcnt(17)
    v_mfma_f32_16x16x32_bf16 a[4:7], v[132:135], v[88:91], a[4:7]
    v_mfma_f32_16x16x32_bf16 a[28:31], v[132:135], v[92:95], a[28:31]
    v_mfma_f32_16x16x32_bf16 a[52:55], v[132:135], v[96:99], a[52:55]
    v_mfma_f32_16x16x32_bf16 a[76:79], v[132:135], v[100:103], a[76:79]
    buffer_load_dwordx4 v[204:207], v3, s[28:31], s48 offen offset:3072
    v_mfma_f32_16x16x32_bf16 a[100:103], v[132:135], v[104:107], a[100:103]
    v_mfma_f32_16x16x32_bf16 a[124:127], v[132:135], v[108:111], a[124:127]
    v_mfma_f32_16x16x32_bf16 a[148:151], v[132:135], v[112:115], a[148:151]
    v_mfma_f32_16x16x32_bf16 a[172:175], v[132:135], v[116:119], a[172:175]
    buffer_load_dwordx4 v[208:211], v3, s[28:31], s49 offen offset:3072
    s_waitcnt vmcnt(18)
    v_mfma_f32_16x16x32_bf16 a[8:11], v[136:139], v[88:91], a[8:11]
    v_mfma_f32_16x16x32_bf16 a[32:35], v[136:139], v[92:95], a[32:35]
    v_mfma_f32_16x16x32_bf16 a[56:59], v[136:139], v[96:99], a[56:59]
    v_mfma_f32_16x16x32_bf16 a[80:83], v[136:139], v[100:103], a[80:83]
    buffer_load_dwordx4 v[212:215], v3, s[28:31], s50 offen offset:3072
    v_mfma_f32_16x16x32_bf16 a[104:107], v[136:139], v[104:107], a[104:107]
    v_mfma_f32_16x16x32_bf16 a[128:131], v[136:139], v[108:111], a[128:131]
    v_mfma_f32_16x16x32_bf16 a[152:155], v[136:139], v[112:115], a[152:155]
    v_mfma_f32_16x16x32_bf16 a[176:179], v[136:139], v[116:119], a[176:179]
    buffer_load_dwordx4 v[216:219], v3, s[28:31], s51 offen offset:3072
    s_waitcnt vmcnt(19)
    v_mfma_f32_16x16x32_bf16 a[12:15], v[140:143], v[88:91], a[12:15]
    v_mfma_f32_16x16x32_bf16 a[36:39], v[140:143], v[92:95], a[36:39]
    v_mfma_f32_16x16x32_bf16 a[60:63], v[140:143], v[96:99], a[60:63]
    v_mfma_f32_16x16x32_bf16 a[84:87], v[140:143], v[100:103], a[84:87]
    buffer_load_dwordx4 v[220:223], v3, s[28:31], s52 offen offset:3072
    v_mfma_f32_16x16x32_bf16 a[108:111], v[140:143], v[104:107], a[108:111]
    v_mfma_f32_16x16x32_bf16 a[132:135], v[140:143], v[108:111], a[132:135]
    v_mfma_f32_16x16x32_bf16 a[156:159], v[140:143], v[112:115], a[156:159]
    v_mfma_f32_16x16x32_bf16 a[180:183], v[140:143], v[116:119], a[180:183]
    v_add_u32 v2, 4096, v2
    buffer_load_dwordx4 v[224:227], v2, s[24:27], s53 offen offset:0
    s_waitcnt vmcnt(20)
    v_mfma_f32_16x16x32_bf16 a[16:19], v[144:147], v[88:91], a[16:19]
    v_mfma_f32_16x16x32_bf16 a[40:43], v[144:147], v[92:95], a[40:43]
    v_mfma_f32_16x16x32_bf16 a[64:67], v[144:147], v[96:99], a[64:67]
    v_mfma_f32_16x16x32_bf16 a[88:91], v[144:147], v[100:103], a[88:91]
    buffer_load_dwordx4 v[228:231], v2, s[24:27], s54 offen offset:0
    v_mfma_f32_16x16x32_bf16 a[112:115], v[144:147], v[104:107], a[112:115]
    v_mfma_f32_16x16x32_bf16 a[136:139], v[144:147], v[108:111], a[136:139]
    v_mfma_f32_16x16x32_bf16 a[160:163], v[144:147], v[112:115], a[160:163]
    v_mfma_f32_16x16x32_bf16 a[184:187], v[144:147], v[116:119], a[184:187]
    buffer_load_dwordx4 v[232:235], v2, s[24:27], s55 offen offset:0
    s_waitcnt vmcnt(21)
    v_mfma_f32_16x16x32_bf16 a[20:23], v[148:151], v[88:91], a[20:23]
    v_mfma_f32_16x16x32_bf16 a[44:47], v[148:151], v[92:95], a[44:47]
    v_mfma_f32_16x16x32_bf16 a[68:71], v[148:151], v[96:99], a[68:71]
    v_mfma_f32_16x16x32_bf16 a[92:95], v[148:151], v[100:103], a[92:95]
    buffer_load_dwordx4 v[236:239], v2, s[24:27], s56 offen offset:0
    v_mfma_f32_16x16x32_bf16 a[116:119], v[148:151], v[104:107], a[116:119]
    v_mfma_f32_16x16x32_bf16 a[140:143], v[148:151], v[108:111], a[140:143]
    v_mfma_f32_16x16x32_bf16 a[164:167], v[148:151], v[112:115], a[164:167]
    v_mfma_f32_16x16x32_bf16 a[188:191], v[148:151], v[116:119], a[188:191]
    buffer_load_dwordx4 v[240:243], v2, s[24:27], s57 offen offset:0
    s_waitcnt vmcnt(22)
    v_mfma_f32_16x16x32_bf16 v[80:83], v[152:155], v[88:91], v[80:83]
    v_mfma_f32_16x16x32_bf16 v[84:87], v[152:155], v[92:95], v[84:87]
    v_mfma_f32_16x16x32_bf16 a[192:195], v[152:155], v[96:99], a[192:195]
    v_mfma_f32_16x16x32_bf16 a[196:199], v[152:155], v[100:103], a[196:199]
    buffer_load_dwordx4 v[244:247], v2, s[24:27], s58 offen offset:0
    v_mfma_f32_16x16x32_bf16 a[200:203], v[152:155], v[104:107], a[200:203]
    v_mfma_f32_16x16x32_bf16 a[204:207], v[152:155], v[108:111], a[204:207]
    v_mfma_f32_16x16x32_bf16 a[208:211], v[152:155], v[112:115], a[208:211]
    v_mfma_f32_16x16x32_bf16 a[212:215], v[152:155], v[116:119], a[212:215]
    buffer_load_dwordx4 v[248:251], v2, s[24:27], s59 offen offset:0
    s_waitcnt vmcnt(15)
    v_mfma_f32_16x16x32_bf16 v[16:19], v[188:191], v[156:159], v[16:19]
    v_mfma_f32_16x16x32_bf16 v[24:27], v[188:191], v[160:163], v[24:27]
    v_mfma_f32_16x16x32_bf16 v[32:35], v[188:191], v[164:167], v[32:35]
    v_mfma_f32_16x16x32_bf16 v[40:43], v[188:191], v[168:171], v[40:43]
    buffer_load_dwordx4 v[252:255], v2, s[24:27], s60 offen offset:0
    v_mfma_f32_16x16x32_bf16 v[48:51], v[188:191], v[172:175], v[48:51]
    v_mfma_f32_16x16x32_bf16 v[56:59], v[188:191], v[176:179], v[56:59]
    v_mfma_f32_16x16x32_bf16 v[64:67], v[188:191], v[180:183], v[64:67]
    v_mfma_f32_16x16x32_bf16 v[72:75], v[188:191], v[184:187], v[72:75]
    v_add_u32 v3, 4096, v3
    buffer_load_dwordx4 a[216:219], v3, s[28:31], s44 offen offset:0
    s_waitcnt vmcnt(16)
    v_mfma_f32_16x16x32_bf16 v[20:23], v[192:195], v[156:159], v[20:23]
    v_mfma_f32_16x16x32_bf16 v[28:31], v[192:195], v[160:163], v[28:31]
    v_mfma_f32_16x16x32_bf16 v[36:39], v[192:195], v[164:167], v[36:39]
    v_mfma_f32_16x16x32_bf16 v[44:47], v[192:195], v[168:171], v[44:47]
    buffer_load_dwordx4 a[220:223], v3, s[28:31], s45 offen offset:0
    v_mfma_f32_16x16x32_bf16 v[52:55], v[192:195], v[172:175], v[52:55]
    v_mfma_f32_16x16x32_bf16 v[60:63], v[192:195], v[176:179], v[60:63]
    v_mfma_f32_16x16x32_bf16 v[68:71], v[192:195], v[180:183], v[68:71]
    v_mfma_f32_16x16x32_bf16 v[76:79], v[192:195], v[184:187], v[76:79]
    buffer_load_dwordx4 a[224:227], v3, s[28:31], s46 offen offset:0
    s_waitcnt vmcnt(17)
    v_mfma_f32_16x16x32_bf16 a[0:3], v[196:199], v[156:159], a[0:3]
    v_mfma_f32_16x16x32_bf16 a[24:27], v[196:199], v[160:163], a[24:27]
    v_mfma_f32_16x16x32_bf16 a[48:51], v[196:199], v[164:167], a[48:51]
    v_mfma_f32_16x16x32_bf16 a[72:75], v[196:199], v[168:171], a[72:75]
    buffer_load_dwordx4 a[228:231], v3, s[28:31], s47 offen offset:0
    v_mfma_f32_16x16x32_bf16 a[96:99], v[196:199], v[172:175], a[96:99]
    v_mfma_f32_16x16x32_bf16 a[120:123], v[196:199], v[176:179], a[120:123]
    v_mfma_f32_16x16x32_bf16 a[144:147], v[196:199], v[180:183], a[144:147]
    v_mfma_f32_16x16x32_bf16 a[168:171], v[196:199], v[184:187], a[168:171]
    buffer_load_dwordx4 a[232:235], v3, s[28:31], s48 offen offset:0
    s_waitcnt vmcnt(18)
    v_mfma_f32_16x16x32_bf16 a[4:7], v[200:203], v[156:159], a[4:7]
    v_mfma_f32_16x16x32_bf16 a[28:31], v[200:203], v[160:163], a[28:31]
    v_mfma_f32_16x16x32_bf16 a[52:55], v[200:203], v[164:167], a[52:55]
    v_mfma_f32_16x16x32_bf16 a[76:79], v[200:203], v[168:171], a[76:79]
    buffer_load_dwordx4 a[236:239], v3, s[28:31], s49 offen offset:0
    v_mfma_f32_16x16x32_bf16 a[100:103], v[200:203], v[172:175], a[100:103]
    v_mfma_f32_16x16x32_bf16 a[124:127], v[200:203], v[176:179], a[124:127]
    v_mfma_f32_16x16x32_bf16 a[148:151], v[200:203], v[180:183], a[148:151]
    v_mfma_f32_16x16x32_bf16 a[172:175], v[200:203], v[184:187], a[172:175]
    buffer_load_dwordx4 a[240:243], v3, s[28:31], s50 offen offset:0
    s_waitcnt vmcnt(19)
    v_mfma_f32_16x16x32_bf16 a[8:11], v[204:207], v[156:159], a[8:11]
    v_mfma_f32_16x16x32_bf16 a[32:35], v[204:207], v[160:163], a[32:35]
    v_mfma_f32_16x16x32_bf16 a[56:59], v[204:207], v[164:167], a[56:59]
    v_mfma_f32_16x16x32_bf16 a[80:83], v[204:207], v[168:171], a[80:83]
    buffer_load_dwordx4 a[244:247], v3, s[28:31], s51 offen offset:0
    v_mfma_f32_16x16x32_bf16 a[104:107], v[204:207], v[172:175], a[104:107]
    v_mfma_f32_16x16x32_bf16 a[128:131], v[204:207], v[176:179], a[128:131]
    v_mfma_f32_16x16x32_bf16 a[152:155], v[204:207], v[180:183], a[152:155]
    v_mfma_f32_16x16x32_bf16 a[176:179], v[204:207], v[184:187], a[176:179]
    buffer_load_dwordx4 a[248:251], v3, s[28:31], s52 offen offset:0
    s_waitcnt vmcnt(20)
    v_mfma_f32_16x16x32_bf16 a[12:15], v[208:211], v[156:159], a[12:15]
    v_mfma_f32_16x16x32_bf16 a[36:39], v[208:211], v[160:163], a[36:39]
    v_mfma_f32_16x16x32_bf16 a[60:63], v[208:211], v[164:167], a[60:63]
    v_mfma_f32_16x16x32_bf16 a[84:87], v[208:211], v[168:171], a[84:87]
    buffer_load_dwordx4 v[88:91], v2, s[24:27], s53 offen offset:1024
    v_mfma_f32_16x16x32_bf16 a[108:111], v[208:211], v[172:175], a[108:111]
    v_mfma_f32_16x16x32_bf16 a[132:135], v[208:211], v[176:179], a[132:135]
    v_mfma_f32_16x16x32_bf16 a[156:159], v[208:211], v[180:183], a[156:159]
    v_mfma_f32_16x16x32_bf16 a[180:183], v[208:211], v[184:187], a[180:183]
    buffer_load_dwordx4 v[92:95], v2, s[24:27], s54 offen offset:1024
    s_waitcnt vmcnt(21)
    v_mfma_f32_16x16x32_bf16 a[16:19], v[212:215], v[156:159], a[16:19]
    v_mfma_f32_16x16x32_bf16 a[40:43], v[212:215], v[160:163], a[40:43]
    v_mfma_f32_16x16x32_bf16 a[64:67], v[212:215], v[164:167], a[64:67]
    v_mfma_f32_16x16x32_bf16 a[88:91], v[212:215], v[168:171], a[88:91]
    buffer_load_dwordx4 v[96:99], v2, s[24:27], s55 offen offset:1024
    v_mfma_f32_16x16x32_bf16 a[112:115], v[212:215], v[172:175], a[112:115]
    v_mfma_f32_16x16x32_bf16 a[136:139], v[212:215], v[176:179], a[136:139]
    v_mfma_f32_16x16x32_bf16 a[160:163], v[212:215], v[180:183], a[160:163]
    v_mfma_f32_16x16x32_bf16 a[184:187], v[212:215], v[184:187], a[184:187]
    buffer_load_dwordx4 v[100:103], v2, s[24:27], s56 offen offset:1024
    s_waitcnt vmcnt(22)
    v_mfma_f32_16x16x32_bf16 a[20:23], v[216:219], v[156:159], a[20:23]
    v_mfma_f32_16x16x32_bf16 a[44:47], v[216:219], v[160:163], a[44:47]
    v_mfma_f32_16x16x32_bf16 a[68:71], v[216:219], v[164:167], a[68:71]
    v_mfma_f32_16x16x32_bf16 a[92:95], v[216:219], v[168:171], a[92:95]
    buffer_load_dwordx4 v[104:107], v2, s[24:27], s57 offen offset:1024
    v_mfma_f32_16x16x32_bf16 a[116:119], v[216:219], v[172:175], a[116:119]
    v_mfma_f32_16x16x32_bf16 a[140:143], v[216:219], v[176:179], a[140:143]
    v_mfma_f32_16x16x32_bf16 a[164:167], v[216:219], v[180:183], a[164:167]
    v_mfma_f32_16x16x32_bf16 a[188:191], v[216:219], v[184:187], a[188:191]
    buffer_load_dwordx4 v[108:111], v2, s[24:27], s58 offen offset:1024
    s_waitcnt vmcnt(23)
    v_mfma_f32_16x16x32_bf16 v[80:83], v[220:223], v[156:159], v[80:83]
    v_mfma_f32_16x16x32_bf16 v[84:87], v[220:223], v[160:163], v[84:87]
    v_mfma_f32_16x16x32_bf16 a[192:195], v[220:223], v[164:167], a[192:195]
    v_mfma_f32_16x16x32_bf16 a[196:199], v[220:223], v[168:171], a[196:199]
    buffer_load_dwordx4 v[112:115], v2, s[24:27], s59 offen offset:1024
    v_mfma_f32_16x16x32_bf16 a[200:203], v[220:223], v[172:175], a[200:203]
    v_mfma_f32_16x16x32_bf16 a[204:207], v[220:223], v[176:179], a[204:207]
    v_mfma_f32_16x16x32_bf16 a[208:211], v[220:223], v[180:183], a[208:211]
    v_mfma_f32_16x16x32_bf16 a[212:215], v[220:223], v[184:187], a[212:215]
    buffer_load_dwordx4 v[116:119], v2, s[24:27], s60 offen offset:1024
    s_waitcnt vmcnt(16)
    v_mfma_f32_16x16x32_bf16 v[16:19], a[216:219], v[224:227], v[16:19]
    v_mfma_f32_16x16x32_bf16 v[24:27], a[216:219], v[228:231], v[24:27]
    v_mfma_f32_16x16x32_bf16 v[32:35], a[216:219], v[232:235], v[32:35]
    v_mfma_f32_16x16x32_bf16 v[40:43], a[216:219], v[236:239], v[40:43]
    buffer_load_dwordx4 v[120:123], v3, s[28:31], s44 offen offset:1024
    v_mfma_f32_16x16x32_bf16 v[48:51], a[216:219], v[240:243], v[48:51]
    v_mfma_f32_16x16x32_bf16 v[56:59], a[216:219], v[244:247], v[56:59]
    v_mfma_f32_16x16x32_bf16 v[64:67], a[216:219], v[248:251], v[64:67]
    v_mfma_f32_16x16x32_bf16 v[72:75], a[216:219], v[252:255], v[72:75]
    buffer_load_dwordx4 v[124:127], v3, s[28:31], s45 offen offset:1024
    s_waitcnt vmcnt(17)
    v_mfma_f32_16x16x32_bf16 v[20:23], a[220:223], v[224:227], v[20:23]
    v_mfma_f32_16x16x32_bf16 v[28:31], a[220:223], v[228:231], v[28:31]
    v_mfma_f32_16x16x32_bf16 v[36:39], a[220:223], v[232:235], v[36:39]
    v_mfma_f32_16x16x32_bf16 v[44:47], a[220:223], v[236:239], v[44:47]
    buffer_load_dwordx4 v[128:131], v3, s[28:31], s46 offen offset:1024
    v_mfma_f32_16x16x32_bf16 v[52:55], a[220:223], v[240:243], v[52:55]
    v_mfma_f32_16x16x32_bf16 v[60:63], a[220:223], v[244:247], v[60:63]
    v_mfma_f32_16x16x32_bf16 v[68:71], a[220:223], v[248:251], v[68:71]
    v_mfma_f32_16x16x32_bf16 v[76:79], a[220:223], v[252:255], v[76:79]
    buffer_load_dwordx4 v[132:135], v3, s[28:31], s47 offen offset:1024
    s_waitcnt vmcnt(18)
    v_mfma_f32_16x16x32_bf16 a[0:3], a[224:227], v[224:227], a[0:3]
    v_mfma_f32_16x16x32_bf16 a[24:27], a[224:227], v[228:231], a[24:27]
    v_mfma_f32_16x16x32_bf16 a[48:51], a[224:227], v[232:235], a[48:51]
    v_mfma_f32_16x16x32_bf16 a[72:75], a[224:227], v[236:239], a[72:75]
    buffer_load_dwordx4 v[136:139], v3, s[28:31], s48 offen offset:1024
    v_mfma_f32_16x16x32_bf16 a[96:99], a[224:227], v[240:243], a[96:99]
    v_mfma_f32_16x16x32_bf16 a[120:123], a[224:227], v[244:247], a[120:123]
    v_mfma_f32_16x16x32_bf16 a[144:147], a[224:227], v[248:251], a[144:147]
    v_mfma_f32_16x16x32_bf16 a[168:171], a[224:227], v[252:255], a[168:171]
    buffer_load_dwordx4 v[140:143], v3, s[28:31], s49 offen offset:1024
    s_waitcnt vmcnt(19)
    v_mfma_f32_16x16x32_bf16 a[4:7], a[228:231], v[224:227], a[4:7]
    v_mfma_f32_16x16x32_bf16 a[28:31], a[228:231], v[228:231], a[28:31]
    v_mfma_f32_16x16x32_bf16 a[52:55], a[228:231], v[232:235], a[52:55]
    v_mfma_f32_16x16x32_bf16 a[76:79], a[228:231], v[236:239], a[76:79]
    buffer_load_dwordx4 v[144:147], v3, s[28:31], s50 offen offset:1024
    v_mfma_f32_16x16x32_bf16 a[100:103], a[228:231], v[240:243], a[100:103]
    v_mfma_f32_16x16x32_bf16 a[124:127], a[228:231], v[244:247], a[124:127]
    v_mfma_f32_16x16x32_bf16 a[148:151], a[228:231], v[248:251], a[148:151]
    v_mfma_f32_16x16x32_bf16 a[172:175], a[228:231], v[252:255], a[172:175]
    buffer_load_dwordx4 v[148:151], v3, s[28:31], s51 offen offset:1024
    s_waitcnt vmcnt(20)
    v_mfma_f32_16x16x32_bf16 a[8:11], a[232:235], v[224:227], a[8:11]
    v_mfma_f32_16x16x32_bf16 a[32:35], a[232:235], v[228:231], a[32:35]
    v_mfma_f32_16x16x32_bf16 a[56:59], a[232:235], v[232:235], a[56:59]
    v_mfma_f32_16x16x32_bf16 a[80:83], a[232:235], v[236:239], a[80:83]
    buffer_load_dwordx4 v[152:155], v3, s[28:31], s52 offen offset:1024
    v_mfma_f32_16x16x32_bf16 a[104:107], a[232:235], v[240:243], a[104:107]
    v_mfma_f32_16x16x32_bf16 a[128:131], a[232:235], v[244:247], a[128:131]
    v_mfma_f32_16x16x32_bf16 a[152:155], a[232:235], v[248:251], a[152:155]
    v_mfma_f32_16x16x32_bf16 a[176:179], a[232:235], v[252:255], a[176:179]
    buffer_load_dwordx4 v[156:159], v2, s[24:27], s53 offen offset:2048
    s_waitcnt vmcnt(21)
    v_mfma_f32_16x16x32_bf16 a[12:15], a[236:239], v[224:227], a[12:15]
    v_mfma_f32_16x16x32_bf16 a[36:39], a[236:239], v[228:231], a[36:39]
    v_mfma_f32_16x16x32_bf16 a[60:63], a[236:239], v[232:235], a[60:63]
    v_mfma_f32_16x16x32_bf16 a[84:87], a[236:239], v[236:239], a[84:87]
    buffer_load_dwordx4 v[160:163], v2, s[24:27], s54 offen offset:2048
    v_mfma_f32_16x16x32_bf16 a[108:111], a[236:239], v[240:243], a[108:111]
    v_mfma_f32_16x16x32_bf16 a[132:135], a[236:239], v[244:247], a[132:135]
    v_mfma_f32_16x16x32_bf16 a[156:159], a[236:239], v[248:251], a[156:159]
    v_mfma_f32_16x16x32_bf16 a[180:183], a[236:239], v[252:255], a[180:183]
    buffer_load_dwordx4 v[164:167], v2, s[24:27], s55 offen offset:2048
    s_waitcnt vmcnt(22)
    v_mfma_f32_16x16x32_bf16 a[16:19], a[240:243], v[224:227], a[16:19]
    v_mfma_f32_16x16x32_bf16 a[40:43], a[240:243], v[228:231], a[40:43]
    v_mfma_f32_16x16x32_bf16 a[64:67], a[240:243], v[232:235], a[64:67]
    v_mfma_f32_16x16x32_bf16 a[88:91], a[240:243], v[236:239], a[88:91]
    buffer_load_dwordx4 v[168:171], v2, s[24:27], s56 offen offset:2048
    v_mfma_f32_16x16x32_bf16 a[112:115], a[240:243], v[240:243], a[112:115]
    v_mfma_f32_16x16x32_bf16 a[136:139], a[240:243], v[244:247], a[136:139]
    v_mfma_f32_16x16x32_bf16 a[160:163], a[240:243], v[248:251], a[160:163]
    v_mfma_f32_16x16x32_bf16 a[184:187], a[240:243], v[252:255], a[184:187]
    buffer_load_dwordx4 v[172:175], v2, s[24:27], s57 offen offset:2048
    s_waitcnt vmcnt(23)
    v_mfma_f32_16x16x32_bf16 a[20:23], a[244:247], v[224:227], a[20:23]
    v_mfma_f32_16x16x32_bf16 a[44:47], a[244:247], v[228:231], a[44:47]
    v_mfma_f32_16x16x32_bf16 a[68:71], a[244:247], v[232:235], a[68:71]
    v_mfma_f32_16x16x32_bf16 a[92:95], a[244:247], v[236:239], a[92:95]
    buffer_load_dwordx4 v[176:179], v2, s[24:27], s58 offen offset:2048
    v_mfma_f32_16x16x32_bf16 a[116:119], a[244:247], v[240:243], a[116:119]
    v_mfma_f32_16x16x32_bf16 a[140:143], a[244:247], v[244:247], a[140:143]
    v_mfma_f32_16x16x32_bf16 a[164:167], a[244:247], v[248:251], a[164:167]
    v_mfma_f32_16x16x32_bf16 a[188:191], a[244:247], v[252:255], a[188:191]
    buffer_load_dwordx4 v[180:183], v2, s[24:27], s59 offen offset:2048
    s_waitcnt vmcnt(24)
    v_mfma_f32_16x16x32_bf16 v[80:83], a[248:251], v[224:227], v[80:83]
    v_mfma_f32_16x16x32_bf16 v[84:87], a[248:251], v[228:231], v[84:87]
    v_mfma_f32_16x16x32_bf16 a[192:195], a[248:251], v[232:235], a[192:195]
    v_mfma_f32_16x16x32_bf16 a[196:199], a[248:251], v[236:239], a[196:199]
    buffer_load_dwordx4 v[184:187], v2, s[24:27], s60 offen offset:2048
    v_mfma_f32_16x16x32_bf16 a[200:203], a[248:251], v[240:243], a[200:203]
    v_mfma_f32_16x16x32_bf16 a[204:207], a[248:251], v[244:247], a[204:207]
    v_mfma_f32_16x16x32_bf16 a[208:211], a[248:251], v[248:251], a[208:211]
    v_mfma_f32_16x16x32_bf16 a[212:215], a[248:251], v[252:255], a[212:215]
    buffer_load_dwordx4 v[188:191], v3, s[28:31], s44 offen offset:2048
    s_waitcnt vmcnt(17)
    v_mfma_f32_16x16x32_bf16 v[16:19], v[120:123], v[88:91], v[16:19]
    v_mfma_f32_16x16x32_bf16 v[24:27], v[120:123], v[92:95], v[24:27]
    v_mfma_f32_16x16x32_bf16 v[32:35], v[120:123], v[96:99], v[32:35]
    v_mfma_f32_16x16x32_bf16 v[40:43], v[120:123], v[100:103], v[40:43]
    buffer_load_dwordx4 v[192:195], v3, s[28:31], s45 offen offset:2048
    v_mfma_f32_16x16x32_bf16 v[48:51], v[120:123], v[104:107], v[48:51]
    v_mfma_f32_16x16x32_bf16 v[56:59], v[120:123], v[108:111], v[56:59]
    v_mfma_f32_16x16x32_bf16 v[64:67], v[120:123], v[112:115], v[64:67]
    v_mfma_f32_16x16x32_bf16 v[72:75], v[120:123], v[116:119], v[72:75]
    buffer_load_dwordx4 v[196:199], v3, s[28:31], s46 offen offset:2048
    s_waitcnt vmcnt(18)
    v_mfma_f32_16x16x32_bf16 v[20:23], v[124:127], v[88:91], v[20:23]
    v_mfma_f32_16x16x32_bf16 v[28:31], v[124:127], v[92:95], v[28:31]
    v_mfma_f32_16x16x32_bf16 v[36:39], v[124:127], v[96:99], v[36:39]
    v_mfma_f32_16x16x32_bf16 v[44:47], v[124:127], v[100:103], v[44:47]
    buffer_load_dwordx4 v[200:203], v3, s[28:31], s47 offen offset:2048
    v_mfma_f32_16x16x32_bf16 v[52:55], v[124:127], v[104:107], v[52:55]
    v_mfma_f32_16x16x32_bf16 v[60:63], v[124:127], v[108:111], v[60:63]
    v_mfma_f32_16x16x32_bf16 v[68:71], v[124:127], v[112:115], v[68:71]
    v_mfma_f32_16x16x32_bf16 v[76:79], v[124:127], v[116:119], v[76:79]
    buffer_load_dwordx4 v[204:207], v3, s[28:31], s48 offen offset:2048
    s_waitcnt vmcnt(19)
    v_mfma_f32_16x16x32_bf16 a[0:3], v[128:131], v[88:91], a[0:3]
    v_mfma_f32_16x16x32_bf16 a[24:27], v[128:131], v[92:95], a[24:27]
    v_mfma_f32_16x16x32_bf16 a[48:51], v[128:131], v[96:99], a[48:51]
    v_mfma_f32_16x16x32_bf16 a[72:75], v[128:131], v[100:103], a[72:75]
    buffer_load_dwordx4 v[208:211], v3, s[28:31], s49 offen offset:2048
    v_mfma_f32_16x16x32_bf16 a[96:99], v[128:131], v[104:107], a[96:99]
    v_mfma_f32_16x16x32_bf16 a[120:123], v[128:131], v[108:111], a[120:123]
    v_mfma_f32_16x16x32_bf16 a[144:147], v[128:131], v[112:115], a[144:147]
    v_mfma_f32_16x16x32_bf16 a[168:171], v[128:131], v[116:119], a[168:171]
    buffer_load_dwordx4 v[212:215], v3, s[28:31], s50 offen offset:2048
    s_waitcnt vmcnt(20)
    v_mfma_f32_16x16x32_bf16 a[4:7], v[132:135], v[88:91], a[4:7]
    v_mfma_f32_16x16x32_bf16 a[28:31], v[132:135], v[92:95], a[28:31]
    v_mfma_f32_16x16x32_bf16 a[52:55], v[132:135], v[96:99], a[52:55]
    v_mfma_f32_16x16x32_bf16 a[76:79], v[132:135], v[100:103], a[76:79]
    buffer_load_dwordx4 v[216:219], v3, s[28:31], s51 offen offset:2048
    v_mfma_f32_16x16x32_bf16 a[100:103], v[132:135], v[104:107], a[100:103]
    v_mfma_f32_16x16x32_bf16 a[124:127], v[132:135], v[108:111], a[124:127]
    v_mfma_f32_16x16x32_bf16 a[148:151], v[132:135], v[112:115], a[148:151]
    v_mfma_f32_16x16x32_bf16 a[172:175], v[132:135], v[116:119], a[172:175]
    buffer_load_dwordx4 v[220:223], v3, s[28:31], s52 offen offset:2048
    s_waitcnt vmcnt(21)
    v_mfma_f32_16x16x32_bf16 a[8:11], v[136:139], v[88:91], a[8:11]
    v_mfma_f32_16x16x32_bf16 a[32:35], v[136:139], v[92:95], a[32:35]
    v_mfma_f32_16x16x32_bf16 a[56:59], v[136:139], v[96:99], a[56:59]
    v_mfma_f32_16x16x32_bf16 a[80:83], v[136:139], v[100:103], a[80:83]
    buffer_load_dwordx4 v[224:227], v2, s[24:27], s53 offen offset:3072
    v_mfma_f32_16x16x32_bf16 a[104:107], v[136:139], v[104:107], a[104:107]
    v_mfma_f32_16x16x32_bf16 a[128:131], v[136:139], v[108:111], a[128:131]
    v_mfma_f32_16x16x32_bf16 a[152:155], v[136:139], v[112:115], a[152:155]
    v_mfma_f32_16x16x32_bf16 a[176:179], v[136:139], v[116:119], a[176:179]
    buffer_load_dwordx4 v[228:231], v2, s[24:27], s54 offen offset:3072
    s_waitcnt vmcnt(22)
    v_mfma_f32_16x16x32_bf16 a[12:15], v[140:143], v[88:91], a[12:15]
    v_mfma_f32_16x16x32_bf16 a[36:39], v[140:143], v[92:95], a[36:39]
    v_mfma_f32_16x16x32_bf16 a[60:63], v[140:143], v[96:99], a[60:63]
    v_mfma_f32_16x16x32_bf16 a[84:87], v[140:143], v[100:103], a[84:87]
    buffer_load_dwordx4 v[232:235], v2, s[24:27], s55 offen offset:3072
    v_mfma_f32_16x16x32_bf16 a[108:111], v[140:143], v[104:107], a[108:111]
    v_mfma_f32_16x16x32_bf16 a[132:135], v[140:143], v[108:111], a[132:135]
    v_mfma_f32_16x16x32_bf16 a[156:159], v[140:143], v[112:115], a[156:159]
    v_mfma_f32_16x16x32_bf16 a[180:183], v[140:143], v[116:119], a[180:183]
    buffer_load_dwordx4 v[236:239], v2, s[24:27], s56 offen offset:3072
    s_waitcnt vmcnt(23)
    v_mfma_f32_16x16x32_bf16 a[16:19], v[144:147], v[88:91], a[16:19]
    v_mfma_f32_16x16x32_bf16 a[40:43], v[144:147], v[92:95], a[40:43]
    v_mfma_f32_16x16x32_bf16 a[64:67], v[144:147], v[96:99], a[64:67]
    v_mfma_f32_16x16x32_bf16 a[88:91], v[144:147], v[100:103], a[88:91]
    buffer_load_dwordx4 v[240:243], v2, s[24:27], s57 offen offset:3072
    v_mfma_f32_16x16x32_bf16 a[112:115], v[144:147], v[104:107], a[112:115]
    v_mfma_f32_16x16x32_bf16 a[136:139], v[144:147], v[108:111], a[136:139]
    v_mfma_f32_16x16x32_bf16 a[160:163], v[144:147], v[112:115], a[160:163]
    v_mfma_f32_16x16x32_bf16 a[184:187], v[144:147], v[116:119], a[184:187]
    buffer_load_dwordx4 v[244:247], v2, s[24:27], s58 offen offset:3072
    s_waitcnt vmcnt(24)
    v_mfma_f32_16x16x32_bf16 a[20:23], v[148:151], v[88:91], a[20:23]
    v_mfma_f32_16x16x32_bf16 a[44:47], v[148:151], v[92:95], a[44:47]
    v_mfma_f32_16x16x32_bf16 a[68:71], v[148:151], v[96:99], a[68:71]
    v_mfma_f32_16x16x32_bf16 a[92:95], v[148:151], v[100:103], a[92:95]
    buffer_load_dwordx4 v[248:251], v2, s[24:27], s59 offen offset:3072
    v_mfma_f32_16x16x32_bf16 a[116:119], v[148:151], v[104:107], a[116:119]
    v_mfma_f32_16x16x32_bf16 a[140:143], v[148:151], v[108:111], a[140:143]
    v_mfma_f32_16x16x32_bf16 a[164:167], v[148:151], v[112:115], a[164:167]
    v_mfma_f32_16x16x32_bf16 a[188:191], v[148:151], v[116:119], a[188:191]
    buffer_load_dwordx4 v[252:255], v2, s[24:27], s60 offen offset:3072
    s_waitcnt vmcnt(25)
    v_mfma_f32_16x16x32_bf16 v[80:83], v[152:155], v[88:91], v[80:83]
    v_mfma_f32_16x16x32_bf16 v[84:87], v[152:155], v[92:95], v[84:87]
    v_mfma_f32_16x16x32_bf16 a[192:195], v[152:155], v[96:99], a[192:195]
    v_mfma_f32_16x16x32_bf16 a[196:199], v[152:155], v[100:103], a[196:199]
    buffer_load_dwordx4 a[216:219], v3, s[28:31], s44 offen offset:3072
    v_mfma_f32_16x16x32_bf16 a[200:203], v[152:155], v[104:107], a[200:203]
    v_mfma_f32_16x16x32_bf16 a[204:207], v[152:155], v[108:111], a[204:207]
    v_mfma_f32_16x16x32_bf16 a[208:211], v[152:155], v[112:115], a[208:211]
    v_mfma_f32_16x16x32_bf16 a[212:215], v[152:155], v[116:119], a[212:215]
    buffer_load_dwordx4 a[220:223], v3, s[28:31], s45 offen offset:3072
    s_waitcnt vmcnt(18)
    v_mfma_f32_16x16x32_bf16 v[16:19], v[188:191], v[156:159], v[16:19]
    v_mfma_f32_16x16x32_bf16 v[24:27], v[188:191], v[160:163], v[24:27]
    v_mfma_f32_16x16x32_bf16 v[32:35], v[188:191], v[164:167], v[32:35]
    v_mfma_f32_16x16x32_bf16 v[40:43], v[188:191], v[168:171], v[40:43]
    buffer_load_dwordx4 a[224:227], v3, s[28:31], s46 offen offset:3072
    v_mfma_f32_16x16x32_bf16 v[48:51], v[188:191], v[172:175], v[48:51]
    v_mfma_f32_16x16x32_bf16 v[56:59], v[188:191], v[176:179], v[56:59]
    v_mfma_f32_16x16x32_bf16 v[64:67], v[188:191], v[180:183], v[64:67]
    v_mfma_f32_16x16x32_bf16 v[72:75], v[188:191], v[184:187], v[72:75]
    buffer_load_dwordx4 a[228:231], v3, s[28:31], s47 offen offset:3072
    s_waitcnt vmcnt(19)
    v_mfma_f32_16x16x32_bf16 v[20:23], v[192:195], v[156:159], v[20:23]
    v_mfma_f32_16x16x32_bf16 v[28:31], v[192:195], v[160:163], v[28:31]
    v_mfma_f32_16x16x32_bf16 v[36:39], v[192:195], v[164:167], v[36:39]
    v_mfma_f32_16x16x32_bf16 v[44:47], v[192:195], v[168:171], v[44:47]
    buffer_load_dwordx4 a[232:235], v3, s[28:31], s48 offen offset:3072
    v_mfma_f32_16x16x32_bf16 v[52:55], v[192:195], v[172:175], v[52:55]
    v_mfma_f32_16x16x32_bf16 v[60:63], v[192:195], v[176:179], v[60:63]
    v_mfma_f32_16x16x32_bf16 v[68:71], v[192:195], v[180:183], v[68:71]
    v_mfma_f32_16x16x32_bf16 v[76:79], v[192:195], v[184:187], v[76:79]
    buffer_load_dwordx4 a[236:239], v3, s[28:31], s49 offen offset:3072
    s_waitcnt vmcnt(20)
    v_mfma_f32_16x16x32_bf16 a[0:3], v[196:199], v[156:159], a[0:3]
    v_mfma_f32_16x16x32_bf16 a[24:27], v[196:199], v[160:163], a[24:27]
    v_mfma_f32_16x16x32_bf16 a[48:51], v[196:199], v[164:167], a[48:51]
    v_mfma_f32_16x16x32_bf16 a[72:75], v[196:199], v[168:171], a[72:75]
    buffer_load_dwordx4 a[240:243], v3, s[28:31], s50 offen offset:3072
    v_mfma_f32_16x16x32_bf16 a[96:99], v[196:199], v[172:175], a[96:99]
    v_mfma_f32_16x16x32_bf16 a[120:123], v[196:199], v[176:179], a[120:123]
    v_mfma_f32_16x16x32_bf16 a[144:147], v[196:199], v[180:183], a[144:147]
    v_mfma_f32_16x16x32_bf16 a[168:171], v[196:199], v[184:187], a[168:171]
    buffer_load_dwordx4 a[244:247], v3, s[28:31], s51 offen offset:3072
    s_waitcnt vmcnt(21)
    v_mfma_f32_16x16x32_bf16 a[4:7], v[200:203], v[156:159], a[4:7]
    v_mfma_f32_16x16x32_bf16 a[28:31], v[200:203], v[160:163], a[28:31]
    v_mfma_f32_16x16x32_bf16 a[52:55], v[200:203], v[164:167], a[52:55]
    v_mfma_f32_16x16x32_bf16 a[76:79], v[200:203], v[168:171], a[76:79]
    buffer_load_dwordx4 a[248:251], v3, s[28:31], s52 offen offset:3072
    v_mfma_f32_16x16x32_bf16 a[100:103], v[200:203], v[172:175], a[100:103]
    v_mfma_f32_16x16x32_bf16 a[124:127], v[200:203], v[176:179], a[124:127]
    v_mfma_f32_16x16x32_bf16 a[148:151], v[200:203], v[180:183], a[148:151]
    v_mfma_f32_16x16x32_bf16 a[172:175], v[200:203], v[184:187], a[172:175]
    v_add_u32 v2, 4096, v2
    buffer_load_dwordx4 v[88:91], v2, s[24:27], s53 offen offset:0
    s_waitcnt vmcnt(22)
    v_mfma_f32_16x16x32_bf16 a[8:11], v[204:207], v[156:159], a[8:11]
    v_mfma_f32_16x16x32_bf16 a[32:35], v[204:207], v[160:163], a[32:35]
    v_mfma_f32_16x16x32_bf16 a[56:59], v[204:207], v[164:167], a[56:59]
    v_mfma_f32_16x16x32_bf16 a[80:83], v[204:207], v[168:171], a[80:83]
    buffer_load_dwordx4 v[92:95], v2, s[24:27], s54 offen offset:0
    v_mfma_f32_16x16x32_bf16 a[104:107], v[204:207], v[172:175], a[104:107]
    v_mfma_f32_16x16x32_bf16 a[128:131], v[204:207], v[176:179], a[128:131]
    v_mfma_f32_16x16x32_bf16 a[152:155], v[204:207], v[180:183], a[152:155]
    v_mfma_f32_16x16x32_bf16 a[176:179], v[204:207], v[184:187], a[176:179]
    buffer_load_dwordx4 v[96:99], v2, s[24:27], s55 offen offset:0
    s_waitcnt vmcnt(23)
    v_mfma_f32_16x16x32_bf16 a[12:15], v[208:211], v[156:159], a[12:15]
    v_mfma_f32_16x16x32_bf16 a[36:39], v[208:211], v[160:163], a[36:39]
    v_mfma_f32_16x16x32_bf16 a[60:63], v[208:211], v[164:167], a[60:63]
    v_mfma_f32_16x16x32_bf16 a[84:87], v[208:211], v[168:171], a[84:87]
    buffer_load_dwordx4 v[100:103], v2, s[24:27], s56 offen offset:0
    v_mfma_f32_16x16x32_bf16 a[108:111], v[208:211], v[172:175], a[108:111]
    v_mfma_f32_16x16x32_bf16 a[132:135], v[208:211], v[176:179], a[132:135]
    v_mfma_f32_16x16x32_bf16 a[156:159], v[208:211], v[180:183], a[156:159]
    v_mfma_f32_16x16x32_bf16 a[180:183], v[208:211], v[184:187], a[180:183]
    buffer_load_dwordx4 v[104:107], v2, s[24:27], s57 offen offset:0
    s_waitcnt vmcnt(24)
    v_mfma_f32_16x16x32_bf16 a[16:19], v[212:215], v[156:159], a[16:19]
    v_mfma_f32_16x16x32_bf16 a[40:43], v[212:215], v[160:163], a[40:43]
    v_mfma_f32_16x16x32_bf16 a[64:67], v[212:215], v[164:167], a[64:67]
    v_mfma_f32_16x16x32_bf16 a[88:91], v[212:215], v[168:171], a[88:91]
    buffer_load_dwordx4 v[108:111], v2, s[24:27], s58 offen offset:0
    v_mfma_f32_16x16x32_bf16 a[112:115], v[212:215], v[172:175], a[112:115]
    v_mfma_f32_16x16x32_bf16 a[136:139], v[212:215], v[176:179], a[136:139]
    v_mfma_f32_16x16x32_bf16 a[160:163], v[212:215], v[180:183], a[160:163]
    v_mfma_f32_16x16x32_bf16 a[184:187], v[212:215], v[184:187], a[184:187]
    buffer_load_dwordx4 v[112:115], v2, s[24:27], s59 offen offset:0
    s_waitcnt vmcnt(25)
    v_mfma_f32_16x16x32_bf16 a[20:23], v[216:219], v[156:159], a[20:23]
    v_mfma_f32_16x16x32_bf16 a[44:47], v[216:219], v[160:163], a[44:47]
    v_mfma_f32_16x16x32_bf16 a[68:71], v[216:219], v[164:167], a[68:71]
    v_mfma_f32_16x16x32_bf16 a[92:95], v[216:219], v[168:171], a[92:95]
    buffer_load_dwordx4 v[116:119], v2, s[24:27], s60 offen offset:0
    v_mfma_f32_16x16x32_bf16 a[116:119], v[216:219], v[172:175], a[116:119]
    v_mfma_f32_16x16x32_bf16 a[140:143], v[216:219], v[176:179], a[140:143]
    v_mfma_f32_16x16x32_bf16 a[164:167], v[216:219], v[180:183], a[164:167]
    v_mfma_f32_16x16x32_bf16 a[188:191], v[216:219], v[184:187], a[188:191]
    v_add_u32 v3, 4096, v3
    buffer_load_dwordx4 v[120:123], v3, s[28:31], s44 offen offset:0
    s_waitcnt vmcnt(26)
    v_mfma_f32_16x16x32_bf16 v[80:83], v[220:223], v[156:159], v[80:83]
    v_mfma_f32_16x16x32_bf16 v[84:87], v[220:223], v[160:163], v[84:87]
    v_mfma_f32_16x16x32_bf16 a[192:195], v[220:223], v[164:167], a[192:195]
    v_mfma_f32_16x16x32_bf16 a[196:199], v[220:223], v[168:171], a[196:199]
    buffer_load_dwordx4 v[124:127], v3, s[28:31], s45 offen offset:0
    v_mfma_f32_16x16x32_bf16 a[200:203], v[220:223], v[172:175], a[200:203]
    v_mfma_f32_16x16x32_bf16 a[204:207], v[220:223], v[176:179], a[204:207]
    v_mfma_f32_16x16x32_bf16 a[208:211], v[220:223], v[180:183], a[208:211]
    v_mfma_f32_16x16x32_bf16 a[212:215], v[220:223], v[184:187], a[212:215]
    buffer_load_dwordx4 v[128:131], v3, s[28:31], s46 offen offset:0
    s_waitcnt vmcnt(19)
    v_mfma_f32_16x16x32_bf16 v[16:19], a[216:219], v[224:227], v[16:19]
    v_mfma_f32_16x16x32_bf16 v[24:27], a[216:219], v[228:231], v[24:27]
    v_mfma_f32_16x16x32_bf16 v[32:35], a[216:219], v[232:235], v[32:35]
    v_mfma_f32_16x16x32_bf16 v[40:43], a[216:219], v[236:239], v[40:43]
    buffer_load_dwordx4 v[132:135], v3, s[28:31], s47 offen offset:0
    v_mfma_f32_16x16x32_bf16 v[48:51], a[216:219], v[240:243], v[48:51]
    v_mfma_f32_16x16x32_bf16 v[56:59], a[216:219], v[244:247], v[56:59]
    v_mfma_f32_16x16x32_bf16 v[64:67], a[216:219], v[248:251], v[64:67]
    v_mfma_f32_16x16x32_bf16 v[72:75], a[216:219], v[252:255], v[72:75]
    buffer_load_dwordx4 v[136:139], v3, s[28:31], s48 offen offset:0
    s_waitcnt vmcnt(20)
    v_mfma_f32_16x16x32_bf16 v[20:23], a[220:223], v[224:227], v[20:23]
    v_mfma_f32_16x16x32_bf16 v[28:31], a[220:223], v[228:231], v[28:31]
    v_mfma_f32_16x16x32_bf16 v[36:39], a[220:223], v[232:235], v[36:39]
    v_mfma_f32_16x16x32_bf16 v[44:47], a[220:223], v[236:239], v[44:47]
    buffer_load_dwordx4 v[140:143], v3, s[28:31], s49 offen offset:0
    v_mfma_f32_16x16x32_bf16 v[52:55], a[220:223], v[240:243], v[52:55]
    v_mfma_f32_16x16x32_bf16 v[60:63], a[220:223], v[244:247], v[60:63]
    v_mfma_f32_16x16x32_bf16 v[68:71], a[220:223], v[248:251], v[68:71]
    v_mfma_f32_16x16x32_bf16 v[76:79], a[220:223], v[252:255], v[76:79]
    buffer_load_dwordx4 v[144:147], v3, s[28:31], s50 offen offset:0
    s_waitcnt vmcnt(21)
    v_mfma_f32_16x16x32_bf16 a[0:3], a[224:227], v[224:227], a[0:3]
    v_mfma_f32_16x16x32_bf16 a[24:27], a[224:227], v[228:231], a[24:27]
    v_mfma_f32_16x16x32_bf16 a[48:51], a[224:227], v[232:235], a[48:51]
    v_mfma_f32_16x16x32_bf16 a[72:75], a[224:227], v[236:239], a[72:75]
    buffer_load_dwordx4 v[148:151], v3, s[28:31], s51 offen offset:0
    v_mfma_f32_16x16x32_bf16 a[96:99], a[224:227], v[240:243], a[96:99]
    v_mfma_f32_16x16x32_bf16 a[120:123], a[224:227], v[244:247], a[120:123]
    v_mfma_f32_16x16x32_bf16 a[144:147], a[224:227], v[248:251], a[144:147]
    v_mfma_f32_16x16x32_bf16 a[168:171], a[224:227], v[252:255], a[168:171]
    buffer_load_dwordx4 v[152:155], v3, s[28:31], s52 offen offset:0
    s_waitcnt vmcnt(22)
    v_mfma_f32_16x16x32_bf16 a[4:7], a[228:231], v[224:227], a[4:7]
    v_mfma_f32_16x16x32_bf16 a[28:31], a[228:231], v[228:231], a[28:31]
    v_mfma_f32_16x16x32_bf16 a[52:55], a[228:231], v[232:235], a[52:55]
    v_mfma_f32_16x16x32_bf16 a[76:79], a[228:231], v[236:239], a[76:79]
    buffer_load_dwordx4 v[156:159], v2, s[24:27], s53 offen offset:1024
    v_mfma_f32_16x16x32_bf16 a[100:103], a[228:231], v[240:243], a[100:103]
    v_mfma_f32_16x16x32_bf16 a[124:127], a[228:231], v[244:247], a[124:127]
    v_mfma_f32_16x16x32_bf16 a[148:151], a[228:231], v[248:251], a[148:151]
    v_mfma_f32_16x16x32_bf16 a[172:175], a[228:231], v[252:255], a[172:175]
    buffer_load_dwordx4 v[160:163], v2, s[24:27], s54 offen offset:1024
    s_waitcnt vmcnt(23)
    v_mfma_f32_16x16x32_bf16 a[8:11], a[232:235], v[224:227], a[8:11]
    v_mfma_f32_16x16x32_bf16 a[32:35], a[232:235], v[228:231], a[32:35]
    v_mfma_f32_16x16x32_bf16 a[56:59], a[232:235], v[232:235], a[56:59]
    v_mfma_f32_16x16x32_bf16 a[80:83], a[232:235], v[236:239], a[80:83]
    buffer_load_dwordx4 v[164:167], v2, s[24:27], s55 offen offset:1024
    v_mfma_f32_16x16x32_bf16 a[104:107], a[232:235], v[240:243], a[104:107]
    v_mfma_f32_16x16x32_bf16 a[128:131], a[232:235], v[244:247], a[128:131]
    v_mfma_f32_16x16x32_bf16 a[152:155], a[232:235], v[248:251], a[152:155]
    v_mfma_f32_16x16x32_bf16 a[176:179], a[232:235], v[252:255], a[176:179]
    buffer_load_dwordx4 v[168:171], v2, s[24:27], s56 offen offset:1024
    s_waitcnt vmcnt(24)
    v_mfma_f32_16x16x32_bf16 a[12:15], a[236:239], v[224:227], a[12:15]
    v_mfma_f32_16x16x32_bf16 a[36:39], a[236:239], v[228:231], a[36:39]
    v_mfma_f32_16x16x32_bf16 a[60:63], a[236:239], v[232:235], a[60:63]
    v_mfma_f32_16x16x32_bf16 a[84:87], a[236:239], v[236:239], a[84:87]
    buffer_load_dwordx4 v[172:175], v2, s[24:27], s57 offen offset:1024
    v_mfma_f32_16x16x32_bf16 a[108:111], a[236:239], v[240:243], a[108:111]
    v_mfma_f32_16x16x32_bf16 a[132:135], a[236:239], v[244:247], a[132:135]
    v_mfma_f32_16x16x32_bf16 a[156:159], a[236:239], v[248:251], a[156:159]
    v_mfma_f32_16x16x32_bf16 a[180:183], a[236:239], v[252:255], a[180:183]
    buffer_load_dwordx4 v[176:179], v2, s[24:27], s58 offen offset:1024
    s_waitcnt vmcnt(25)
    v_mfma_f32_16x16x32_bf16 a[16:19], a[240:243], v[224:227], a[16:19]
    v_mfma_f32_16x16x32_bf16 a[40:43], a[240:243], v[228:231], a[40:43]
    v_mfma_f32_16x16x32_bf16 a[64:67], a[240:243], v[232:235], a[64:67]
    v_mfma_f32_16x16x32_bf16 a[88:91], a[240:243], v[236:239], a[88:91]
    buffer_load_dwordx4 v[180:183], v2, s[24:27], s59 offen offset:1024
    v_mfma_f32_16x16x32_bf16 a[112:115], a[240:243], v[240:243], a[112:115]
    v_mfma_f32_16x16x32_bf16 a[136:139], a[240:243], v[244:247], a[136:139]
    v_mfma_f32_16x16x32_bf16 a[160:163], a[240:243], v[248:251], a[160:163]
    v_mfma_f32_16x16x32_bf16 a[184:187], a[240:243], v[252:255], a[184:187]
    buffer_load_dwordx4 v[184:187], v2, s[24:27], s60 offen offset:1024
    s_waitcnt vmcnt(26)
    v_mfma_f32_16x16x32_bf16 a[20:23], a[244:247], v[224:227], a[20:23]
    v_mfma_f32_16x16x32_bf16 a[44:47], a[244:247], v[228:231], a[44:47]
    v_mfma_f32_16x16x32_bf16 a[68:71], a[244:247], v[232:235], a[68:71]
    v_mfma_f32_16x16x32_bf16 a[92:95], a[244:247], v[236:239], a[92:95]
    buffer_load_dwordx4 v[188:191], v3, s[28:31], s44 offen offset:1024
    v_mfma_f32_16x16x32_bf16 a[116:119], a[244:247], v[240:243], a[116:119]
    v_mfma_f32_16x16x32_bf16 a[140:143], a[244:247], v[244:247], a[140:143]
    v_mfma_f32_16x16x32_bf16 a[164:167], a[244:247], v[248:251], a[164:167]
    v_mfma_f32_16x16x32_bf16 a[188:191], a[244:247], v[252:255], a[188:191]
    buffer_load_dwordx4 v[192:195], v3, s[28:31], s45 offen offset:1024
    s_waitcnt vmcnt(27)
    v_mfma_f32_16x16x32_bf16 v[80:83], a[248:251], v[224:227], v[80:83]
    v_mfma_f32_16x16x32_bf16 v[84:87], a[248:251], v[228:231], v[84:87]
    v_mfma_f32_16x16x32_bf16 a[192:195], a[248:251], v[232:235], a[192:195]
    v_mfma_f32_16x16x32_bf16 a[196:199], a[248:251], v[236:239], a[196:199]
    buffer_load_dwordx4 v[196:199], v3, s[28:31], s46 offen offset:1024
    v_mfma_f32_16x16x32_bf16 a[200:203], a[248:251], v[240:243], a[200:203]
    v_mfma_f32_16x16x32_bf16 a[204:207], a[248:251], v[244:247], a[204:207]
    v_mfma_f32_16x16x32_bf16 a[208:211], a[248:251], v[248:251], a[208:211]
    v_mfma_f32_16x16x32_bf16 a[212:215], a[248:251], v[252:255], a[212:215]
    buffer_load_dwordx4 v[200:203], v3, s[28:31], s47 offen offset:1024
    s_waitcnt vmcnt(20)
    v_mfma_f32_16x16x32_bf16 v[16:19], v[120:123], v[88:91], v[16:19]
    v_mfma_f32_16x16x32_bf16 v[24:27], v[120:123], v[92:95], v[24:27]
    v_mfma_f32_16x16x32_bf16 v[32:35], v[120:123], v[96:99], v[32:35]
    v_mfma_f32_16x16x32_bf16 v[40:43], v[120:123], v[100:103], v[40:43]
    buffer_load_dwordx4 v[204:207], v3, s[28:31], s48 offen offset:1024
    v_mfma_f32_16x16x32_bf16 v[48:51], v[120:123], v[104:107], v[48:51]
    v_mfma_f32_16x16x32_bf16 v[56:59], v[120:123], v[108:111], v[56:59]
    v_mfma_f32_16x16x32_bf16 v[64:67], v[120:123], v[112:115], v[64:67]
    v_mfma_f32_16x16x32_bf16 v[72:75], v[120:123], v[116:119], v[72:75]
    buffer_load_dwordx4 v[208:211], v3, s[28:31], s49 offen offset:1024
    s_waitcnt vmcnt(21)
    v_mfma_f32_16x16x32_bf16 v[20:23], v[124:127], v[88:91], v[20:23]
    v_mfma_f32_16x16x32_bf16 v[28:31], v[124:127], v[92:95], v[28:31]
    v_mfma_f32_16x16x32_bf16 v[36:39], v[124:127], v[96:99], v[36:39]
    v_mfma_f32_16x16x32_bf16 v[44:47], v[124:127], v[100:103], v[44:47]
    buffer_load_dwordx4 v[212:215], v3, s[28:31], s50 offen offset:1024
    v_mfma_f32_16x16x32_bf16 v[52:55], v[124:127], v[104:107], v[52:55]
    v_mfma_f32_16x16x32_bf16 v[60:63], v[124:127], v[108:111], v[60:63]
    v_mfma_f32_16x16x32_bf16 v[68:71], v[124:127], v[112:115], v[68:71]
    v_mfma_f32_16x16x32_bf16 v[76:79], v[124:127], v[116:119], v[76:79]
    buffer_load_dwordx4 v[216:219], v3, s[28:31], s51 offen offset:1024
    s_waitcnt vmcnt(22)
    v_mfma_f32_16x16x32_bf16 a[0:3], v[128:131], v[88:91], a[0:3]
    v_mfma_f32_16x16x32_bf16 a[24:27], v[128:131], v[92:95], a[24:27]
    v_mfma_f32_16x16x32_bf16 a[48:51], v[128:131], v[96:99], a[48:51]
    v_mfma_f32_16x16x32_bf16 a[72:75], v[128:131], v[100:103], a[72:75]
    buffer_load_dwordx4 v[220:223], v3, s[28:31], s52 offen offset:1024
    v_mfma_f32_16x16x32_bf16 a[96:99], v[128:131], v[104:107], a[96:99]
    v_mfma_f32_16x16x32_bf16 a[120:123], v[128:131], v[108:111], a[120:123]
    v_mfma_f32_16x16x32_bf16 a[144:147], v[128:131], v[112:115], a[144:147]
    v_mfma_f32_16x16x32_bf16 a[168:171], v[128:131], v[116:119], a[168:171]
    buffer_load_dwordx4 v[224:227], v2, s[24:27], s53 offen offset:2048
    s_waitcnt vmcnt(23)
    v_mfma_f32_16x16x32_bf16 a[4:7], v[132:135], v[88:91], a[4:7]
    v_mfma_f32_16x16x32_bf16 a[28:31], v[132:135], v[92:95], a[28:31]
    v_mfma_f32_16x16x32_bf16 a[52:55], v[132:135], v[96:99], a[52:55]
    v_mfma_f32_16x16x32_bf16 a[76:79], v[132:135], v[100:103], a[76:79]
    buffer_load_dwordx4 v[228:231], v2, s[24:27], s54 offen offset:2048
    v_mfma_f32_16x16x32_bf16 a[100:103], v[132:135], v[104:107], a[100:103]
    v_mfma_f32_16x16x32_bf16 a[124:127], v[132:135], v[108:111], a[124:127]
    v_mfma_f32_16x16x32_bf16 a[148:151], v[132:135], v[112:115], a[148:151]
    v_mfma_f32_16x16x32_bf16 a[172:175], v[132:135], v[116:119], a[172:175]
    buffer_load_dwordx4 v[232:235], v2, s[24:27], s55 offen offset:2048
    s_waitcnt vmcnt(24)
    v_mfma_f32_16x16x32_bf16 a[8:11], v[136:139], v[88:91], a[8:11]
    v_mfma_f32_16x16x32_bf16 a[32:35], v[136:139], v[92:95], a[32:35]
    v_mfma_f32_16x16x32_bf16 a[56:59], v[136:139], v[96:99], a[56:59]
    v_mfma_f32_16x16x32_bf16 a[80:83], v[136:139], v[100:103], a[80:83]
    buffer_load_dwordx4 v[236:239], v2, s[24:27], s56 offen offset:2048
    v_mfma_f32_16x16x32_bf16 a[104:107], v[136:139], v[104:107], a[104:107]
    v_mfma_f32_16x16x32_bf16 a[128:131], v[136:139], v[108:111], a[128:131]
    v_mfma_f32_16x16x32_bf16 a[152:155], v[136:139], v[112:115], a[152:155]
    v_mfma_f32_16x16x32_bf16 a[176:179], v[136:139], v[116:119], a[176:179]
    buffer_load_dwordx4 v[240:243], v2, s[24:27], s57 offen offset:2048
    s_waitcnt vmcnt(25)
    v_mfma_f32_16x16x32_bf16 a[12:15], v[140:143], v[88:91], a[12:15]
    v_mfma_f32_16x16x32_bf16 a[36:39], v[140:143], v[92:95], a[36:39]
    v_mfma_f32_16x16x32_bf16 a[60:63], v[140:143], v[96:99], a[60:63]
    v_mfma_f32_16x16x32_bf16 a[84:87], v[140:143], v[100:103], a[84:87]
    buffer_load_dwordx4 v[244:247], v2, s[24:27], s58 offen offset:2048
    v_mfma_f32_16x16x32_bf16 a[108:111], v[140:143], v[104:107], a[108:111]
    v_mfma_f32_16x16x32_bf16 a[132:135], v[140:143], v[108:111], a[132:135]
    v_mfma_f32_16x16x32_bf16 a[156:159], v[140:143], v[112:115], a[156:159]
    v_mfma_f32_16x16x32_bf16 a[180:183], v[140:143], v[116:119], a[180:183]
    buffer_load_dwordx4 v[248:251], v2, s[24:27], s59 offen offset:2048
    s_waitcnt vmcnt(26)
    v_mfma_f32_16x16x32_bf16 a[16:19], v[144:147], v[88:91], a[16:19]
    v_mfma_f32_16x16x32_bf16 a[40:43], v[144:147], v[92:95], a[40:43]
    v_mfma_f32_16x16x32_bf16 a[64:67], v[144:147], v[96:99], a[64:67]
    v_mfma_f32_16x16x32_bf16 a[88:91], v[144:147], v[100:103], a[88:91]
    buffer_load_dwordx4 v[252:255], v2, s[24:27], s60 offen offset:2048
    v_mfma_f32_16x16x32_bf16 a[112:115], v[144:147], v[104:107], a[112:115]
    v_mfma_f32_16x16x32_bf16 a[136:139], v[144:147], v[108:111], a[136:139]
    v_mfma_f32_16x16x32_bf16 a[160:163], v[144:147], v[112:115], a[160:163]
    v_mfma_f32_16x16x32_bf16 a[184:187], v[144:147], v[116:119], a[184:187]
    buffer_load_dwordx4 a[216:219], v3, s[28:31], s44 offen offset:2048
    s_waitcnt vmcnt(27)
    v_mfma_f32_16x16x32_bf16 a[20:23], v[148:151], v[88:91], a[20:23]
    v_mfma_f32_16x16x32_bf16 a[44:47], v[148:151], v[92:95], a[44:47]
    v_mfma_f32_16x16x32_bf16 a[68:71], v[148:151], v[96:99], a[68:71]
    v_mfma_f32_16x16x32_bf16 a[92:95], v[148:151], v[100:103], a[92:95]
    buffer_load_dwordx4 a[220:223], v3, s[28:31], s45 offen offset:2048
    v_mfma_f32_16x16x32_bf16 a[116:119], v[148:151], v[104:107], a[116:119]
    v_mfma_f32_16x16x32_bf16 a[140:143], v[148:151], v[108:111], a[140:143]
    v_mfma_f32_16x16x32_bf16 a[164:167], v[148:151], v[112:115], a[164:167]
    v_mfma_f32_16x16x32_bf16 a[188:191], v[148:151], v[116:119], a[188:191]
    buffer_load_dwordx4 a[224:227], v3, s[28:31], s46 offen offset:2048
    s_waitcnt vmcnt(28)
    v_mfma_f32_16x16x32_bf16 v[80:83], v[152:155], v[88:91], v[80:83]
    v_mfma_f32_16x16x32_bf16 v[84:87], v[152:155], v[92:95], v[84:87]
    v_mfma_f32_16x16x32_bf16 a[192:195], v[152:155], v[96:99], a[192:195]
    v_mfma_f32_16x16x32_bf16 a[196:199], v[152:155], v[100:103], a[196:199]
    buffer_load_dwordx4 a[228:231], v3, s[28:31], s47 offen offset:2048
    v_mfma_f32_16x16x32_bf16 a[200:203], v[152:155], v[104:107], a[200:203]
    v_mfma_f32_16x16x32_bf16 a[204:207], v[152:155], v[108:111], a[204:207]
    v_mfma_f32_16x16x32_bf16 a[208:211], v[152:155], v[112:115], a[208:211]
    v_mfma_f32_16x16x32_bf16 a[212:215], v[152:155], v[116:119], a[212:215]
    buffer_load_dwordx4 a[232:235], v3, s[28:31], s48 offen offset:2048
    s_waitcnt vmcnt(21)
    v_mfma_f32_16x16x32_bf16 v[16:19], v[188:191], v[156:159], v[16:19]
    v_mfma_f32_16x16x32_bf16 v[24:27], v[188:191], v[160:163], v[24:27]
    v_mfma_f32_16x16x32_bf16 v[32:35], v[188:191], v[164:167], v[32:35]
    v_mfma_f32_16x16x32_bf16 v[40:43], v[188:191], v[168:171], v[40:43]
    buffer_load_dwordx4 a[236:239], v3, s[28:31], s49 offen offset:2048
    v_mfma_f32_16x16x32_bf16 v[48:51], v[188:191], v[172:175], v[48:51]
    v_mfma_f32_16x16x32_bf16 v[56:59], v[188:191], v[176:179], v[56:59]
    v_mfma_f32_16x16x32_bf16 v[64:67], v[188:191], v[180:183], v[64:67]
    v_mfma_f32_16x16x32_bf16 v[72:75], v[188:191], v[184:187], v[72:75]
    buffer_load_dwordx4 a[240:243], v3, s[28:31], s50 offen offset:2048
    s_waitcnt vmcnt(22)
    v_mfma_f32_16x16x32_bf16 v[20:23], v[192:195], v[156:159], v[20:23]
    v_mfma_f32_16x16x32_bf16 v[28:31], v[192:195], v[160:163], v[28:31]
    v_mfma_f32_16x16x32_bf16 v[36:39], v[192:195], v[164:167], v[36:39]
    v_mfma_f32_16x16x32_bf16 v[44:47], v[192:195], v[168:171], v[44:47]
    buffer_load_dwordx4 a[244:247], v3, s[28:31], s51 offen offset:2048
    v_mfma_f32_16x16x32_bf16 v[52:55], v[192:195], v[172:175], v[52:55]
    v_mfma_f32_16x16x32_bf16 v[60:63], v[192:195], v[176:179], v[60:63]
    v_mfma_f32_16x16x32_bf16 v[68:71], v[192:195], v[180:183], v[68:71]
    v_mfma_f32_16x16x32_bf16 v[76:79], v[192:195], v[184:187], v[76:79]
    buffer_load_dwordx4 a[248:251], v3, s[28:31], s52 offen offset:2048
    s_waitcnt vmcnt(23)
    v_mfma_f32_16x16x32_bf16 a[0:3], v[196:199], v[156:159], a[0:3]
    v_mfma_f32_16x16x32_bf16 a[24:27], v[196:199], v[160:163], a[24:27]
    v_mfma_f32_16x16x32_bf16 a[48:51], v[196:199], v[164:167], a[48:51]
    v_mfma_f32_16x16x32_bf16 a[72:75], v[196:199], v[168:171], a[72:75]
    buffer_load_dwordx4 v[88:91], v2, s[24:27], s53 offen offset:3072
    v_mfma_f32_16x16x32_bf16 a[96:99], v[196:199], v[172:175], a[96:99]
    v_mfma_f32_16x16x32_bf16 a[120:123], v[196:199], v[176:179], a[120:123]
    v_mfma_f32_16x16x32_bf16 a[144:147], v[196:199], v[180:183], a[144:147]
    v_mfma_f32_16x16x32_bf16 a[168:171], v[196:199], v[184:187], a[168:171]
    buffer_load_dwordx4 v[92:95], v2, s[24:27], s54 offen offset:3072
    s_waitcnt vmcnt(24)
    v_mfma_f32_16x16x32_bf16 a[4:7], v[200:203], v[156:159], a[4:7]
    v_mfma_f32_16x16x32_bf16 a[28:31], v[200:203], v[160:163], a[28:31]
    v_mfma_f32_16x16x32_bf16 a[52:55], v[200:203], v[164:167], a[52:55]
    v_mfma_f32_16x16x32_bf16 a[76:79], v[200:203], v[168:171], a[76:79]
    buffer_load_dwordx4 v[96:99], v2, s[24:27], s55 offen offset:3072
    v_mfma_f32_16x16x32_bf16 a[100:103], v[200:203], v[172:175], a[100:103]
    v_mfma_f32_16x16x32_bf16 a[124:127], v[200:203], v[176:179], a[124:127]
    v_mfma_f32_16x16x32_bf16 a[148:151], v[200:203], v[180:183], a[148:151]
    v_mfma_f32_16x16x32_bf16 a[172:175], v[200:203], v[184:187], a[172:175]
    buffer_load_dwordx4 v[100:103], v2, s[24:27], s56 offen offset:3072
    s_waitcnt vmcnt(25)
    v_mfma_f32_16x16x32_bf16 a[8:11], v[204:207], v[156:159], a[8:11]
    v_mfma_f32_16x16x32_bf16 a[32:35], v[204:207], v[160:163], a[32:35]
    v_mfma_f32_16x16x32_bf16 a[56:59], v[204:207], v[164:167], a[56:59]
    v_mfma_f32_16x16x32_bf16 a[80:83], v[204:207], v[168:171], a[80:83]
    buffer_load_dwordx4 v[104:107], v2, s[24:27], s57 offen offset:3072
    v_mfma_f32_16x16x32_bf16 a[104:107], v[204:207], v[172:175], a[104:107]
    v_mfma_f32_16x16x32_bf16 a[128:131], v[204:207], v[176:179], a[128:131]
    v_mfma_f32_16x16x32_bf16 a[152:155], v[204:207], v[180:183], a[152:155]
    v_mfma_f32_16x16x32_bf16 a[176:179], v[204:207], v[184:187], a[176:179]
    buffer_load_dwordx4 v[108:111], v2, s[24:27], s58 offen offset:3072
    s_waitcnt vmcnt(26)
    v_mfma_f32_16x16x32_bf16 a[12:15], v[208:211], v[156:159], a[12:15]
    v_mfma_f32_16x16x32_bf16 a[36:39], v[208:211], v[160:163], a[36:39]
    v_mfma_f32_16x16x32_bf16 a[60:63], v[208:211], v[164:167], a[60:63]
    v_mfma_f32_16x16x32_bf16 a[84:87], v[208:211], v[168:171], a[84:87]
    buffer_load_dwordx4 v[112:115], v2, s[24:27], s59 offen offset:3072
    v_mfma_f32_16x16x32_bf16 a[108:111], v[208:211], v[172:175], a[108:111]
    v_mfma_f32_16x16x32_bf16 a[132:135], v[208:211], v[176:179], a[132:135]
    v_mfma_f32_16x16x32_bf16 a[156:159], v[208:211], v[180:183], a[156:159]
    v_mfma_f32_16x16x32_bf16 a[180:183], v[208:211], v[184:187], a[180:183]
    buffer_load_dwordx4 v[116:119], v2, s[24:27], s60 offen offset:3072
    s_waitcnt vmcnt(27)
    v_mfma_f32_16x16x32_bf16 a[16:19], v[212:215], v[156:159], a[16:19]
    v_mfma_f32_16x16x32_bf16 a[40:43], v[212:215], v[160:163], a[40:43]
    v_mfma_f32_16x16x32_bf16 a[64:67], v[212:215], v[164:167], a[64:67]
    v_mfma_f32_16x16x32_bf16 a[88:91], v[212:215], v[168:171], a[88:91]
    buffer_load_dwordx4 v[120:123], v3, s[28:31], s44 offen offset:3072
    v_mfma_f32_16x16x32_bf16 a[112:115], v[212:215], v[172:175], a[112:115]
    v_mfma_f32_16x16x32_bf16 a[136:139], v[212:215], v[176:179], a[136:139]
    v_mfma_f32_16x16x32_bf16 a[160:163], v[212:215], v[180:183], a[160:163]
    v_mfma_f32_16x16x32_bf16 a[184:187], v[212:215], v[184:187], a[184:187]
    buffer_load_dwordx4 v[124:127], v3, s[28:31], s45 offen offset:3072
    s_waitcnt vmcnt(28)
    v_mfma_f32_16x16x32_bf16 a[20:23], v[216:219], v[156:159], a[20:23]
    v_mfma_f32_16x16x32_bf16 a[44:47], v[216:219], v[160:163], a[44:47]
    v_mfma_f32_16x16x32_bf16 a[68:71], v[216:219], v[164:167], a[68:71]
    v_mfma_f32_16x16x32_bf16 a[92:95], v[216:219], v[168:171], a[92:95]
    buffer_load_dwordx4 v[128:131], v3, s[28:31], s46 offen offset:3072
    v_mfma_f32_16x16x32_bf16 a[116:119], v[216:219], v[172:175], a[116:119]
    v_mfma_f32_16x16x32_bf16 a[140:143], v[216:219], v[176:179], a[140:143]
    v_mfma_f32_16x16x32_bf16 a[164:167], v[216:219], v[180:183], a[164:167]
    v_mfma_f32_16x16x32_bf16 a[188:191], v[216:219], v[184:187], a[188:191]
    buffer_load_dwordx4 v[132:135], v3, s[28:31], s47 offen offset:3072
    s_waitcnt vmcnt(29)
    v_mfma_f32_16x16x32_bf16 v[80:83], v[220:223], v[156:159], v[80:83]
    v_mfma_f32_16x16x32_bf16 v[84:87], v[220:223], v[160:163], v[84:87]
    v_mfma_f32_16x16x32_bf16 a[192:195], v[220:223], v[164:167], a[192:195]
    v_mfma_f32_16x16x32_bf16 a[196:199], v[220:223], v[168:171], a[196:199]
    buffer_load_dwordx4 v[136:139], v3, s[28:31], s48 offen offset:3072
    v_mfma_f32_16x16x32_bf16 a[200:203], v[220:223], v[172:175], a[200:203]
    v_mfma_f32_16x16x32_bf16 a[204:207], v[220:223], v[176:179], a[204:207]
    v_mfma_f32_16x16x32_bf16 a[208:211], v[220:223], v[180:183], a[208:211]
    v_mfma_f32_16x16x32_bf16 a[212:215], v[220:223], v[184:187], a[212:215]
    buffer_load_dwordx4 v[140:143], v3, s[28:31], s49 offen offset:3072
    s_waitcnt vmcnt(22)
    v_mfma_f32_16x16x32_bf16 v[16:19], a[216:219], v[224:227], v[16:19]
    v_mfma_f32_16x16x32_bf16 v[24:27], a[216:219], v[228:231], v[24:27]
    v_mfma_f32_16x16x32_bf16 v[32:35], a[216:219], v[232:235], v[32:35]
    v_mfma_f32_16x16x32_bf16 v[40:43], a[216:219], v[236:239], v[40:43]
    buffer_load_dwordx4 v[144:147], v3, s[28:31], s50 offen offset:3072
    v_mfma_f32_16x16x32_bf16 v[48:51], a[216:219], v[240:243], v[48:51]
    v_mfma_f32_16x16x32_bf16 v[56:59], a[216:219], v[244:247], v[56:59]
    v_mfma_f32_16x16x32_bf16 v[64:67], a[216:219], v[248:251], v[64:67]
    v_mfma_f32_16x16x32_bf16 v[72:75], a[216:219], v[252:255], v[72:75]
    buffer_load_dwordx4 v[148:151], v3, s[28:31], s51 offen offset:3072
    s_waitcnt vmcnt(23)
    v_mfma_f32_16x16x32_bf16 v[20:23], a[220:223], v[224:227], v[20:23]
    v_mfma_f32_16x16x32_bf16 v[28:31], a[220:223], v[228:231], v[28:31]
    v_mfma_f32_16x16x32_bf16 v[36:39], a[220:223], v[232:235], v[36:39]
    v_mfma_f32_16x16x32_bf16 v[44:47], a[220:223], v[236:239], v[44:47]
    buffer_load_dwordx4 v[152:155], v3, s[28:31], s52 offen offset:3072
    v_mfma_f32_16x16x32_bf16 v[52:55], a[220:223], v[240:243], v[52:55]
    v_mfma_f32_16x16x32_bf16 v[60:63], a[220:223], v[244:247], v[60:63]
    v_mfma_f32_16x16x32_bf16 v[68:71], a[220:223], v[248:251], v[68:71]
    v_mfma_f32_16x16x32_bf16 v[76:79], a[220:223], v[252:255], v[76:79]
    v_add_u32 v2, 4096, v2
    buffer_load_dwordx4 v[156:159], v2, s[24:27], s53 offen offset:0
    s_waitcnt vmcnt(24)
    v_mfma_f32_16x16x32_bf16 a[0:3], a[224:227], v[224:227], a[0:3]
    v_mfma_f32_16x16x32_bf16 a[24:27], a[224:227], v[228:231], a[24:27]
    v_mfma_f32_16x16x32_bf16 a[48:51], a[224:227], v[232:235], a[48:51]
    v_mfma_f32_16x16x32_bf16 a[72:75], a[224:227], v[236:239], a[72:75]
    buffer_load_dwordx4 v[160:163], v2, s[24:27], s54 offen offset:0
    v_mfma_f32_16x16x32_bf16 a[96:99], a[224:227], v[240:243], a[96:99]
    v_mfma_f32_16x16x32_bf16 a[120:123], a[224:227], v[244:247], a[120:123]
    v_mfma_f32_16x16x32_bf16 a[144:147], a[224:227], v[248:251], a[144:147]
    v_mfma_f32_16x16x32_bf16 a[168:171], a[224:227], v[252:255], a[168:171]
    buffer_load_dwordx4 v[164:167], v2, s[24:27], s55 offen offset:0
    s_waitcnt vmcnt(25)
    v_mfma_f32_16x16x32_bf16 a[4:7], a[228:231], v[224:227], a[4:7]
    v_mfma_f32_16x16x32_bf16 a[28:31], a[228:231], v[228:231], a[28:31]
    v_mfma_f32_16x16x32_bf16 a[52:55], a[228:231], v[232:235], a[52:55]
    v_mfma_f32_16x16x32_bf16 a[76:79], a[228:231], v[236:239], a[76:79]
    buffer_load_dwordx4 v[168:171], v2, s[24:27], s56 offen offset:0
    v_mfma_f32_16x16x32_bf16 a[100:103], a[228:231], v[240:243], a[100:103]
    v_mfma_f32_16x16x32_bf16 a[124:127], a[228:231], v[244:247], a[124:127]
    v_mfma_f32_16x16x32_bf16 a[148:151], a[228:231], v[248:251], a[148:151]
    v_mfma_f32_16x16x32_bf16 a[172:175], a[228:231], v[252:255], a[172:175]
    buffer_load_dwordx4 v[172:175], v2, s[24:27], s57 offen offset:0
    s_waitcnt vmcnt(26)
    v_mfma_f32_16x16x32_bf16 a[8:11], a[232:235], v[224:227], a[8:11]
    v_mfma_f32_16x16x32_bf16 a[32:35], a[232:235], v[228:231], a[32:35]
    v_mfma_f32_16x16x32_bf16 a[56:59], a[232:235], v[232:235], a[56:59]
    v_mfma_f32_16x16x32_bf16 a[80:83], a[232:235], v[236:239], a[80:83]
    buffer_load_dwordx4 v[176:179], v2, s[24:27], s58 offen offset:0
    v_mfma_f32_16x16x32_bf16 a[104:107], a[232:235], v[240:243], a[104:107]
    v_mfma_f32_16x16x32_bf16 a[128:131], a[232:235], v[244:247], a[128:131]
    v_mfma_f32_16x16x32_bf16 a[152:155], a[232:235], v[248:251], a[152:155]
    v_mfma_f32_16x16x32_bf16 a[176:179], a[232:235], v[252:255], a[176:179]
    buffer_load_dwordx4 v[180:183], v2, s[24:27], s59 offen offset:0
    s_waitcnt vmcnt(27)
    v_mfma_f32_16x16x32_bf16 a[12:15], a[236:239], v[224:227], a[12:15]
    v_mfma_f32_16x16x32_bf16 a[36:39], a[236:239], v[228:231], a[36:39]
    v_mfma_f32_16x16x32_bf16 a[60:63], a[236:239], v[232:235], a[60:63]
    v_mfma_f32_16x16x32_bf16 a[84:87], a[236:239], v[236:239], a[84:87]
    buffer_load_dwordx4 v[184:187], v2, s[24:27], s60 offen offset:0
    v_mfma_f32_16x16x32_bf16 a[108:111], a[236:239], v[240:243], a[108:111]
    v_mfma_f32_16x16x32_bf16 a[132:135], a[236:239], v[244:247], a[132:135]
    v_mfma_f32_16x16x32_bf16 a[156:159], a[236:239], v[248:251], a[156:159]
    v_mfma_f32_16x16x32_bf16 a[180:183], a[236:239], v[252:255], a[180:183]
    v_add_u32 v3, 4096, v3
    buffer_load_dwordx4 v[188:191], v3, s[28:31], s44 offen offset:0
    s_waitcnt vmcnt(28)
    v_mfma_f32_16x16x32_bf16 a[16:19], a[240:243], v[224:227], a[16:19]
    v_mfma_f32_16x16x32_bf16 a[40:43], a[240:243], v[228:231], a[40:43]
    v_mfma_f32_16x16x32_bf16 a[64:67], a[240:243], v[232:235], a[64:67]
    v_mfma_f32_16x16x32_bf16 a[88:91], a[240:243], v[236:239], a[88:91]
    buffer_load_dwordx4 v[192:195], v3, s[28:31], s45 offen offset:0
    v_mfma_f32_16x16x32_bf16 a[112:115], a[240:243], v[240:243], a[112:115]
    v_mfma_f32_16x16x32_bf16 a[136:139], a[240:243], v[244:247], a[136:139]
    v_mfma_f32_16x16x32_bf16 a[160:163], a[240:243], v[248:251], a[160:163]
    v_mfma_f32_16x16x32_bf16 a[184:187], a[240:243], v[252:255], a[184:187]
    buffer_load_dwordx4 v[196:199], v3, s[28:31], s46 offen offset:0
    s_waitcnt vmcnt(29)
    v_mfma_f32_16x16x32_bf16 a[20:23], a[244:247], v[224:227], a[20:23]
    v_mfma_f32_16x16x32_bf16 a[44:47], a[244:247], v[228:231], a[44:47]
    v_mfma_f32_16x16x32_bf16 a[68:71], a[244:247], v[232:235], a[68:71]
    v_mfma_f32_16x16x32_bf16 a[92:95], a[244:247], v[236:239], a[92:95]
    buffer_load_dwordx4 v[200:203], v3, s[28:31], s47 offen offset:0
    v_mfma_f32_16x16x32_bf16 a[116:119], a[244:247], v[240:243], a[116:119]
    v_mfma_f32_16x16x32_bf16 a[140:143], a[244:247], v[244:247], a[140:143]
    v_mfma_f32_16x16x32_bf16 a[164:167], a[244:247], v[248:251], a[164:167]
    v_mfma_f32_16x16x32_bf16 a[188:191], a[244:247], v[252:255], a[188:191]
    buffer_load_dwordx4 v[204:207], v3, s[28:31], s48 offen offset:0
    s_waitcnt vmcnt(30)
    v_mfma_f32_16x16x32_bf16 v[80:83], a[248:251], v[224:227], v[80:83]
    v_mfma_f32_16x16x32_bf16 v[84:87], a[248:251], v[228:231], v[84:87]
    v_mfma_f32_16x16x32_bf16 a[192:195], a[248:251], v[232:235], a[192:195]
    v_mfma_f32_16x16x32_bf16 a[196:199], a[248:251], v[236:239], a[196:199]
    buffer_load_dwordx4 v[208:211], v3, s[28:31], s49 offen offset:0
    v_mfma_f32_16x16x32_bf16 a[200:203], a[248:251], v[240:243], a[200:203]
    v_mfma_f32_16x16x32_bf16 a[204:207], a[248:251], v[244:247], a[204:207]
    v_mfma_f32_16x16x32_bf16 a[208:211], a[248:251], v[248:251], a[208:211]
    v_mfma_f32_16x16x32_bf16 a[212:215], a[248:251], v[252:255], a[212:215]
    buffer_load_dwordx4 v[212:215], v3, s[28:31], s50 offen offset:0
    s_waitcnt vmcnt(23)
    v_mfma_f32_16x16x32_bf16 v[16:19], v[120:123], v[88:91], v[16:19]
    v_mfma_f32_16x16x32_bf16 v[24:27], v[120:123], v[92:95], v[24:27]
    v_mfma_f32_16x16x32_bf16 v[32:35], v[120:123], v[96:99], v[32:35]
    v_mfma_f32_16x16x32_bf16 v[40:43], v[120:123], v[100:103], v[40:43]
    buffer_load_dwordx4 v[216:219], v3, s[28:31], s51 offen offset:0
    v_mfma_f32_16x16x32_bf16 v[48:51], v[120:123], v[104:107], v[48:51]
    v_mfma_f32_16x16x32_bf16 v[56:59], v[120:123], v[108:111], v[56:59]
    v_mfma_f32_16x16x32_bf16 v[64:67], v[120:123], v[112:115], v[64:67]
    v_mfma_f32_16x16x32_bf16 v[72:75], v[120:123], v[116:119], v[72:75]
    buffer_load_dwordx4 v[220:223], v3, s[28:31], s52 offen offset:0
    s_waitcnt vmcnt(24)
    v_mfma_f32_16x16x32_bf16 v[20:23], v[124:127], v[88:91], v[20:23]
    v_mfma_f32_16x16x32_bf16 v[28:31], v[124:127], v[92:95], v[28:31]
    v_mfma_f32_16x16x32_bf16 v[36:39], v[124:127], v[96:99], v[36:39]
    v_mfma_f32_16x16x32_bf16 v[44:47], v[124:127], v[100:103], v[44:47]
    buffer_load_dwordx4 v[224:227], v2, s[24:27], s53 offen offset:1024
    v_mfma_f32_16x16x32_bf16 v[52:55], v[124:127], v[104:107], v[52:55]
    v_mfma_f32_16x16x32_bf16 v[60:63], v[124:127], v[108:111], v[60:63]
    v_mfma_f32_16x16x32_bf16 v[68:71], v[124:127], v[112:115], v[68:71]
    v_mfma_f32_16x16x32_bf16 v[76:79], v[124:127], v[116:119], v[76:79]
    buffer_load_dwordx4 v[228:231], v2, s[24:27], s54 offen offset:1024
    s_waitcnt vmcnt(25)
    v_mfma_f32_16x16x32_bf16 a[0:3], v[128:131], v[88:91], a[0:3]
    v_mfma_f32_16x16x32_bf16 a[24:27], v[128:131], v[92:95], a[24:27]
    v_mfma_f32_16x16x32_bf16 a[48:51], v[128:131], v[96:99], a[48:51]
    v_mfma_f32_16x16x32_bf16 a[72:75], v[128:131], v[100:103], a[72:75]
    buffer_load_dwordx4 v[232:235], v2, s[24:27], s55 offen offset:1024
    v_mfma_f32_16x16x32_bf16 a[96:99], v[128:131], v[104:107], a[96:99]
    v_mfma_f32_16x16x32_bf16 a[120:123], v[128:131], v[108:111], a[120:123]
    v_mfma_f32_16x16x32_bf16 a[144:147], v[128:131], v[112:115], a[144:147]
    v_mfma_f32_16x16x32_bf16 a[168:171], v[128:131], v[116:119], a[168:171]
    buffer_load_dwordx4 v[236:239], v2, s[24:27], s56 offen offset:1024
    s_waitcnt vmcnt(26)
    v_mfma_f32_16x16x32_bf16 a[4:7], v[132:135], v[88:91], a[4:7]
    v_mfma_f32_16x16x32_bf16 a[28:31], v[132:135], v[92:95], a[28:31]
    v_mfma_f32_16x16x32_bf16 a[52:55], v[132:135], v[96:99], a[52:55]
    v_mfma_f32_16x16x32_bf16 a[76:79], v[132:135], v[100:103], a[76:79]
    buffer_load_dwordx4 v[240:243], v2, s[24:27], s57 offen offset:1024
    v_mfma_f32_16x16x32_bf16 a[100:103], v[132:135], v[104:107], a[100:103]
    v_mfma_f32_16x16x32_bf16 a[124:127], v[132:135], v[108:111], a[124:127]
    v_mfma_f32_16x16x32_bf16 a[148:151], v[132:135], v[112:115], a[148:151]
    v_mfma_f32_16x16x32_bf16 a[172:175], v[132:135], v[116:119], a[172:175]
    buffer_load_dwordx4 v[244:247], v2, s[24:27], s58 offen offset:1024
    s_waitcnt vmcnt(27)
    v_mfma_f32_16x16x32_bf16 a[8:11], v[136:139], v[88:91], a[8:11]
    v_mfma_f32_16x16x32_bf16 a[32:35], v[136:139], v[92:95], a[32:35]
    v_mfma_f32_16x16x32_bf16 a[56:59], v[136:139], v[96:99], a[56:59]
    v_mfma_f32_16x16x32_bf16 a[80:83], v[136:139], v[100:103], a[80:83]
    buffer_load_dwordx4 v[248:251], v2, s[24:27], s59 offen offset:1024
    v_mfma_f32_16x16x32_bf16 a[104:107], v[136:139], v[104:107], a[104:107]
    v_mfma_f32_16x16x32_bf16 a[128:131], v[136:139], v[108:111], a[128:131]
    v_mfma_f32_16x16x32_bf16 a[152:155], v[136:139], v[112:115], a[152:155]
    v_mfma_f32_16x16x32_bf16 a[176:179], v[136:139], v[116:119], a[176:179]
    buffer_load_dwordx4 v[252:255], v2, s[24:27], s60 offen offset:1024
    s_waitcnt vmcnt(28)
    v_mfma_f32_16x16x32_bf16 a[12:15], v[140:143], v[88:91], a[12:15]
    v_mfma_f32_16x16x32_bf16 a[36:39], v[140:143], v[92:95], a[36:39]
    v_mfma_f32_16x16x32_bf16 a[60:63], v[140:143], v[96:99], a[60:63]
    v_mfma_f32_16x16x32_bf16 a[84:87], v[140:143], v[100:103], a[84:87]
    buffer_load_dwordx4 a[216:219], v3, s[28:31], s44 offen offset:1024
    v_mfma_f32_16x16x32_bf16 a[108:111], v[140:143], v[104:107], a[108:111]
    v_mfma_f32_16x16x32_bf16 a[132:135], v[140:143], v[108:111], a[132:135]
    v_mfma_f32_16x16x32_bf16 a[156:159], v[140:143], v[112:115], a[156:159]
    v_mfma_f32_16x16x32_bf16 a[180:183], v[140:143], v[116:119], a[180:183]
    buffer_load_dwordx4 a[220:223], v3, s[28:31], s45 offen offset:1024
    s_waitcnt vmcnt(29)
    v_mfma_f32_16x16x32_bf16 a[16:19], v[144:147], v[88:91], a[16:19]
    v_mfma_f32_16x16x32_bf16 a[40:43], v[144:147], v[92:95], a[40:43]
    v_mfma_f32_16x16x32_bf16 a[64:67], v[144:147], v[96:99], a[64:67]
    v_mfma_f32_16x16x32_bf16 a[88:91], v[144:147], v[100:103], a[88:91]
    buffer_load_dwordx4 a[224:227], v3, s[28:31], s46 offen offset:1024
    v_mfma_f32_16x16x32_bf16 a[112:115], v[144:147], v[104:107], a[112:115]
    v_mfma_f32_16x16x32_bf16 a[136:139], v[144:147], v[108:111], a[136:139]
    v_mfma_f32_16x16x32_bf16 a[160:163], v[144:147], v[112:115], a[160:163]
    v_mfma_f32_16x16x32_bf16 a[184:187], v[144:147], v[116:119], a[184:187]
    buffer_load_dwordx4 a[228:231], v3, s[28:31], s47 offen offset:1024
    s_waitcnt vmcnt(30)
    v_mfma_f32_16x16x32_bf16 a[20:23], v[148:151], v[88:91], a[20:23]
    v_mfma_f32_16x16x32_bf16 a[44:47], v[148:151], v[92:95], a[44:47]
    v_mfma_f32_16x16x32_bf16 a[68:71], v[148:151], v[96:99], a[68:71]
    v_mfma_f32_16x16x32_bf16 a[92:95], v[148:151], v[100:103], a[92:95]
    buffer_load_dwordx4 a[232:235], v3, s[28:31], s48 offen offset:1024
    v_mfma_f32_16x16x32_bf16 a[116:119], v[148:151], v[104:107], a[116:119]
    v_mfma_f32_16x16x32_bf16 a[140:143], v[148:151], v[108:111], a[140:143]
    v_mfma_f32_16x16x32_bf16 a[164:167], v[148:151], v[112:115], a[164:167]
    v_mfma_f32_16x16x32_bf16 a[188:191], v[148:151], v[116:119], a[188:191]
    buffer_load_dwordx4 a[236:239], v3, s[28:31], s49 offen offset:1024
    s_waitcnt vmcnt(31)
    v_mfma_f32_16x16x32_bf16 v[80:83], v[152:155], v[88:91], v[80:83]
    v_mfma_f32_16x16x32_bf16 v[84:87], v[152:155], v[92:95], v[84:87]
    v_mfma_f32_16x16x32_bf16 a[192:195], v[152:155], v[96:99], a[192:195]
    v_mfma_f32_16x16x32_bf16 a[196:199], v[152:155], v[100:103], a[196:199]
    buffer_load_dwordx4 a[240:243], v3, s[28:31], s50 offen offset:1024
    v_mfma_f32_16x16x32_bf16 a[200:203], v[152:155], v[104:107], a[200:203]
    v_mfma_f32_16x16x32_bf16 a[204:207], v[152:155], v[108:111], a[204:207]
    v_mfma_f32_16x16x32_bf16 a[208:211], v[152:155], v[112:115], a[208:211]
    v_mfma_f32_16x16x32_bf16 a[212:215], v[152:155], v[116:119], a[212:215]
    buffer_load_dwordx4 a[244:247], v3, s[28:31], s51 offen offset:1024
    s_waitcnt vmcnt(24)
    v_mfma_f32_16x16x32_bf16 v[16:19], v[188:191], v[156:159], v[16:19]
    v_mfma_f32_16x16x32_bf16 v[24:27], v[188:191], v[160:163], v[24:27]
    v_mfma_f32_16x16x32_bf16 v[32:35], v[188:191], v[164:167], v[32:35]
    v_mfma_f32_16x16x32_bf16 v[40:43], v[188:191], v[168:171], v[40:43]
    buffer_load_dwordx4 a[248:251], v3, s[28:31], s52 offen offset:1024
    v_mfma_f32_16x16x32_bf16 v[48:51], v[188:191], v[172:175], v[48:51]
    v_mfma_f32_16x16x32_bf16 v[56:59], v[188:191], v[176:179], v[56:59]
    v_mfma_f32_16x16x32_bf16 v[64:67], v[188:191], v[180:183], v[64:67]
    v_mfma_f32_16x16x32_bf16 v[72:75], v[188:191], v[184:187], v[72:75]
    s_waitcnt vmcnt(24)
    v_mfma_f32_16x16x32_bf16 v[20:23], v[192:195], v[156:159], v[20:23]
    v_mfma_f32_16x16x32_bf16 v[28:31], v[192:195], v[160:163], v[28:31]
    v_mfma_f32_16x16x32_bf16 v[36:39], v[192:195], v[164:167], v[36:39]
    v_mfma_f32_16x16x32_bf16 v[44:47], v[192:195], v[168:171], v[44:47]
    v_mfma_f32_16x16x32_bf16 v[52:55], v[192:195], v[172:175], v[52:55]
    v_mfma_f32_16x16x32_bf16 v[60:63], v[192:195], v[176:179], v[60:63]
    v_mfma_f32_16x16x32_bf16 v[68:71], v[192:195], v[180:183], v[68:71]
    v_mfma_f32_16x16x32_bf16 v[76:79], v[192:195], v[184:187], v[76:79]
    s_waitcnt vmcnt(23)
    v_mfma_f32_16x16x32_bf16 a[0:3], v[196:199], v[156:159], a[0:3]
    v_mfma_f32_16x16x32_bf16 a[24:27], v[196:199], v[160:163], a[24:27]
    v_mfma_f32_16x16x32_bf16 a[48:51], v[196:199], v[164:167], a[48:51]
    v_mfma_f32_16x16x32_bf16 a[72:75], v[196:199], v[168:171], a[72:75]
    v_mfma_f32_16x16x32_bf16 a[96:99], v[196:199], v[172:175], a[96:99]
    v_mfma_f32_16x16x32_bf16 a[120:123], v[196:199], v[176:179], a[120:123]
    v_mfma_f32_16x16x32_bf16 a[144:147], v[196:199], v[180:183], a[144:147]
    v_mfma_f32_16x16x32_bf16 a[168:171], v[196:199], v[184:187], a[168:171]
    s_waitcnt vmcnt(22)
    v_mfma_f32_16x16x32_bf16 a[4:7], v[200:203], v[156:159], a[4:7]
    v_mfma_f32_16x16x32_bf16 a[28:31], v[200:203], v[160:163], a[28:31]
    v_mfma_f32_16x16x32_bf16 a[52:55], v[200:203], v[164:167], a[52:55]
    v_mfma_f32_16x16x32_bf16 a[76:79], v[200:203], v[168:171], a[76:79]
    v_mfma_f32_16x16x32_bf16 a[100:103], v[200:203], v[172:175], a[100:103]
    v_mfma_f32_16x16x32_bf16 a[124:127], v[200:203], v[176:179], a[124:127]
    v_mfma_f32_16x16x32_bf16 a[148:151], v[200:203], v[180:183], a[148:151]
    v_mfma_f32_16x16x32_bf16 a[172:175], v[200:203], v[184:187], a[172:175]
    s_waitcnt vmcnt(21)
    v_mfma_f32_16x16x32_bf16 a[8:11], v[204:207], v[156:159], a[8:11]
    v_mfma_f32_16x16x32_bf16 a[32:35], v[204:207], v[160:163], a[32:35]
    v_mfma_f32_16x16x32_bf16 a[56:59], v[204:207], v[164:167], a[56:59]
    v_mfma_f32_16x16x32_bf16 a[80:83], v[204:207], v[168:171], a[80:83]
    v_mfma_f32_16x16x32_bf16 a[104:107], v[204:207], v[172:175], a[104:107]
    v_mfma_f32_16x16x32_bf16 a[128:131], v[204:207], v[176:179], a[128:131]
    v_mfma_f32_16x16x32_bf16 a[152:155], v[204:207], v[180:183], a[152:155]
    v_mfma_f32_16x16x32_bf16 a[176:179], v[204:207], v[184:187], a[176:179]
    s_waitcnt vmcnt(20)
    v_mfma_f32_16x16x32_bf16 a[12:15], v[208:211], v[156:159], a[12:15]
    v_mfma_f32_16x16x32_bf16 a[36:39], v[208:211], v[160:163], a[36:39]
    v_mfma_f32_16x16x32_bf16 a[60:63], v[208:211], v[164:167], a[60:63]
    v_mfma_f32_16x16x32_bf16 a[84:87], v[208:211], v[168:171], a[84:87]
    v_mfma_f32_16x16x32_bf16 a[108:111], v[208:211], v[172:175], a[108:111]
    v_mfma_f32_16x16x32_bf16 a[132:135], v[208:211], v[176:179], a[132:135]
    v_mfma_f32_16x16x32_bf16 a[156:159], v[208:211], v[180:183], a[156:159]
    v_mfma_f32_16x16x32_bf16 a[180:183], v[208:211], v[184:187], a[180:183]
    s_waitcnt vmcnt(19)
    v_mfma_f32_16x16x32_bf16 a[16:19], v[212:215], v[156:159], a[16:19]
    v_mfma_f32_16x16x32_bf16 a[40:43], v[212:215], v[160:163], a[40:43]
    v_mfma_f32_16x16x32_bf16 a[64:67], v[212:215], v[164:167], a[64:67]
    v_mfma_f32_16x16x32_bf16 a[88:91], v[212:215], v[168:171], a[88:91]
    v_mfma_f32_16x16x32_bf16 a[112:115], v[212:215], v[172:175], a[112:115]
    v_mfma_f32_16x16x32_bf16 a[136:139], v[212:215], v[176:179], a[136:139]
    v_mfma_f32_16x16x32_bf16 a[160:163], v[212:215], v[180:183], a[160:163]
    v_mfma_f32_16x16x32_bf16 a[184:187], v[212:215], v[184:187], a[184:187]
    s_waitcnt vmcnt(18)
    v_mfma_f32_16x16x32_bf16 a[20:23], v[216:219], v[156:159], a[20:23]
    v_mfma_f32_16x16x32_bf16 a[44:47], v[216:219], v[160:163], a[44:47]
    v_mfma_f32_16x16x32_bf16 a[68:71], v[216:219], v[164:167], a[68:71]
    v_mfma_f32_16x16x32_bf16 a[92:95], v[216:219], v[168:171], a[92:95]
    v_mfma_f32_16x16x32_bf16 a[116:119], v[216:219], v[172:175], a[116:119]
    v_mfma_f32_16x16x32_bf16 a[140:143], v[216:219], v[176:179], a[140:143]
    v_mfma_f32_16x16x32_bf16 a[164:167], v[216:219], v[180:183], a[164:167]
    v_mfma_f32_16x16x32_bf16 a[188:191], v[216:219], v[184:187], a[188:191]
    s_waitcnt vmcnt(17)
    v_mfma_f32_16x16x32_bf16 v[80:83], v[220:223], v[156:159], v[80:83]
    v_mfma_f32_16x16x32_bf16 v[84:87], v[220:223], v[160:163], v[84:87]
    v_mfma_f32_16x16x32_bf16 a[192:195], v[220:223], v[164:167], a[192:195]
    v_mfma_f32_16x16x32_bf16 a[196:199], v[220:223], v[168:171], a[196:199]
    v_mfma_f32_16x16x32_bf16 a[200:203], v[220:223], v[172:175], a[200:203]
    v_mfma_f32_16x16x32_bf16 a[204:207], v[220:223], v[176:179], a[204:207]
    v_mfma_f32_16x16x32_bf16 a[208:211], v[220:223], v[180:183], a[208:211]
    v_mfma_f32_16x16x32_bf16 a[212:215], v[220:223], v[184:187], a[212:215]
    s_waitcnt vmcnt(8)
    v_mfma_f32_16x16x32_bf16 v[16:19], a[216:219], v[224:227], v[16:19]
    s_waitcnt vmcnt(7)
    v_mfma_f32_16x16x32_bf16 v[20:23], a[220:223], v[224:227], v[20:23]
    s_waitcnt vmcnt(6)
    v_mfma_f32_16x16x32_bf16 a[0:3], a[224:227], v[224:227], a[0:3]
    s_waitcnt vmcnt(5)
    v_mfma_f32_16x16x32_bf16 a[4:7], a[228:231], v[224:227], a[4:7]
    s_waitcnt vmcnt(4)
    v_mfma_f32_16x16x32_bf16 a[8:11], a[232:235], v[224:227], a[8:11]
    s_waitcnt vmcnt(3)
    v_mfma_f32_16x16x32_bf16 a[12:15], a[236:239], v[224:227], a[12:15]
    s_waitcnt vmcnt(2)
    v_mfma_f32_16x16x32_bf16 a[16:19], a[240:243], v[224:227], a[16:19]
    s_waitcnt vmcnt(1)
    v_mfma_f32_16x16x32_bf16 a[20:23], a[244:247], v[224:227], a[20:23]
    s_waitcnt vmcnt(0)
    v_mfma_f32_16x16x32_bf16 v[80:83], a[248:251], v[224:227], v[80:83]
    v_mfma_f32_16x16x32_bf16 v[24:27], a[216:219], v[228:231], v[24:27]
    v_mfma_f32_16x16x32_bf16 v[28:31], a[220:223], v[228:231], v[28:31]
    v_mfma_f32_16x16x32_bf16 a[24:27], a[224:227], v[228:231], a[24:27]
    v_mfma_f32_16x16x32_bf16 a[28:31], a[228:231], v[228:231], a[28:31]
    v_mfma_f32_16x16x32_bf16 a[32:35], a[232:235], v[228:231], a[32:35]
    v_mfma_f32_16x16x32_bf16 a[36:39], a[236:239], v[228:231], a[36:39]
    v_mfma_f32_16x16x32_bf16 a[40:43], a[240:243], v[228:231], a[40:43]
    v_mfma_f32_16x16x32_bf16 a[44:47], a[244:247], v[228:231], a[44:47]
    v_mfma_f32_16x16x32_bf16 v[84:87], a[248:251], v[228:231], v[84:87]
    v_mfma_f32_16x16x32_bf16 v[32:35], a[216:219], v[232:235], v[32:35]
    v_mfma_f32_16x16x32_bf16 v[36:39], a[220:223], v[232:235], v[36:39]
    v_mfma_f32_16x16x32_bf16 a[48:51], a[224:227], v[232:235], a[48:51]
    v_mfma_f32_16x16x32_bf16 a[52:55], a[228:231], v[232:235], a[52:55]
    v_mfma_f32_16x16x32_bf16 a[56:59], a[232:235], v[232:235], a[56:59]
    v_mfma_f32_16x16x32_bf16 a[60:63], a[236:239], v[232:235], a[60:63]
    v_mfma_f32_16x16x32_bf16 a[64:67], a[240:243], v[232:235], a[64:67]
    v_mfma_f32_16x16x32_bf16 a[68:71], a[244:247], v[232:235], a[68:71]
    v_mfma_f32_16x16x32_bf16 a[192:195], a[248:251], v[232:235], a[192:195]
    v_mfma_f32_16x16x32_bf16 v[40:43], a[216:219], v[236:239], v[40:43]
    v_mfma_f32_16x16x32_bf16 v[44:47], a[220:223], v[236:239], v[44:47]
    ds_write_b128 v6, a[0:3] offset:0
    v_mfma_f32_16x16x32_bf16 a[72:75], a[224:227], v[236:239], a[72:75]
    v_mfma_f32_16x16x32_bf16 a[76:79], a[228:231], v[236:239], a[76:79]
    ds_write_b128 v6, a[4:7] offset:1024
    v_mfma_f32_16x16x32_bf16 a[80:83], a[232:235], v[236:239], a[80:83]
    v_mfma_f32_16x16x32_bf16 a[84:87], a[236:239], v[236:239], a[84:87]
    ds_write_b128 v6, a[8:11] offset:2048
    v_mfma_f32_16x16x32_bf16 a[88:91], a[240:243], v[236:239], a[88:91]
    v_mfma_f32_16x16x32_bf16 a[92:95], a[244:247], v[236:239], a[92:95]
    ds_write_b128 v6, a[12:15] offset:3072
    v_mfma_f32_16x16x32_bf16 a[196:199], a[248:251], v[236:239], a[196:199]
    v_mfma_f32_16x16x32_bf16 v[48:51], a[216:219], v[240:243], v[48:51]
    ds_write_b128 v6, a[16:19] offset:4096
    v_mfma_f32_16x16x32_bf16 v[52:55], a[220:223], v[240:243], v[52:55]
    v_mfma_f32_16x16x32_bf16 a[96:99], a[224:227], v[240:243], a[96:99]
    ds_write_b128 v6, a[20:23] offset:5120
    v_mfma_f32_16x16x32_bf16 a[100:103], a[228:231], v[240:243], a[100:103]
    v_mfma_f32_16x16x32_bf16 a[104:107], a[232:235], v[240:243], a[104:107]
    ds_write_b128 v6, a[24:27] offset:6144
    v_mfma_f32_16x16x32_bf16 a[108:111], a[236:239], v[240:243], a[108:111]
    v_mfma_f32_16x16x32_bf16 a[112:115], a[240:243], v[240:243], a[112:115]
    ds_write_b128 v6, a[28:31] offset:7168
    v_mfma_f32_16x16x32_bf16 a[116:119], a[244:247], v[240:243], a[116:119]
    v_mfma_f32_16x16x32_bf16 a[200:203], a[248:251], v[240:243], a[200:203]
    ds_write_b128 v6, a[32:35] offset:8192
    v_mfma_f32_16x16x32_bf16 v[56:59], a[216:219], v[244:247], v[56:59]
    v_mfma_f32_16x16x32_bf16 v[60:63], a[220:223], v[244:247], v[60:63]
    ds_write_b128 v6, a[36:39] offset:9216
    v_mfma_f32_16x16x32_bf16 a[120:123], a[224:227], v[244:247], a[120:123]
    v_mfma_f32_16x16x32_bf16 a[124:127], a[228:231], v[244:247], a[124:127]
    ds_write_b128 v6, a[40:43] offset:10240
    v_mfma_f32_16x16x32_bf16 a[128:131], a[232:235], v[244:247], a[128:131]
    v_mfma_f32_16x16x32_bf16 a[132:135], a[236:239], v[244:247], a[132:135]
    ds_write_b128 v6, a[44:47] offset:11264
    v_mfma_f32_16x16x32_bf16 a[136:139], a[240:243], v[244:247], a[136:139]
    v_mfma_f32_16x16x32_bf16 a[140:143], a[244:247], v[244:247], a[140:143]
    ds_write_b128 v6, a[48:51] offset:12288
    v_mfma_f32_16x16x32_bf16 a[204:207], a[248:251], v[244:247], a[204:207]
    v_mfma_f32_16x16x32_bf16 v[64:67], a[216:219], v[248:251], v[64:67]
    ds_write_b128 v6, a[52:55] offset:13312
    v_mfma_f32_16x16x32_bf16 v[68:71], a[220:223], v[248:251], v[68:71]
    v_mfma_f32_16x16x32_bf16 a[144:147], a[224:227], v[248:251], a[144:147]
    ds_write_b128 v6, a[56:59] offset:14336
    v_mfma_f32_16x16x32_bf16 a[148:151], a[228:231], v[248:251], a[148:151]
    v_mfma_f32_16x16x32_bf16 a[152:155], a[232:235], v[248:251], a[152:155]
    ds_write_b128 v6, a[60:63] offset:15360
    v_mfma_f32_16x16x32_bf16 a[156:159], a[236:239], v[248:251], a[156:159]
    v_mfma_f32_16x16x32_bf16 a[160:163], a[240:243], v[248:251], a[160:163]
    ds_write_b128 v6, a[64:67] offset:16384
    v_mfma_f32_16x16x32_bf16 a[164:167], a[244:247], v[248:251], a[164:167]
    v_mfma_f32_16x16x32_bf16 a[208:211], a[248:251], v[248:251], a[208:211]
    ds_write_b128 v6, a[68:71] offset:17408
    v_mfma_f32_16x16x32_bf16 v[72:75], a[216:219], v[252:255], v[72:75]
    v_mfma_f32_16x16x32_bf16 v[76:79], a[220:223], v[252:255], v[76:79]
    ds_write_b128 v6, a[192:195] offset:18432
    v_mfma_f32_16x16x32_bf16 a[168:171], a[224:227], v[252:255], a[168:171]
    v_mfma_f32_16x16x32_bf16 a[172:175], a[228:231], v[252:255], a[172:175]
    ds_write_b128 v6, a[72:75] offset:19456
    v_mfma_f32_16x16x32_bf16 a[176:179], a[232:235], v[252:255], a[176:179]
    v_mfma_f32_16x16x32_bf16 a[180:183], a[236:239], v[252:255], a[180:183]
    ds_write_b128 v6, a[76:79] offset:20480
    v_mfma_f32_16x16x32_bf16 a[184:187], a[240:243], v[252:255], a[184:187]
    v_mfma_f32_16x16x32_bf16 a[188:191], a[244:247], v[252:255], a[188:191]
    ds_write_b128 v6, a[80:83] offset:21504
    v_mfma_f32_16x16x32_bf16 a[212:215], a[248:251], v[252:255], a[212:215]
    ds_write_b128 v6, a[84:87] offset:22528
    ds_write_b128 v6, a[88:91] offset:23552
    ds_write_b128 v6, a[92:95] offset:24576
    ds_write_b128 v6, a[196:199] offset:25600
    ds_write_b128 v6, a[96:99] offset:26624
    ds_write_b128 v6, a[100:103] offset:27648
    ds_write_b128 v6, a[104:107] offset:28672
    ds_write_b128 v6, a[108:111] offset:29696
    ds_write_b128 v6, a[112:115] offset:30720
    ds_write_b128 v6, a[116:119] offset:31744
    ds_write_b128 v6, a[200:203] offset:32768
    ds_write_b128 v6, a[120:123] offset:33792
    ds_write_b128 v6, a[124:127] offset:34816
    ds_write_b128 v6, a[128:131] offset:35840
    ds_write_b128 v6, a[132:135] offset:36864
    ds_write_b128 v6, a[136:139] offset:37888
    ds_write_b128 v6, a[140:143] offset:38912
    ds_write_b128 v6, a[204:207] offset:39936
    v_lshlrev_b32 v2, 4, v1
    v_and_b32 v3, 15, v1
    v_lshrrev_b32 v4, 4, v1
    v_lshrrev_b32 v5, 1, v4
    v_and_b32 v10, 1, v4
    v_lshl_add_u32 v5, v10, 1, v5
    v_mul_u32_u24 v10, 1152, v3
    v_lshl_add_u32 v11, v5, 4, v10
    v_lshl_add_u32 v12, v4, 3, v10
    v_mov_b32 v13, 0
    s_and_b32 s12, s8, 7
    s_lshl_b32 s13, s4, 3
    s_add_u32 s13, s13, s12
    s_mul_i32 s13, s13, 18432
    s_mul_i32 s14, s5, 288
    s_add_u32 s13, s13, s14
    s_lshl_b32 s14, s9, 5
    s_add_u32 s78, s13, s14
    s_add_u32 s79, s13, 256
    s_mov_b32 s40, s16
    s_mov_b32 s41, s17
    s_mov_b32 s42, 2359296
    s_mov_b32 s43, 0x20000
    s_mov_b32 s44, s32
    s_mov_b32 s45, s33
    s_mov_b32 s46, 2359296
    s_mov_b32 s47, 0x20000
    s_add_u32 s12, s78, 0
    buffer_load_dwordx4 v[88:91], v11, s[40:43], s12 offen
    s_add_u32 s12, s78, 18432
    buffer_load_dwordx4 v[92:95], v11, s[40:43], s12 offen
    s_add_u32 s12, s79, 0
    buffer_load_dwordx2 v[96:97], v12, s[40:43], s12 offen
    s_add_u32 s12, s79, 18432
    buffer_load_dwordx2 v[98:99], v12, s[40:43], s12 offen
    s_waitcnt lgkmcnt(0)
    s_barrier
    ds_read_b128 v[108:111], v7 offset:4096
    ds_read_b128 v[112:115], v7 offset:5120
    ds_read_b128 v[116:119], v7 offset:10240
    ds_read_b128 v[120:123], v7 offset:11264
    ds_read_b128 v[124:127], v8 offset:2048
    ds_read_b128 v[128:131], v8 offset:3072
    ds_read_b128 v[132:135], v8 offset:8192
    ds_read_b128 v[136:139], v8 offset:9216
    ds_read_b128 v[140:143], v9 offset:0
    ds_read_b128 v[144:147], v9 offset:1024
    ds_read_b128 v[148:151], v9 offset:6144
    ds_read_b128 v[152:155], v9 offset:7168
    ds_read_b128 v[156:159], v7 offset:16384
    ds_read_b128 v[160:163], v7 offset:17408
    ds_read_b128 v[164:167], v7 offset:23552
    ds_read_b128 v[168:171], v7 offset:24576
    ds_read_b128 v[172:175], v8 offset:14336
    ds_read_b128 v[176:179], v8 offset:15360
    ds_read_b128 v[180:183], v8 offset:21504
    ds_read_b128 v[184:187], v8 offset:22528
    ds_read_b128 v[188:191], v9 offset:12288
    ds_read_b128 v[192:195], v9 offset:13312
    ds_read_b128 v[196:199], v9 offset:19456
    ds_read_b128 v[200:203], v9 offset:20480
    ds_read_b128 v[204:207], v9 offset:18432
    ds_read_b128 v[208:211], v9 offset:25600
    s_waitcnt lgkmcnt(15)
    v_add_f32 v32, v32, v108
    v_add_f32 v33, v33, v109
    v_add_f32 v34, v34, v110
    v_add_f32 v35, v35, v111
    v_add_f32 v36, v36, v112
    v_add_f32 v37, v37, v113
    v_add_f32 v38, v38, v114
    v_add_f32 v39, v39, v115
    v_add_f32 v40, v40, v116
    v_add_f32 v41, v41, v117
    v_add_f32 v42, v42, v118
    v_add_f32 v43, v43, v119
    v_add_f32 v44, v44, v120
    v_add_f32 v45, v45, v121
    v_add_f32 v46, v46, v122
    v_add_f32 v47, v47, v123
    v_add_f32 v48, v48, v124
    v_add_f32 v49, v49, v125
    v_add_f32 v50, v50, v126
    v_add_f32 v51, v51, v127
    v_add_f32 v52, v52, v128
    v_add_f32 v53, v53, v129
    v_add_f32 v54, v54, v130
    v_add_f32 v55, v55, v131
    v_add_f32 v56, v56, v132
    v_add_f32 v57, v57, v133
    v_add_f32 v58, v58, v134
    v_add_f32 v59, v59, v135
    v_add_f32 v60, v60, v136
    v_add_f32 v61, v61, v137
    v_add_f32 v62, v62, v138
    v_add_f32 v63, v63, v139
    v_add_f32 v64, v64, v140
    v_add_f32 v65, v65, v141
    v_add_f32 v66, v66, v142
    v_add_f32 v67, v67, v143
    v_add_f32 v68, v68, v144
    v_add_f32 v69, v69, v145
    v_add_f32 v70, v70, v146
    v_add_f32 v71, v71, v147
    v_add_f32 v72, v72, v148
    v_add_f32 v73, v73, v149
    v_add_f32 v74, v74, v150
    v_add_f32 v75, v75, v151
    s_waitcnt lgkmcnt(14)
    v_add_f32 v76, v76, v152
    v_add_f32 v77, v77, v153
    v_add_f32 v78, v78, v154
    v_add_f32 v79, v79, v155
    s_waitcnt lgkmcnt(13)
    v_add_f32 v48, v48, v156
    v_add_f32 v49, v49, v157
    v_add_f32 v50, v50, v158
    v_add_f32 v51, v51, v159
    s_waitcnt lgkmcnt(12)
    v_add_f32 v52, v52, v160
    v_add_f32 v53, v53, v161
    v_add_f32 v54, v54, v162
    v_add_f32 v55, v55, v163
    s_waitcnt lgkmcnt(11)
    v_add_f32 v56, v56, v164
    v_add_f32 v57, v57, v165
    v_add_f32 v58, v58, v166
    v_add_f32 v59, v59, v167
    s_waitcnt lgkmcnt(10)
    v_add_f32 v60, v60, v168
    v_add_f32 v61, v61, v169
    v_add_f32 v62, v62, v170
    v_add_f32 v63, v63, v171
    s_waitcnt lgkmcnt(9)
    v_add_f32 v64, v64, v172
    v_add_f32 v65, v65, v173
    v_add_f32 v66, v66, v174
    v_add_f32 v67, v67, v175
    s_waitcnt lgkmcnt(8)
    v_add_f32 v68, v68, v176
    v_add_f32 v69, v69, v177
    v_add_f32 v70, v70, v178
    v_add_f32 v71, v71, v179
    s_waitcnt lgkmcnt(7)
    v_add_f32 v72, v72, v180
    v_add_f32 v73, v73, v181
    v_add_f32 v74, v74, v182
    v_add_f32 v75, v75, v183
    s_waitcnt lgkmcnt(6)
    v_add_f32 v76, v76, v184
    v_add_f32 v77, v77, v185
    v_add_f32 v78, v78, v186
    v_add_f32 v79, v79, v187
    s_waitcnt lgkmcnt(5)
    v_add_f32 v16, v16, v188
    v_add_f32 v17, v17, v189
    v_add_f32 v18, v18, v190
    v_add_f32 v19, v19, v191
    s_waitcnt lgkmcnt(4)
    v_add_f32 v20, v20, v192
    v_add_f32 v21, v21, v193
    v_add_f32 v22, v22, v194
    v_add_f32 v23, v23, v195
    s_waitcnt lgkmcnt(3)
    v_add_f32 v24, v24, v196
    v_add_f32 v25, v25, v197
    v_add_f32 v26, v26, v198
    v_add_f32 v27, v27, v199
    s_waitcnt lgkmcnt(2)
    v_add_f32 v28, v28, v200
    v_add_f32 v29, v29, v201
    v_add_f32 v30, v30, v202
    v_add_f32 v31, v31, v203
    s_waitcnt lgkmcnt(1)
    v_add_f32 v80, v80, v204
    v_add_f32 v81, v81, v205
    v_add_f32 v82, v82, v206
    v_add_f32 v83, v83, v207
    s_waitcnt lgkmcnt(0)
    v_add_f32 v84, v84, v208
    v_add_f32 v85, v85, v209
    v_add_f32 v86, v86, v210
    v_add_f32 v87, v87, v211
    s_barrier
    ds_read_b128 v[108:111], v7 offset:30720
    ds_read_b128 v[112:115], v7 offset:31744
    ds_read_b128 v[116:119], v7 offset:37888
    ds_read_b128 v[120:123], v7 offset:38912
    ds_read_b128 v[124:127], v8 offset:28672
    ds_read_b128 v[128:131], v8 offset:29696
    ds_read_b128 v[132:135], v8 offset:35840
    ds_read_b128 v[136:139], v8 offset:36864
    ds_read_b128 v[140:143], v8 offset:32768
    ds_read_b128 v[144:147], v8 offset:39936
    ds_read_b128 v[148:151], v9 offset:26624
    ds_read_b128 v[152:155], v9 offset:27648
    ds_read_b128 v[156:159], v9 offset:33792
    ds_read_b128 v[160:163], v9 offset:34816
    ds_write_b128 v6, a[144:147] offset:0
    s_waitcnt lgkmcnt(14)
    v_add_f32 v64, v64, v108
    v_add_f32 v65, v65, v109
    v_add_f32 v66, v66, v110
    v_add_f32 v67, v67, v111
    ds_write_b128 v6, a[148:151] offset:1024
    s_waitcnt lgkmcnt(14)
    v_add_f32 v68, v68, v112
    v_add_f32 v69, v69, v113
    v_add_f32 v70, v70, v114
    v_add_f32 v71, v71, v115
    ds_write_b128 v6, a[152:155] offset:2048
    s_waitcnt lgkmcnt(14)
    v_add_f32 v72, v72, v116
    v_add_f32 v73, v73, v117
    v_add_f32 v74, v74, v118
    v_add_f32 v75, v75, v119
    ds_write_b128 v6, a[156:159] offset:3072
    s_waitcnt lgkmcnt(14)
    v_add_f32 v76, v76, v120
    v_add_f32 v77, v77, v121
    v_add_f32 v78, v78, v122
    v_add_f32 v79, v79, v123
    ds_write_b128 v6, a[160:163] offset:4096
    s_waitcnt lgkmcnt(14)
    v_add_f32 v16, v16, v124
    v_add_f32 v17, v17, v125
    v_add_f32 v18, v18, v126
    v_add_f32 v19, v19, v127
    ds_write_b128 v6, a[164:167] offset:5120
    s_waitcnt lgkmcnt(14)
    v_add_f32 v20, v20, v128
    v_add_f32 v21, v21, v129
    v_add_f32 v22, v22, v130
    v_add_f32 v23, v23, v131
    ds_write_b128 v6, a[208:211] offset:6144
    s_waitcnt lgkmcnt(14)
    v_add_f32 v24, v24, v132
    v_add_f32 v25, v25, v133
    v_add_f32 v26, v26, v134
    v_add_f32 v27, v27, v135
    ds_write_b128 v6, a[168:171] offset:7168
    s_waitcnt lgkmcnt(14)
    v_add_f32 v28, v28, v136
    v_add_f32 v29, v29, v137
    v_add_f32 v30, v30, v138
    v_add_f32 v31, v31, v139
    ds_write_b128 v6, a[172:175] offset:8192
    s_waitcnt lgkmcnt(14)
    v_add_f32 v80, v80, v140
    v_add_f32 v81, v81, v141
    v_add_f32 v82, v82, v142
    v_add_f32 v83, v83, v143
    ds_write_b128 v6, a[176:179] offset:9216
    s_waitcnt lgkmcnt(14)
    v_add_f32 v84, v84, v144
    v_add_f32 v85, v85, v145
    v_add_f32 v86, v86, v146
    v_add_f32 v87, v87, v147
    ds_write_b128 v6, a[180:183] offset:10240
    s_waitcnt lgkmcnt(14)
    v_add_f32 v32, v32, v148
    v_add_f32 v33, v33, v149
    v_add_f32 v34, v34, v150
    v_add_f32 v35, v35, v151
    ds_write_b128 v6, a[184:187] offset:11264
    s_waitcnt lgkmcnt(14)
    v_add_f32 v36, v36, v152
    v_add_f32 v37, v37, v153
    v_add_f32 v38, v38, v154
    v_add_f32 v39, v39, v155
    ds_write_b128 v6, a[188:191] offset:12288
    s_waitcnt lgkmcnt(14)
    v_add_f32 v40, v40, v156
    v_add_f32 v41, v41, v157
    v_add_f32 v42, v42, v158
    v_add_f32 v43, v43, v159
    ds_write_b128 v6, a[212:215] offset:13312
    s_waitcnt lgkmcnt(14)
    v_add_f32 v44, v44, v160
    v_add_f32 v45, v45, v161
    v_add_f32 v46, v46, v162
    v_add_f32 v47, v47, v163
    s_waitcnt lgkmcnt(0)
    s_barrier
    ds_read_b128 v[108:111], v7 offset:4096
    ds_read_b128 v[112:115], v7 offset:5120
    ds_read_b128 v[116:119], v7 offset:11264
    ds_read_b128 v[120:123], v7 offset:12288
    ds_read_b128 v[124:127], v7 offset:6144
    ds_read_b128 v[128:131], v7 offset:13312
    ds_read_b128 v[132:135], v8 offset:2048
    ds_read_b128 v[136:139], v8 offset:3072
    ds_read_b128 v[140:143], v8 offset:9216
    ds_read_b128 v[144:147], v8 offset:10240
    ds_read_b128 v[148:151], v9 offset:0
    ds_read_b128 v[152:155], v9 offset:1024
    ds_read_b128 v[156:159], v9 offset:7168
    ds_read_b128 v[160:163], v9 offset:8192
    s_waitcnt lgkmcnt(13)
    v_add_f32 v16, v16, v108
    v_add_f32 v17, v17, v109
    v_add_f32 v18, v18, v110
    v_add_f32 v19, v19, v111
    s_waitcnt lgkmcnt(12)
    v_add_f32 v20, v20, v112
    v_add_f32 v21, v21, v113
    v_add_f32 v22, v22, v114
    v_add_f32 v23, v23, v115
    s_waitcnt lgkmcnt(11)
    v_add_f32 v24, v24, v116
    v_add_f32 v25, v25, v117
    v_add_f32 v26, v26, v118
    v_add_f32 v27, v27, v119
    s_waitcnt lgkmcnt(10)
    v_add_f32 v28, v28, v120
    v_add_f32 v29, v29, v121
    v_add_f32 v30, v30, v122
    v_add_f32 v31, v31, v123
    s_waitcnt lgkmcnt(9)
    v_add_f32 v80, v80, v124
    v_add_f32 v81, v81, v125
    v_add_f32 v82, v82, v126
    v_add_f32 v83, v83, v127
    s_waitcnt lgkmcnt(8)
    v_add_f32 v84, v84, v128
    v_add_f32 v85, v85, v129
    v_add_f32 v86, v86, v130
    v_add_f32 v87, v87, v131
    s_waitcnt lgkmcnt(7)
    v_add_f32 v32, v32, v132
    v_add_f32 v33, v33, v133
    v_add_f32 v34, v34, v134
    v_add_f32 v35, v35, v135
    s_waitcnt lgkmcnt(6)
    v_add_f32 v36, v36, v136
    v_add_f32 v37, v37, v137
    v_add_f32 v38, v38, v138
    v_add_f32 v39, v39, v139
    s_waitcnt lgkmcnt(5)
    v_add_f32 v40, v40, v140
    v_add_f32 v41, v41, v141
    v_add_f32 v42, v42, v142
    v_add_f32 v43, v43, v143
    s_waitcnt lgkmcnt(4)
    v_add_f32 v44, v44, v144
    v_add_f32 v45, v45, v145
    v_add_f32 v46, v46, v146
    v_add_f32 v47, v47, v147
    s_waitcnt lgkmcnt(3)
    v_add_f32 v48, v48, v148
    v_add_f32 v49, v49, v149
    v_add_f32 v50, v50, v150
    v_add_f32 v51, v51, v151
    s_waitcnt lgkmcnt(2)
    v_add_f32 v52, v52, v152
    v_add_f32 v53, v53, v153
    v_add_f32 v54, v54, v154
    v_add_f32 v55, v55, v155
    s_waitcnt lgkmcnt(1)
    v_add_f32 v56, v56, v156
    v_add_f32 v57, v57, v157
    v_add_f32 v58, v58, v158
    v_add_f32 v59, v59, v159
    s_waitcnt lgkmcnt(0)
    v_add_f32 v60, v60, v160
    v_add_f32 v61, v61, v161
    v_add_f32 v62, v62, v162
    v_add_f32 v63, v63, v163
    s_add_u32 s48, s36, 25165824
    s_addc_u32 s49, s37, 0
    s_mov_b32 s50, 9437184
    s_mov_b32 s51, 0x20000
    s_lshl_b32 s12, s4, 2
    s_add_u32 s12, s12, s5
    s_lshl_b32 s13, s12, 17
    s_lshl_b32 s14, s3, 13
    s_add_u32 s13, s13, s14
    s_lshl_b32 s14, s12, 14
    s_add_u32 s14, s14, 8388608
    s_lshl_b32 s15, s6, 15
    s_add_u32 s15, s15, s13
    v_cvt_pk_bf16_f32 v116, v32, v33
    v_cvt_pk_bf16_f32 v117, v34, v35
    v_cvt_pk_bf16_f32 v118, v36, v37
    v_cvt_pk_bf16_f32 v119, v38, v39
    v_min_u32 v116, -2, v116
    v_min_u32 v117, -2, v117
    v_min_u32 v118, -2, v118
    v_min_u32 v119, -2, v119
    s_add_u32 s12, s8, 2
    s_and_b32 s12, s12, 7
    s_lshl_b32 s12, s12, 10
    s_add_u32 s12, s12, s15
    buffer_store_dwordx4 v[116:119], v2, s[48:51], s12 offen sc1
    v_cvt_pk_bf16_f32 v120, v40, v41
    v_cvt_pk_bf16_f32 v121, v42, v43
    v_cvt_pk_bf16_f32 v122, v44, v45
    v_cvt_pk_bf16_f32 v123, v46, v47
    v_min_u32 v120, -2, v120
    v_min_u32 v121, -2, v121
    v_min_u32 v122, -2, v122
    v_min_u32 v123, -2, v123
    s_add_u32 s12, s8, 3
    s_and_b32 s12, s12, 7
    s_lshl_b32 s12, s12, 10
    s_add_u32 s12, s12, s15
    buffer_store_dwordx4 v[120:123], v2, s[48:51], s12 offen sc1
    v_cvt_pk_bf16_f32 v124, v48, v49
    v_cvt_pk_bf16_f32 v125, v50, v51
    v_cvt_pk_bf16_f32 v126, v52, v53
    v_cvt_pk_bf16_f32 v127, v54, v55
    v_min_u32 v124, -2, v124
    v_min_u32 v125, -2, v125
    v_min_u32 v126, -2, v126
    v_min_u32 v127, -2, v127
    s_add_u32 s12, s8, 4
    s_and_b32 s12, s12, 7
    s_lshl_b32 s12, s12, 10
    s_add_u32 s12, s12, s15
    buffer_store_dwordx4 v[124:127], v2, s[48:51], s12 offen sc1
    v_cvt_pk_bf16_f32 v128, v56, v57
    v_cvt_pk_bf16_f32 v129, v58, v59
    v_cvt_pk_bf16_f32 v130, v60, v61
    v_cvt_pk_bf16_f32 v131, v62, v63
    v_min_u32 v128, -2, v128
    v_min_u32 v129, -2, v129
    v_min_u32 v130, -2, v130
    v_min_u32 v131, -2, v131
    s_add_u32 s12, s8, 5
    s_and_b32 s12, s12, 7
    s_lshl_b32 s12, s12, 10
    s_add_u32 s12, s12, s15
    buffer_store_dwordx4 v[128:131], v2, s[48:51], s12 offen sc1
    v_cvt_pk_bf16_f32 v132, v64, v65
    v_cvt_pk_bf16_f32 v133, v66, v67
    v_cvt_pk_bf16_f32 v134, v68, v69
    v_cvt_pk_bf16_f32 v135, v70, v71
    v_min_u32 v132, -2, v132
    v_min_u32 v133, -2, v133
    v_min_u32 v134, -2, v134
    v_min_u32 v135, -2, v135
    s_add_u32 s12, s8, 6
    s_and_b32 s12, s12, 7
    s_lshl_b32 s12, s12, 10
    s_add_u32 s12, s12, s15
    buffer_store_dwordx4 v[132:135], v2, s[48:51], s12 offen sc1
    v_cvt_pk_bf16_f32 v136, v72, v73
    v_cvt_pk_bf16_f32 v137, v74, v75
    v_cvt_pk_bf16_f32 v138, v76, v77
    v_cvt_pk_bf16_f32 v139, v78, v79
    v_min_u32 v136, -2, v136
    v_min_u32 v137, -2, v137
    v_min_u32 v138, -2, v138
    v_min_u32 v139, -2, v139
    s_add_u32 s12, s8, 7
    s_and_b32 s12, s12, 7
    s_lshl_b32 s12, s12, 10
    s_add_u32 s12, s12, s15
    buffer_store_dwordx4 v[136:139], v2, s[48:51], s12 offen sc1
    v_cvt_pk_bf16_f32 v140, v80, v81
    v_cvt_pk_bf16_f32 v141, v82, v83
    v_cvt_pk_bf16_f32 v142, v84, v85
    v_cvt_pk_bf16_f32 v143, v86, v87
    v_min_u32 v140, -2, v140
    v_min_u32 v141, -2, v141
    v_min_u32 v142, -2, v142
    v_min_u32 v143, -2, v143
    s_cmp_eq_u32 s3, 0
    s_cbranch_scc1 K2_nospF
    s_lshr_b32 s12, s8, 1
    s_and_b32 s12, s12, 3
    s_lshl_b32 s15, s6, 2
    s_add_u32 s12, s12, s15
    s_lshl_b32 s12, s12, 10
    s_add_u32 s12, s12, s14
    buffer_store_dwordx4 v[140:143], v2, s[48:51], s12 offen sc1
K2_nospF:
    v_cvt_pk_bf16_f32 v108, v16, v17
    v_cvt_pk_bf16_f32 v109, v18, v19
    v_cvt_pk_bf16_f32 v110, v20, v21
    v_cvt_pk_bf16_f32 v111, v22, v23
    v_min_u32 v108, -2, v108
    v_min_u32 v109, -2, v109
    v_min_u32 v110, -2, v110
    v_min_u32 v111, -2, v111
    v_cvt_pk_bf16_f32 v112, v24, v25
    v_cvt_pk_bf16_f32 v113, v26, v27
    v_cvt_pk_bf16_f32 v114, v28, v29
    v_cvt_pk_bf16_f32 v115, v30, v31
    v_min_u32 v112, -2, v112
    v_min_u32 v113, -2, v113
    v_min_u32 v114, -2, v114
    v_min_u32 v115, -2, v115
    s_and_b32 s12, s8, 7
    s_lshl_b32 s12, s12, 10
    s_add_u32 s13, s13, s12
    s_xor_b32 s12, s6, 1
    s_lshl_b32 s15, s12, 15
    s_add_u32 s61, s13, s15
    s_lshl_b32 s15, s12, 12
    s_add_u32 s15, s15, s14
    s_lshl_b32 s12, s6, 10
    s_add_u32 s65, s15, s12
    s_xor_b32 s12, s6, 2
    s_lshl_b32 s15, s12, 15
    s_add_u32 s62, s13, s15
    s_lshl_b32 s15, s12, 12
    s_add_u32 s15, s15, s14
    s_lshl_b32 s12, s6, 10
    s_add_u32 s66, s15, s12
    s_xor_b32 s12, s6, 3
    s_lshl_b32 s15, s12, 15
    s_add_u32 s63, s13, s15
    s_lshl_b32 s15, s12, 12
    s_add_u32 s15, s15, s14
    s_lshl_b32 s12, s6, 10
    s_add_u32 s67, s15, s12
    s_cmp_eq_u32 s3, 0
    s_cselect_b32 s65, s65, s61
    s_cselect_b32 s66, s66, s62
    s_cselect_b32 s67, s67, s63
    s_mov_b32 s74, 0
K2_lpF:
    s_sleep 4
    buffer_load_dword v149, v13, s[48:51], s61 offen offset:2044 sc1
    buffer_load_dword v152, v13, s[48:51], s65 offen offset:1020 sc1
    buffer_load_dword v150, v13, s[48:51], s62 offen offset:2044 sc1
    buffer_load_dword v153, v13, s[48:51], s66 offen offset:1020 sc1
    buffer_load_dword v151, v13, s[48:51], s63 offen offset:2044 sc1
    buffer_load_dword v154, v13, s[48:51], s67 offen offset:1020 sc1
    s_waitcnt vmcnt(0)
    v_max3_u32 v14, v149, v150, v151
    v_max3_u32 v14, v14, v152, v153
    v_max_u32 v14, v14, v154
    v_cmp_eq_u32 vcc, -1, v14
    s_add_u32 s74, s74, 1
    s_cmp_gt_u32 s74, 200000
    s_cbranch_scc1 K2_goF
    s_cbranch_vccnz K2_lpF
    buffer_load_dwordx4 v[148:151], v2, s[48:51], s61 offen offset:0 sc1
    buffer_load_dwordx4 v[152:155], v2, s[48:51], s61 offen offset:1024 sc1
    buffer_load_dwordx4 v[156:159], v2, s[48:51], s65 offen sc1
    buffer_load_dwordx4 v[160:163], v2, s[48:51], s62 offen offset:0 sc1
    buffer_load_dwordx4 v[164:167], v2, s[48:51], s62 offen offset:1024 sc1
    buffer_load_dwordx4 v[168:171], v2, s[48:51], s66 offen sc1
    buffer_load_dwordx4 v[172:175], v2, s[48:51], s63 offen offset:0 sc1
    buffer_load_dwordx4 v[176:179], v2, s[48:51], s63 offen offset:1024 sc1
    buffer_load_dwordx4 v[180:183], v2, s[48:51], s67 offen sc1
    s_waitcnt vmcnt(0)
    v_max_u32 v14, v148, v149
    v_max3_u32 v14, v14, v150, v151
    v_max3_u32 v14, v14, v152, v153
    v_max3_u32 v14, v14, v154, v155
    v_max3_u32 v14, v14, v156, v157
    v_max3_u32 v14, v14, v158, v159
    v_max3_u32 v14, v14, v160, v161
    v_max3_u32 v14, v14, v162, v163
    v_max3_u32 v14, v14, v164, v165
    v_max3_u32 v14, v14, v166, v167
    v_max3_u32 v14, v14, v168, v169
    v_max3_u32 v14, v14, v170, v171
    v_max3_u32 v14, v14, v172, v173
    v_max3_u32 v14, v14, v174, v175
    v_max3_u32 v14, v14, v176, v177
    v_max3_u32 v14, v14, v178, v179
    v_max3_u32 v14, v14, v180, v181
    v_max3_u32 v14, v14, v182, v183
    v_cmp_eq_u32 vcc, -1, v14
    s_cbranch_vccnz K2_lpF
K2_goF:
    v_lshlrev_b32 v16, 16, v108
    v_and_b32 v17, s95, v108
    v_lshlrev_b32 v18, 16, v109
    v_and_b32 v19, s95, v109
    v_lshlrev_b32 v64, 16, v148
    v_and_b32 v65, s95, v148
    v_lshlrev_b32 v66, 16, v149
    v_and_b32 v67, s95, v149
    v_add_f32 v16, v16, v64
    v_add_f32 v17, v17, v65
    v_add_f32 v18, v18, v66
    v_add_f32 v19, v19, v67
    v_cvt_pk_bf16_f32 v14, v16, v17
    v_cvt_pk_bf16_f32 v15, v18, v19
    v_lshlrev_b32 v16, 16, v14
    v_and_b32 v17, s95, v14
    v_lshlrev_b32 v18, 16, v15
    v_and_b32 v19, s95, v15
    v_lshlrev_b32 v40, 16, v160
    v_and_b32 v41, s95, v160
    v_lshlrev_b32 v42, 16, v161
    v_and_b32 v43, s95, v161
    v_lshlrev_b32 v64, 16, v172
    v_and_b32 v65, s95, v172
    v_lshlrev_b32 v66, 16, v173
    v_and_b32 v67, s95, v173
    v_add_f32 v40, v40, v64
    v_add_f32 v41, v41, v65
    v_add_f32 v42, v42, v66
    v_add_f32 v43, v43, v67
    v_cvt_pk_bf16_f32 v14, v40, v41
    v_cvt_pk_bf16_f32 v15, v42, v43
    v_lshlrev_b32 v40, 16, v14
    v_and_b32 v41, s95, v14
    v_lshlrev_b32 v42, 16, v15
    v_and_b32 v43, s95, v15
    v_lshlrev_b32 v20, 16, v110
    v_and_b32 v21, s95, v110
    v_lshlrev_b32 v22, 16, v111
    v_and_b32 v23, s95, v111
    v_lshlrev_b32 v64, 16, v150
    v_and_b32 v65, s95, v150
    v_lshlrev_b32 v66, 16, v151
    v_and_b32 v67, s95, v151
    v_add_f32 v20, v20, v64
    v_add_f32 v21, v21, v65
    v_add_f32 v22, v22, v66
    v_add_f32 v23, v23, v67
    v_cvt_pk_bf16_f32 v14, v20, v21
    v_cvt_pk_bf16_f32 v15, v22, v23
    v_lshlrev_b32 v20, 16, v14
    v_and_b32 v21, s95, v14
    v_lshlrev_b32 v22, 16, v15
    v_and_b32 v23, s95, v15
    v_lshlrev_b32 v44, 16, v162
    v_and_b32 v45, s95, v162
    v_lshlrev_b32 v46, 16, v163
    v_and_b32 v47, s95, v163
    v_lshlrev_b32 v64, 16, v174
    v_and_b32 v65, s95, v174
    v_lshlrev_b32 v66, 16, v175
    v_and_b32 v67, s95, v175
    v_add_f32 v44, v44, v64
    v_add_f32 v45, v45, v65
    v_add_f32 v46, v46, v66
    v_add_f32 v47, v47, v67
    v_cvt_pk_bf16_f32 v14, v44, v45
    v_cvt_pk_bf16_f32 v15, v46, v47
    v_lshlrev_b32 v44, 16, v14
    v_and_b32 v45, s95, v14
    v_lshlrev_b32 v46, 16, v15
    v_and_b32 v47, s95, v15
    s_nop 1
    v_permlane16_swap_b32 v16, v20
    v_permlane16_swap_b32 v17, v21
    v_permlane16_swap_b32 v18, v22
    v_permlane16_swap_b32 v19, v23
    v_permlane16_swap_b32 v40, v44
    v_permlane16_swap_b32 v41, v45
    v_permlane16_swap_b32 v42, v46
    v_permlane16_swap_b32 v43, v47
    v_lshlrev_b32 v64, 16, v88
    v_and_b32 v65, s95, v88
    v_lshlrev_b32 v66, 16, v89
    v_and_b32 v67, s95, v89
    v_add_f32 v40, v40, v64
    v_add_f32 v41, v41, v65
    v_add_f32 v42, v42, v66
    v_add_f32 v43, v43, v67
    v_cvt_pk_bf16_f32 v14, v40, v41
    v_cvt_pk_bf16_f32 v15, v42, v43
    v_lshlrev_b32 v40, 16, v14
    v_and_b32 v41, s95, v14
    v_lshlrev_b32 v42, 16, v15
    v_and_b32 v43, s95, v15
    v_add_f32 v40, v40, v16
    v_add_f32 v41, v41, v17
    v_add_f32 v42, v42, v18
    v_add_f32 v43, v43, v19
    v_cvt_pk_bf16_f32 v72, v40, v41
    v_cvt_pk_bf16_f32 v73, v42, v43
    v_lshlrev_b32 v64, 16, v90
    v_and_b32 v65, s95, v90
    v_lshlrev_b32 v66, 16, v91
    v_and_b32 v67, s95, v91
    v_add_f32 v44, v44, v64
    v_add_f32 v45, v45, v65
    v_add_f32 v46, v46, v66
    v_add_f32 v47, v47, v67
    v_cvt_pk_bf16_f32 v14, v44, v45
    v_cvt_pk_bf16_f32 v15, v46, v47
    v_lshlrev_b32 v44, 16, v14
    v_and_b32 v45, s95, v14
    v_lshlrev_b32 v46, 16, v15
    v_and_b32 v47, s95, v15
    v_add_f32 v44, v44, v20
    v_add_f32 v45, v45, v21
    v_add_f32 v46, v46, v22
    v_add_f32 v47, v47, v23
    v_cvt_pk_bf16_f32 v74, v44, v45
    v_cvt_pk_bf16_f32 v75, v46, v47
    s_add_u32 s12, s78, 0
    buffer_store_dwordx4 v[72:75], v11, s[44:47], s12 offen
    v_lshlrev_b32 v24, 16, v112
    v_and_b32 v25, s95, v112
    v_lshlrev_b32 v26, 16, v113
    v_and_b32 v27, s95, v113
    v_lshlrev_b32 v64, 16, v152
    v_and_b32 v65, s95, v152
    v_lshlrev_b32 v66, 16, v153
    v_and_b32 v67, s95, v153
    v_add_f32 v24, v24, v64
    v_add_f32 v25, v25, v65
    v_add_f32 v26, v26, v66
    v_add_f32 v27, v27, v67
    v_cvt_pk_bf16_f32 v14, v24, v25
    v_cvt_pk_bf16_f32 v15, v26, v27
    v_lshlrev_b32 v24, 16, v14
    v_and_b32 v25, s95, v14
    v_lshlrev_b32 v26, 16, v15
    v_and_b32 v27, s95, v15
    v_lshlrev_b32 v48, 16, v164
    v_and_b32 v49, s95, v164
    v_lshlrev_b32 v50, 16, v165
    v_and_b32 v51, s95, v165
    v_lshlrev_b32 v64, 16, v176
    v_and_b32 v65, s95, v176
    v_lshlrev_b32 v66, 16, v177
    v_and_b32 v67, s95, v177
    v_add_f32 v48, v48, v64
    v_add_f32 v49, v49, v65
    v_add_f32 v50, v50, v66
    v_add_f32 v51, v51, v67
    v_cvt_pk_bf16_f32 v14, v48, v49
    v_cvt_pk_bf16_f32 v15, v50, v51
    v_lshlrev_b32 v48, 16, v14
    v_and_b32 v49, s95, v14
    v_lshlrev_b32 v50, 16, v15
    v_and_b32 v51, s95, v15
    v_lshlrev_b32 v28, 16, v114
    v_and_b32 v29, s95, v114
    v_lshlrev_b32 v30, 16, v115
    v_and_b32 v31, s95, v115
    v_lshlrev_b32 v64, 16, v154
    v_and_b32 v65, s95, v154
    v_lshlrev_b32 v66, 16, v155
    v_and_b32 v67, s95, v155
    v_add_f32 v28, v28, v64
    v_add_f32 v29, v29, v65
    v_add_f32 v30, v30, v66
    v_add_f32 v31, v31, v67
    v_cvt_pk_bf16_f32 v14, v28, v29
    v_cvt_pk_bf16_f32 v15, v30, v31
    v_lshlrev_b32 v28, 16, v14
    v_and_b32 v29, s95, v14
    v_lshlrev_b32 v30, 16, v15
    v_and_b32 v31, s95, v15
    v_lshlrev_b32 v52, 16, v166
    v_and_b32 v53, s95, v166
    v_lshlrev_b32 v54, 16, v167
    v_and_b32 v55, s95, v167
    v_lshlrev_b32 v64, 16, v178
    v_and_b32 v65, s95, v178
    v_lshlrev_b32 v66, 16, v179
    v_and_b32 v67, s95, v179
    v_add_f32 v52, v52, v64
    v_add_f32 v53, v53, v65
    v_add_f32 v54, v54, v66
    v_add_f32 v55, v55, v67
    v_cvt_pk_bf16_f32 v14, v52, v53
    v_cvt_pk_bf16_f32 v15, v54, v55
    v_lshlrev_b32 v52, 16, v14
    v_and_b32 v53, s95, v14
    v_lshlrev_b32 v54, 16, v15
    v_and_b32 v55, s95, v15
    s_nop 1
    v_permlane16_swap_b32 v24, v28
    v_permlane16_swap_b32 v25, v29
    v_permlane16_swap_b32 v26, v30
    v_permlane16_swap_b32 v27, v31
    v_permlane16_swap_b32 v48, v52
    v_permlane16_swap_b32 v49, v53
    v_permlane16_swap_b32 v50, v54
    v_permlane16_swap_b32 v51, v55
    v_lshlrev_b32 v64, 16, v92
    v_and_b32 v65, s95, v92
    v_lshlrev_b32 v66, 16, v93
    v_and_b32 v67, s95, v93
    v_add_f32 v48, v48, v64
    v_add_f32 v49, v49, v65
    v_add_f32 v50, v50, v66
    v_add_f32 v51, v51, v67
    v_cvt_pk_bf16_f32 v14, v48, v49
    v_cvt_pk_bf16_f32 v15, v50, v51
    v_lshlrev_b32 v48, 16, v14
    v_and_b32 v49, s95, v14
    v_lshlrev_b32 v50, 16, v15
    v_and_b32 v51, s95, v15
    v_add_f32 v48, v48, v24
    v_add_f32 v49, v49, v25
    v_add_f32 v50, v50, v26
    v_add_f32 v51, v51, v27
    v_cvt_pk_bf16_f32 v76, v48, v49
    v_cvt_pk_bf16_f32 v77, v50, v51
    v_lshlrev_b32 v64, 16, v94
    v_and_b32 v65, s95, v94
    v_lshlrev_b32 v66, 16, v95
    v_and_b32 v67, s95, v95
    v_add_f32 v52, v52, v64
    v_add_f32 v53, v53, v65
    v_add_f32 v54, v54, v66
    v_add_f32 v55, v55, v67
    v_cvt_pk_bf16_f32 v14, v52, v53
    v_cvt_pk_bf16_f32 v15, v54, v55
    v_lshlrev_b32 v52, 16, v14
    v_and_b32 v53, s95, v14
    v_lshlrev_b32 v54, 16, v15
    v_and_b32 v55, s95, v15
    v_add_f32 v52, v52, v28
    v_add_f32 v53, v53, v29
    v_add_f32 v54, v54, v30
    v_add_f32 v55, v55, v31
    v_cvt_pk_bf16_f32 v78, v52, v53
    v_cvt_pk_bf16_f32 v79, v54, v55
    s_add_u32 s12, s78, 18432
    buffer_store_dwordx4 v[76:79], v11, s[44:47], s12 offen
    s_cmp_eq_u32 s3, 0
    s_cbranch_scc0 K2_finF
    v_lshlrev_b32 v32, 16, v140
    v_and_b32 v33, s95, v140
    v_lshlrev_b32 v34, 16, v141
    v_and_b32 v35, s95, v141
    v_lshlrev_b32 v64, 16, v156
    v_and_b32 v65, s95, v156
    v_lshlrev_b32 v66, 16, v157
    v_and_b32 v67, s95, v157
    v_add_f32 v32, v32, v64
    v_add_f32 v33, v33, v65
    v_add_f32 v34, v34, v66
    v_add_f32 v35, v35, v67
    v_cvt_pk_bf16_f32 v14, v32, v33
    v_cvt_pk_bf16_f32 v15, v34, v35
    v_lshlrev_b32 v32, 16, v14
    v_and_b32 v33, s95, v14
    v_lshlrev_b32 v34, 16, v15
    v_and_b32 v35, s95, v15
    v_lshlrev_b32 v56, 16, v168
    v_and_b32 v57, s95, v168
    v_lshlrev_b32 v58, 16, v169
    v_and_b32 v59, s95, v169
    v_lshlrev_b32 v64, 16, v180
    v_and_b32 v65, s95, v180
    v_lshlrev_b32 v66, 16, v181
    v_and_b32 v67, s95, v181
    v_add_f32 v56, v56, v64
    v_add_f32 v57, v57, v65
    v_add_f32 v58, v58, v66
    v_add_f32 v59, v59, v67
    v_cvt_pk_bf16_f32 v14, v56, v57
    v_cvt_pk_bf16_f32 v15, v58, v59
    v_lshlrev_b32 v56, 16, v14
    v_and_b32 v57, s95, v14
    v_lshlrev_b32 v58, 16, v15
    v_and_b32 v59, s95, v15
    v_lshlrev_b32 v64, 16, v96
    v_and_b32 v65, s95, v96
    v_lshlrev_b32 v66, 16, v97
    v_and_b32 v67, s95, v97
    v_add_f32 v56, v56, v64
    v_add_f32 v57, v57, v65
    v_add_f32 v58, v58, v66
    v_add_f32 v59, v59, v67
    v_cvt_pk_bf16_f32 v14, v56, v57
    v_cvt_pk_bf16_f32 v15, v58, v59
    v_lshlrev_b32 v56, 16, v14
    v_and_b32 v57, s95, v14
    v_lshlrev_b32 v58, 16, v15
    v_and_b32 v59, s95, v15
    v_add_f32 v56, v56, v32
    v_add_f32 v57, v57, v33
    v_add_f32 v58, v58, v34
    v_add_f32 v59, v59, v35
    v_cvt_pk_bf16_f32 v80, v56, v57
    v_cvt_pk_bf16_f32 v81, v58, v59
    s_add_u32 s12, s79, 0
    buffer_store_dwordx2 v[80:81], v12, s[44:47], s12 offen
    v_lshlrev_b32 v36, 16, v142
    v_and_b32 v37, s95, v142
    v_lshlrev_b32 v38, 16, v143
    v_and_b32 v39, s95, v143
    v_lshlrev_b32 v64, 16, v158
    v_and_b32 v65, s95, v158
    v_lshlrev_b32 v66, 16, v159
    v_and_b32 v67, s95, v159
    v_add_f32 v36, v36, v64
    v_add_f32 v37, v37, v65
    v_add_f32 v38, v38, v66
    v_add_f32 v39, v39, v67
    v_cvt_pk_bf16_f32 v14, v36, v37
    v_cvt_pk_bf16_f32 v15, v38, v39
    v_lshlrev_b32 v36, 16, v14
    v_and_b32 v37, s95, v14
    v_lshlrev_b32 v38, 16, v15
    v_and_b32 v39, s95, v15
    v_lshlrev_b32 v60, 16, v170
    v_and_b32 v61, s95, v170
    v_lshlrev_b32 v62, 16, v171
    v_and_b32 v63, s95, v171
    v_lshlrev_b32 v64, 16, v182
    v_and_b32 v65, s95, v182
    v_lshlrev_b32 v66, 16, v183
    v_and_b32 v67, s95, v183
    v_add_f32 v60, v60, v64
    v_add_f32 v61, v61, v65
    v_add_f32 v62, v62, v66
    v_add_f32 v63, v63, v67
    v_cvt_pk_bf16_f32 v14, v60, v61
    v_cvt_pk_bf16_f32 v15, v62, v63
    v_lshlrev_b32 v60, 16, v14
    v_and_b32 v61, s95, v14
    v_lshlrev_b32 v62, 16, v15
    v_and_b32 v63, s95, v15
    v_lshlrev_b32 v64, 16, v98
    v_and_b32 v65, s95, v98
    v_lshlrev_b32 v66, 16, v99
    v_and_b32 v67, s95, v99
    v_add_f32 v60, v60, v64
    v_add_f32 v61, v61, v65
    v_add_f32 v62, v62, v66
    v_add_f32 v63, v63, v67
    v_cvt_pk_bf16_f32 v14, v60, v61
    v_cvt_pk_bf16_f32 v15, v62, v63
    v_lshlrev_b32 v60, 16, v14
    v_and_b32 v61, s95, v14
    v_lshlrev_b32 v62, 16, v15
    v_and_b32 v63, s95, v15
    v_add_f32 v60, v60, v36
    v_add_f32 v61, v61, v37
    v_add_f32 v62, v62, v38
    v_add_f32 v63, v63, v39
    v_cvt_pk_bf16_f32 v82, v60, v61
    v_cvt_pk_bf16_f32 v83, v62, v63
    s_add_u32 s12, s79, 18432
    buffer_store_dwordx2 v[82:83], v12, s[44:47], s12 offen
K2_finF:
    s_waitcnt vmcnt(0)
K2_end:
    s_endpgm
.section .rodata,"a"
.p2align 6
.amdhsa_kernel k1_kernel
  .amdhsa_next_free_vgpr 512
  .amdhsa_next_free_sgpr 102
  .amdhsa_accum_offset 256
  .amdhsa_group_segment_fixed_size 0
  .amdhsa_kernarg_size 88
  .amdhsa_user_sgpr_count 2
  .amdhsa_user_sgpr_kernarg_segment_ptr 1
  .amdhsa_system_sgpr_workgroup_id_x 1
.end_amdhsa_kernel

.p2align 6
.amdhsa_kernel k2_kernel
  .amdhsa_next_free_vgpr 512
  .amdhsa_next_free_sgpr 102
  .amdhsa_accum_offset 256
  .amdhsa_group_segment_fixed_size 0
  .amdhsa_kernarg_size 88
  .amdhsa_user_sgpr_count 2
  .amdhsa_user_sgpr_kernarg_segment_ptr 1
  .amdhsa_system_sgpr_workgroup_id_x 1
.end_amdhsa_kernel
```
